```python
import torch

def _softmax(x, axis=-1):
    return torch.softmax(x, dim=axis)
def _gelu(x):
    return torch.nn.functional.gelu(x, approximate="tanh")
def _silu(x):
    return torch.nn.functional.silu(x)
def _sigmoid(x):
    return torch.sigmoid(x)
def _layernorm(x, axis=-1, eps=1e-5):
    m = x.mean(dim=axis, keepdim=True)
    v = x.var(dim=axis, keepdim=True, unbiased=False)
    return (x - m) / torch.sqrt(v + eps)
def _scatter_add(tgt, idx, src, axis=0):
    return tgt.clone().index_add_(axis, idx, src)
def _segment_sum(src, seg, n):
    out = torch.zeros((n,) + src.shape[1:], dtype=src.dtype)
    return out.index_add_(0, seg, src)
def _pad(x, pw):
    flat = tuple(v for pair in reversed(pw) for v in pair)
    return torch.nn.functional.pad(x, flat)

kernel_name = 'parallel_sum__compressed_kv_cla__dense_activation_mish__prompt'

def setup_inputs():

    _w = (lambda a: (lambda t: t.to(torch.bfloat16) if t.is_floating_point() else t)(torch.as_tensor(a)))
    def _A_setup():
        B, H, Sq, Sk, D, M = 1, 32, 2048, 2048, 128, 512
        Dc = 4 * D
        return {
            "x": _w((lambda *s: torch.randn(*s, dtype=torch.bfloat16) * 0.05)(B, Sq, M)),
            "c_kv": _w((lambda *s: torch.randn(*s, dtype=torch.bfloat16) * 0.4)(B, Sk, Dc)),
            "w_q": _w((lambda *s: torch.randn(*s, dtype=torch.bfloat16) * 3.2)(M, H, D) * (M ** -0.5)),
            "w_uk": _w((lambda *s: torch.randn(*s, dtype=torch.bfloat16) * 3.2)(Dc, H, D) * (Dc ** -0.5)),
            "w_uv": _w((lambda *s: torch.randn(*s, dtype=torch.bfloat16) * 0.4)(Dc, H, D) * (Dc ** -0.5)),
            "w_o": _w((lambda *s: torch.randn(*s, dtype=torch.bfloat16) * 0.4)(H, D, M) * ((H * D) ** -0.5)),
        }
    _A_in = _A_setup()

    def _B_setup():
        B, S, D, F = 1, 2048, 512, 1792
        return {
            "x": _w((lambda *s: torch.randn(*s, dtype=torch.bfloat16) * 0.05)(B, S, D)),
            "w1": _w((lambda *s: torch.randn(*s, dtype=torch.bfloat16) * 0.8)(D, F) * (D ** -0.5)),
            "b1": _w((lambda *s: torch.randn(*s, dtype=torch.bfloat16) * 0.2)(F)),
            "w2": _w((lambda *s: torch.randn(*s, dtype=torch.bfloat16) * 0.1)(F, D) * (F ** -0.5)),
        }
    _B_in = _B_setup()

    return {
        "A_x": _A_in["x"],
        "A_c_kv": _A_in["c_kv"],
        "A_w_q": _A_in["w_q"],
        "A_w_uk": _A_in["w_uk"],
        "A_w_uv": _A_in["w_uv"],
        "A_w_o": _A_in["w_o"],
        "B_x": _B_in["x"],
        "B_w1": _B_in["w1"],
        "B_b1": _B_in["b1"],
        "B_w2": _B_in["w2"],
    }

def reference(A_x, A_c_kv, A_w_q, A_w_uk, A_w_uv, A_w_o, B_x, B_w1, B_b1, B_w2):
    def _A_ref(x, c_kv, w_q, w_uk, w_uv, w_o):
        B, Sq, M = x.shape[0], x.shape[1], x.shape[2]
        Sk = c_kv.shape[1]
        H, D = w_q.shape[1], w_q.shape[2]
        q = torch.einsum("bqm,mhd->bhqd", x, w_q)
        k = torch.einsum("bkc,chd->bhkd", c_kv, w_uk)
        v = torch.einsum("bkc,chd->bhkd", c_kv, w_uv)
        scores = torch.einsum("bhqd,bhkd->bhqk", q, k) * (D ** -0.5)
        off = Sk - Sq
        qi = torch.arange(Sq)[:, None]
        kj = torch.arange(Sk)[None, :]
        cmask = kj <= (qi + off)
        scores = torch.where(cmask[None, None], scores, -1e9)
        p = _softmax(scores, axis=-1)
        ctx = torch.einsum("bhqk,bhkd->bhqd", p, v)
        return torch.einsum("bhqd,hdm->bqm", ctx, w_o)

    def _B_ref(x, w1, b1, w2):
        h = torch.einsum("bsd,df->bsf", x, w1) + b1
        sp = torch.log1p(torch.exp(-torch.abs(h))) + torch.where(h > 0, h, torch.zeros_like(h))
        act = h * torch.tanh(sp)
        return torch.einsum("bsf,fd->bsd", act, w2)

    x = A_x
    xn = _layernorm(x, axis=-1)
    return x + _A_ref(xn, A_c_kv, A_w_q, A_w_uk, A_w_uv, A_w_o) + _B_ref(xn, B_w1, B_b1, B_w2)
```

```asm
; @launch grid=(256,1,1) block=(256,1,1) lds=163840
.amdgcn_target "amdgcn-amd-amdhsa--gfx950"
.text
.globl parallel_sum__compressed_kv_cla__dense_activation_mish__prompt_kernel
.p2align 12
.p2align 8
.type parallel_sum__compressed_kv_cla__dense_activation_mish__prompt_kernel,@function
parallel_sum__compressed_kv_cla__dense_activation_mish__prompt_kernel:
  s_cmp_ge_u32 s2, 256
  s_cbranch_scc1 L_end
  s_load_dwordx16 s[48:63], s[0:1], 0
  s_load_dwordx8 s[64:71], s[0:1], 64
  s_load_dwordx2 s[72:73], s[0:1], 96
  v_lshrrev_b32 v20, 6, v0
  v_and_b32 v0, 63, v0
  v_readfirstlane_b32 s3, v20
  v_lshlrev_b32 v1, 4, v0
  s_and_b32 s6, s2, 7
  s_lshr_b32 s7, s2, 6
  s_lshl_b32 s7, s7, 3
  s_add_u32 s4, s6, s7
  s_lshr_b32 s5, s2, 3
  s_and_b32 s5, s5, 7
  s_getpc_b64 s[96:97]
L_pc:
  s_lshr_b32 s6, s2, 3
  s_mul_i32 s6, s6, 3072
  v_min_u32 v20, 23, v0
  v_lshl_add_u32 v20, v20, 7, s6
  v_min_u32 v20, L_hot_end-L_pc, v20
  s_cmp_lg_u32 s3, 0
  s_cbranch_scc1 L_nocpf
  global_load_dword v30, v20, s[96:97]
L_nocpf:
  v_lshrrev_b32 v20, 3, v0
  v_and_b32 v21, 7, v0
  v_lshrrev_b32 v22, 4, v0
  v_xor_b32 v23, v21, v22
  v_lshlrev_b32 v23, 4, v23
  v_lshl_add_u32 v2, v20, 10, v23
  v_xor_b32 v24, 64, v2
  v_add_u32 v3, 7168, v24
  v_add_u32 v4, 14336, v2
  v_add_u32 v5, 21504, v24
  v_and_b32 v22, 1, v22
  v_lshlrev_b32 v22, 1, v22
  v_xor_b32 v23, v21, v22
  v_lshlrev_b32 v23, 4, v23
  v_xor_b32 v25, 64, v23
  v_lshl_add_u32 v6, v20, 13, v23
  v_lshl_add_u32 v7, v20, 13, v25
  v_mul_u32_u24 v24, 3584, v20
  v_add_u32 v10, v24, v23
  v_add_u32 v11, v24, v25
  v_add_u32 v8, 129024, v6
  v_add_u32 v9, 193536, v7
  v_add_u32 v7, 64512, v7
  v_add_u32 v12, 55296, v10
  v_add_u32 v13, 82944, v11
  v_add_u32 v11, 27648, v11
  v_lshrrev_b32 v20, 4, v0
  v_lshlrev_b32 v20, 3, v20
  v_bfe_u32 v21, v0, 2, 2
  v_add_u32 v20, v20, v21
  v_lshlrev_b32 v20, 7, v20
  v_and_b32 v21, 3, v0
  v_lshl_add_u32 v20, v21, 3, v20
  v_bfe_u32 v21, v0, 3, 2
  v_lshl_add_u32 v14, v21, 5, v20
  v_xor_b32 v15, 32, v14
  v_xor_b32 v16, 64, v14
  v_xor_b32 v17, 96, v14
  s_lshl_b32 s6, s3, 13
  s_add_u32 s74, s6, 98304
  v_and_b32 v20, 15, v0
  v_lshlrev_b32 v20, 7, v20
  v_add_u32 v20, s74, v20
  v_bfe_u32 v21, v0, 1, 3
  v_lshrrev_b32 v22, 4, v0
  v_xor_b32 v21, v21, v22
  v_lshl_add_u32 v18, v21, 4, v20
  v_xor_b32 v19, 64, v18
  s_lshl_b32 s75, s5, 2
  s_add_u32 s75, s75, s3
  s_lshl_b32 s75, s75, 16
  s_lshl_b32 s76, s4, 8
  s_lshl_b32 s77, s3, 12
  s_lshr_b32 s6, s3, 1
  s_lshl_b32 s6, s6, 7
  s_and_b32 s7, s3, 1
  s_lshl_b32 s7, s7, 18
  s_add_u32 s78, s76, s6
  s_add_u32 s78, s78, s7
  s_add_u32 s79, s5, s4
  s_and_b32 s79, s79, 7
  s_lshl_b32 s100, s79, 19
  s_lshl_b32 s101, s79, 7
  v_and_b32 v20, 7, v0
  v_lshrrev_b32 v21, 3, v0
  v_lshlrev_b32 v21, 4, v21
  v_lshl_add_u32 v20, v20, 10, v21
  s_lshl_b32 s6, s2, 13
  s_lshl_b32 s7, s3, 8
  s_add_u32 s6, s6, s7
  s_waitcnt lgkmcnt(0)
  s_mov_b32 s8, s50
  s_and_b32 s9, s51, 0xffff
  s_mov_b32 s10, 2097152
  s_mov_b32 s11, 0x20000
  s_add_u32 m0, s74, 0
  s_add_u32 s80, s101, 0
  s_and_b32 s80, s80, 0x3ff
  s_add_u32 s80, s80, s75
  buffer_load_dwordx4 v2, s[8:11], s80 offen offset:0 lds
  buffer_load_dwordx4 v3, s[8:11], s80 offen offset:1024 lds
  buffer_load_dwordx4 v4, s[8:11], s80 offen offset:2048 lds
  buffer_load_dwordx4 v5, s[8:11], s80 offen offset:3072 lds
  s_add_u32 m0, s74, 4096
  s_add_u32 s80, s80, 32768
  buffer_load_dwordx4 v2, s[8:11], s80 offen offset:0 lds
  buffer_load_dwordx4 v3, s[8:11], s80 offen offset:1024 lds
  buffer_load_dwordx4 v4, s[8:11], s80 offen offset:2048 lds
  buffer_load_dwordx4 v5, s[8:11], s80 offen offset:3072 lds
  s_mov_b32 s96, s6
  s_mov_b32 s32, s48
  s_and_b32 s33, s49, 0xffff
  s_mov_b32 s34, 2097152
  s_mov_b32 s35, 0x20000
  s_mov_b32 s12, s54
  s_and_b32 s13, s55, 0xffff
  s_mov_b32 s14, 4194304
  s_mov_b32 s15, 0x20000
  s_mov_b32 s28, s72
  s_and_b32 s29, s73, 0xffff
  s_mov_b32 s30, 268435456
  s_mov_b32 s31, 0x20000
  s_mov_b32 s16, s56
  s_and_b32 s17, s57, 0xffff
  s_mov_b32 s18, 4194304
  s_mov_b32 s19, 0x20000
  s_mov_b32 s24, s52
  s_and_b32 s25, s53, 0xffff
  s_mov_b32 s26, 4194304
  s_mov_b32 s27, 0x20000
  s_mov_b32 s20, s62
  s_and_b32 s21, s63, 0xffff
  s_mov_b32 s22, 1835008
  s_mov_b32 s23, 0x20000
  s_mov_b32 s36, s64
  s_and_b32 s37, s65, 0xffff
  s_mov_b32 s38, 3584
  s_mov_b32 s39, 0x20000
  s_mov_b32 s40, s70
  s_and_b32 s41, s71, 0xffff
  s_mov_b32 s42, 256
  s_mov_b32 s43, 0x20000
  s_mov_b32 s44, s72
  s_and_b32 s45, s73, 0xffff
  s_mov_b32 s46, 268435456
  s_mov_b32 s47, 0x20000
  s_cmp_lt_u32 s4, 28
  s_cselect_b32 s22, s22, 0
  s_cselect_b32 s46, s46, 0
  s_lshl_b32 s83, s4, 7
  s_lshl_b32 s6, s4, 6
  s_lshl_b32 s7, s5, 3
  s_add_u32 s6, s6, s7
  s_lshl_b32 s7, s3, 1
  s_add_u32 s6, s6, s7
  s_lshl_b32 s6, s6, 14
  s_add_u32 s84, s6, 2097152
  s_mul_i32 s6, s4, 0
  s_add_u32 s84, s84, s6
  s_add_u32 s85, s84, 4096
  s_add_u32 s86, s84, 8192
  s_add_u32 s87, s84, 12288
  s_add_u32 s88, s84, 16384
  s_add_u32 s89, s84, 20480
  s_add_u32 s90, s84, 24576
  s_add_u32 s91, s84, 28672
  s_lshl_b32 s6, s79, 1
  s_add_u32 s6, s6, s3
  s_lshl_b32 s6, s6, 5
  s_add_u32 s7, s6, 0
  s_and_b32 s7, s7, 511
  s_lshl_b32 s60, s7, 13
  s_add_u32 s60, s60, s76
  s_add_u32 s7, s6, 128
  s_and_b32 s7, s7, 511
  s_lshl_b32 s61, s7, 13
  s_add_u32 s61, s61, s76
  s_add_u32 s7, s6, 256
  s_and_b32 s7, s7, 511
  s_lshl_b32 s62, s7, 13
  s_add_u32 s62, s62, s76
  s_add_u32 s7, s6, 384
  s_and_b32 s7, s7, 511
  s_lshl_b32 s63, s7, 13
  s_add_u32 s63, s63, s76
  s_and_b32 s79, s79, 7
  s_lshl_b32 s6, s79, 1
  s_add_u32 s6, s6, s3
  s_lshl_b32 s82, s6, 5
  s_add_u32 s7, s82, 0
  s_and_b32 s7, s7, 511
  s_mul_i32 s52, s7, 3584
  s_add_u32 s52, s52, s83
  s_add_u32 s7, s82, 128
  s_and_b32 s7, s7, 511
  s_mul_i32 s53, s7, 3584
  s_add_u32 s53, s53, s83
  s_add_u32 s7, s82, 256
  s_and_b32 s7, s7, 511
  s_mul_i32 s54, s7, 3584
  s_add_u32 s54, s54, s83
  s_add_u32 s7, s82, 384
  s_and_b32 s7, s7, 511
  s_mul_i32 s55, s7, 3584
  s_add_u32 s55, s55, s83
  s_lshl_b32 s70, s79, 12
  s_lshl_b32 s48, s5, 2
  s_add_u32 s48, s48, s3
  s_sub_u32 s49, 63, s48
  s_mul_i32 s92, s48, 32768
  s_mul_i32 s93, s49, 32768
  s_mul_i32 s50, s48, 376832
  s_mul_i32 s51, s49, 376832
  s_add_u32 s50, s50, 35651584
  s_add_u32 s51, s51, 35651584
  s_lshl_b32 s6, s4, 12
  s_add_u32 s6, s6, 262144
  s_add_u32 s94, s50, s6
  s_add_u32 s95, s51, s6
  s_add_u32 m0, s77, 0
  s_add_u32 s81, s100, 0
  s_and_b32 s81, s81, 0x3fffff
  s_add_u32 s81, s81, s78
  buffer_load_dwordx4 v6, s[12:15], s81 offen offset:0 lds
  buffer_load_dwordx4 v7, s[12:15], s81 offen offset:1024 lds
  buffer_load_dwordx4 v8, s[12:15], s81 offen offset:2048 lds
  buffer_load_dwordx4 v9, s[12:15], s81 offen offset:3072 lds
  buffer_load_dwordx4 v[224:227], v20, s[32:35], s96 offen
  buffer_load_dwordx4 v[228:231], v20, s[32:35], s96 offen offset:128
  v_and_b32 v21, 7, v0
  v_lshlrev_b32 v21, 4, v21
  v_bfe_u32 v24, v0, 3, 2
  v_lshl_add_u32 v24, v24, 8, v21
  v_lshrrev_b32 v25, 5, v0
  v_lshl_add_u32 v24, v25, 11, v24
  v_add_u32 v21, 81920, v21
  s_lshl_b32 s6, s3, 2
  v_add_u32 v22, s6, v21
  s_lshr_b32 s6, s2, 2
  s_mul_i32 s6, s6, 32768
  s_and_b32 s7, s2, 2
  s_lshl_b32 s7, s7, 9
  s_add_u32 s6, s6, s7
  s_and_b32 s7, s2, 1
  s_lshl_b32 s7, s7, 7
  s_add_u32 s6, s6, s7
  s_lshl_b32 s7, s3, 13
  s_add_u32 s96, s6, s7
  s_add_u32 s97, s96, 4096
  s_lshl_b32 s65, s4, 5
  s_add_u32 s65, s65, s48
  s_lshl_b32 s65, s65, 2
  s_add_u32 s65, s65, 60882944
  s_getreg_b32 s57, hwreg(HW_REG_XCC_ID, 0, 4)
  s_lshl_b32 s64, s2, 8
  s_add_u32 s64, s64, 60817408
  s_and_b32 s65, s65, 0xfffffff0
  s_cmp_eq_u32 s3, 0
  s_cselect_b32 s64, s64, 0x80000000
  s_cmp_eq_u32 s3, 1
  s_cselect_b32 s65, s65, 0x80000000
  s_and_b32 s71, s2, 63
  s_lshl_b32 s71, s71, 2
  v_mov_b32 v27, 0
  v_lshlrev_b32 v26, 2, v0
  v_mov_b32 v28, 1
  v_mov_b32 v72, s57
  v_mov_b32 v73, s57
  v_mov_b32 v74, s57
  v_mov_b32 v75, s57
  v_bfe_u32 v25, v0, 1, 4
  v_lshlrev_b32 v25, 13, v25
  v_and_b32 v23, 1, v0
  v_lshl_add_u32 v25, v23, 7, v25
  s_lshl_b32 s56, s75, 1
  s_add_u32 s56, s56, s76
  s_mov_b64 exec, 0
  s_cmp_eq_u32 s3, 1
  s_cbranch_scc1 L_pad1
  s_cmp_eq_u32 s3, 2
  s_cbranch_scc1 L_pad2
  s_cmp_eq_u32 s3, 3
  s_cbranch_scc1 L_pad3
  s_branch L_pad0
L_padret:
  s_mov_b64 exec, -1
  s_branch L_main
.p2align 12
L_main:
L_pad0:
  s_cbranch_execz L_pad4
  s_add_u32 m0, s74, 32768
  s_add_u32 s80, s101, 128
  s_and_b32 s80, s80, 0x3ff
  s_add_u32 s80, s80, s75
  buffer_load_dwordx4 v2, s[8:11], s80 offen offset:0 lds
  buffer_load_dwordx4 v3, s[8:11], s80 offen offset:1024 lds
  buffer_load_dwordx4 v4, s[8:11], s80 offen offset:2048 lds
  buffer_load_dwordx4 v5, s[8:11], s80 offen offset:3072 lds
  s_add_u32 m0, s74, 36864
  s_add_u32 s80, s80, 32768
  buffer_load_dwordx4 v2, s[8:11], s80 offen offset:0 lds
  buffer_load_dwordx4 v3, s[8:11], s80 offen offset:1024 lds
  buffer_load_dwordx4 v4, s[8:11], s80 offen offset:2048 lds
  buffer_load_dwordx4 v5, s[8:11], s80 offen offset:3072 lds
  s_waitcnt vmcnt(14)
  ds_read_b128 a[0:3], v18 offset:0
  ds_read_b128 a[4:7], v18 offset:2048
  ds_read_b128 a[128:131], v18 offset:4096
  ds_read_b128 a[132:135], v18 offset:6144
  ds_read_b128 a[8:11], v19 offset:0
  ds_read_b128 a[12:15], v19 offset:2048
  ds_read_b128 a[136:139], v19 offset:4096
  ds_read_b128 a[140:143], v19 offset:6144
  s_waitcnt vmcnt(10)
  s_barrier
  ds_read_b64_tr_b16 v[32:33], v14 offset:0
  ds_read_b64_tr_b16 v[34:35], v14 offset:512
  ds_read_b64_tr_b16 v[36:37], v14 offset:4096
  ds_read_b64_tr_b16 v[38:39], v14 offset:4608
  ds_read_b64_tr_b16 v[40:41], v15 offset:0
  ds_read_b64_tr_b16 v[42:43], v15 offset:512
  ds_read_b64_tr_b16 v[44:45], v15 offset:4096
  ds_read_b64_tr_b16 v[46:47], v15 offset:4608
  s_waitcnt lgkmcnt(4)
  v_mfma_f32_16x16x32_bf16 v[96:99], v[32:35], a[0:3], 0
  s_add_u32 m0, s77, 16384
  ds_read_b64_tr_b16 v[48:49], v16 offset:0
  v_mfma_f32_16x16x32_bf16 v[96:99], v[36:39], a[8:11], v[96:99]
  s_add_u32 s81, s100, 524288
  v_mfma_f32_16x16x32_bf16 v[104:107], v[36:39], a[12:15], 0
  s_and_b32 s81, s81, 0x3fffff
  ds_read_b64_tr_b16 v[50:51], v16 offset:512
  v_mfma_f32_16x16x32_bf16 v[104:107], v[32:35], a[4:7], v[104:107]
  s_add_u32 s81, s81, s78
  buffer_load_dwordx4 v6, s[12:15], s81 offen offset:0 lds
  v_mfma_f32_16x16x32_bf16 v[112:115], v[32:35], a[128:131], 0
  ds_read_b64_tr_b16 v[52:53], v16 offset:4096
  v_mfma_f32_16x16x32_bf16 v[112:115], v[36:39], a[136:139], v[112:115]
  buffer_load_dwordx4 v7, s[12:15], s81 offen offset:1024 lds
  v_mfma_f32_16x16x32_bf16 v[120:123], v[36:39], a[140:143], 0
  ds_read_b64_tr_b16 v[54:55], v16 offset:4608
  v_mfma_f32_16x16x32_bf16 v[120:123], v[32:35], a[132:135], v[120:123]
  s_waitcnt lgkmcnt(4)
  buffer_load_dwordx4 v8, s[12:15], s81 offen offset:2048 lds
  v_mfma_f32_16x16x32_bf16 v[124:127], v[40:43], a[132:135], 0
  ds_read_b64_tr_b16 v[56:57], v17 offset:0
  v_mfma_f32_16x16x32_bf16 v[124:127], v[44:47], a[140:143], v[124:127]
  buffer_load_dwordx4 v9, s[12:15], s81 offen offset:3072 lds
  v_mfma_f32_16x16x32_bf16 v[116:119], v[44:47], a[136:139], 0
  s_add_u32 m0, s74, 0
  ds_read_b64_tr_b16 v[58:59], v17 offset:512
  v_mfma_f32_16x16x32_bf16 v[116:119], v[40:43], a[128:131], v[116:119]
  s_add_u32 s80, s101, 256
  v_mfma_f32_16x16x32_bf16 v[108:111], v[40:43], a[4:7], 0
  s_and_b32 s80, s80, 0x3ff
  ds_read_b64_tr_b16 v[60:61], v17 offset:4096
  v_mfma_f32_16x16x32_bf16 v[108:111], v[44:47], a[12:15], v[108:111]
  s_add_u32 s80, s80, s75
  buffer_load_dwordx4 v2, s[8:11], s80 offen offset:0 lds
  v_mfma_f32_16x16x32_bf16 v[100:103], v[44:47], a[8:11], 0
  ds_read_b64_tr_b16 v[62:63], v17 offset:4608
  v_mfma_f32_16x16x32_bf16 v[100:103], v[40:43], a[0:3], v[100:103]
  s_waitcnt lgkmcnt(4)
  v_mfma_f32_16x16x32_bf16 v[128:131], v[48:51], a[0:3], 0
  ds_read_b64_tr_b16 v[32:33], v14 offset:8192
  v_mfma_f32_16x16x32_bf16 v[128:131], v[52:55], a[8:11], v[128:131]
  buffer_load_dwordx4 v3, s[8:11], s80 offen offset:1024 lds
  v_mfma_f32_16x16x32_bf16 v[136:139], v[52:55], a[12:15], 0
  ds_read_b64_tr_b16 v[34:35], v14 offset:8704
  v_mfma_f32_16x16x32_bf16 v[136:139], v[48:51], a[4:7], v[136:139]
  v_mfma_f32_16x16x32_bf16 v[144:147], v[48:51], a[128:131], 0
  ds_read_b64_tr_b16 v[36:37], v14 offset:12288
  v_mfma_f32_16x16x32_bf16 v[144:147], v[52:55], a[136:139], v[144:147]
  buffer_load_dwordx4 v4, s[8:11], s80 offen offset:2048 lds
  v_mfma_f32_16x16x32_bf16 v[152:155], v[52:55], a[140:143], 0
  ds_read_b64_tr_b16 v[38:39], v14 offset:12800
  v_mfma_f32_16x16x32_bf16 v[152:155], v[48:51], a[132:135], v[152:155]
  s_waitcnt lgkmcnt(4)
  v_mfma_f32_16x16x32_bf16 v[156:159], v[56:59], a[132:135], 0
  ds_read_b64_tr_b16 v[40:41], v15 offset:8192
  v_mfma_f32_16x16x32_bf16 v[156:159], v[60:63], a[140:143], v[156:159]
  buffer_load_dwordx4 v5, s[8:11], s80 offen offset:3072 lds
  v_mfma_f32_16x16x32_bf16 v[148:151], v[60:63], a[136:139], 0
  ds_read_b64_tr_b16 v[42:43], v15 offset:8704
  v_mfma_f32_16x16x32_bf16 v[148:151], v[56:59], a[128:131], v[148:151]
  v_mfma_f32_16x16x32_bf16 v[140:143], v[56:59], a[4:7], 0
  s_add_u32 m0, s74, 4096
  ds_read_b64_tr_b16 v[44:45], v15 offset:12288
  v_mfma_f32_16x16x32_bf16 v[140:143], v[60:63], a[12:15], v[140:143]
  s_add_u32 s80, s80, 32768
  buffer_load_dwordx4 v2, s[8:11], s80 offen offset:0 lds
  v_mfma_f32_16x16x32_bf16 v[132:135], v[60:63], a[8:11], 0
  ds_read_b64_tr_b16 v[46:47], v15 offset:12800
  v_mfma_f32_16x16x32_bf16 v[132:135], v[56:59], a[0:3], v[132:135]
  s_waitcnt lgkmcnt(4)
  v_mfma_f32_16x16x32_bf16 v[160:163], v[32:35], a[0:3], 0
  ds_read_b64_tr_b16 v[48:49], v16 offset:8192
  v_mfma_f32_16x16x32_bf16 v[160:163], v[36:39], a[8:11], v[160:163]
  buffer_load_dwordx4 v3, s[8:11], s80 offen offset:1024 lds
  v_mfma_f32_16x16x32_bf16 v[168:171], v[36:39], a[12:15], 0
  ds_read_b64_tr_b16 v[50:51], v16 offset:8704
  v_mfma_f32_16x16x32_bf16 v[168:171], v[32:35], a[4:7], v[168:171]
  v_mfma_f32_16x16x32_bf16 v[176:179], v[32:35], a[128:131], 0
  s_waitcnt vmcnt(10)
  ds_read_b64_tr_b16 v[52:53], v16 offset:12288
  ds_read_b128 a[16:19], v18 offset:32768
  v_mfma_f32_16x16x32_bf16 v[176:179], v[36:39], a[136:139], v[176:179]
  buffer_load_dwordx4 v4, s[8:11], s80 offen offset:2048 lds
  v_mfma_f32_16x16x32_bf16 v[184:187], v[36:39], a[140:143], 0
  ds_read_b64_tr_b16 v[54:55], v16 offset:12800
  ds_read_b128 a[20:23], v18 offset:34816
  v_mfma_f32_16x16x32_bf16 v[184:187], v[32:35], a[132:135], v[184:187]
  s_waitcnt lgkmcnt(6)
  v_mfma_f32_16x16x32_bf16 v[188:191], v[40:43], a[132:135], 0
  ds_read_b64_tr_b16 v[56:57], v17 offset:8192
  ds_read_b128 a[144:147], v18 offset:36864
  v_mfma_f32_16x16x32_bf16 v[188:191], v[44:47], a[140:143], v[188:191]
  buffer_load_dwordx4 v5, s[8:11], s80 offen offset:3072 lds
  v_mfma_f32_16x16x32_bf16 v[180:183], v[44:47], a[136:139], 0
  s_add_u32 m0, s77, 32768
  s_add_u32 s81, s100, 1048576
  ds_read_b64_tr_b16 v[58:59], v17 offset:8704
  ds_read_b128 a[148:151], v18 offset:38912
  v_mfma_f32_16x16x32_bf16 v[180:183], v[40:43], a[128:131], v[180:183]
  s_and_b32 s81, s81, 0x3fffff
  v_mfma_f32_16x16x32_bf16 v[172:175], v[40:43], a[4:7], 0
  s_add_u32 s81, s81, s78
  ds_read_b64_tr_b16 v[60:61], v17 offset:12288
  ds_read_b128 a[24:27], v19 offset:32768
  v_mfma_f32_16x16x32_bf16 v[172:175], v[44:47], a[12:15], v[172:175]
  s_waitcnt vmcnt(8)
  buffer_load_dwordx4 v6, s[12:15], s81 offen offset:0 lds
  v_mfma_f32_16x16x32_bf16 v[164:167], v[44:47], a[8:11], 0
  s_barrier
  ds_read_b64_tr_b16 v[62:63], v17 offset:12800
  ds_read_b128 a[28:31], v19 offset:34816
  v_mfma_f32_16x16x32_bf16 v[164:167], v[40:43], a[0:3], v[164:167]
  s_waitcnt lgkmcnt(9)
  v_mfma_f32_16x16x32_bf16 v[192:195], v[48:51], a[0:3], 0
  ds_read_b64_tr_b16 v[32:33], v14 offset:16384
  ds_read_b128 a[152:155], v19 offset:36864
  v_mfma_f32_16x16x32_bf16 v[192:195], v[52:55], a[8:11], v[192:195]
  buffer_load_dwordx4 v7, s[12:15], s81 offen offset:1024 lds
  v_mfma_f32_16x16x32_bf16 v[200:203], v[52:55], a[12:15], 0
  ds_read_b64_tr_b16 v[34:35], v14 offset:16896
  ds_read_b128 a[156:159], v19 offset:38912
  v_mfma_f32_16x16x32_bf16 v[200:203], v[48:51], a[4:7], v[200:203]
  v_mfma_f32_16x16x32_bf16 v[208:211], v[48:51], a[128:131], 0
  ds_read_b64_tr_b16 v[36:37], v14 offset:20480
  v_mfma_f32_16x16x32_bf16 v[208:211], v[52:55], a[136:139], v[208:211]
  buffer_load_dwordx4 v8, s[12:15], s81 offen offset:2048 lds
  v_mfma_f32_16x16x32_bf16 v[216:219], v[52:55], a[140:143], 0
  ds_read_b64_tr_b16 v[38:39], v14 offset:20992
  v_mfma_f32_16x16x32_bf16 v[216:219], v[48:51], a[132:135], v[216:219]
  s_waitcnt lgkmcnt(7)
  v_mfma_f32_16x16x32_bf16 v[220:223], v[56:59], a[132:135], 0
  ds_read_b64_tr_b16 v[40:41], v15 offset:16384
  v_mfma_f32_16x16x32_bf16 v[220:223], v[60:63], a[140:143], v[220:223]
  buffer_load_dwordx4 v9, s[12:15], s81 offen offset:3072 lds
  v_mfma_f32_16x16x32_bf16 v[212:215], v[60:63], a[136:139], 0
  ds_read_b64_tr_b16 v[42:43], v15 offset:16896
  v_mfma_f32_16x16x32_bf16 v[212:215], v[56:59], a[128:131], v[212:215]
  v_mfma_f32_16x16x32_bf16 v[204:207], v[56:59], a[4:7], 0
  ds_read_b64_tr_b16 v[44:45], v15 offset:20480
  v_and_b32 v233, 0xffff0000, v224
  v_lshlrev_b32 v232, 16, v224
  v_and_b32 v235, 0xffff0000, v225
  v_lshlrev_b32 v234, 16, v225
  v_and_b32 v237, 0xffff0000, v226
  v_lshlrev_b32 v236, 16, v226
  v_and_b32 v239, 0xffff0000, v227
  v_lshlrev_b32 v238, 16, v227
  v_and_b32 v241, 0xffff0000, v228
  v_lshlrev_b32 v240, 16, v228
  v_and_b32 v243, 0xffff0000, v229
  v_lshlrev_b32 v242, 16, v229
  v_and_b32 v245, 0xffff0000, v230
  v_lshlrev_b32 v244, 16, v230
  v_and_b32 v247, 0xffff0000, v231
  v_lshlrev_b32 v246, 16, v231
  v_add_f32 v80, v232, v233
  v_add_f32 v80, v80, v234
  v_add_f32 v80, v80, v235
  v_add_f32 v80, v80, v236
  v_add_f32 v80, v80, v237
  v_add_f32 v80, v80, v238
  v_add_f32 v80, v80, v239
  v_add_f32 v80, v80, v240
  v_add_f32 v80, v80, v241
  v_add_f32 v80, v80, v242
  v_add_f32 v80, v80, v243
  v_add_f32 v80, v80, v244
  v_add_f32 v80, v80, v245
  v_add_f32 v80, v80, v246
  v_add_f32 v80, v80, v247
  s_nop 1
  v_add_f32_dpp v80, v80, v80 row_ror:8 row_mask:0xf bank_mask:0xf
  v_mov_b32 v76, v80
  s_nop 1
  v_permlane16_swap_b32 v80, v76
  v_add_f32 v80, v80, v76
  v_mov_b32 v76, v80
  s_nop 1
  v_permlane32_swap_b32 v80, v76
  v_add_f32 v80, v80, v76
  ds_write_b32 v22, v80 offset:0
  s_waitcnt lgkmcnt(0)
  s_barrier
  ds_read_b128 v[76:79], v21 offset:0
  s_waitcnt lgkmcnt(0)
  v_add_f32 v76, v76, v77
  v_add_f32 v78, v78, v79
  v_add_f32 v80, v76, v78
  v_mul_f32 v80, 0x3b000000, v80
  v_sub_f32 v76, v232, v80
  v_mul_f32 v81, v76, v76
  v_sub_f32 v76, v233, v80
  v_fmac_f32 v81, v76, v76
  v_sub_f32 v76, v234, v80
  v_fmac_f32 v81, v76, v76
  v_sub_f32 v76, v235, v80
  v_fmac_f32 v81, v76, v76
  v_sub_f32 v76, v236, v80
  v_fmac_f32 v81, v76, v76
  v_sub_f32 v76, v237, v80
  v_fmac_f32 v81, v76, v76
  v_sub_f32 v76, v238, v80
  v_fmac_f32 v81, v76, v76
  v_sub_f32 v76, v239, v80
  v_fmac_f32 v81, v76, v76
  v_sub_f32 v76, v240, v80
  v_fmac_f32 v81, v76, v76
  v_sub_f32 v76, v241, v80
  v_fmac_f32 v81, v76, v76
  v_sub_f32 v76, v242, v80
  v_fmac_f32 v81, v76, v76
  v_sub_f32 v76, v243, v80
  v_fmac_f32 v81, v76, v76
  v_sub_f32 v76, v244, v80
  v_fmac_f32 v81, v76, v76
  v_sub_f32 v76, v245, v80
  v_fmac_f32 v81, v76, v76
  v_sub_f32 v76, v246, v80
  v_fmac_f32 v81, v76, v76
  v_sub_f32 v76, v247, v80
  v_fmac_f32 v81, v76, v76
  s_nop 1
  v_add_f32_dpp v81, v81, v81 row_ror:8 row_mask:0xf bank_mask:0xf
  v_mov_b32 v76, v81
  s_nop 1
  v_permlane16_swap_b32 v81, v76
  v_add_f32 v81, v81, v76
  v_mov_b32 v76, v81
  s_nop 1
  v_permlane32_swap_b32 v81, v76
  v_add_f32 v81, v81, v76
  ds_write_b32 v22, v81 offset:128
  s_waitcnt lgkmcnt(0)
  s_barrier
  ds_read_b128 v[76:79], v21 offset:128
  s_waitcnt lgkmcnt(0)
  v_add_f32 v76, v76, v77
  v_add_f32 v78, v78, v79
  v_add_f32 v81, v76, v78
  v_mul_f32 v81, 0x3b000000, v81
  v_mfma_f32_16x16x32_bf16 v[204:207], v[60:63], a[12:15], v[204:207]
  s_add_u32 m0, s74, 32768
  v_mfma_f32_16x16x32_bf16 v[196:199], v[60:63], a[8:11], 0
  s_add_u32 s80, s101, 384
  ds_read_b64_tr_b16 v[46:47], v15 offset:20992
  v_mfma_f32_16x16x32_bf16 v[196:199], v[56:59], a[0:3], v[196:199]
  v_mfma_f32_16x16x32_bf16 v[96:99], v[32:35], a[16:19], v[96:99]
  s_and_b32 s80, s80, 0x3ff
  ds_read_b64_tr_b16 v[48:49], v16 offset:16384
  v_mfma_f32_16x16x32_bf16 v[96:99], v[36:39], a[24:27], v[96:99]
  s_add_u32 s80, s80, s75
  buffer_load_dwordx4 v2, s[8:11], s80 offen offset:0 lds
  v_mfma_f32_16x16x32_bf16 v[104:107], v[36:39], a[28:31], v[104:107]
  ds_read_b64_tr_b16 v[50:51], v16 offset:16896
  v_mfma_f32_16x16x32_bf16 v[104:107], v[32:35], a[20:23], v[104:107]
  v_mfma_f32_16x16x32_bf16 v[112:115], v[32:35], a[144:147], v[112:115]
  ds_read_b64_tr_b16 v[52:53], v16 offset:20480
  v_mfma_f32_16x16x32_bf16 v[112:115], v[36:39], a[152:155], v[112:115]
  buffer_load_dwordx4 v3, s[8:11], s80 offen offset:1024 lds
  v_mfma_f32_16x16x32_bf16 v[120:123], v[36:39], a[156:159], v[120:123]
  ds_read_b64_tr_b16 v[54:55], v16 offset:20992
  v_mfma_f32_16x16x32_bf16 v[120:123], v[32:35], a[148:151], v[120:123]
  s_waitcnt lgkmcnt(4)
  v_mfma_f32_16x16x32_bf16 v[124:127], v[40:43], a[148:151], v[124:127]
  ds_read_b64_tr_b16 v[56:57], v17 offset:16384
  v_mfma_f32_16x16x32_bf16 v[124:127], v[44:47], a[156:159], v[124:127]
  buffer_load_dwordx4 v4, s[8:11], s80 offen offset:2048 lds
  v_mfma_f32_16x16x32_bf16 v[116:119], v[44:47], a[152:155], v[116:119]
  ds_read_b64_tr_b16 v[58:59], v17 offset:16896
  v_mfma_f32_16x16x32_bf16 v[116:119], v[40:43], a[144:147], v[116:119]
  v_mfma_f32_16x16x32_bf16 v[108:111], v[40:43], a[20:23], v[108:111]
  ds_read_b64_tr_b16 v[60:61], v17 offset:20480
  v_mfma_f32_16x16x32_bf16 v[108:111], v[44:47], a[28:31], v[108:111]
  buffer_load_dwordx4 v5, s[8:11], s80 offen offset:3072 lds
  v_mfma_f32_16x16x32_bf16 v[100:103], v[44:47], a[24:27], v[100:103]
  ds_read_b64_tr_b16 v[62:63], v17 offset:20992
  v_mfma_f32_16x16x32_bf16 v[100:103], v[40:43], a[16:19], v[100:103]
  s_waitcnt lgkmcnt(4)
  v_mfma_f32_16x16x32_bf16 v[128:131], v[48:51], a[16:19], v[128:131]
  s_add_u32 m0, s74, 36864
  ds_read_b64_tr_b16 v[32:33], v14 offset:24576
  v_mfma_f32_16x16x32_bf16 v[128:131], v[52:55], a[24:27], v[128:131]
  s_add_u32 s80, s80, 32768
  buffer_load_dwordx4 v2, s[8:11], s80 offen offset:0 lds
  v_mfma_f32_16x16x32_bf16 v[136:139], v[52:55], a[28:31], v[136:139]
  ds_read_b64_tr_b16 v[34:35], v14 offset:25088
  v_mfma_f32_16x16x32_bf16 v[136:139], v[48:51], a[20:23], v[136:139]
  v_mfma_f32_16x16x32_bf16 v[144:147], v[48:51], a[144:147], v[144:147]
  ds_read_b64_tr_b16 v[36:37], v14 offset:28672
  v_mfma_f32_16x16x32_bf16 v[144:147], v[52:55], a[152:155], v[144:147]
  buffer_load_dwordx4 v3, s[8:11], s80 offen offset:1024 lds
  v_mfma_f32_16x16x32_bf16 v[152:155], v[52:55], a[156:159], v[152:155]
  ds_read_b64_tr_b16 v[38:39], v14 offset:29184
  v_mfma_f32_16x16x32_bf16 v[152:155], v[48:51], a[148:151], v[152:155]
  s_waitcnt lgkmcnt(4)
  v_mfma_f32_16x16x32_bf16 v[156:159], v[56:59], a[148:151], v[156:159]
  ds_read_b64_tr_b16 v[40:41], v15 offset:24576
  v_mfma_f32_16x16x32_bf16 v[156:159], v[60:63], a[156:159], v[156:159]
  buffer_load_dwordx4 v4, s[8:11], s80 offen offset:2048 lds
  v_mfma_f32_16x16x32_bf16 v[148:151], v[60:63], a[152:155], v[148:151]
  ds_read_b64_tr_b16 v[42:43], v15 offset:25088
  v_mfma_f32_16x16x32_bf16 v[148:151], v[56:59], a[144:147], v[148:151]
  v_mfma_f32_16x16x32_bf16 v[140:143], v[56:59], a[20:23], v[140:143]
  ds_read_b64_tr_b16 v[44:45], v15 offset:28672
  v_mfma_f32_16x16x32_bf16 v[140:143], v[60:63], a[28:31], v[140:143]
  buffer_load_dwordx4 v5, s[8:11], s80 offen offset:3072 lds
  v_mfma_f32_16x16x32_bf16 v[132:135], v[60:63], a[24:27], v[132:135]
  s_add_u32 m0, s77, 49152
  s_add_u32 s81, s100, 1572864
  ds_read_b64_tr_b16 v[46:47], v15 offset:29184
  v_mfma_f32_16x16x32_bf16 v[132:135], v[56:59], a[16:19], v[132:135]
  s_waitcnt lgkmcnt(4)
  v_mfma_f32_16x16x32_bf16 v[160:163], v[32:35], a[16:19], v[160:163]
  s_and_b32 s81, s81, 0x3fffff
  ds_read_b64_tr_b16 v[48:49], v16 offset:24576
  v_mfma_f32_16x16x32_bf16 v[160:163], v[36:39], a[24:27], v[160:163]
  s_add_u32 s81, s81, s78
  buffer_load_dwordx4 v6, s[12:15], s81 offen offset:0 lds
  v_mfma_f32_16x16x32_bf16 v[168:171], v[36:39], a[28:31], v[168:171]
  ds_read_b64_tr_b16 v[50:51], v16 offset:25088
  v_mfma_f32_16x16x32_bf16 v[168:171], v[32:35], a[20:23], v[168:171]
  v_mfma_f32_16x16x32_bf16 v[176:179], v[32:35], a[144:147], v[176:179]
  s_waitcnt vmcnt(13)
  ds_read_b64_tr_b16 v[52:53], v16 offset:28672
  ds_read_b128 a[32:35], v18 offset:0
  v_mfma_f32_16x16x32_bf16 v[176:179], v[36:39], a[152:155], v[176:179]
  buffer_load_dwordx4 v7, s[12:15], s81 offen offset:1024 lds
  v_mfma_f32_16x16x32_bf16 v[184:187], v[36:39], a[156:159], v[184:187]
  ds_read_b64_tr_b16 v[54:55], v16 offset:29184
  ds_read_b128 a[36:39], v18 offset:2048
  v_mfma_f32_16x16x32_bf16 v[184:187], v[32:35], a[148:151], v[184:187]
  s_waitcnt lgkmcnt(6)
  v_mfma_f32_16x16x32_bf16 v[188:191], v[40:43], a[148:151], v[188:191]
  ds_read_b64_tr_b16 v[56:57], v17 offset:24576
  ds_read_b128 a[160:163], v18 offset:4096
  v_mfma_f32_16x16x32_bf16 v[188:191], v[44:47], a[156:159], v[188:191]
  buffer_load_dwordx4 v8, s[12:15], s81 offen offset:2048 lds
  v_mfma_f32_16x16x32_bf16 v[180:183], v[44:47], a[152:155], v[180:183]
  ds_read_b64_tr_b16 v[58:59], v17 offset:25088
  ds_read_b128 a[164:167], v18 offset:6144
  v_mfma_f32_16x16x32_bf16 v[180:183], v[40:43], a[144:147], v[180:183]
  v_mfma_f32_16x16x32_bf16 v[172:175], v[40:43], a[20:23], v[172:175]
  ds_read_b64_tr_b16 v[60:61], v17 offset:28672
  ds_read_b128 a[40:43], v19 offset:0
  v_mfma_f32_16x16x32_bf16 v[172:175], v[44:47], a[28:31], v[172:175]
  s_waitcnt vmcnt(11)
  buffer_load_dwordx4 v9, s[12:15], s81 offen offset:3072 lds
  v_mfma_f32_16x16x32_bf16 v[164:167], v[44:47], a[24:27], v[164:167]
  s_barrier
  ds_read_b64_tr_b16 v[62:63], v17 offset:29184
  ds_read_b128 a[44:47], v19 offset:2048
  v_mfma_f32_16x16x32_bf16 v[164:167], v[40:43], a[16:19], v[164:167]
  s_waitcnt lgkmcnt(9)
  v_mfma_f32_16x16x32_bf16 v[192:195], v[48:51], a[16:19], v[192:195]
  ds_read_b64_tr_b16 v[32:33], v14 offset:32768
  ds_read_b128 a[168:171], v19 offset:4096
  v_mfma_f32_16x16x32_bf16 v[192:195], v[52:55], a[24:27], v[192:195]
  v_mfma_f32_16x16x32_bf16 v[200:203], v[52:55], a[28:31], v[200:203]
  ds_read_b64_tr_b16 v[34:35], v14 offset:33280
  ds_read_b128 a[172:175], v19 offset:6144
  v_mfma_f32_16x16x32_bf16 v[200:203], v[48:51], a[20:23], v[200:203]
  v_mfma_f32_16x16x32_bf16 v[208:211], v[48:51], a[144:147], v[208:211]
  ds_read_b64_tr_b16 v[36:37], v14 offset:36864
  v_mfma_f32_16x16x32_bf16 v[208:211], v[52:55], a[152:155], v[208:211]
  v_mfma_f32_16x16x32_bf16 v[216:219], v[52:55], a[156:159], v[216:219]
  ds_read_b64_tr_b16 v[38:39], v14 offset:37376
  v_mfma_f32_16x16x32_bf16 v[216:219], v[48:51], a[148:151], v[216:219]
  s_waitcnt lgkmcnt(7)
  v_mfma_f32_16x16x32_bf16 v[220:223], v[56:59], a[148:151], v[220:223]
  ds_read_b64_tr_b16 v[40:41], v15 offset:32768
  v_mfma_f32_16x16x32_bf16 v[220:223], v[60:63], a[156:159], v[220:223]
  v_mfma_f32_16x16x32_bf16 v[212:215], v[60:63], a[152:155], v[212:215]
  ds_read_b64_tr_b16 v[42:43], v15 offset:33280
  v_mfma_f32_16x16x32_bf16 v[212:215], v[56:59], a[144:147], v[212:215]
  v_mfma_f32_16x16x32_bf16 v[204:207], v[56:59], a[20:23], v[204:207]
  ds_read_b64_tr_b16 v[44:45], v15 offset:36864
  v_mfma_f32_16x16x32_bf16 v[204:207], v[60:63], a[28:31], v[204:207]
  s_add_u32 m0, s74, 0
  v_cvt_pk_bf16_f32 v76, v80, v81
  v_lshlrev_b32 v80, 16, v76
  v_and_b32 v81, 0xffff0000, v76
  v_add_f32 v81, 0x3727c5ac, v81
  v_cvt_pk_bf16_f32 v76, v81, v81
  v_lshlrev_b32 v81, 16, v76
  v_sqrt_f32 v81, v81
  v_sub_f32 v232, v232, v80
  v_cvt_pk_bf16_f32 v76, v81, v81
  v_lshlrev_b32 v81, 16, v76
  v_rcp_f32 v81, v81
  v_sub_f32 v233, v233, v80
  v_sub_f32 v234, v234, v80
  v_sub_f32 v235, v235, v80
  v_sub_f32 v236, v236, v80
  v_sub_f32 v237, v237, v80
  v_sub_f32 v238, v238, v80
  v_sub_f32 v239, v239, v80
  v_sub_f32 v240, v240, v80
  v_sub_f32 v241, v241, v80
  v_sub_f32 v242, v242, v80
  v_sub_f32 v243, v243, v80
  v_sub_f32 v244, v244, v80
  v_sub_f32 v245, v245, v80
  v_sub_f32 v246, v246, v80
  v_sub_f32 v247, v247, v80
  v_cvt_pk_bf16_f32 v76, v232, v233
  v_lshlrev_b32 v77, 16, v76
  v_and_b32 v78, 0xffff0000, v76
  v_mul_f32 v77, v77, v81
  v_mul_f32 v78, v78, v81
  v_cvt_pk_bf16_f32 v64, v77, v78
  v_cvt_pk_bf16_f32 v76, v234, v235
  v_lshlrev_b32 v77, 16, v76
  v_and_b32 v78, 0xffff0000, v76
  v_mul_f32 v77, v77, v81
  v_mul_f32 v78, v78, v81
  v_cvt_pk_bf16_f32 v65, v77, v78
  v_cvt_pk_bf16_f32 v76, v236, v237
  v_lshlrev_b32 v77, 16, v76
  v_and_b32 v78, 0xffff0000, v76
  v_mul_f32 v77, v77, v81
  v_mul_f32 v78, v78, v81
  v_cvt_pk_bf16_f32 v66, v77, v78
  v_cvt_pk_bf16_f32 v76, v238, v239
  v_lshlrev_b32 v77, 16, v76
  v_and_b32 v78, 0xffff0000, v76
  v_mul_f32 v77, v77, v81
  v_mul_f32 v78, v78, v81
  v_cvt_pk_bf16_f32 v67, v77, v78
  v_cvt_pk_bf16_f32 v76, v240, v241
  v_lshlrev_b32 v77, 16, v76
  v_and_b32 v78, 0xffff0000, v76
  v_mul_f32 v77, v77, v81
  v_mul_f32 v78, v78, v81
  v_cvt_pk_bf16_f32 v68, v77, v78
  v_cvt_pk_bf16_f32 v76, v242, v243
  v_lshlrev_b32 v77, 16, v76
  v_and_b32 v78, 0xffff0000, v76
  v_mul_f32 v77, v77, v81
  v_mul_f32 v78, v78, v81
  v_cvt_pk_bf16_f32 v69, v77, v78
  v_cvt_pk_bf16_f32 v76, v244, v245
  v_lshlrev_b32 v77, 16, v76
  v_and_b32 v78, 0xffff0000, v76
  v_mul_f32 v77, v77, v81
  v_mul_f32 v78, v78, v81
  v_cvt_pk_bf16_f32 v70, v77, v78
  v_cvt_pk_bf16_f32 v76, v246, v247
  v_lshlrev_b32 v77, 16, v76
  v_and_b32 v78, 0xffff0000, v76
  v_mul_f32 v77, v77, v81
  v_mul_f32 v78, v78, v81
  v_cvt_pk_bf16_f32 v71, v77, v78
  v_mfma_f32_16x16x32_bf16 v[196:199], v[60:63], a[24:27], v[196:199]
  s_add_u32 s80, s101, 512
  ds_read_b64_tr_b16 v[46:47], v15 offset:37376
  v_mfma_f32_16x16x32_bf16 v[196:199], v[56:59], a[16:19], v[196:199]
  s_waitcnt lgkmcnt(4)
  buffer_store_dwordx4 v[64:67], v24, s[28:31], s96 offen sc1
  v_mfma_f32_16x16x32_bf16 v[96:99], v[32:35], a[32:35], v[96:99]
  s_and_b32 s80, s80, 0x3ff
  ds_read_b64_tr_b16 v[48:49], v16 offset:32768
  v_mfma_f32_16x16x32_bf16 v[96:99], v[36:39], a[40:43], v[96:99]
  s_add_u32 s80, s80, s75
  buffer_load_dwordx4 v2, s[8:11], s80 offen offset:0 lds
  v_mfma_f32_16x16x32_bf16 v[104:107], v[36:39], a[44:47], v[104:107]
  ds_read_b64_tr_b16 v[50:51], v16 offset:33280
  v_mfma_f32_16x16x32_bf16 v[104:107], v[32:35], a[36:39], v[104:107]
  buffer_store_dwordx4 v[68:71], v24, s[28:31], s97 offen sc1
  v_mfma_f32_16x16x32_bf16 v[112:115], v[32:35], a[160:163], v[112:115]
  ds_read_b64_tr_b16 v[52:53], v16 offset:36864
  v_mfma_f32_16x16x32_bf16 v[112:115], v[36:39], a[168:171], v[112:115]
  buffer_load_dwordx4 v3, s[8:11], s80 offen offset:1024 lds
  v_mfma_f32_16x16x32_bf16 v[120:123], v[36:39], a[172:175], v[120:123]
  ds_read_b64_tr_b16 v[54:55], v16 offset:37376
  v_mfma_f32_16x16x32_bf16 v[120:123], v[32:35], a[164:167], v[120:123]
  s_waitcnt lgkmcnt(4)
  buffer_store_dword v27, v26, s[28:31], s64 offen sc1
  v_mfma_f32_16x16x32_bf16 v[124:127], v[40:43], a[164:167], v[124:127]
  ds_read_b64_tr_b16 v[56:57], v17 offset:32768
  v_mfma_f32_16x16x32_bf16 v[124:127], v[44:47], a[172:175], v[124:127]
  buffer_load_dwordx4 v4, s[8:11], s80 offen offset:2048 lds
  v_mfma_f32_16x16x32_bf16 v[116:119], v[44:47], a[168:171], v[116:119]
  ds_read_b64_tr_b16 v[58:59], v17 offset:33280
  v_mfma_f32_16x16x32_bf16 v[116:119], v[40:43], a[160:163], v[116:119]
  buffer_store_dwordx4 v[72:75], off, s[28:31], s65 sc1
  v_mfma_f32_16x16x32_bf16 v[108:111], v[40:43], a[36:39], v[108:111]
  ds_read_b64_tr_b16 v[60:61], v17 offset:36864
  v_mfma_f32_16x16x32_bf16 v[108:111], v[44:47], a[44:47], v[108:111]
  buffer_load_dwordx4 v5, s[8:11], s80 offen offset:3072 lds
  v_mfma_f32_16x16x32_bf16 v[100:103], v[44:47], a[40:43], v[100:103]
  ds_read_b64_tr_b16 v[62:63], v17 offset:37376
  v_mfma_f32_16x16x32_bf16 v[100:103], v[40:43], a[32:35], v[100:103]
  s_waitcnt lgkmcnt(4)
  v_mfma_f32_16x16x32_bf16 v[128:131], v[48:51], a[32:35], v[128:131]
  s_add_u32 m0, s74, 4096
  ds_read_b64_tr_b16 v[32:33], v14 offset:40960
  v_mfma_f32_16x16x32_bf16 v[128:131], v[52:55], a[40:43], v[128:131]
  s_add_u32 s80, s80, 32768
  buffer_load_dwordx4 v2, s[8:11], s80 offen offset:0 lds
  v_mfma_f32_16x16x32_bf16 v[136:139], v[52:55], a[44:47], v[136:139]
  ds_read_b64_tr_b16 v[34:35], v14 offset:41472
  v_mfma_f32_16x16x32_bf16 v[136:139], v[48:51], a[36:39], v[136:139]
  v_mfma_f32_16x16x32_bf16 v[144:147], v[48:51], a[160:163], v[144:147]
  ds_read_b64_tr_b16 v[36:37], v14 offset:45056
  v_mfma_f32_16x16x32_bf16 v[144:147], v[52:55], a[168:171], v[144:147]
  buffer_load_dwordx4 v3, s[8:11], s80 offen offset:1024 lds
  v_mfma_f32_16x16x32_bf16 v[152:155], v[52:55], a[172:175], v[152:155]
  ds_read_b64_tr_b16 v[38:39], v14 offset:45568
  v_mfma_f32_16x16x32_bf16 v[152:155], v[48:51], a[164:167], v[152:155]
  s_waitcnt lgkmcnt(4)
  buffer_load_dword v30, v25, s[24:27], s56 offen
  v_mfma_f32_16x16x32_bf16 v[156:159], v[56:59], a[164:167], v[156:159]
  ds_read_b64_tr_b16 v[40:41], v15 offset:40960
  v_mfma_f32_16x16x32_bf16 v[156:159], v[60:63], a[172:175], v[156:159]
  buffer_load_dwordx4 v4, s[8:11], s80 offen offset:2048 lds
  v_mfma_f32_16x16x32_bf16 v[148:151], v[60:63], a[168:171], v[148:151]
  ds_read_b64_tr_b16 v[42:43], v15 offset:41472
  v_mfma_f32_16x16x32_bf16 v[148:151], v[56:59], a[160:163], v[148:151]
  v_mfma_f32_16x16x32_bf16 v[140:143], v[56:59], a[36:39], v[140:143]
  ds_read_b64_tr_b16 v[44:45], v15 offset:45056
  v_mfma_f32_16x16x32_bf16 v[140:143], v[60:63], a[44:47], v[140:143]
  buffer_load_dwordx4 v5, s[8:11], s80 offen offset:3072 lds
  v_mfma_f32_16x16x32_bf16 v[132:135], v[60:63], a[40:43], v[132:135]
  s_add_u32 m0, s77, 65536
  s_add_u32 s81, s100, 2097152
  ds_read_b64_tr_b16 v[46:47], v15 offset:45568
  v_mfma_f32_16x16x32_bf16 v[132:135], v[56:59], a[32:35], v[132:135]
  s_waitcnt lgkmcnt(4)
  v_mfma_f32_16x16x32_bf16 v[160:163], v[32:35], a[32:35], v[160:163]
  s_and_b32 s81, s81, 0x3fffff
  ds_read_b64_tr_b16 v[48:49], v16 offset:40960
  v_mfma_f32_16x16x32_bf16 v[160:163], v[36:39], a[40:43], v[160:163]
  s_add_u32 s81, s81, s78
  buffer_load_dwordx4 v6, s[12:15], s81 offen offset:0 lds
  v_mfma_f32_16x16x32_bf16 v[168:171], v[36:39], a[44:47], v[168:171]
  ds_read_b64_tr_b16 v[50:51], v16 offset:41472
  v_mfma_f32_16x16x32_bf16 v[168:171], v[32:35], a[36:39], v[168:171]
  v_mfma_f32_16x16x32_bf16 v[176:179], v[32:35], a[160:163], v[176:179]
  s_waitcnt vmcnt(18)
  ds_read_b64_tr_b16 v[52:53], v16 offset:45056
  ds_read_b128 a[48:51], v18 offset:32768
  v_mfma_f32_16x16x32_bf16 v[176:179], v[36:39], a[168:171], v[176:179]
  buffer_load_dwordx4 v7, s[12:15], s81 offen offset:1024 lds
  v_mfma_f32_16x16x32_bf16 v[184:187], v[36:39], a[172:175], v[184:187]
  ds_read_b64_tr_b16 v[54:55], v16 offset:45568
  ds_read_b128 a[52:55], v18 offset:34816
  v_mfma_f32_16x16x32_bf16 v[184:187], v[32:35], a[164:167], v[184:187]
  s_waitcnt lgkmcnt(6)
  v_mfma_f32_16x16x32_bf16 v[188:191], v[40:43], a[164:167], v[188:191]
  ds_read_b64_tr_b16 v[56:57], v17 offset:40960
  ds_read_b128 a[176:179], v18 offset:36864
  v_mfma_f32_16x16x32_bf16 v[188:191], v[44:47], a[172:175], v[188:191]
  buffer_load_dwordx4 v8, s[12:15], s81 offen offset:2048 lds
  v_mfma_f32_16x16x32_bf16 v[180:183], v[44:47], a[168:171], v[180:183]
  ds_read_b64_tr_b16 v[58:59], v17 offset:41472
  ds_read_b128 a[180:183], v18 offset:38912
  v_mfma_f32_16x16x32_bf16 v[180:183], v[40:43], a[160:163], v[180:183]
  v_mfma_f32_16x16x32_bf16 v[172:175], v[40:43], a[36:39], v[172:175]
  ds_read_b64_tr_b16 v[60:61], v17 offset:45056
  ds_read_b128 a[56:59], v19 offset:32768
  v_mfma_f32_16x16x32_bf16 v[172:175], v[44:47], a[44:47], v[172:175]
  s_waitcnt vmcnt(16)
  buffer_load_dwordx4 v9, s[12:15], s81 offen offset:3072 lds
  v_mfma_f32_16x16x32_bf16 v[164:167], v[44:47], a[40:43], v[164:167]
  s_barrier
  ds_read_b64_tr_b16 v[62:63], v17 offset:45568
  ds_read_b128 a[60:63], v19 offset:34816
  v_mfma_f32_16x16x32_bf16 v[164:167], v[40:43], a[32:35], v[164:167]
L_pad1:
  s_cbranch_execz L_pad5
  s_waitcnt lgkmcnt(9)
  v_mfma_f32_16x16x32_bf16 v[192:195], v[48:51], a[32:35], v[192:195]
  ds_read_b64_tr_b16 v[32:33], v14 offset:49152
  ds_read_b128 a[184:187], v19 offset:36864
  v_mfma_f32_16x16x32_bf16 v[192:195], v[52:55], a[40:43], v[192:195]
  v_mfma_f32_16x16x32_bf16 v[200:203], v[52:55], a[44:47], v[200:203]
  ds_read_b64_tr_b16 v[34:35], v14 offset:49664
  ds_read_b128 a[188:191], v19 offset:38912
  v_mfma_f32_16x16x32_bf16 v[200:203], v[48:51], a[36:39], v[200:203]
  v_mfma_f32_16x16x32_bf16 v[208:211], v[48:51], a[160:163], v[208:211]
  ds_read_b64_tr_b16 v[36:37], v14 offset:53248
  v_mfma_f32_16x16x32_bf16 v[208:211], v[52:55], a[168:171], v[208:211]
  v_mfma_f32_16x16x32_bf16 v[216:219], v[52:55], a[172:175], v[216:219]
  ds_read_b64_tr_b16 v[38:39], v14 offset:53760
  v_mfma_f32_16x16x32_bf16 v[216:219], v[48:51], a[164:167], v[216:219]
  s_waitcnt lgkmcnt(7)
  v_mfma_f32_16x16x32_bf16 v[220:223], v[56:59], a[164:167], v[220:223]
  ds_read_b64_tr_b16 v[40:41], v15 offset:49152
  v_mfma_f32_16x16x32_bf16 v[220:223], v[60:63], a[172:175], v[220:223]
  v_mfma_f32_16x16x32_bf16 v[212:215], v[60:63], a[168:171], v[212:215]
  ds_read_b64_tr_b16 v[42:43], v15 offset:49664
  v_mfma_f32_16x16x32_bf16 v[212:215], v[56:59], a[160:163], v[212:215]
  v_mfma_f32_16x16x32_bf16 v[204:207], v[56:59], a[36:39], v[204:207]
  ds_read_b64_tr_b16 v[44:45], v15 offset:53248
  v_mfma_f32_16x16x32_bf16 v[204:207], v[60:63], a[44:47], v[204:207]
  s_add_u32 m0, s74, 32768
  v_mfma_f32_16x16x32_bf16 v[196:199], v[60:63], a[40:43], v[196:199]
  s_add_u32 s80, s101, 640
  ds_read_b64_tr_b16 v[46:47], v15 offset:53760
  v_mfma_f32_16x16x32_bf16 v[196:199], v[56:59], a[32:35], v[196:199]
  s_waitcnt lgkmcnt(4)
  v_mfma_f32_16x16x32_bf16 v[96:99], v[32:35], a[48:51], v[96:99]
  s_and_b32 s80, s80, 0x3ff
  ds_read_b64_tr_b16 v[48:49], v16 offset:49152
  v_mfma_f32_16x16x32_bf16 v[96:99], v[36:39], a[56:59], v[96:99]
  s_add_u32 s80, s80, s75
  buffer_load_dwordx4 v2, s[8:11], s80 offen offset:0 lds
  v_mfma_f32_16x16x32_bf16 v[104:107], v[36:39], a[60:63], v[104:107]
  ds_read_b64_tr_b16 v[50:51], v16 offset:49664
  v_mfma_f32_16x16x32_bf16 v[104:107], v[32:35], a[52:55], v[104:107]
  v_mfma_f32_16x16x32_bf16 v[112:115], v[32:35], a[176:179], v[112:115]
  ds_read_b64_tr_b16 v[52:53], v16 offset:53248
  v_mfma_f32_16x16x32_bf16 v[112:115], v[36:39], a[184:187], v[112:115]
  buffer_load_dwordx4 v3, s[8:11], s80 offen offset:1024 lds
  v_mfma_f32_16x16x32_bf16 v[120:123], v[36:39], a[188:191], v[120:123]
  ds_read_b64_tr_b16 v[54:55], v16 offset:53760
  v_mfma_f32_16x16x32_bf16 v[120:123], v[32:35], a[180:183], v[120:123]
  s_waitcnt lgkmcnt(4)
  v_mfma_f32_16x16x32_bf16 v[124:127], v[40:43], a[180:183], v[124:127]
  ds_read_b64_tr_b16 v[56:57], v17 offset:49152
  v_mfma_f32_16x16x32_bf16 v[124:127], v[44:47], a[188:191], v[124:127]
  buffer_load_dwordx4 v4, s[8:11], s80 offen offset:2048 lds
  v_mfma_f32_16x16x32_bf16 v[116:119], v[44:47], a[184:187], v[116:119]
  ds_read_b64_tr_b16 v[58:59], v17 offset:49664
  v_mfma_f32_16x16x32_bf16 v[116:119], v[40:43], a[176:179], v[116:119]
  v_mfma_f32_16x16x32_bf16 v[108:111], v[40:43], a[52:55], v[108:111]
  ds_read_b64_tr_b16 v[60:61], v17 offset:53248
  v_mfma_f32_16x16x32_bf16 v[108:111], v[44:47], a[60:63], v[108:111]
  buffer_load_dwordx4 v5, s[8:11], s80 offen offset:3072 lds
  v_mfma_f32_16x16x32_bf16 v[100:103], v[44:47], a[56:59], v[100:103]
  ds_read_b64_tr_b16 v[62:63], v17 offset:53760
  v_mfma_f32_16x16x32_bf16 v[100:103], v[40:43], a[48:51], v[100:103]
  s_waitcnt lgkmcnt(4)
  v_mfma_f32_16x16x32_bf16 v[128:131], v[48:51], a[48:51], v[128:131]
  s_add_u32 m0, s74, 36864
  ds_read_b64_tr_b16 v[32:33], v14 offset:57344
  v_mfma_f32_16x16x32_bf16 v[128:131], v[52:55], a[56:59], v[128:131]
  s_add_u32 s80, s80, 32768
  buffer_load_dwordx4 v2, s[8:11], s80 offen offset:0 lds
  v_mfma_f32_16x16x32_bf16 v[136:139], v[52:55], a[60:63], v[136:139]
  ds_read_b64_tr_b16 v[34:35], v14 offset:57856
  v_mfma_f32_16x16x32_bf16 v[136:139], v[48:51], a[52:55], v[136:139]
  v_mfma_f32_16x16x32_bf16 v[144:147], v[48:51], a[176:179], v[144:147]
  ds_read_b64_tr_b16 v[36:37], v14 offset:61440
  v_mfma_f32_16x16x32_bf16 v[144:147], v[52:55], a[184:187], v[144:147]
  buffer_load_dwordx4 v3, s[8:11], s80 offen offset:1024 lds
  v_mfma_f32_16x16x32_bf16 v[152:155], v[52:55], a[188:191], v[152:155]
  ds_read_b64_tr_b16 v[38:39], v14 offset:61952
  v_add_u32 v14, 0x10000, v14
  v_mfma_f32_16x16x32_bf16 v[152:155], v[48:51], a[180:183], v[152:155]
  s_waitcnt lgkmcnt(4)
  v_mfma_f32_16x16x32_bf16 v[156:159], v[56:59], a[180:183], v[156:159]
  ds_read_b64_tr_b16 v[40:41], v15 offset:57344
  v_mfma_f32_16x16x32_bf16 v[156:159], v[60:63], a[188:191], v[156:159]
  buffer_load_dwordx4 v4, s[8:11], s80 offen offset:2048 lds
  v_mfma_f32_16x16x32_bf16 v[148:151], v[60:63], a[184:187], v[148:151]
  ds_read_b64_tr_b16 v[42:43], v15 offset:57856
  v_mfma_f32_16x16x32_bf16 v[148:151], v[56:59], a[176:179], v[148:151]
  v_mfma_f32_16x16x32_bf16 v[140:143], v[56:59], a[52:55], v[140:143]
  ds_read_b64_tr_b16 v[44:45], v15 offset:61440
  v_mfma_f32_16x16x32_bf16 v[140:143], v[60:63], a[60:63], v[140:143]
  buffer_load_dwordx4 v5, s[8:11], s80 offen offset:3072 lds
  v_mfma_f32_16x16x32_bf16 v[132:135], v[60:63], a[56:59], v[132:135]
  s_add_u32 m0, s77, 81920
  s_add_u32 s81, s100, 2621440
  ds_read_b64_tr_b16 v[46:47], v15 offset:61952
  v_add_u32 v15, 0x10000, v15
  v_mfma_f32_16x16x32_bf16 v[132:135], v[56:59], a[48:51], v[132:135]
  s_waitcnt lgkmcnt(4)
  v_mfma_f32_16x16x32_bf16 v[160:163], v[32:35], a[48:51], v[160:163]
  s_and_b32 s81, s81, 0x3fffff
  ds_read_b64_tr_b16 v[48:49], v16 offset:57344
  v_mfma_f32_16x16x32_bf16 v[160:163], v[36:39], a[56:59], v[160:163]
  s_add_u32 s81, s81, s78
  buffer_load_dwordx4 v6, s[12:15], s81 offen offset:0 lds
  v_mfma_f32_16x16x32_bf16 v[168:171], v[36:39], a[60:63], v[168:171]
  ds_read_b64_tr_b16 v[50:51], v16 offset:57856
  v_mfma_f32_16x16x32_bf16 v[168:171], v[32:35], a[52:55], v[168:171]
  v_mfma_f32_16x16x32_bf16 v[176:179], v[32:35], a[176:179], v[176:179]
  s_waitcnt vmcnt(13)
  ds_read_b64_tr_b16 v[52:53], v16 offset:61440
  ds_read_b128 a[64:67], v18 offset:0
  v_mfma_f32_16x16x32_bf16 v[176:179], v[36:39], a[184:187], v[176:179]
  buffer_load_dwordx4 v7, s[12:15], s81 offen offset:1024 lds
  v_mfma_f32_16x16x32_bf16 v[184:187], v[36:39], a[188:191], v[184:187]
  ds_read_b64_tr_b16 v[54:55], v16 offset:61952
  ds_read_b128 a[68:71], v18 offset:2048
  v_add_u32 v16, 0x10000, v16
  v_mfma_f32_16x16x32_bf16 v[184:187], v[32:35], a[180:183], v[184:187]
  s_waitcnt lgkmcnt(6)
  v_mfma_f32_16x16x32_bf16 v[188:191], v[40:43], a[180:183], v[188:191]
  ds_read_b64_tr_b16 v[56:57], v17 offset:57344
  ds_read_b128 a[192:195], v18 offset:4096
  v_mfma_f32_16x16x32_bf16 v[188:191], v[44:47], a[188:191], v[188:191]
  buffer_load_dwordx4 v8, s[12:15], s81 offen offset:2048 lds
  v_mfma_f32_16x16x32_bf16 v[180:183], v[44:47], a[184:187], v[180:183]
  ds_read_b64_tr_b16 v[58:59], v17 offset:57856
  ds_read_b128 a[196:199], v18 offset:6144
  v_mfma_f32_16x16x32_bf16 v[180:183], v[40:43], a[176:179], v[180:183]
  v_mfma_f32_16x16x32_bf16 v[172:175], v[40:43], a[52:55], v[172:175]
  ds_read_b64_tr_b16 v[60:61], v17 offset:61440
  ds_read_b128 a[72:75], v19 offset:0
  v_mfma_f32_16x16x32_bf16 v[172:175], v[44:47], a[60:63], v[172:175]
  s_waitcnt vmcnt(11)
  buffer_load_dwordx4 v9, s[12:15], s81 offen offset:3072 lds
  v_mfma_f32_16x16x32_bf16 v[164:167], v[44:47], a[56:59], v[164:167]
  s_barrier
  ds_read_b64_tr_b16 v[62:63], v17 offset:61952
  ds_read_b128 a[76:79], v19 offset:2048
  v_add_u32 v17, 0x10000, v17
  v_mfma_f32_16x16x32_bf16 v[164:167], v[40:43], a[48:51], v[164:167]
  s_waitcnt lgkmcnt(9)
  v_mfma_f32_16x16x32_bf16 v[192:195], v[48:51], a[48:51], v[192:195]
  s_mov_b32 s7, 1
  s_cmp_lg_u32 s3, 0
  s_cbranch_scc1 L_nosig
  s_atomic_add s7, s[40:41], s71
L_nosig:
  ds_read_b64_tr_b16 v[32:33], v14 offset:0
  ds_read_b128 a[200:203], v19 offset:4096
  v_mfma_f32_16x16x32_bf16 v[192:195], v[52:55], a[56:59], v[192:195]
  v_mfma_f32_16x16x32_bf16 v[200:203], v[52:55], a[60:63], v[200:203]
  ds_read_b64_tr_b16 v[34:35], v14 offset:512
  ds_read_b128 a[204:207], v19 offset:6144
  v_mfma_f32_16x16x32_bf16 v[200:203], v[48:51], a[52:55], v[200:203]
  v_mfma_f32_16x16x32_bf16 v[208:211], v[48:51], a[176:179], v[208:211]
  ds_read_b64_tr_b16 v[36:37], v14 offset:4096
  v_mfma_f32_16x16x32_bf16 v[208:211], v[52:55], a[184:187], v[208:211]
  v_mfma_f32_16x16x32_bf16 v[216:219], v[52:55], a[188:191], v[216:219]
  ds_read_b64_tr_b16 v[38:39], v14 offset:4608
  v_mfma_f32_16x16x32_bf16 v[216:219], v[48:51], a[180:183], v[216:219]
  s_waitcnt lgkmcnt(7)
  v_mfma_f32_16x16x32_bf16 v[220:223], v[56:59], a[180:183], v[220:223]
  ds_read_b64_tr_b16 v[40:41], v15 offset:0
  v_mfma_f32_16x16x32_bf16 v[220:223], v[60:63], a[188:191], v[220:223]
  v_mfma_f32_16x16x32_bf16 v[212:215], v[60:63], a[184:187], v[212:215]
  ds_read_b64_tr_b16 v[42:43], v15 offset:512
  v_mfma_f32_16x16x32_bf16 v[212:215], v[56:59], a[176:179], v[212:215]
  v_mfma_f32_16x16x32_bf16 v[204:207], v[56:59], a[52:55], v[204:207]
  ds_read_b64_tr_b16 v[44:45], v15 offset:4096
  v_mfma_f32_16x16x32_bf16 v[204:207], v[60:63], a[60:63], v[204:207]
  s_add_u32 m0, s74, 0
  v_mfma_f32_16x16x32_bf16 v[196:199], v[60:63], a[56:59], v[196:199]
  s_add_u32 s80, s101, 768
  ds_read_b64_tr_b16 v[46:47], v15 offset:4608
  v_mfma_f32_16x16x32_bf16 v[196:199], v[56:59], a[48:51], v[196:199]
  s_waitcnt lgkmcnt(4)
  v_mfma_f32_16x16x32_bf16 v[96:99], v[32:35], a[64:67], v[96:99]
  s_and_b32 s80, s80, 0x3ff
  ds_read_b64_tr_b16 v[48:49], v16 offset:0
  v_mfma_f32_16x16x32_bf16 v[96:99], v[36:39], a[72:75], v[96:99]
  s_add_u32 s80, s80, s75
  buffer_load_dwordx4 v2, s[8:11], s80 offen offset:0 lds
  v_mfma_f32_16x16x32_bf16 v[104:107], v[36:39], a[76:79], v[104:107]
  ds_read_b64_tr_b16 v[50:51], v16 offset:512
  v_mfma_f32_16x16x32_bf16 v[104:107], v[32:35], a[68:71], v[104:107]
  v_mfma_f32_16x16x32_bf16 v[112:115], v[32:35], a[192:195], v[112:115]
  ds_read_b64_tr_b16 v[52:53], v16 offset:4096
  v_mfma_f32_16x16x32_bf16 v[112:115], v[36:39], a[200:203], v[112:115]
  buffer_load_dwordx4 v3, s[8:11], s80 offen offset:1024 lds
  v_mfma_f32_16x16x32_bf16 v[120:123], v[36:39], a[204:207], v[120:123]
  ds_read_b64_tr_b16 v[54:55], v16 offset:4608
  v_mfma_f32_16x16x32_bf16 v[120:123], v[32:35], a[196:199], v[120:123]
  s_waitcnt lgkmcnt(4)
  v_mfma_f32_16x16x32_bf16 v[124:127], v[40:43], a[196:199], v[124:127]
  ds_read_b64_tr_b16 v[56:57], v17 offset:0
  v_mfma_f32_16x16x32_bf16 v[124:127], v[44:47], a[204:207], v[124:127]
  buffer_load_dwordx4 v4, s[8:11], s80 offen offset:2048 lds
  v_mfma_f32_16x16x32_bf16 v[116:119], v[44:47], a[200:203], v[116:119]
  ds_read_b64_tr_b16 v[58:59], v17 offset:512
  v_mfma_f32_16x16x32_bf16 v[116:119], v[40:43], a[192:195], v[116:119]
  v_mfma_f32_16x16x32_bf16 v[108:111], v[40:43], a[68:71], v[108:111]
  ds_read_b64_tr_b16 v[60:61], v17 offset:4096
  v_mfma_f32_16x16x32_bf16 v[108:111], v[44:47], a[76:79], v[108:111]
  buffer_load_dwordx4 v5, s[8:11], s80 offen offset:3072 lds
  v_mfma_f32_16x16x32_bf16 v[100:103], v[44:47], a[72:75], v[100:103]
  ds_read_b64_tr_b16 v[62:63], v17 offset:4608
  v_mfma_f32_16x16x32_bf16 v[100:103], v[40:43], a[64:67], v[100:103]
  s_waitcnt lgkmcnt(4)
  v_mfma_f32_16x16x32_bf16 v[128:131], v[48:51], a[64:67], v[128:131]
  s_add_u32 m0, s74, 4096
  ds_read_b64_tr_b16 v[32:33], v14 offset:8192
  v_mfma_f32_16x16x32_bf16 v[128:131], v[52:55], a[72:75], v[128:131]
  s_add_u32 s80, s80, 32768
  buffer_load_dwordx4 v2, s[8:11], s80 offen offset:0 lds
  v_mfma_f32_16x16x32_bf16 v[136:139], v[52:55], a[76:79], v[136:139]
  ds_read_b64_tr_b16 v[34:35], v14 offset:8704
  v_mfma_f32_16x16x32_bf16 v[136:139], v[48:51], a[68:71], v[136:139]
  v_mfma_f32_16x16x32_bf16 v[144:147], v[48:51], a[192:195], v[144:147]
  ds_read_b64_tr_b16 v[36:37], v14 offset:12288
  v_mfma_f32_16x16x32_bf16 v[144:147], v[52:55], a[200:203], v[144:147]
  buffer_load_dwordx4 v3, s[8:11], s80 offen offset:1024 lds
  v_mfma_f32_16x16x32_bf16 v[152:155], v[52:55], a[204:207], v[152:155]
  ds_read_b64_tr_b16 v[38:39], v14 offset:12800
  v_mfma_f32_16x16x32_bf16 v[152:155], v[48:51], a[196:199], v[152:155]
  s_waitcnt lgkmcnt(4)
  v_mfma_f32_16x16x32_bf16 v[156:159], v[56:59], a[196:199], v[156:159]
  ds_read_b64_tr_b16 v[40:41], v15 offset:8192
  v_mfma_f32_16x16x32_bf16 v[156:159], v[60:63], a[204:207], v[156:159]
  buffer_load_dwordx4 v4, s[8:11], s80 offen offset:2048 lds
  v_mfma_f32_16x16x32_bf16 v[148:151], v[60:63], a[200:203], v[148:151]
  ds_read_b64_tr_b16 v[42:43], v15 offset:8704
  v_mfma_f32_16x16x32_bf16 v[148:151], v[56:59], a[192:195], v[148:151]
  v_mfma_f32_16x16x32_bf16 v[140:143], v[56:59], a[68:71], v[140:143]
  ds_read_b64_tr_b16 v[44:45], v15 offset:12288
  v_mfma_f32_16x16x32_bf16 v[140:143], v[60:63], a[76:79], v[140:143]
  buffer_load_dwordx4 v5, s[8:11], s80 offen offset:3072 lds
  v_mfma_f32_16x16x32_bf16 v[132:135], v[60:63], a[72:75], v[132:135]
  s_add_u32 m0, s77, 0
  s_add_u32 s81, s100, 3145728
  ds_read_b64_tr_b16 v[46:47], v15 offset:12800
  v_mfma_f32_16x16x32_bf16 v[132:135], v[56:59], a[64:67], v[132:135]
  s_waitcnt lgkmcnt(4)
  v_mfma_f32_16x16x32_bf16 v[160:163], v[32:35], a[64:67], v[160:163]
  s_and_b32 s81, s81, 0x3fffff
  ds_read_b64_tr_b16 v[48:49], v16 offset:8192
  v_mfma_f32_16x16x32_bf16 v[160:163], v[36:39], a[72:75], v[160:163]
  s_add_u32 s81, s81, s78
  buffer_load_dwordx4 v6, s[12:15], s81 offen offset:0 lds
  v_mfma_f32_16x16x32_bf16 v[168:171], v[36:39], a[76:79], v[168:171]
  ds_read_b64_tr_b16 v[50:51], v16 offset:8704
  v_mfma_f32_16x16x32_bf16 v[168:171], v[32:35], a[68:71], v[168:171]
  v_mfma_f32_16x16x32_bf16 v[176:179], v[32:35], a[192:195], v[176:179]
  s_waitcnt vmcnt(13)
  ds_read_b64_tr_b16 v[52:53], v16 offset:12288
  ds_read_b128 a[80:83], v18 offset:32768
  v_mfma_f32_16x16x32_bf16 v[176:179], v[36:39], a[200:203], v[176:179]
  buffer_load_dwordx4 v7, s[12:15], s81 offen offset:1024 lds
  v_mfma_f32_16x16x32_bf16 v[184:187], v[36:39], a[204:207], v[184:187]
  ds_read_b64_tr_b16 v[54:55], v16 offset:12800
  ds_read_b128 a[84:87], v18 offset:34816
  v_mfma_f32_16x16x32_bf16 v[184:187], v[32:35], a[196:199], v[184:187]
  s_waitcnt lgkmcnt(6)
  v_mfma_f32_16x16x32_bf16 v[188:191], v[40:43], a[196:199], v[188:191]
  ds_read_b64_tr_b16 v[56:57], v17 offset:8192
  ds_read_b128 a[208:211], v18 offset:36864
  v_mfma_f32_16x16x32_bf16 v[188:191], v[44:47], a[204:207], v[188:191]
  buffer_load_dwordx4 v8, s[12:15], s81 offen offset:2048 lds
  v_mfma_f32_16x16x32_bf16 v[180:183], v[44:47], a[200:203], v[180:183]
  ds_read_b64_tr_b16 v[58:59], v17 offset:8704
  ds_read_b128 a[212:215], v18 offset:38912
  v_mfma_f32_16x16x32_bf16 v[180:183], v[40:43], a[192:195], v[180:183]
  v_mfma_f32_16x16x32_bf16 v[172:175], v[40:43], a[68:71], v[172:175]
  ds_read_b64_tr_b16 v[60:61], v17 offset:12288
  ds_read_b128 a[88:91], v19 offset:32768
  v_mfma_f32_16x16x32_bf16 v[172:175], v[44:47], a[76:79], v[172:175]
  s_waitcnt vmcnt(11)
  buffer_load_dwordx4 v9, s[12:15], s81 offen offset:3072 lds
  v_mfma_f32_16x16x32_bf16 v[164:167], v[44:47], a[72:75], v[164:167]
  s_barrier
  ds_read_b64_tr_b16 v[62:63], v17 offset:12800
  ds_read_b128 a[92:95], v19 offset:34816
  v_mfma_f32_16x16x32_bf16 v[164:167], v[40:43], a[64:67], v[164:167]
  s_waitcnt lgkmcnt(9)
  v_mfma_f32_16x16x32_bf16 v[192:195], v[48:51], a[64:67], v[192:195]
  ds_read_b64_tr_b16 v[32:33], v14 offset:16384
  ds_read_b128 a[216:219], v19 offset:36864
  v_mfma_f32_16x16x32_bf16 v[192:195], v[52:55], a[72:75], v[192:195]
  v_mfma_f32_16x16x32_bf16 v[200:203], v[52:55], a[76:79], v[200:203]
  ds_read_b64_tr_b16 v[34:35], v14 offset:16896
  ds_read_b128 a[220:223], v19 offset:38912
  v_mfma_f32_16x16x32_bf16 v[200:203], v[48:51], a[68:71], v[200:203]
  v_mfma_f32_16x16x32_bf16 v[208:211], v[48:51], a[192:195], v[208:211]
  ds_read_b64_tr_b16 v[36:37], v14 offset:20480
  v_mfma_f32_16x16x32_bf16 v[208:211], v[52:55], a[200:203], v[208:211]
  v_mfma_f32_16x16x32_bf16 v[216:219], v[52:55], a[204:207], v[216:219]
  ds_read_b64_tr_b16 v[38:39], v14 offset:20992
  v_mfma_f32_16x16x32_bf16 v[216:219], v[48:51], a[196:199], v[216:219]
  s_waitcnt lgkmcnt(7)
  v_mfma_f32_16x16x32_bf16 v[220:223], v[56:59], a[196:199], v[220:223]
  ds_read_b64_tr_b16 v[40:41], v15 offset:16384
  v_mfma_f32_16x16x32_bf16 v[220:223], v[60:63], a[204:207], v[220:223]
  v_mfma_f32_16x16x32_bf16 v[212:215], v[60:63], a[200:203], v[212:215]
  ds_read_b64_tr_b16 v[42:43], v15 offset:16896
  v_mfma_f32_16x16x32_bf16 v[212:215], v[56:59], a[192:195], v[212:215]
  v_mfma_f32_16x16x32_bf16 v[204:207], v[56:59], a[68:71], v[204:207]
  ds_read_b64_tr_b16 v[44:45], v15 offset:20480
  v_mfma_f32_16x16x32_bf16 v[204:207], v[60:63], a[76:79], v[204:207]
  s_add_u32 m0, s74, 32768
  v_mfma_f32_16x16x32_bf16 v[196:199], v[60:63], a[72:75], v[196:199]
  s_add_u32 s80, s101, 896
  ds_read_b64_tr_b16 v[46:47], v15 offset:20992
  v_mfma_f32_16x16x32_bf16 v[196:199], v[56:59], a[64:67], v[196:199]
  s_waitcnt lgkmcnt(4)
  v_mfma_f32_16x16x32_bf16 v[96:99], v[32:35], a[80:83], v[96:99]
  s_and_b32 s80, s80, 0x3ff
  ds_read_b64_tr_b16 v[48:49], v16 offset:16384
  v_mfma_f32_16x16x32_bf16 v[96:99], v[36:39], a[88:91], v[96:99]
  s_add_u32 s80, s80, s75
  buffer_load_dwordx4 v2, s[8:11], s80 offen offset:0 lds
  v_mfma_f32_16x16x32_bf16 v[104:107], v[36:39], a[92:95], v[104:107]
  ds_read_b64_tr_b16 v[50:51], v16 offset:16896
  v_mfma_f32_16x16x32_bf16 v[104:107], v[32:35], a[84:87], v[104:107]
  v_mfma_f32_16x16x32_bf16 v[112:115], v[32:35], a[208:211], v[112:115]
  ds_read_b64_tr_b16 v[52:53], v16 offset:20480
  v_mfma_f32_16x16x32_bf16 v[112:115], v[36:39], a[216:219], v[112:115]
  buffer_load_dwordx4 v3, s[8:11], s80 offen offset:1024 lds
  v_mfma_f32_16x16x32_bf16 v[120:123], v[36:39], a[220:223], v[120:123]
  ds_read_b64_tr_b16 v[54:55], v16 offset:20992
  v_mfma_f32_16x16x32_bf16 v[120:123], v[32:35], a[212:215], v[120:123]
  s_waitcnt lgkmcnt(4)
  v_mfma_f32_16x16x32_bf16 v[124:127], v[40:43], a[212:215], v[124:127]
  ds_read_b64_tr_b16 v[56:57], v17 offset:16384
  v_mfma_f32_16x16x32_bf16 v[124:127], v[44:47], a[220:223], v[124:127]
  buffer_load_dwordx4 v4, s[8:11], s80 offen offset:2048 lds
  v_mfma_f32_16x16x32_bf16 v[116:119], v[44:47], a[216:219], v[116:119]
  ds_read_b64_tr_b16 v[58:59], v17 offset:16896
  v_mfma_f32_16x16x32_bf16 v[116:119], v[40:43], a[208:211], v[116:119]
  v_mfma_f32_16x16x32_bf16 v[108:111], v[40:43], a[84:87], v[108:111]
  ds_read_b64_tr_b16 v[60:61], v17 offset:20480
  v_mfma_f32_16x16x32_bf16 v[108:111], v[44:47], a[92:95], v[108:111]
  buffer_load_dwordx4 v5, s[8:11], s80 offen offset:3072 lds
  v_mfma_f32_16x16x32_bf16 v[100:103], v[44:47], a[88:91], v[100:103]
  ds_read_b64_tr_b16 v[62:63], v17 offset:20992
  v_mfma_f32_16x16x32_bf16 v[100:103], v[40:43], a[80:83], v[100:103]
  s_waitcnt lgkmcnt(4)
  v_mfma_f32_16x16x32_bf16 v[128:131], v[48:51], a[80:83], v[128:131]
  s_add_u32 m0, s74, 36864
  ds_read_b64_tr_b16 v[32:33], v14 offset:24576
  v_mfma_f32_16x16x32_bf16 v[128:131], v[52:55], a[88:91], v[128:131]
  s_add_u32 s80, s80, 32768
  buffer_load_dwordx4 v2, s[8:11], s80 offen offset:0 lds
  v_mfma_f32_16x16x32_bf16 v[136:139], v[52:55], a[92:95], v[136:139]
  ds_read_b64_tr_b16 v[34:35], v14 offset:25088
  v_mfma_f32_16x16x32_bf16 v[136:139], v[48:51], a[84:87], v[136:139]
  v_mfma_f32_16x16x32_bf16 v[144:147], v[48:51], a[208:211], v[144:147]
  ds_read_b64_tr_b16 v[36:37], v14 offset:28672
  v_mfma_f32_16x16x32_bf16 v[144:147], v[52:55], a[216:219], v[144:147]
  buffer_load_dwordx4 v3, s[8:11], s80 offen offset:1024 lds
  v_mfma_f32_16x16x32_bf16 v[152:155], v[52:55], a[220:223], v[152:155]
  ds_read_b64_tr_b16 v[38:39], v14 offset:29184
  v_add_u32 v14, 0xffff0000, v14
  v_mfma_f32_16x16x32_bf16 v[152:155], v[48:51], a[212:215], v[152:155]
  s_waitcnt lgkmcnt(4)
  v_mfma_f32_16x16x32_bf16 v[156:159], v[56:59], a[212:215], v[156:159]
  ds_read_b64_tr_b16 v[40:41], v15 offset:24576
  v_mfma_f32_16x16x32_bf16 v[156:159], v[60:63], a[220:223], v[156:159]
  buffer_load_dwordx4 v4, s[8:11], s80 offen offset:2048 lds
  v_mfma_f32_16x16x32_bf16 v[148:151], v[60:63], a[216:219], v[148:151]
  ds_read_b64_tr_b16 v[42:43], v15 offset:25088
  v_mfma_f32_16x16x32_bf16 v[148:151], v[56:59], a[208:211], v[148:151]
  v_mfma_f32_16x16x32_bf16 v[140:143], v[56:59], a[84:87], v[140:143]
  ds_read_b64_tr_b16 v[44:45], v15 offset:28672
  v_mfma_f32_16x16x32_bf16 v[140:143], v[60:63], a[92:95], v[140:143]
  buffer_load_dwordx4 v5, s[8:11], s80 offen offset:3072 lds
  v_mfma_f32_16x16x32_bf16 v[132:135], v[60:63], a[88:91], v[132:135]
  s_add_u32 m0, s77, 16384
  s_add_u32 s81, s100, 3670016
  ds_read_b64_tr_b16 v[46:47], v15 offset:29184
  v_add_u32 v15, 0xffff0000, v15
  v_mfma_f32_16x16x32_bf16 v[132:135], v[56:59], a[80:83], v[132:135]
  s_waitcnt lgkmcnt(4)
  v_mfma_f32_16x16x32_bf16 v[160:163], v[32:35], a[80:83], v[160:163]
  s_and_b32 s81, s81, 0x3fffff
  ds_read_b64_tr_b16 v[48:49], v16 offset:24576
  v_mfma_f32_16x16x32_bf16 v[160:163], v[36:39], a[88:91], v[160:163]
  s_add_u32 s81, s81, s78
  buffer_load_dwordx4 v6, s[12:15], s81 offen offset:0 lds
  v_mfma_f32_16x16x32_bf16 v[168:171], v[36:39], a[92:95], v[168:171]
  ds_read_b64_tr_b16 v[50:51], v16 offset:25088
  v_mfma_f32_16x16x32_bf16 v[168:171], v[32:35], a[84:87], v[168:171]
  v_mfma_f32_16x16x32_bf16 v[176:179], v[32:35], a[208:211], v[176:179]
  s_waitcnt vmcnt(13)
  ds_read_b64_tr_b16 v[52:53], v16 offset:28672
  ds_read_b128 a[96:99], v18 offset:0
  v_mfma_f32_16x16x32_bf16 v[176:179], v[36:39], a[216:219], v[176:179]
  buffer_load_dwordx4 v7, s[12:15], s81 offen offset:1024 lds
  v_mfma_f32_16x16x32_bf16 v[184:187], v[36:39], a[220:223], v[184:187]
  ds_read_b64_tr_b16 v[54:55], v16 offset:29184
  ds_read_b128 a[100:103], v18 offset:2048
  v_add_u32 v16, 0xffff0000, v16
  v_mfma_f32_16x16x32_bf16 v[184:187], v[32:35], a[212:215], v[184:187]
  s_waitcnt lgkmcnt(6)
  v_mfma_f32_16x16x32_bf16 v[188:191], v[40:43], a[212:215], v[188:191]
  ds_read_b64_tr_b16 v[56:57], v17 offset:24576
  ds_read_b128 a[224:227], v18 offset:4096
  v_mfma_f32_16x16x32_bf16 v[188:191], v[44:47], a[220:223], v[188:191]
  buffer_load_dwordx4 v8, s[12:15], s81 offen offset:2048 lds
  v_mfma_f32_16x16x32_bf16 v[180:183], v[44:47], a[216:219], v[180:183]
  ds_read_b64_tr_b16 v[58:59], v17 offset:25088
  ds_read_b128 a[228:231], v18 offset:6144
  v_mfma_f32_16x16x32_bf16 v[180:183], v[40:43], a[208:211], v[180:183]
  v_mfma_f32_16x16x32_bf16 v[172:175], v[40:43], a[84:87], v[172:175]
  ds_read_b64_tr_b16 v[60:61], v17 offset:28672
  ds_read_b128 a[104:107], v19 offset:0
  v_mfma_f32_16x16x32_bf16 v[172:175], v[44:47], a[92:95], v[172:175]
  s_waitcnt vmcnt(11)
  buffer_load_dwordx4 v9, s[12:15], s81 offen offset:3072 lds
  v_mfma_f32_16x16x32_bf16 v[164:167], v[44:47], a[88:91], v[164:167]
  s_barrier
  ds_read_b64_tr_b16 v[62:63], v17 offset:29184
  ds_read_b128 a[108:111], v19 offset:2048
  v_add_u32 v17, 0xffff0000, v17
  v_mfma_f32_16x16x32_bf16 v[164:167], v[40:43], a[80:83], v[164:167]
  s_waitcnt lgkmcnt(9)
  v_mfma_f32_16x16x32_bf16 v[192:195], v[48:51], a[80:83], v[192:195]
  ds_read_b64_tr_b16 v[32:33], v14 offset:0
  ds_read_b128 a[232:235], v19 offset:4096
  v_mfma_f32_16x16x32_bf16 v[192:195], v[52:55], a[88:91], v[192:195]
  v_mfma_f32_16x16x32_bf16 v[200:203], v[52:55], a[92:95], v[200:203]
  s_add_u32 m0, s77, 32768
  ds_read_b64_tr_b16 v[34:35], v14 offset:512
  ds_read_b128 a[236:239], v19 offset:6144
  v_mfma_f32_16x16x32_bf16 v[200:203], v[48:51], a[84:87], v[200:203]
  s_add_u32 s81, s60, 0
  buffer_load_dwordx4 v6, s[16:19], s81 offen offset:0 lds
  v_mfma_f32_16x16x32_bf16 v[208:211], v[48:51], a[208:211], v[208:211]
  ds_read_b64_tr_b16 v[36:37], v14 offset:4096
  v_mfma_f32_16x16x32_bf16 v[208:211], v[52:55], a[216:219], v[208:211]
  v_mfma_f32_16x16x32_bf16 v[216:219], v[52:55], a[220:223], v[216:219]
  ds_read_b64_tr_b16 v[38:39], v14 offset:4608
  v_mfma_f32_16x16x32_bf16 v[216:219], v[48:51], a[212:215], v[216:219]
  s_waitcnt lgkmcnt(7)
  buffer_load_dwordx4 v7, s[16:19], s81 offen offset:1024 lds
  v_mfma_f32_16x16x32_bf16 v[220:223], v[56:59], a[212:215], v[220:223]
  ds_read_b64_tr_b16 v[40:41], v15 offset:0
  v_mfma_f32_16x16x32_bf16 v[220:223], v[60:63], a[220:223], v[220:223]
  v_mfma_f32_16x16x32_bf16 v[212:215], v[60:63], a[216:219], v[212:215]
  ds_read_b64_tr_b16 v[42:43], v15 offset:512
  v_mfma_f32_16x16x32_bf16 v[212:215], v[56:59], a[208:211], v[212:215]
  buffer_load_dwordx4 v8, s[16:19], s81 offen offset:2048 lds
  v_mfma_f32_16x16x32_bf16 v[204:207], v[56:59], a[84:87], v[204:207]
  ds_read_b64_tr_b16 v[44:45], v15 offset:4096
  v_mfma_f32_16x16x32_bf16 v[204:207], v[60:63], a[92:95], v[204:207]
  v_mfma_f32_16x16x32_bf16 v[196:199], v[60:63], a[88:91], v[196:199]
  ds_read_b64_tr_b16 v[46:47], v15 offset:4608
  v_mfma_f32_16x16x32_bf16 v[196:199], v[56:59], a[80:83], v[196:199]
  s_waitcnt lgkmcnt(4)
  buffer_load_dwordx4 v9, s[16:19], s81 offen offset:3072 lds
  v_mfma_f32_16x16x32_bf16 v[96:99], v[32:35], a[96:99], v[96:99]
  ds_read_b64_tr_b16 v[48:49], v16 offset:0
  v_mfma_f32_16x16x32_bf16 v[96:99], v[36:39], a[104:107], v[96:99]
  v_mfma_f32_16x16x32_bf16 v[104:107], v[36:39], a[108:111], v[104:107]
  s_add_u32 m0, s77, 49152
  ds_read_b64_tr_b16 v[50:51], v16 offset:512
  v_mfma_f32_16x16x32_bf16 v[104:107], v[32:35], a[100:103], v[104:107]
  s_add_u32 s81, s61, 0
  buffer_load_dwordx4 v6, s[16:19], s81 offen offset:0 lds
  v_mfma_f32_16x16x32_bf16 v[112:115], v[32:35], a[224:227], v[112:115]
  ds_read_b64_tr_b16 v[52:53], v16 offset:4096
  v_mfma_f32_16x16x32_bf16 v[112:115], v[36:39], a[232:235], v[112:115]
  v_mfma_f32_16x16x32_bf16 v[120:123], v[36:39], a[236:239], v[120:123]
  ds_read_b64_tr_b16 v[54:55], v16 offset:4608
  v_mfma_f32_16x16x32_bf16 v[120:123], v[32:35], a[228:231], v[120:123]
  s_waitcnt lgkmcnt(4)
  buffer_load_dwordx4 v7, s[16:19], s81 offen offset:1024 lds
  v_mfma_f32_16x16x32_bf16 v[124:127], v[40:43], a[228:231], v[124:127]
  ds_read_b64_tr_b16 v[56:57], v17 offset:0
  v_mfma_f32_16x16x32_bf16 v[124:127], v[44:47], a[236:239], v[124:127]
  v_mfma_f32_16x16x32_bf16 v[116:119], v[44:47], a[232:235], v[116:119]
  ds_read_b64_tr_b16 v[58:59], v17 offset:512
  v_mfma_f32_16x16x32_bf16 v[116:119], v[40:43], a[224:227], v[116:119]
  buffer_load_dwordx4 v8, s[16:19], s81 offen offset:2048 lds
  v_mfma_f32_16x16x32_bf16 v[108:111], v[40:43], a[100:103], v[108:111]
  ds_read_b64_tr_b16 v[60:61], v17 offset:4096
  v_mfma_f32_16x16x32_bf16 v[108:111], v[44:47], a[108:111], v[108:111]
  v_mfma_f32_16x16x32_bf16 v[100:103], v[44:47], a[104:107], v[100:103]
  ds_read_b64_tr_b16 v[62:63], v17 offset:4608
  v_mfma_f32_16x16x32_bf16 v[100:103], v[40:43], a[96:99], v[100:103]
  s_waitcnt lgkmcnt(4)
  buffer_load_dwordx4 v9, s[16:19], s81 offen offset:3072 lds
  v_mfma_f32_16x16x32_bf16 v[128:131], v[48:51], a[96:99], v[128:131]
  ds_read_b64_tr_b16 v[32:33], v14 offset:8192
  v_mfma_f32_16x16x32_bf16 v[128:131], v[52:55], a[104:107], v[128:131]
  v_mfma_f32_16x16x32_bf16 v[136:139], v[52:55], a[108:111], v[136:139]
  s_add_u32 m0, s77, 65536
  ds_read_b64_tr_b16 v[34:35], v14 offset:8704
  v_mfma_f32_16x16x32_bf16 v[136:139], v[48:51], a[100:103], v[136:139]
  s_add_u32 s81, s62, 0
  buffer_load_dwordx4 v6, s[16:19], s81 offen offset:0 lds
  v_mfma_f32_16x16x32_bf16 v[144:147], v[48:51], a[224:227], v[144:147]
  ds_read_b64_tr_b16 v[36:37], v14 offset:12288
  v_mfma_f32_16x16x32_bf16 v[144:147], v[52:55], a[232:235], v[144:147]
  v_mfma_f32_16x16x32_bf16 v[152:155], v[52:55], a[236:239], v[152:155]
  ds_read_b64_tr_b16 v[38:39], v14 offset:12800
  v_mfma_f32_16x16x32_bf16 v[152:155], v[48:51], a[228:231], v[152:155]
  s_waitcnt lgkmcnt(4)
  buffer_load_dwordx4 v7, s[16:19], s81 offen offset:1024 lds
  v_mfma_f32_16x16x32_bf16 v[156:159], v[56:59], a[228:231], v[156:159]
  ds_read_b64_tr_b16 v[40:41], v15 offset:8192
  v_mfma_f32_16x16x32_bf16 v[156:159], v[60:63], a[236:239], v[156:159]
  v_mfma_f32_16x16x32_bf16 v[148:151], v[60:63], a[232:235], v[148:151]
  ds_read_b64_tr_b16 v[42:43], v15 offset:8704
  v_mfma_f32_16x16x32_bf16 v[148:151], v[56:59], a[224:227], v[148:151]
  buffer_load_dwordx4 v8, s[16:19], s81 offen offset:2048 lds
  v_mfma_f32_16x16x32_bf16 v[140:143], v[56:59], a[100:103], v[140:143]
  ds_read_b64_tr_b16 v[44:45], v15 offset:12288
  v_mfma_f32_16x16x32_bf16 v[140:143], v[60:63], a[108:111], v[140:143]
  v_mfma_f32_16x16x32_bf16 v[132:135], v[60:63], a[104:107], v[132:135]
  ds_read_b64_tr_b16 v[46:47], v15 offset:12800
  v_mfma_f32_16x16x32_bf16 v[132:135], v[56:59], a[96:99], v[132:135]
  s_waitcnt lgkmcnt(4)
  buffer_load_dwordx4 v9, s[16:19], s81 offen offset:3072 lds
  v_mfma_f32_16x16x32_bf16 v[160:163], v[32:35], a[96:99], v[160:163]
  ds_read_b64_tr_b16 v[48:49], v16 offset:8192
  v_mfma_f32_16x16x32_bf16 v[160:163], v[36:39], a[104:107], v[160:163]
  v_mfma_f32_16x16x32_bf16 v[168:171], v[36:39], a[108:111], v[168:171]
  ds_read_b64_tr_b16 v[50:51], v16 offset:8704
  v_mfma_f32_16x16x32_bf16 v[168:171], v[32:35], a[100:103], v[168:171]
  v_mfma_f32_16x16x32_bf16 v[176:179], v[32:35], a[224:227], v[176:179]
  s_waitcnt vmcnt(16)
  ds_read_b64_tr_b16 v[52:53], v16 offset:12288
  ds_read_b128 a[112:115], v18 offset:32768
  v_mfma_f32_16x16x32_bf16 v[176:179], v[36:39], a[232:235], v[176:179]
  v_mfma_f32_16x16x32_bf16 v[184:187], v[36:39], a[236:239], v[184:187]
L_pad2:
  s_cbranch_execz L_pad6
  ds_read_b64_tr_b16 v[54:55], v16 offset:12800
  ds_read_b128 a[116:119], v18 offset:34816
  v_mfma_f32_16x16x32_bf16 v[184:187], v[32:35], a[228:231], v[184:187]
  s_waitcnt lgkmcnt(6)
  v_mfma_f32_16x16x32_bf16 v[188:191], v[40:43], a[228:231], v[188:191]
  ds_read_b64_tr_b16 v[56:57], v17 offset:8192
  ds_read_b128 a[240:243], v18 offset:36864
  v_mfma_f32_16x16x32_bf16 v[188:191], v[44:47], a[236:239], v[188:191]
  v_mfma_f32_16x16x32_bf16 v[180:183], v[44:47], a[232:235], v[180:183]
  ds_read_b64_tr_b16 v[58:59], v17 offset:8704
  ds_read_b128 a[244:247], v18 offset:38912
  v_mfma_f32_16x16x32_bf16 v[180:183], v[40:43], a[224:227], v[180:183]
  v_mfma_f32_16x16x32_bf16 v[172:175], v[40:43], a[100:103], v[172:175]
  ds_read_b64_tr_b16 v[60:61], v17 offset:12288
  ds_read_b128 a[120:123], v19 offset:32768
  v_mfma_f32_16x16x32_bf16 v[172:175], v[44:47], a[108:111], v[172:175]
  s_waitcnt vmcnt(12)
  v_mfma_f32_16x16x32_bf16 v[164:167], v[44:47], a[104:107], v[164:167]
  s_barrier
  ds_read_b64_tr_b16 v[62:63], v17 offset:12800
  ds_read_b128 a[124:127], v19 offset:34816
  v_mfma_f32_16x16x32_bf16 v[164:167], v[40:43], a[96:99], v[164:167]
  s_waitcnt lgkmcnt(9)
  v_mfma_f32_16x16x32_bf16 v[192:195], v[48:51], a[96:99], v[192:195]
  ds_read_b64_tr_b16 v[32:33], v14 offset:16384
  ds_read_b128 a[248:251], v19 offset:36864
  v_mfma_f32_16x16x32_bf16 v[192:195], v[52:55], a[104:107], v[192:195]
  v_mfma_f32_16x16x32_bf16 v[200:203], v[52:55], a[108:111], v[200:203]
  s_add_u32 m0, s77, 81920
  ds_read_b64_tr_b16 v[34:35], v14 offset:16896
  ds_read_b128 a[252:255], v19 offset:38912
  v_mfma_f32_16x16x32_bf16 v[200:203], v[48:51], a[100:103], v[200:203]
  s_add_u32 s81, s63, 0
  buffer_load_dwordx4 v6, s[16:19], s81 offen offset:0 lds
  v_mfma_f32_16x16x32_bf16 v[208:211], v[48:51], a[224:227], v[208:211]
  ds_read_b64_tr_b16 v[36:37], v14 offset:20480
  v_mfma_f32_16x16x32_bf16 v[208:211], v[52:55], a[232:235], v[208:211]
  v_mfma_f32_16x16x32_bf16 v[216:219], v[52:55], a[236:239], v[216:219]
  ds_read_b64_tr_b16 v[38:39], v14 offset:20992
  v_mfma_f32_16x16x32_bf16 v[216:219], v[48:51], a[228:231], v[216:219]
  s_waitcnt lgkmcnt(7)
  buffer_load_dwordx4 v7, s[16:19], s81 offen offset:1024 lds
  v_mfma_f32_16x16x32_bf16 v[220:223], v[56:59], a[228:231], v[220:223]
  ds_read_b64_tr_b16 v[40:41], v15 offset:16384
  v_mfma_f32_16x16x32_bf16 v[220:223], v[60:63], a[236:239], v[220:223]
  v_mfma_f32_16x16x32_bf16 v[212:215], v[60:63], a[232:235], v[212:215]
  ds_read_b64_tr_b16 v[42:43], v15 offset:16896
  v_mfma_f32_16x16x32_bf16 v[212:215], v[56:59], a[224:227], v[212:215]
  buffer_load_dwordx4 v8, s[16:19], s81 offen offset:2048 lds
  v_mfma_f32_16x16x32_bf16 v[204:207], v[56:59], a[100:103], v[204:207]
  ds_read_b64_tr_b16 v[44:45], v15 offset:20480
  v_mfma_f32_16x16x32_bf16 v[204:207], v[60:63], a[108:111], v[204:207]
  v_mfma_f32_16x16x32_bf16 v[196:199], v[60:63], a[104:107], v[196:199]
  ds_read_b64_tr_b16 v[46:47], v15 offset:20992
  v_mfma_f32_16x16x32_bf16 v[196:199], v[56:59], a[96:99], v[196:199]
  s_waitcnt lgkmcnt(4)
  buffer_load_dwordx4 v9, s[16:19], s81 offen offset:3072 lds
  v_mfma_f32_16x16x32_bf16 v[96:99], v[32:35], a[112:115], v[96:99]
  ds_read_b64_tr_b16 v[48:49], v16 offset:16384
  v_mfma_f32_16x16x32_bf16 v[96:99], v[36:39], a[120:123], v[96:99]
  v_mfma_f32_16x16x32_bf16 v[104:107], v[36:39], a[124:127], v[104:107]
  s_add_u32 m0, s77, 98304
  ds_read_b64_tr_b16 v[50:51], v16 offset:16896
  v_mfma_f32_16x16x32_bf16 v[104:107], v[32:35], a[116:119], v[104:107]
  s_add_u32 s81, s60, 128
  buffer_load_dwordx4 v6, s[16:19], s81 offen offset:0 lds
  v_mfma_f32_16x16x32_bf16 v[112:115], v[32:35], a[240:243], v[112:115]
  ds_read_b64_tr_b16 v[52:53], v16 offset:20480
  v_mfma_f32_16x16x32_bf16 v[112:115], v[36:39], a[248:251], v[112:115]
  v_mfma_f32_16x16x32_bf16 v[120:123], v[36:39], a[252:255], v[120:123]
  ds_read_b64_tr_b16 v[54:55], v16 offset:20992
  v_mfma_f32_16x16x32_bf16 v[120:123], v[32:35], a[244:247], v[120:123]
  s_waitcnt lgkmcnt(4)
  buffer_load_dwordx4 v7, s[16:19], s81 offen offset:1024 lds
  v_mfma_f32_16x16x32_bf16 v[124:127], v[40:43], a[244:247], v[124:127]
  ds_read_b64_tr_b16 v[56:57], v17 offset:16384
  v_mfma_f32_16x16x32_bf16 v[124:127], v[44:47], a[252:255], v[124:127]
  v_mfma_f32_16x16x32_bf16 v[116:119], v[44:47], a[248:251], v[116:119]
  ds_read_b64_tr_b16 v[58:59], v17 offset:16896
  v_mfma_f32_16x16x32_bf16 v[116:119], v[40:43], a[240:243], v[116:119]
  buffer_load_dwordx4 v8, s[16:19], s81 offen offset:2048 lds
  v_mfma_f32_16x16x32_bf16 v[108:111], v[40:43], a[116:119], v[108:111]
  ds_read_b64_tr_b16 v[60:61], v17 offset:20480
  v_mfma_f32_16x16x32_bf16 v[108:111], v[44:47], a[124:127], v[108:111]
  v_mfma_f32_16x16x32_bf16 v[100:103], v[44:47], a[120:123], v[100:103]
  ds_read_b64_tr_b16 v[62:63], v17 offset:20992
  v_mfma_f32_16x16x32_bf16 v[100:103], v[40:43], a[112:115], v[100:103]
  s_waitcnt lgkmcnt(4)
  buffer_load_dwordx4 v9, s[16:19], s81 offen offset:3072 lds
  v_mfma_f32_16x16x32_bf16 v[128:131], v[48:51], a[112:115], v[128:131]
  ds_read_b64_tr_b16 v[32:33], v14 offset:24576
  v_mfma_f32_16x16x32_bf16 v[128:131], v[52:55], a[120:123], v[128:131]
  v_mfma_f32_16x16x32_bf16 v[136:139], v[52:55], a[124:127], v[136:139]
  s_add_u32 m0, s77, 114688
  ds_read_b64_tr_b16 v[34:35], v14 offset:25088
  v_mfma_f32_16x16x32_bf16 v[136:139], v[48:51], a[116:119], v[136:139]
  s_add_u32 s81, s61, 128
  buffer_load_dwordx4 v6, s[16:19], s81 offen offset:0 lds
  v_mfma_f32_16x16x32_bf16 v[144:147], v[48:51], a[240:243], v[144:147]
  ds_read_b64_tr_b16 v[36:37], v14 offset:28672
  v_mfma_f32_16x16x32_bf16 v[144:147], v[52:55], a[248:251], v[144:147]
  v_mfma_f32_16x16x32_bf16 v[152:155], v[52:55], a[252:255], v[152:155]
  ds_read_b64_tr_b16 v[38:39], v14 offset:29184
  v_mfma_f32_16x16x32_bf16 v[152:155], v[48:51], a[244:247], v[152:155]
  s_waitcnt lgkmcnt(4)
  buffer_load_dwordx4 v7, s[16:19], s81 offen offset:1024 lds
  v_mfma_f32_16x16x32_bf16 v[156:159], v[56:59], a[244:247], v[156:159]
  ds_read_b64_tr_b16 v[40:41], v15 offset:24576
  v_mfma_f32_16x16x32_bf16 v[156:159], v[60:63], a[252:255], v[156:159]
  v_mfma_f32_16x16x32_bf16 v[148:151], v[60:63], a[248:251], v[148:151]
  ds_read_b64_tr_b16 v[42:43], v15 offset:25088
  v_mfma_f32_16x16x32_bf16 v[148:151], v[56:59], a[240:243], v[148:151]
  buffer_load_dwordx4 v8, s[16:19], s81 offen offset:2048 lds
  v_mfma_f32_16x16x32_bf16 v[140:143], v[56:59], a[116:119], v[140:143]
  ds_read_b64_tr_b16 v[44:45], v15 offset:28672
  v_cvt_pk_bf16_f32 v64, v96, v97
  v_mfma_f32_16x16x32_bf16 v[140:143], v[60:63], a[124:127], v[140:143]
  v_cvt_pk_bf16_f32 v65, v98, v99
  v_cvt_pk_bf16_f32 v66, v100, v101
  v_mfma_f32_16x16x32_bf16 v[132:135], v[60:63], a[120:123], v[132:135]
  ds_read_b64_tr_b16 v[46:47], v15 offset:29184
  v_mfma_f32_16x16x32_bf16 v[132:135], v[56:59], a[112:115], v[132:135]
  s_waitcnt lgkmcnt(4)
  buffer_load_dwordx4 v9, s[16:19], s81 offen offset:3072 lds
  v_mfma_f32_16x16x32_bf16 v[160:163], v[32:35], a[112:115], v[160:163]
  ds_read_b64_tr_b16 v[48:49], v16 offset:24576
  v_cvt_pk_bf16_f32 v67, v102, v103
  v_mfma_f32_16x16x32_bf16 v[160:163], v[36:39], a[120:123], v[160:163]
  v_cvt_pk_bf16_f32 v68, v104, v105
  v_mfma_f32_16x16x32_bf16 v[168:171], v[36:39], a[124:127], v[168:171]
  ds_read_b64_tr_b16 v[50:51], v16 offset:25088
  v_cvt_pk_bf16_f32 v69, v106, v107
  v_mfma_f32_16x16x32_bf16 v[168:171], v[32:35], a[116:119], v[168:171]
  v_cvt_pk_bf16_f32 v70, v108, v109
  v_cvt_pk_bf16_f32 v71, v110, v111
  v_mfma_f32_16x16x32_bf16 v[176:179], v[32:35], a[240:243], v[176:179]
  ds_read_b64_tr_b16 v[52:53], v16 offset:28672
  v_mfma_f32_16x16x32_bf16 v[176:179], v[36:39], a[248:251], v[176:179]
  v_cvt_pk_bf16_f32 v72, v112, v113
  v_cvt_pk_bf16_f32 v73, v114, v115
  v_mfma_f32_16x16x32_bf16 v[184:187], v[36:39], a[252:255], v[184:187]
  ds_read_b64_tr_b16 v[54:55], v16 offset:29184
  v_mfma_f32_16x16x32_bf16 v[184:187], v[32:35], a[244:247], v[184:187]
  s_waitcnt lgkmcnt(4)
  v_cvt_pk_bf16_f32 v74, v116, v117
  v_cvt_pk_bf16_f32 v75, v118, v119
  v_mfma_f32_16x16x32_bf16 v[188:191], v[40:43], a[244:247], v[188:191]
  ds_read_b64_tr_b16 v[56:57], v17 offset:24576
  v_cvt_pk_bf16_f32 v76, v120, v121
  v_mfma_f32_16x16x32_bf16 v[188:191], v[44:47], a[252:255], v[188:191]
  v_cvt_pk_bf16_f32 v77, v122, v123
  v_mfma_f32_16x16x32_bf16 v[180:183], v[44:47], a[248:251], v[180:183]
  ds_read_b64_tr_b16 v[58:59], v17 offset:25088
  v_cvt_pk_bf16_f32 v78, v124, v125
  v_mfma_f32_16x16x32_bf16 v[180:183], v[40:43], a[240:243], v[180:183]
  v_cvt_pk_bf16_f32 v79, v126, v127
  v_mfma_f32_16x16x32_bf16 v[172:175], v[40:43], a[116:119], v[172:175]
  ds_read_b64_tr_b16 v[60:61], v17 offset:28672
  v_cvt_pk_bf16_f32 v80, v128, v129
  v_mfma_f32_16x16x32_bf16 v[172:175], v[44:47], a[124:127], v[172:175]
  s_waitcnt vmcnt(20)
  v_cvt_pk_bf16_f32 v81, v130, v131
  v_mfma_f32_16x16x32_bf16 v[164:167], v[44:47], a[120:123], v[164:167]
  s_barrier
  ds_read_b64_tr_b16 v[62:63], v17 offset:29184
  v_mfma_f32_16x16x32_bf16 v[164:167], v[40:43], a[112:115], v[164:167]
  s_waitcnt lgkmcnt(4)
  v_cvt_pk_bf16_f32 v82, v132, v133
  v_cvt_pk_bf16_f32 v83, v134, v135
  v_mfma_f32_16x16x32_bf16 v[192:195], v[48:51], a[112:115], v[192:195]
  ds_read_b64_tr_b16 v[32:33], v14 offset:32768
  v_mfma_f32_16x16x32_bf16 v[192:195], v[52:55], a[120:123], v[192:195]
  v_cvt_pk_bf16_f32 v84, v136, v137
  v_cvt_pk_bf16_f32 v85, v138, v139
  v_mfma_f32_16x16x32_bf16 v[200:203], v[52:55], a[124:127], v[200:203]
  s_add_u32 m0, s77, 0
  ds_read_b64_tr_b16 v[34:35], v14 offset:33280
  v_cvt_pk_bf16_f32 v86, v140, v141
  v_mfma_f32_16x16x32_bf16 v[200:203], v[48:51], a[116:119], v[200:203]
  s_add_u32 s81, s62, 128
  buffer_load_dwordx4 v6, s[16:19], s81 offen offset:0 lds
  v_mfma_f32_16x16x32_bf16 v[208:211], v[48:51], a[240:243], v[208:211]
  ds_read_b64_tr_b16 v[36:37], v14 offset:36864
  v_mfma_f32_16x16x32_bf16 v[208:211], v[52:55], a[248:251], v[208:211]
  v_cvt_pk_bf16_f32 v87, v142, v143
  v_cvt_pk_bf16_f32 v88, v144, v145
  v_mfma_f32_16x16x32_bf16 v[216:219], v[52:55], a[252:255], v[216:219]
  ds_read_b64_tr_b16 v[38:39], v14 offset:37376
  v_mfma_f32_16x16x32_bf16 v[216:219], v[48:51], a[244:247], v[216:219]
  s_waitcnt lgkmcnt(4)
  v_cvt_pk_bf16_f32 v89, v146, v147
  v_cvt_pk_bf16_f32 v90, v148, v149
  v_mfma_f32_16x16x32_bf16 v[220:223], v[56:59], a[244:247], v[220:223]
  ds_read_b64_tr_b16 v[40:41], v15 offset:32768
  v_cvt_pk_bf16_f32 v91, v150, v151
  v_mfma_f32_16x16x32_bf16 v[220:223], v[60:63], a[252:255], v[220:223]
  buffer_load_dwordx4 v7, s[16:19], s81 offen offset:1024 lds
  v_mfma_f32_16x16x32_bf16 v[212:215], v[60:63], a[248:251], v[212:215]
  ds_read_b64_tr_b16 v[42:43], v15 offset:33280
  v_mfma_f32_16x16x32_bf16 v[212:215], v[56:59], a[240:243], v[212:215]
  v_cvt_pk_bf16_f32 v92, v152, v153
  v_cvt_pk_bf16_f32 v93, v154, v155
  v_mfma_f32_16x16x32_bf16 v[204:207], v[56:59], a[116:119], v[204:207]
  ds_read_b64_tr_b16 v[44:45], v15 offset:36864
  v_mfma_f32_16x16x32_bf16 v[204:207], v[60:63], a[124:127], v[204:207]
  v_cvt_pk_bf16_f32 v94, v156, v157
  v_cvt_pk_bf16_f32 v95, v158, v159
  v_mfma_f32_16x16x32_bf16 v[196:199], v[60:63], a[120:123], v[196:199]
  ds_read_b64_tr_b16 v[46:47], v15 offset:37376
  v_mfma_f32_16x16x32_bf16 v[196:199], v[56:59], a[112:115], v[196:199]
  s_waitcnt lgkmcnt(4)
  buffer_load_dwordx4 v8, s[16:19], s81 offen offset:2048 lds
  v_mfma_f32_16x16x32_bf16 v[96:99], a[0:3], v[32:35], 0
  ds_read_b64_tr_b16 v[48:49], v16 offset:32768
  v_mfma_f32_16x16x32_bf16 v[96:99], a[8:11], v[36:39], v[96:99]
  v_mfma_f32_16x16x32_bf16 v[100:103], a[12:15], v[36:39], 0
  ds_read_b64_tr_b16 v[50:51], v16 offset:33280
  v_cvt_pk_bf16_f32 v160, v160, v161
  v_mfma_f32_16x16x32_bf16 v[100:103], a[4:7], v[32:35], v[100:103]
  v_cvt_pk_bf16_f32 v161, v162, v163
  v_cvt_pk_bf16_f32 v162, v164, v165
  v_mfma_f32_16x16x32_bf16 v[128:131], a[128:131], v[32:35], 0
  ds_read_b64_tr_b16 v[52:53], v16 offset:36864
  v_mfma_f32_16x16x32_bf16 v[128:131], a[136:139], v[36:39], v[128:131]
  buffer_load_dwordx4 v9, s[16:19], s81 offen offset:3072 lds
  v_mfma_f32_16x16x32_bf16 v[132:135], a[140:143], v[36:39], 0
  ds_read_b64_tr_b16 v[54:55], v16 offset:37376
  v_cvt_pk_bf16_f32 v163, v166, v167
  v_mfma_f32_16x16x32_bf16 v[132:135], a[132:135], v[32:35], v[132:135]
  s_waitcnt lgkmcnt(4)
  buffer_store_dwordx4 v[64:67], v1, s[28:31], s84 offen offset:0
  v_mfma_f32_16x16x32_bf16 v[140:143], a[132:135], v[40:43], 0
  ds_read_b64_tr_b16 v[56:57], v17 offset:32768
  v_cvt_pk_bf16_f32 v168, v168, v169
  v_mfma_f32_16x16x32_bf16 v[140:143], a[140:143], v[44:47], v[140:143]
  v_cvt_pk_bf16_f32 v169, v170, v171
  v_mfma_f32_16x16x32_bf16 v[136:139], a[136:139], v[44:47], 0
  s_add_u32 m0, s77, 131072
  ds_read_b64_tr_b16 v[58:59], v17 offset:33280
  v_cvt_pk_bf16_f32 v170, v172, v173
  v_mfma_f32_16x16x32_bf16 v[136:139], a[128:131], v[40:43], v[136:139]
  s_add_u32 s81, s63, 128
  buffer_load_dwordx4 v6, s[16:19], s81 offen offset:0 lds
  v_mfma_f32_16x16x32_bf16 v[108:111], a[4:7], v[40:43], 0
  ds_read_b64_tr_b16 v[60:61], v17 offset:36864
  v_cvt_pk_bf16_f32 v171, v174, v175
  v_mfma_f32_16x16x32_bf16 v[108:111], a[12:15], v[44:47], v[108:111]
  v_cvt_pk_bf16_f32 v176, v176, v177
  v_mfma_f32_16x16x32_bf16 v[104:107], a[8:11], v[44:47], 0
  ds_read_b64_tr_b16 v[62:63], v17 offset:37376
  v_cvt_pk_bf16_f32 v177, v178, v179
  v_mfma_f32_16x16x32_bf16 v[104:107], a[0:3], v[40:43], v[104:107]
  s_waitcnt lgkmcnt(4)
  v_cvt_pk_bf16_f32 v178, v180, v181
  v_cvt_pk_bf16_f32 v179, v182, v183
  v_mfma_f32_16x16x32_bf16 v[112:115], a[0:3], v[48:51], 0
  ds_read_b64_tr_b16 v[32:33], v14 offset:40960
  v_mfma_f32_16x16x32_bf16 v[112:115], a[8:11], v[52:55], v[112:115]
  buffer_load_dwordx4 v7, s[16:19], s81 offen offset:1024 lds
  v_mfma_f32_16x16x32_bf16 v[116:119], a[12:15], v[52:55], 0
  ds_read_b64_tr_b16 v[34:35], v14 offset:41472
  v_cvt_pk_bf16_f32 v184, v184, v185
  v_mfma_f32_16x16x32_bf16 v[116:119], a[4:7], v[48:51], v[116:119]
  v_cvt_pk_bf16_f32 v185, v186, v187
  v_cvt_pk_bf16_f32 v186, v188, v189
  v_mfma_f32_16x16x32_bf16 v[144:147], a[128:131], v[48:51], 0
  ds_read_b64_tr_b16 v[36:37], v14 offset:45056
  v_mfma_f32_16x16x32_bf16 v[144:147], a[136:139], v[52:55], v[144:147]
  v_cvt_pk_bf16_f32 v187, v190, v191
  v_cvt_pk_bf16_f32 v192, v192, v193
  v_mfma_f32_16x16x32_bf16 v[148:151], a[140:143], v[52:55], 0
  ds_read_b64_tr_b16 v[38:39], v14 offset:45568
  v_cvt_pk_bf16_f32 v193, v194, v195
  v_mfma_f32_16x16x32_bf16 v[148:151], a[132:135], v[48:51], v[148:151]
  s_waitcnt lgkmcnt(4)
  buffer_load_dwordx4 v8, s[16:19], s81 offen offset:2048 lds
  v_mfma_f32_16x16x32_bf16 v[156:159], a[132:135], v[56:59], 0
  ds_read_b64_tr_b16 v[40:41], v15 offset:40960
  v_mfma_f32_16x16x32_bf16 v[156:159], a[140:143], v[60:63], v[156:159]
  v_cvt_pk_bf16_f32 v194, v196, v197
  v_cvt_pk_bf16_f32 v195, v198, v199
  v_mfma_f32_16x16x32_bf16 v[152:155], a[136:139], v[60:63], 0
  ds_read_b64_tr_b16 v[42:43], v15 offset:41472
  v_cvt_pk_bf16_f32 v200, v200, v201
  v_mfma_f32_16x16x32_bf16 v[152:155], a[128:131], v[56:59], v[152:155]
  buffer_store_dwordx4 v[68:71], v1, s[28:31], s85 offen offset:0
  v_mfma_f32_16x16x32_bf16 v[124:127], a[4:7], v[56:59], 0
  ds_read_b64_tr_b16 v[44:45], v15 offset:45056
  v_mfma_f32_16x16x32_bf16 v[124:127], a[12:15], v[60:63], v[124:127]
  buffer_load_dwordx4 v9, s[16:19], s81 offen offset:3072 lds
  v_mfma_f32_16x16x32_bf16 v[120:123], a[8:11], v[60:63], 0
  ds_read_b64_tr_b16 v[46:47], v15 offset:45568
  v_cvt_pk_bf16_f32 v201, v202, v203
  v_mfma_f32_16x16x32_bf16 v[120:123], a[0:3], v[56:59], v[120:123]
  s_waitcnt lgkmcnt(4)
  v_cvt_pk_bf16_f32 v202, v204, v205
  v_cvt_pk_bf16_f32 v203, v206, v207
  v_mfma_f32_16x16x32_bf16 v[96:99], a[16:19], v[32:35], v[96:99]
  ds_read_b64_tr_b16 v[48:49], v16 offset:40960
  v_mfma_f32_16x16x32_bf16 v[96:99], a[24:27], v[36:39], v[96:99]
  v_cvt_pk_bf16_f32 v208, v208, v209
  v_cvt_pk_bf16_f32 v209, v210, v211
  v_mfma_f32_16x16x32_bf16 v[100:103], a[28:31], v[36:39], v[100:103]
  ds_read_b64_tr_b16 v[50:51], v16 offset:41472
  v_cvt_pk_bf16_f32 v210, v212, v213
  v_mfma_f32_16x16x32_bf16 v[100:103], a[20:23], v[32:35], v[100:103]
  v_cvt_pk_bf16_f32 v211, v214, v215
  v_mfma_f32_16x16x32_bf16 v[128:131], a[144:147], v[32:35], v[128:131]
  ds_read_b64_tr_b16 v[52:53], v16 offset:45056
  v_cvt_pk_bf16_f32 v216, v216, v217
  v_mfma_f32_16x16x32_bf16 v[128:131], a[152:155], v[36:39], v[128:131]
  v_cvt_pk_bf16_f32 v217, v218, v219
  v_mfma_f32_16x16x32_bf16 v[132:135], a[156:159], v[36:39], v[132:135]
  ds_read_b64_tr_b16 v[54:55], v16 offset:45568
  v_cvt_pk_bf16_f32 v218, v220, v221
  v_mfma_f32_16x16x32_bf16 v[132:135], a[148:151], v[32:35], v[132:135]
  s_waitcnt lgkmcnt(4)
  v_cvt_pk_bf16_f32 v219, v222, v223
  v_mfma_f32_16x16x32_bf16 v[140:143], a[148:151], v[40:43], v[140:143]
  ds_read_b64_tr_b16 v[56:57], v17 offset:40960
  v_mfma_f32_16x16x32_bf16 v[140:143], a[156:159], v[44:47], v[140:143]
  v_mfma_f32_16x16x32_bf16 v[136:139], a[152:155], v[44:47], v[136:139]
  ds_read_b64_tr_b16 v[58:59], v17 offset:41472
  v_mfma_f32_16x16x32_bf16 v[136:139], a[144:147], v[40:43], v[136:139]
  v_mfma_f32_16x16x32_bf16 v[108:111], a[20:23], v[40:43], v[108:111]
  ds_read_b64_tr_b16 v[60:61], v17 offset:45056
  v_mfma_f32_16x16x32_bf16 v[108:111], a[28:31], v[44:47], v[108:111]
  s_waitcnt vmcnt(26)
  v_mfma_f32_16x16x32_bf16 v[104:107], a[24:27], v[44:47], v[104:107]
  s_barrier
  ds_read_b64_tr_b16 v[62:63], v17 offset:45568
  v_mfma_f32_16x16x32_bf16 v[104:107], a[16:19], v[40:43], v[104:107]
  s_waitcnt lgkmcnt(4)
  buffer_store_dwordx4 v[160:163], v1, s[28:31], s84 offen offset:2048
  v_mfma_f32_16x16x32_bf16 v[112:115], a[16:19], v[48:51], v[112:115]
  ds_read_b64_tr_b16 v[32:33], v14 offset:49152
  v_mfma_f32_16x16x32_bf16 v[112:115], a[24:27], v[52:55], v[112:115]
  v_mfma_f32_16x16x32_bf16 v[116:119], a[28:31], v[52:55], v[116:119]
  s_add_u32 m0, s77, 147456
  ds_read_b64_tr_b16 v[34:35], v14 offset:49664
  v_mfma_f32_16x16x32_bf16 v[116:119], a[20:23], v[48:51], v[116:119]
  s_mov_b32 s81, s52
  buffer_load_dwordx4 v10, s[20:23], s81 offen offset:0 lds
  v_mfma_f32_16x16x32_bf16 v[144:147], a[144:147], v[48:51], v[144:147]
  ds_read_b64_tr_b16 v[36:37], v14 offset:53248
  v_mfma_f32_16x16x32_bf16 v[144:147], a[152:155], v[52:55], v[144:147]
  v_mfma_f32_16x16x32_bf16 v[148:151], a[156:159], v[52:55], v[148:151]
  ds_read_b64_tr_b16 v[38:39], v14 offset:53760
  v_mfma_f32_16x16x32_bf16 v[148:151], a[148:151], v[48:51], v[148:151]
  s_waitcnt lgkmcnt(4)
  v_mfma_f32_16x16x32_bf16 v[156:159], a[148:151], v[56:59], v[156:159]
  ds_read_b64_tr_b16 v[40:41], v15 offset:49152
  v_mfma_f32_16x16x32_bf16 v[156:159], a[156:159], v[60:63], v[156:159]
  buffer_load_dwordx4 v11, s[20:23], s81 offen offset:1024 lds
  v_mfma_f32_16x16x32_bf16 v[152:155], a[152:155], v[60:63], v[152:155]
  ds_read_b64_tr_b16 v[42:43], v15 offset:49664
  v_mfma_f32_16x16x32_bf16 v[152:155], a[144:147], v[56:59], v[152:155]
  v_mfma_f32_16x16x32_bf16 v[124:127], a[20:23], v[56:59], v[124:127]
  ds_read_b64_tr_b16 v[44:45], v15 offset:53248
  v_mfma_f32_16x16x32_bf16 v[124:127], a[28:31], v[60:63], v[124:127]
  v_mfma_f32_16x16x32_bf16 v[120:123], a[24:27], v[60:63], v[120:123]
  ds_read_b64_tr_b16 v[46:47], v15 offset:53760
  v_mfma_f32_16x16x32_bf16 v[120:123], a[16:19], v[56:59], v[120:123]
  s_waitcnt lgkmcnt(4)
  buffer_load_dwordx4 v12, s[20:23], s81 offen offset:2048 lds
  v_mfma_f32_16x16x32_bf16 v[96:99], a[32:35], v[32:35], v[96:99]
  ds_read_b64_tr_b16 v[48:49], v16 offset:49152
  v_mfma_f32_16x16x32_bf16 v[96:99], a[40:43], v[36:39], v[96:99]
  v_mfma_f32_16x16x32_bf16 v[100:103], a[44:47], v[36:39], v[100:103]
  ds_read_b64_tr_b16 v[50:51], v16 offset:49664
  v_mfma_f32_16x16x32_bf16 v[100:103], a[36:39], v[32:35], v[100:103]
  buffer_store_dwordx4 v[168:171], v1, s[28:31], s85 offen offset:2048
  v_mfma_f32_16x16x32_bf16 v[128:131], a[160:163], v[32:35], v[128:131]
  ds_read_b64_tr_b16 v[52:53], v16 offset:53248
  v_mfma_f32_16x16x32_bf16 v[128:131], a[168:171], v[36:39], v[128:131]
  buffer_load_dwordx4 v13, s[20:23], s81 offen offset:3072 lds
  v_mfma_f32_16x16x32_bf16 v[132:135], a[172:175], v[36:39], v[132:135]
  ds_read_b64_tr_b16 v[54:55], v16 offset:53760
  v_mfma_f32_16x16x32_bf16 v[132:135], a[164:167], v[32:35], v[132:135]
  s_waitcnt lgkmcnt(4)
  v_mfma_f32_16x16x32_bf16 v[140:143], a[164:167], v[40:43], v[140:143]
  ds_read_b64_tr_b16 v[56:57], v17 offset:49152
  v_mfma_f32_16x16x32_bf16 v[140:143], a[172:175], v[44:47], v[140:143]
  v_mfma_f32_16x16x32_bf16 v[136:139], a[168:171], v[44:47], v[136:139]
  s_add_u32 m0, s77, 16384
  ds_read_b64_tr_b16 v[58:59], v17 offset:49664
  v_mfma_f32_16x16x32_bf16 v[136:139], a[160:163], v[40:43], v[136:139]
  s_mov_b32 s81, s53
  buffer_load_dwordx4 v10, s[20:23], s81 offen offset:0 lds
  v_mfma_f32_16x16x32_bf16 v[108:111], a[36:39], v[40:43], v[108:111]
  ds_read_b64_tr_b16 v[60:61], v17 offset:53248
  v_mfma_f32_16x16x32_bf16 v[108:111], a[44:47], v[44:47], v[108:111]
  v_mfma_f32_16x16x32_bf16 v[104:107], a[40:43], v[44:47], v[104:107]
  ds_read_b64_tr_b16 v[62:63], v17 offset:53760
  v_mfma_f32_16x16x32_bf16 v[104:107], a[32:35], v[40:43], v[104:107]
  s_waitcnt lgkmcnt(4)
  v_mfma_f32_16x16x32_bf16 v[112:115], a[32:35], v[48:51], v[112:115]
  ds_read_b64_tr_b16 v[32:33], v14 offset:57344
  v_mfma_f32_16x16x32_bf16 v[112:115], a[40:43], v[52:55], v[112:115]
  buffer_load_dwordx4 v11, s[20:23], s81 offen offset:1024 lds
  v_mfma_f32_16x16x32_bf16 v[116:119], a[44:47], v[52:55], v[116:119]
  ds_read_b64_tr_b16 v[34:35], v14 offset:57856
  v_mfma_f32_16x16x32_bf16 v[116:119], a[36:39], v[48:51], v[116:119]
  v_mfma_f32_16x16x32_bf16 v[144:147], a[160:163], v[48:51], v[144:147]
  ds_read_b64_tr_b16 v[36:37], v14 offset:61440
  v_mfma_f32_16x16x32_bf16 v[144:147], a[168:171], v[52:55], v[144:147]
  v_mfma_f32_16x16x32_bf16 v[148:151], a[172:175], v[52:55], v[148:151]
  ds_read_b64_tr_b16 v[38:39], v14 offset:61952
  v_add_u32 v14, 0x10000, v14
  v_mfma_f32_16x16x32_bf16 v[148:151], a[164:167], v[48:51], v[148:151]
  s_waitcnt lgkmcnt(4)
  buffer_load_dwordx4 v12, s[20:23], s81 offen offset:2048 lds
  v_mfma_f32_16x16x32_bf16 v[156:159], a[164:167], v[56:59], v[156:159]
  ds_read_b64_tr_b16 v[40:41], v15 offset:57344
  v_mfma_f32_16x16x32_bf16 v[156:159], a[172:175], v[60:63], v[156:159]
  buffer_store_dwordx4 v[176:179], v1, s[28:31], s88 offen offset:2048
  v_mfma_f32_16x16x32_bf16 v[152:155], a[168:171], v[60:63], v[152:155]
  ds_read_b64_tr_b16 v[42:43], v15 offset:57856
  v_mfma_f32_16x16x32_bf16 v[152:155], a[160:163], v[56:59], v[152:155]
  v_mfma_f32_16x16x32_bf16 v[124:127], a[36:39], v[56:59], v[124:127]
  ds_read_b64_tr_b16 v[44:45], v15 offset:61440
  v_mfma_f32_16x16x32_bf16 v[124:127], a[44:47], v[60:63], v[124:127]
  buffer_load_dwordx4 v13, s[20:23], s81 offen offset:3072 lds
  v_mfma_f32_16x16x32_bf16 v[120:123], a[40:43], v[60:63], v[120:123]
  ds_read_b64_tr_b16 v[46:47], v15 offset:61952
  v_add_u32 v15, 0x10000, v15
  v_mfma_f32_16x16x32_bf16 v[120:123], a[32:35], v[56:59], v[120:123]
  s_waitcnt lgkmcnt(4)
  v_mfma_f32_16x16x32_bf16 v[96:99], a[48:51], v[32:35], v[96:99]
  ds_read_b64_tr_b16 v[48:49], v16 offset:57344
  v_mfma_f32_16x16x32_bf16 v[96:99], a[56:59], v[36:39], v[96:99]
  v_mfma_f32_16x16x32_bf16 v[100:103], a[60:63], v[36:39], v[100:103]
  ds_read_b64_tr_b16 v[50:51], v16 offset:57856
  v_mfma_f32_16x16x32_bf16 v[100:103], a[52:55], v[32:35], v[100:103]
  v_mfma_f32_16x16x32_bf16 v[128:131], a[176:179], v[32:35], v[128:131]
  ds_read_b64_tr_b16 v[52:53], v16 offset:61440
  v_mfma_f32_16x16x32_bf16 v[128:131], a[184:187], v[36:39], v[128:131]
  v_mfma_f32_16x16x32_bf16 v[132:135], a[188:191], v[36:39], v[132:135]
  ds_read_b64_tr_b16 v[54:55], v16 offset:61952
  v_add_u32 v16, 0x10000, v16
  v_mfma_f32_16x16x32_bf16 v[132:135], a[180:183], v[32:35], v[132:135]
  s_waitcnt lgkmcnt(4)
  v_mfma_f32_16x16x32_bf16 v[140:143], a[180:183], v[40:43], v[140:143]
  ds_read_b64_tr_b16 v[56:57], v17 offset:57344
  v_mfma_f32_16x16x32_bf16 v[140:143], a[188:191], v[44:47], v[140:143]
  v_mfma_f32_16x16x32_bf16 v[136:139], a[184:187], v[44:47], v[136:139]
  ds_read_b64_tr_b16 v[58:59], v17 offset:57856
  v_mfma_f32_16x16x32_bf16 v[136:139], a[176:179], v[40:43], v[136:139]
  buffer_store_dwordx4 v[184:187], v1, s[28:31], s89 offen offset:2048
  v_mfma_f32_16x16x32_bf16 v[108:111], a[52:55], v[40:43], v[108:111]
  ds_read_b64_tr_b16 v[60:61], v17 offset:61440
  v_mfma_f32_16x16x32_bf16 v[108:111], a[60:63], v[44:47], v[108:111]
  s_waitcnt vmcnt(34)
  v_mfma_f32_16x16x32_bf16 v[104:107], a[56:59], v[44:47], v[104:107]
  s_barrier
  ds_read_b64_tr_b16 v[62:63], v17 offset:61952
  v_add_u32 v17, 0x10000, v17
  v_mfma_f32_16x16x32_bf16 v[104:107], a[48:51], v[40:43], v[104:107]
  s_waitcnt lgkmcnt(4)
  v_mfma_f32_16x16x32_bf16 v[112:115], a[48:51], v[48:51], v[112:115]
  ds_read_b64_tr_b16 v[32:33], v14 offset:0
  v_mfma_f32_16x16x32_bf16 v[112:115], a[56:59], v[52:55], v[112:115]
  v_mfma_f32_16x16x32_bf16 v[116:119], a[60:63], v[52:55], v[116:119]
  s_add_u32 m0, s77, 32768
  ds_read_b64_tr_b16 v[34:35], v14 offset:512
  v_mfma_f32_16x16x32_bf16 v[116:119], a[52:55], v[48:51], v[116:119]
  s_mov_b32 s81, s54
  buffer_load_dwordx4 v10, s[20:23], s81 offen offset:0 lds
  v_mfma_f32_16x16x32_bf16 v[144:147], a[176:179], v[48:51], v[144:147]
  ds_read_b64_tr_b16 v[36:37], v14 offset:4096
  v_mfma_f32_16x16x32_bf16 v[144:147], a[184:187], v[52:55], v[144:147]
  v_mfma_f32_16x16x32_bf16 v[148:151], a[188:191], v[52:55], v[148:151]
  ds_read_b64_tr_b16 v[38:39], v14 offset:4608
  v_mfma_f32_16x16x32_bf16 v[148:151], a[180:183], v[48:51], v[148:151]
  s_waitcnt lgkmcnt(4)
  v_mfma_f32_16x16x32_bf16 v[156:159], a[180:183], v[56:59], v[156:159]
  ds_read_b64_tr_b16 v[40:41], v15 offset:0
  v_mfma_f32_16x16x32_bf16 v[156:159], a[188:191], v[60:63], v[156:159]
  buffer_load_dwordx4 v11, s[20:23], s81 offen offset:1024 lds
  v_mfma_f32_16x16x32_bf16 v[152:155], a[184:187], v[60:63], v[152:155]
  ds_read_b64_tr_b16 v[42:43], v15 offset:512
  v_mfma_f32_16x16x32_bf16 v[152:155], a[176:179], v[56:59], v[152:155]
  v_mfma_f32_16x16x32_bf16 v[124:127], a[52:55], v[56:59], v[124:127]
  ds_read_b64_tr_b16 v[44:45], v15 offset:4096
  v_mfma_f32_16x16x32_bf16 v[124:127], a[60:63], v[60:63], v[124:127]
  v_mfma_f32_16x16x32_bf16 v[120:123], a[56:59], v[60:63], v[120:123]
  ds_read_b64_tr_b16 v[46:47], v15 offset:4608
  v_mfma_f32_16x16x32_bf16 v[120:123], a[48:51], v[56:59], v[120:123]
  s_waitcnt lgkmcnt(4)
  buffer_load_dwordx4 v12, s[20:23], s81 offen offset:2048 lds
  v_mfma_f32_16x16x32_bf16 v[96:99], a[64:67], v[32:35], v[96:99]
  ds_read_b64_tr_b16 v[48:49], v16 offset:0
  v_mfma_f32_16x16x32_bf16 v[96:99], a[72:75], v[36:39], v[96:99]
  buffer_store_dwordx4 v[192:195], v1, s[28:31], s84 offen offset:3072
  v_mfma_f32_16x16x32_bf16 v[100:103], a[76:79], v[36:39], v[100:103]
  ds_read_b64_tr_b16 v[50:51], v16 offset:512
  v_mfma_f32_16x16x32_bf16 v[100:103], a[68:71], v[32:35], v[100:103]
  v_mfma_f32_16x16x32_bf16 v[128:131], a[192:195], v[32:35], v[128:131]
  ds_read_b64_tr_b16 v[52:53], v16 offset:4096
  v_mfma_f32_16x16x32_bf16 v[128:131], a[200:203], v[36:39], v[128:131]
  buffer_load_dwordx4 v13, s[20:23], s81 offen offset:3072 lds
  v_mfma_f32_16x16x32_bf16 v[132:135], a[204:207], v[36:39], v[132:135]
  ds_read_b64_tr_b16 v[54:55], v16 offset:4608
  v_mfma_f32_16x16x32_bf16 v[132:135], a[196:199], v[32:35], v[132:135]
  s_waitcnt lgkmcnt(4)
  v_mfma_f32_16x16x32_bf16 v[140:143], a[196:199], v[40:43], v[140:143]
  ds_read_b64_tr_b16 v[56:57], v17 offset:0
  v_mfma_f32_16x16x32_bf16 v[140:143], a[204:207], v[44:47], v[140:143]
  v_mfma_f32_16x16x32_bf16 v[136:139], a[200:203], v[44:47], v[136:139]
  ds_read_b64_tr_b16 v[58:59], v17 offset:512
  v_mfma_f32_16x16x32_bf16 v[136:139], a[192:195], v[40:43], v[136:139]
  v_mfma_f32_16x16x32_bf16 v[108:111], a[68:71], v[40:43], v[108:111]
  ds_read_b64_tr_b16 v[60:61], v17 offset:4096
  v_mfma_f32_16x16x32_bf16 v[108:111], a[76:79], v[44:47], v[108:111]
  v_mfma_f32_16x16x32_bf16 v[104:107], a[72:75], v[44:47], v[104:107]
  ds_read_b64_tr_b16 v[62:63], v17 offset:4608
  v_mfma_f32_16x16x32_bf16 v[104:107], a[64:67], v[40:43], v[104:107]
  s_waitcnt lgkmcnt(4)
  v_mfma_f32_16x16x32_bf16 v[112:115], a[64:67], v[48:51], v[112:115]
  ds_read_b64_tr_b16 v[32:33], v14 offset:8192
  v_mfma_f32_16x16x32_bf16 v[112:115], a[72:75], v[52:55], v[112:115]
  v_mfma_f32_16x16x32_bf16 v[116:119], a[76:79], v[52:55], v[116:119]
  ds_read_b64_tr_b16 v[34:35], v14 offset:8704
  v_mfma_f32_16x16x32_bf16 v[116:119], a[68:71], v[48:51], v[116:119]
  buffer_store_dwordx4 v[200:203], v1, s[28:31], s85 offen offset:3072
  v_mfma_f32_16x16x32_bf16 v[144:147], a[192:195], v[48:51], v[144:147]
  ds_read_b64_tr_b16 v[36:37], v14 offset:12288
  v_mfma_f32_16x16x32_bf16 v[144:147], a[200:203], v[52:55], v[144:147]
  v_mfma_f32_16x16x32_bf16 v[148:151], a[204:207], v[52:55], v[148:151]
  ds_read_b64_tr_b16 v[38:39], v14 offset:12800
  v_mfma_f32_16x16x32_bf16 v[148:151], a[196:199], v[48:51], v[148:151]
  s_waitcnt lgkmcnt(4)
  v_mfma_f32_16x16x32_bf16 v[156:159], a[196:199], v[56:59], v[156:159]
  ds_read_b64_tr_b16 v[40:41], v15 offset:8192
  v_mfma_f32_16x16x32_bf16 v[156:159], a[204:207], v[60:63], v[156:159]
L_pad3:
  s_cbranch_execz L_pad7
  v_mfma_f32_16x16x32_bf16 v[152:155], a[200:203], v[60:63], v[152:155]
  ds_read_b64_tr_b16 v[42:43], v15 offset:8704
  v_mfma_f32_16x16x32_bf16 v[152:155], a[192:195], v[56:59], v[152:155]
  v_mfma_f32_16x16x32_bf16 v[124:127], a[68:71], v[56:59], v[124:127]
  ds_read_b64_tr_b16 v[44:45], v15 offset:12288
  v_mfma_f32_16x16x32_bf16 v[124:127], a[76:79], v[60:63], v[124:127]
  v_mfma_f32_16x16x32_bf16 v[120:123], a[72:75], v[60:63], v[120:123]
  ds_read_b64_tr_b16 v[46:47], v15 offset:12800
  v_mfma_f32_16x16x32_bf16 v[120:123], a[64:67], v[56:59], v[120:123]
  s_waitcnt lgkmcnt(4)
  v_mfma_f32_16x16x32_bf16 v[96:99], a[80:83], v[32:35], v[96:99]
  ds_read_b64_tr_b16 v[48:49], v16 offset:8192
  v_mfma_f32_16x16x32_bf16 v[96:99], a[88:91], v[36:39], v[96:99]
  v_mfma_f32_16x16x32_bf16 v[100:103], a[92:95], v[36:39], v[100:103]
  ds_read_b64_tr_b16 v[50:51], v16 offset:8704
  v_mfma_f32_16x16x32_bf16 v[100:103], a[84:87], v[32:35], v[100:103]
  v_mfma_f32_16x16x32_bf16 v[128:131], a[208:211], v[32:35], v[128:131]
  ds_read_b64_tr_b16 v[52:53], v16 offset:12288
  v_lshrrev_b32 v20, 4, v0
  v_mfma_f32_16x16x32_bf16 v[128:131], a[216:219], v[36:39], v[128:131]
  v_lshlrev_b32 v20, 3, v20
  v_mfma_f32_16x16x32_bf16 v[132:135], a[220:223], v[36:39], v[132:135]
  ds_read_b64_tr_b16 v[54:55], v16 offset:12800
  v_mfma_f32_16x16x32_bf16 v[132:135], a[212:215], v[32:35], v[132:135]
  s_waitcnt lgkmcnt(4)
  buffer_store_dwordx4 v[208:211], v1, s[28:31], s88 offen offset:3072
  v_mfma_f32_16x16x32_bf16 v[140:143], a[212:215], v[40:43], v[140:143]
  ds_read_b64_tr_b16 v[56:57], v17 offset:8192
  v_mfma_f32_16x16x32_bf16 v[140:143], a[220:223], v[44:47], v[140:143]
  v_mfma_f32_16x16x32_bf16 v[136:139], a[216:219], v[44:47], v[136:139]
  ds_read_b64_tr_b16 v[58:59], v17 offset:8704
  v_mfma_f32_16x16x32_bf16 v[136:139], a[208:211], v[40:43], v[136:139]
  v_mfma_f32_16x16x32_bf16 v[108:111], a[84:87], v[40:43], v[108:111]
  ds_read_b64_tr_b16 v[60:61], v17 offset:12288
  v_mfma_f32_16x16x32_bf16 v[108:111], a[92:95], v[44:47], v[108:111]
  s_waitcnt vmcnt(37)
  buffer_load_dwordx2 v[226:227], v20, s[36:39], s83 offen offset:0
  v_mfma_f32_16x16x32_bf16 v[104:107], a[88:91], v[44:47], v[104:107]
  s_barrier
  ds_read_b64_tr_b16 v[62:63], v17 offset:12800
  v_mfma_f32_16x16x32_bf16 v[104:107], a[80:83], v[40:43], v[104:107]
  s_waitcnt lgkmcnt(4)
  v_mfma_f32_16x16x32_bf16 v[112:115], a[80:83], v[48:51], v[112:115]
  ds_read_b64_tr_b16 v[32:33], v14 offset:16384
  v_mfma_f32_16x16x32_bf16 v[112:115], a[88:91], v[52:55], v[112:115]
  v_mfma_f32_16x16x32_bf16 v[116:119], a[92:95], v[52:55], v[116:119]
  s_add_u32 m0, s77, 49152
  ds_read_b64_tr_b16 v[34:35], v14 offset:16896
  v_mfma_f32_16x16x32_bf16 v[116:119], a[84:87], v[48:51], v[116:119]
  s_mov_b32 s81, s55
  buffer_load_dwordx4 v10, s[20:23], s81 offen offset:0 lds
  v_mfma_f32_16x16x32_bf16 v[144:147], a[208:211], v[48:51], v[144:147]
  ds_read_b64_tr_b16 v[36:37], v14 offset:20480
  v_mfma_f32_16x16x32_bf16 v[144:147], a[216:219], v[52:55], v[144:147]
  buffer_load_dwordx2 v[230:231], v20, s[36:39], s83 offen offset:32
  v_mfma_f32_16x16x32_bf16 v[148:151], a[220:223], v[52:55], v[148:151]
  ds_read_b64_tr_b16 v[38:39], v14 offset:20992
  v_mfma_f32_16x16x32_bf16 v[148:151], a[212:215], v[48:51], v[148:151]
  s_waitcnt lgkmcnt(4)
  v_mfma_f32_16x16x32_bf16 v[156:159], a[212:215], v[56:59], v[156:159]
  ds_read_b64_tr_b16 v[40:41], v15 offset:16384
  v_mfma_f32_16x16x32_bf16 v[156:159], a[220:223], v[60:63], v[156:159]
  buffer_load_dwordx4 v11, s[20:23], s81 offen offset:1024 lds
  v_mfma_f32_16x16x32_bf16 v[152:155], a[216:219], v[60:63], v[152:155]
  ds_read_b64_tr_b16 v[42:43], v15 offset:16896
  v_mfma_f32_16x16x32_bf16 v[152:155], a[208:211], v[56:59], v[152:155]
  buffer_store_dwordx4 v[216:219], v1, s[28:31], s89 offen offset:3072
  v_mfma_f32_16x16x32_bf16 v[124:127], a[84:87], v[56:59], v[124:127]
  ds_read_b64_tr_b16 v[44:45], v15 offset:20480
  v_mfma_f32_16x16x32_bf16 v[124:127], a[92:95], v[60:63], v[124:127]
  buffer_load_dwordx2 v[234:235], v20, s[36:39], s83 offen offset:64
  v_mfma_f32_16x16x32_bf16 v[120:123], a[88:91], v[60:63], v[120:123]
  ds_read_b64_tr_b16 v[46:47], v15 offset:20992
  v_mfma_f32_16x16x32_bf16 v[120:123], a[80:83], v[56:59], v[120:123]
  s_waitcnt lgkmcnt(4)
  buffer_load_dwordx4 v12, s[20:23], s81 offen offset:2048 lds
  v_mfma_f32_16x16x32_bf16 v[96:99], a[96:99], v[32:35], v[96:99]
  ds_read_b64_tr_b16 v[48:49], v16 offset:16384
  v_mfma_f32_16x16x32_bf16 v[96:99], a[104:107], v[36:39], v[96:99]
  buffer_load_dwordx2 v[238:239], v20, s[36:39], s83 offen offset:96
  v_mfma_f32_16x16x32_bf16 v[100:103], a[108:111], v[36:39], v[100:103]
  ds_read_b64_tr_b16 v[50:51], v16 offset:16896
  v_mfma_f32_16x16x32_bf16 v[100:103], a[100:103], v[32:35], v[100:103]
  v_mfma_f32_16x16x32_bf16 v[128:131], a[224:227], v[32:35], v[128:131]
  ds_read_b64_tr_b16 v[52:53], v16 offset:20480
  v_mfma_f32_16x16x32_bf16 v[128:131], a[232:235], v[36:39], v[128:131]
  buffer_load_dwordx4 v13, s[20:23], s81 offen offset:3072 lds
  v_mfma_f32_16x16x32_bf16 v[132:135], a[236:239], v[36:39], v[132:135]
  ds_read_b64_tr_b16 v[54:55], v16 offset:20992
  v_mfma_f32_16x16x32_bf16 v[132:135], a[228:231], v[32:35], v[132:135]
  s_waitcnt lgkmcnt(4)
  v_mfma_f32_16x16x32_bf16 v[140:143], a[228:231], v[40:43], v[140:143]
  ds_read_b64_tr_b16 v[56:57], v17 offset:16384
  v_mfma_f32_16x16x32_bf16 v[140:143], a[236:239], v[44:47], v[140:143]
  v_mfma_f32_16x16x32_bf16 v[136:139], a[232:235], v[44:47], v[136:139]
  ds_read_b64_tr_b16 v[58:59], v17 offset:16896
  v_mfma_f32_16x16x32_bf16 v[136:139], a[224:227], v[40:43], v[136:139]
  v_mfma_f32_16x16x32_bf16 v[108:111], a[100:103], v[40:43], v[108:111]
  ds_read_b64_tr_b16 v[60:61], v17 offset:20480
  v_mfma_f32_16x16x32_bf16 v[108:111], a[108:111], v[44:47], v[108:111]
  v_mfma_f32_16x16x32_bf16 v[104:107], a[104:107], v[44:47], v[104:107]
  ds_read_b64_tr_b16 v[62:63], v17 offset:20992
  v_mfma_f32_16x16x32_bf16 v[104:107], a[96:99], v[40:43], v[104:107]
  s_waitcnt lgkmcnt(4)
  buffer_store_dwordx4 v[72:75], v1, s[28:31], s88 offen offset:0
  v_mfma_f32_16x16x32_bf16 v[112:115], a[96:99], v[48:51], v[112:115]
  ds_read_b64_tr_b16 v[32:33], v14 offset:24576
  v_mfma_f32_16x16x32_bf16 v[112:115], a[104:107], v[52:55], v[112:115]
  v_mfma_f32_16x16x32_bf16 v[116:119], a[108:111], v[52:55], v[116:119]
  ds_read_b64_tr_b16 v[34:35], v14 offset:25088
  v_mfma_f32_16x16x32_bf16 v[116:119], a[100:103], v[48:51], v[116:119]
  v_mfma_f32_16x16x32_bf16 v[144:147], a[224:227], v[48:51], v[144:147]
  ds_read_b64_tr_b16 v[36:37], v14 offset:28672
  v_mfma_f32_16x16x32_bf16 v[144:147], a[232:235], v[52:55], v[144:147]
  v_mfma_f32_16x16x32_bf16 v[148:151], a[236:239], v[52:55], v[148:151]
  ds_read_b64_tr_b16 v[38:39], v14 offset:29184
  v_mfma_f32_16x16x32_bf16 v[148:151], a[228:231], v[48:51], v[148:151]
  s_waitcnt lgkmcnt(4)
  v_mfma_f32_16x16x32_bf16 v[156:159], a[228:231], v[56:59], v[156:159]
  ds_read_b64_tr_b16 v[40:41], v15 offset:24576
  v_mfma_f32_16x16x32_bf16 v[156:159], a[236:239], v[60:63], v[156:159]
  v_mfma_f32_16x16x32_bf16 v[152:155], a[232:235], v[60:63], v[152:155]
  ds_read_b64_tr_b16 v[42:43], v15 offset:25088
  v_mfma_f32_16x16x32_bf16 v[152:155], a[224:227], v[56:59], v[152:155]
  v_mfma_f32_16x16x32_bf16 v[124:127], a[100:103], v[56:59], v[124:127]
  ds_read_b64_tr_b16 v[44:45], v15 offset:28672
  v_mfma_f32_16x16x32_bf16 v[124:127], a[108:111], v[60:63], v[124:127]
  v_mfma_f32_16x16x32_bf16 v[120:123], a[104:107], v[60:63], v[120:123]
  ds_read_b64_tr_b16 v[46:47], v15 offset:29184
  v_mfma_f32_16x16x32_bf16 v[120:123], a[96:99], v[56:59], v[120:123]
  s_waitcnt lgkmcnt(4)
  v_mfma_f32_16x16x32_bf16 v[96:99], a[112:115], v[32:35], v[96:99]
  ds_read_b64_tr_b16 v[48:49], v16 offset:24576
  v_mfma_f32_16x16x32_bf16 v[96:99], a[120:123], v[36:39], v[96:99]
  v_mfma_f32_16x16x32_bf16 v[100:103], a[124:127], v[36:39], v[100:103]
  ds_read_b64_tr_b16 v[50:51], v16 offset:25088
  v_mfma_f32_16x16x32_bf16 v[100:103], a[116:119], v[32:35], v[100:103]
  buffer_store_dwordx4 v[76:79], v1, s[28:31], s89 offen offset:0
  v_mfma_f32_16x16x32_bf16 v[128:131], a[240:243], v[32:35], v[128:131]
  ds_read_b64_tr_b16 v[52:53], v16 offset:28672
  v_mfma_f32_16x16x32_bf16 v[128:131], a[248:251], v[36:39], v[128:131]
  v_mfma_f32_16x16x32_bf16 v[132:135], a[252:255], v[36:39], v[132:135]
  ds_read_b64_tr_b16 v[54:55], v16 offset:29184
  v_mfma_f32_16x16x32_bf16 v[132:135], a[244:247], v[32:35], v[132:135]
  s_waitcnt lgkmcnt(4)
  v_mfma_f32_16x16x32_bf16 v[140:143], a[244:247], v[40:43], v[140:143]
  ds_read_b64_tr_b16 v[56:57], v17 offset:24576
  v_mfma_f32_16x16x32_bf16 v[140:143], a[252:255], v[44:47], v[140:143]
  buffer_load_dword v29, v26, s[40:43], 0 offen sc1
  v_mfma_f32_16x16x32_bf16 v[136:139], a[248:251], v[44:47], v[136:139]
  ds_read_b64_tr_b16 v[58:59], v17 offset:25088
  v_mfma_f32_16x16x32_bf16 v[136:139], a[240:243], v[40:43], v[136:139]
  v_mfma_f32_16x16x32_bf16 v[108:111], a[116:119], v[40:43], v[108:111]
  ds_read_b64_tr_b16 v[60:61], v17 offset:28672
  v_mfma_f32_16x16x32_bf16 v[108:111], a[124:127], v[44:47], v[108:111]
  s_waitcnt vmcnt(45)
  v_mfma_f32_16x16x32_bf16 v[104:107], a[120:123], v[44:47], v[104:107]
  s_barrier
  ds_read_b64_tr_b16 v[62:63], v17 offset:29184
  v_mfma_f32_16x16x32_bf16 v[104:107], a[112:115], v[40:43], v[104:107]
  s_waitcnt lgkmcnt(4)
  v_mfma_f32_16x16x32_bf16 v[112:115], a[112:115], v[48:51], v[112:115]
  ds_read_b64_tr_b16 v[32:33], v14 offset:32768
  v_mfma_f32_16x16x32_bf16 v[112:115], a[120:123], v[52:55], v[112:115]
  v_mfma_f32_16x16x32_bf16 v[116:119], a[124:127], v[52:55], v[116:119]
  s_add_u32 m0, s77, 65536
  ds_read_b64_tr_b16 v[34:35], v14 offset:33280
  v_mfma_f32_16x16x32_bf16 v[116:119], a[116:119], v[48:51], v[116:119]
  s_add_u32 s81, s60, 0
  buffer_load_dwordx4 v6, s[24:27], s81 offen offset:0 lds
  v_mfma_f32_16x16x32_bf16 v[144:147], a[240:243], v[48:51], v[144:147]
  ds_read_b64_tr_b16 v[36:37], v14 offset:36864
  v_mfma_f32_16x16x32_bf16 v[144:147], a[248:251], v[52:55], v[144:147]
  v_mfma_f32_16x16x32_bf16 v[148:151], a[252:255], v[52:55], v[148:151]
  ds_read_b64_tr_b16 v[38:39], v14 offset:37376
  v_mfma_f32_16x16x32_bf16 v[148:151], a[244:247], v[48:51], v[148:151]
  s_waitcnt lgkmcnt(4)
  v_mfma_f32_16x16x32_bf16 v[156:159], a[244:247], v[56:59], v[156:159]
  ds_read_b64_tr_b16 v[40:41], v15 offset:32768
  v_mfma_f32_16x16x32_bf16 v[156:159], a[252:255], v[60:63], v[156:159]
  buffer_load_dwordx4 v7, s[24:27], s81 offen offset:1024 lds
  v_mfma_f32_16x16x32_bf16 v[152:155], a[248:251], v[60:63], v[152:155]
  ds_read_b64_tr_b16 v[42:43], v15 offset:33280
  v_mfma_f32_16x16x32_bf16 v[152:155], a[240:243], v[56:59], v[152:155]
  v_mfma_f32_16x16x32_bf16 v[124:127], a[116:119], v[56:59], v[124:127]
  ds_read_b64_tr_b16 v[44:45], v15 offset:36864
  v_mfma_f32_16x16x32_bf16 v[124:127], a[124:127], v[60:63], v[124:127]
  v_mfma_f32_16x16x32_bf16 v[120:123], a[120:123], v[60:63], v[120:123]
  ds_read_b64_tr_b16 v[46:47], v15 offset:37376
  v_mfma_f32_16x16x32_bf16 v[120:123], a[112:115], v[56:59], v[120:123]
  s_waitcnt lgkmcnt(4)
  buffer_load_dwordx4 v8, s[24:27], s81 offen offset:2048 lds
  v_mfma_f32_16x16x32_bf16 v[160:163], a[0:3], v[32:35], 0
  ds_read_b64_tr_b16 v[48:49], v16 offset:32768
  v_mfma_f32_16x16x32_bf16 v[160:163], a[8:11], v[36:39], v[160:163]
  v_mfma_f32_16x16x32_bf16 v[164:167], a[12:15], v[36:39], 0
  ds_read_b64_tr_b16 v[50:51], v16 offset:33280
  v_cvt_pk_bf16_f32 v96, v96, v97
  v_mfma_f32_16x16x32_bf16 v[164:167], a[4:7], v[32:35], v[164:167]
  v_cvt_pk_bf16_f32 v97, v98, v99
  v_cvt_pk_bf16_f32 v98, v100, v101
  v_mfma_f32_16x16x32_bf16 v[192:195], a[128:131], v[32:35], 0
  ds_read_b64_tr_b16 v[52:53], v16 offset:36864
  v_mfma_f32_16x16x32_bf16 v[192:195], a[136:139], v[36:39], v[192:195]
  buffer_load_dwordx4 v9, s[24:27], s81 offen offset:3072 lds
  v_mfma_f32_16x16x32_bf16 v[196:199], a[140:143], v[36:39], 0
  ds_read_b64_tr_b16 v[54:55], v16 offset:37376
  v_cvt_pk_bf16_f32 v99, v102, v103
  v_mfma_f32_16x16x32_bf16 v[196:199], a[132:135], v[32:35], v[196:199]
  s_waitcnt lgkmcnt(4)
  buffer_store_dwordx4 v[80:83], v1, s[28:31], s84 offen offset:1024
  v_mfma_f32_16x16x32_bf16 v[204:207], a[132:135], v[40:43], 0
  ds_read_b64_tr_b16 v[56:57], v17 offset:32768
  v_cvt_pk_bf16_f32 v104, v104, v105
  v_mfma_f32_16x16x32_bf16 v[204:207], a[140:143], v[44:47], v[204:207]
  v_cvt_pk_bf16_f32 v105, v106, v107
  v_mfma_f32_16x16x32_bf16 v[200:203], a[136:139], v[44:47], 0
  ds_read_b64_tr_b16 v[58:59], v17 offset:33280
  v_cvt_pk_bf16_f32 v106, v108, v109
  v_mfma_f32_16x16x32_bf16 v[200:203], a[128:131], v[40:43], v[200:203]
  v_cvt_pk_bf16_f32 v107, v110, v111
  v_mfma_f32_16x16x32_bf16 v[172:175], a[4:7], v[40:43], 0
  ds_read_b64_tr_b16 v[60:61], v17 offset:36864
  v_cvt_pk_bf16_f32 v112, v112, v113
  v_mfma_f32_16x16x32_bf16 v[172:175], a[12:15], v[44:47], v[172:175]
  v_cvt_pk_bf16_f32 v113, v114, v115
  v_mfma_f32_16x16x32_bf16 v[168:171], a[8:11], v[44:47], 0
  ds_read_b64_tr_b16 v[62:63], v17 offset:37376
  v_cvt_pk_bf16_f32 v114, v116, v117
  v_mfma_f32_16x16x32_bf16 v[168:171], a[0:3], v[40:43], v[168:171]
  s_waitcnt lgkmcnt(4)
  v_cvt_pk_bf16_f32 v115, v118, v119
  v_mfma_f32_16x16x32_bf16 v[176:179], a[0:3], v[48:51], 0
  ds_read_b64_tr_b16 v[32:33], v14 offset:40960
  v_cvt_pk_bf16_f32 v120, v120, v121
  v_mfma_f32_16x16x32_bf16 v[176:179], a[8:11], v[52:55], v[176:179]
  v_cvt_pk_bf16_f32 v121, v122, v123
  v_mfma_f32_16x16x32_bf16 v[180:183], a[12:15], v[52:55], 0
  ds_read_b64_tr_b16 v[34:35], v14 offset:41472
  v_cvt_pk_bf16_f32 v122, v124, v125
  v_mfma_f32_16x16x32_bf16 v[180:183], a[4:7], v[48:51], v[180:183]
  v_cvt_pk_bf16_f32 v123, v126, v127
  v_mfma_f32_16x16x32_bf16 v[208:211], a[128:131], v[48:51], 0
  ds_read_b64_tr_b16 v[36:37], v14 offset:45056
  v_cvt_pk_bf16_f32 v128, v128, v129
  v_mfma_f32_16x16x32_bf16 v[208:211], a[136:139], v[52:55], v[208:211]
  v_cvt_pk_bf16_f32 v129, v130, v131
  v_mfma_f32_16x16x32_bf16 v[212:215], a[140:143], v[52:55], 0
  ds_read_b64_tr_b16 v[38:39], v14 offset:45568
  v_cvt_pk_bf16_f32 v130, v132, v133
  v_mfma_f32_16x16x32_bf16 v[212:215], a[132:135], v[48:51], v[212:215]
  s_waitcnt lgkmcnt(4)
  v_cvt_pk_bf16_f32 v131, v134, v135
  v_mfma_f32_16x16x32_bf16 v[220:223], a[132:135], v[56:59], 0
  s_waitcnt vmcnt(5)
  ds_read_b64_tr_b16 v[40:41], v15 offset:40960
  v_cvt_pk_bf16_f32 v136, v136, v137
  v_cmp_gt_u32 vcc, 4, v29
  v_mfma_f32_16x16x32_bf16 v[220:223], a[140:143], v[60:63], v[220:223]
  v_cvt_pk_bf16_f32 v137, v138, v139
  v_mfma_f32_16x16x32_bf16 v[216:219], a[136:139], v[60:63], 0
  ds_read_b64_tr_b16 v[42:43], v15 offset:41472
  v_cvt_pk_bf16_f32 v138, v140, v141
  v_mfma_f32_16x16x32_bf16 v[216:219], a[128:131], v[56:59], v[216:219]
  s_cbranch_vccnz L_pollLN
L_pollLN_back:
  v_cvt_pk_bf16_f32 v139, v142, v143
  v_mfma_f32_16x16x32_bf16 v[188:191], a[4:7], v[56:59], 0
  ds_read_b64_tr_b16 v[44:45], v15 offset:45056
  v_cvt_pk_bf16_f32 v144, v144, v145
  v_mfma_f32_16x16x32_bf16 v[188:191], a[12:15], v[60:63], v[188:191]
  v_cvt_pk_bf16_f32 v145, v146, v147
  v_mfma_f32_16x16x32_bf16 v[184:187], a[8:11], v[60:63], 0
  ds_read_b64_tr_b16 v[46:47], v15 offset:45568
  v_cvt_pk_bf16_f32 v146, v148, v149
  v_mfma_f32_16x16x32_bf16 v[184:187], a[0:3], v[56:59], v[184:187]
  s_waitcnt lgkmcnt(4)
  buffer_store_dwordx4 v[84:87], v1, s[28:31], s85 offen offset:1024
  v_mfma_f32_16x16x32_bf16 v[160:163], a[16:19], v[32:35], v[160:163]
  s_add_u32 s64, s92, s70
  ds_read_b64_tr_b16 v[48:49], v16 offset:40960
  v_cvt_pk_bf16_f32 v147, v150, v151
  v_mfma_f32_16x16x32_bf16 v[160:163], a[24:27], v[36:39], v[160:163]
  s_add_u32 s65, s93, s70
  buffer_load_dwordx4 a[0:3], v1, s[28:31], s64 offen offset:0 sc1
  v_mfma_f32_16x16x32_bf16 v[164:167], a[28:31], v[36:39], v[164:167]
  s_add_u32 s70, s70, 4096
  ds_read_b64_tr_b16 v[50:51], v16 offset:41472
  v_mfma_f32_16x16x32_bf16 v[164:167], a[20:23], v[32:35], v[164:167]
  s_and_b32 s70, s70, 0x7fff
  v_cvt_pk_bf16_f32 v152, v152, v153
  v_cvt_pk_bf16_f32 v153, v154, v155
  v_mfma_f32_16x16x32_bf16 v[192:195], a[144:147], v[32:35], v[192:195]
  ds_read_b64_tr_b16 v[52:53], v16 offset:45056
  v_mfma_f32_16x16x32_bf16 v[192:195], a[152:155], v[36:39], v[192:195]
  v_cvt_pk_bf16_f32 v154, v156, v157
  v_cvt_pk_bf16_f32 v155, v158, v159
  v_mfma_f32_16x16x32_bf16 v[196:199], a[156:159], v[36:39], v[196:199]
  ds_read_b64_tr_b16 v[54:55], v16 offset:45568
  v_mfma_f32_16x16x32_bf16 v[196:199], a[148:151], v[32:35], v[196:199]
  s_waitcnt lgkmcnt(4)
  buffer_load_dwordx4 a[128:131], v1, s[28:31], s65 offen offset:0 sc1
  v_mfma_f32_16x16x32_bf16 v[204:207], a[148:151], v[40:43], v[204:207]
  ds_read_b64_tr_b16 v[56:57], v17 offset:40960
  v_mfma_f32_16x16x32_bf16 v[204:207], a[156:159], v[44:47], v[204:207]
  v_mfma_f32_16x16x32_bf16 v[200:203], a[152:155], v[44:47], v[200:203]
  ds_read_b64_tr_b16 v[58:59], v17 offset:41472
  v_mfma_f32_16x16x32_bf16 v[200:203], a[144:147], v[40:43], v[200:203]
  v_mfma_f32_16x16x32_bf16 v[172:175], a[20:23], v[40:43], v[172:175]
  ds_read_b64_tr_b16 v[60:61], v17 offset:45056
  v_mfma_f32_16x16x32_bf16 v[172:175], a[28:31], v[44:47], v[172:175]
  buffer_load_dwordx4 a[4:7], v1, s[28:31], s64 offen offset:1024 sc1
  v_mfma_f32_16x16x32_bf16 v[168:171], a[24:27], v[44:47], v[168:171]
  s_barrier
  ds_read_b64_tr_b16 v[62:63], v17 offset:45568
  v_mfma_f32_16x16x32_bf16 v[168:171], a[16:19], v[40:43], v[168:171]
  s_waitcnt lgkmcnt(4)
  v_mfma_f32_16x16x32_bf16 v[176:179], a[16:19], v[48:51], v[176:179]
  ds_read_b64_tr_b16 v[32:33], v14 offset:49152
  v_mfma_f32_16x16x32_bf16 v[176:179], a[24:27], v[52:55], v[176:179]
  v_mfma_f32_16x16x32_bf16 v[180:183], a[28:31], v[52:55], v[180:183]
  s_add_u32 m0, s77, 81920
  ds_read_b64_tr_b16 v[34:35], v14 offset:49664
  v_mfma_f32_16x16x32_bf16 v[180:183], a[20:23], v[48:51], v[180:183]
  s_add_u32 s81, s61, 0
  buffer_load_dwordx4 v6, s[24:27], s81 offen offset:0 lds
  v_mfma_f32_16x16x32_bf16 v[208:211], a[144:147], v[48:51], v[208:211]
  ds_read_b64_tr_b16 v[36:37], v14 offset:53248
  v_mfma_f32_16x16x32_bf16 v[208:211], a[152:155], v[52:55], v[208:211]
  buffer_load_dwordx4 a[132:135], v1, s[28:31], s65 offen offset:1024 sc1
  v_mfma_f32_16x16x32_bf16 v[212:215], a[156:159], v[52:55], v[212:215]
  ds_read_b64_tr_b16 v[38:39], v14 offset:53760
  v_mfma_f32_16x16x32_bf16 v[212:215], a[148:151], v[48:51], v[212:215]
  s_waitcnt lgkmcnt(4)
  buffer_store_dwordx4 v[96:99], v1, s[28:31], s86 offen offset:0
  v_mfma_f32_16x16x32_bf16 v[220:223], a[148:151], v[56:59], v[220:223]
  ds_read_b64_tr_b16 v[40:41], v15 offset:49152
  v_mfma_f32_16x16x32_bf16 v[220:223], a[156:159], v[60:63], v[220:223]
  buffer_load_dwordx4 v7, s[24:27], s81 offen offset:1024 lds
  v_mfma_f32_16x16x32_bf16 v[216:219], a[152:155], v[60:63], v[216:219]
  ds_read_b64_tr_b16 v[42:43], v15 offset:49664
  v_mfma_f32_16x16x32_bf16 v[216:219], a[144:147], v[56:59], v[216:219]
  buffer_load_dwordx4 a[8:11], v1, s[28:31], s64 offen offset:2048 sc1
  v_mfma_f32_16x16x32_bf16 v[188:191], a[20:23], v[56:59], v[188:191]
  ds_read_b64_tr_b16 v[44:45], v15 offset:53248
  v_mfma_f32_16x16x32_bf16 v[188:191], a[28:31], v[60:63], v[188:191]
  v_mfma_f32_16x16x32_bf16 v[184:187], a[24:27], v[60:63], v[184:187]
  ds_read_b64_tr_b16 v[46:47], v15 offset:53760
  v_mfma_f32_16x16x32_bf16 v[184:187], a[16:19], v[56:59], v[184:187]
  s_waitcnt lgkmcnt(4)
  buffer_load_dwordx4 v8, s[24:27], s81 offen offset:2048 lds
  v_mfma_f32_16x16x32_bf16 v[160:163], a[32:35], v[32:35], v[160:163]
  ds_read_b64_tr_b16 v[48:49], v16 offset:49152
  v_mfma_f32_16x16x32_bf16 v[160:163], a[40:43], v[36:39], v[160:163]
  buffer_load_dwordx4 a[136:139], v1, s[28:31], s65 offen offset:2048 sc1
  v_mfma_f32_16x16x32_bf16 v[164:167], a[44:47], v[36:39], v[164:167]
  ds_read_b64_tr_b16 v[50:51], v16 offset:49664
  v_mfma_f32_16x16x32_bf16 v[164:167], a[36:39], v[32:35], v[164:167]
  v_mfma_f32_16x16x32_bf16 v[192:195], a[160:163], v[32:35], v[192:195]
  ds_read_b64_tr_b16 v[52:53], v16 offset:53248
  v_mfma_f32_16x16x32_bf16 v[192:195], a[168:171], v[36:39], v[192:195]
  buffer_load_dwordx4 v9, s[24:27], s81 offen offset:3072 lds
  v_mfma_f32_16x16x32_bf16 v[196:199], a[172:175], v[36:39], v[196:199]
  ds_read_b64_tr_b16 v[54:55], v16 offset:53760
  v_mfma_f32_16x16x32_bf16 v[196:199], a[164:167], v[32:35], v[196:199]
  s_waitcnt lgkmcnt(4)
  buffer_load_dwordx4 a[12:15], v1, s[28:31], s64 offen offset:3072 sc1
  v_mfma_f32_16x16x32_bf16 v[204:207], a[164:167], v[40:43], v[204:207]
  ds_read_b64_tr_b16 v[56:57], v17 offset:49152
  v_mfma_f32_16x16x32_bf16 v[204:207], a[172:175], v[44:47], v[204:207]
  v_mfma_f32_16x16x32_bf16 v[200:203], a[168:171], v[44:47], v[200:203]
  ds_read_b64_tr_b16 v[58:59], v17 offset:49664
  v_mfma_f32_16x16x32_bf16 v[200:203], a[160:163], v[40:43], v[200:203]
  buffer_load_dwordx4 a[140:143], v1, s[28:31], s65 offen offset:3072 sc1
  v_mfma_f32_16x16x32_bf16 v[172:175], a[36:39], v[40:43], v[172:175]
  ds_read_b64_tr_b16 v[60:61], v17 offset:53248
  v_mfma_f32_16x16x32_bf16 v[172:175], a[44:47], v[44:47], v[172:175]
  v_mfma_f32_16x16x32_bf16 v[168:171], a[40:43], v[44:47], v[168:171]
  ds_read_b64_tr_b16 v[62:63], v17 offset:53760
  v_mfma_f32_16x16x32_bf16 v[168:171], a[32:35], v[40:43], v[168:171]
  s_waitcnt lgkmcnt(4)
  buffer_store_dwordx4 v[104:107], v1, s[28:31], s86 offen offset:1024
  v_mfma_f32_16x16x32_bf16 v[176:179], a[32:35], v[48:51], v[176:179]
  s_add_u32 s64, s92, s70
  ds_read_b64_tr_b16 v[32:33], v14 offset:57344
  v_mfma_f32_16x16x32_bf16 v[176:179], a[40:43], v[52:55], v[176:179]
  s_add_u32 s65, s93, s70
  buffer_load_dwordx4 a[16:19], v1, s[28:31], s64 offen offset:0 sc1
  v_mfma_f32_16x16x32_bf16 v[180:183], a[44:47], v[52:55], v[180:183]
  s_add_u32 s70, s70, 4096
  ds_read_b64_tr_b16 v[34:35], v14 offset:57856
  v_mfma_f32_16x16x32_bf16 v[180:183], a[36:39], v[48:51], v[180:183]
  s_and_b32 s70, s70, 0x7fff
  v_mfma_f32_16x16x32_bf16 v[208:211], a[160:163], v[48:51], v[208:211]
  ds_read_b64_tr_b16 v[36:37], v14 offset:61440
  v_mfma_f32_16x16x32_bf16 v[208:211], a[168:171], v[52:55], v[208:211]
  v_mfma_f32_16x16x32_bf16 v[212:215], a[172:175], v[52:55], v[212:215]
  ds_read_b64_tr_b16 v[38:39], v14 offset:61952
  v_add_u32 v14, 0xffff0000, v14
  v_mfma_f32_16x16x32_bf16 v[212:215], a[164:167], v[48:51], v[212:215]
  s_waitcnt lgkmcnt(4)
  buffer_load_dwordx4 a[144:147], v1, s[28:31], s65 offen offset:0 sc1
  v_mfma_f32_16x16x32_bf16 v[220:223], a[164:167], v[56:59], v[220:223]
  ds_read_b64_tr_b16 v[40:41], v15 offset:57344
  v_mfma_f32_16x16x32_bf16 v[220:223], a[172:175], v[60:63], v[220:223]
  v_mfma_f32_16x16x32_bf16 v[216:219], a[168:171], v[60:63], v[216:219]
  ds_read_b64_tr_b16 v[42:43], v15 offset:57856
  v_mfma_f32_16x16x32_bf16 v[216:219], a[160:163], v[56:59], v[216:219]
  v_mfma_f32_16x16x32_bf16 v[188:191], a[36:39], v[56:59], v[188:191]
  ds_read_b64_tr_b16 v[44:45], v15 offset:61440
  v_mfma_f32_16x16x32_bf16 v[188:191], a[44:47], v[60:63], v[188:191]
  v_mfma_f32_16x16x32_bf16 v[184:187], a[40:43], v[60:63], v[184:187]
  ds_read_b64_tr_b16 v[46:47], v15 offset:61952
  v_add_u32 v15, 0xffff0000, v15
  v_mfma_f32_16x16x32_bf16 v[184:187], a[32:35], v[56:59], v[184:187]
  s_waitcnt lgkmcnt(4)
  buffer_load_dwordx4 a[20:23], v1, s[28:31], s64 offen offset:1024 sc1
  v_mfma_f32_16x16x32_bf16 v[160:163], a[48:51], v[32:35], v[160:163]
  ds_read_b64_tr_b16 v[48:49], v16 offset:57344
  v_mfma_f32_16x16x32_bf16 v[160:163], a[56:59], v[36:39], v[160:163]
  v_mfma_f32_16x16x32_bf16 v[164:167], a[60:63], v[36:39], v[164:167]
  ds_read_b64_tr_b16 v[50:51], v16 offset:57856
  v_mfma_f32_16x16x32_bf16 v[164:167], a[52:55], v[32:35], v[164:167]
  v_mfma_f32_16x16x32_bf16 v[192:195], a[176:179], v[32:35], v[192:195]
  ds_read_b64_tr_b16 v[52:53], v16 offset:61440
  v_mfma_f32_16x16x32_bf16 v[192:195], a[184:187], v[36:39], v[192:195]
  buffer_load_dwordx4 a[148:151], v1, s[28:31], s65 offen offset:1024 sc1
  v_mfma_f32_16x16x32_bf16 v[196:199], a[188:191], v[36:39], v[196:199]
  ds_read_b64_tr_b16 v[54:55], v16 offset:61952
  v_add_u32 v16, 0xffff0000, v16
  v_mfma_f32_16x16x32_bf16 v[196:199], a[180:183], v[32:35], v[196:199]
  s_waitcnt lgkmcnt(4)
  buffer_store_dwordx4 v[112:115], v1, s[28:31], s86 offen offset:2048
  v_mfma_f32_16x16x32_bf16 v[204:207], a[180:183], v[40:43], v[204:207]
  ds_read_b64_tr_b16 v[56:57], v17 offset:57344
  v_mfma_f32_16x16x32_bf16 v[204:207], a[188:191], v[44:47], v[204:207]
  v_mfma_f32_16x16x32_bf16 v[200:203], a[184:187], v[44:47], v[200:203]
  ds_read_b64_tr_b16 v[58:59], v17 offset:57856
  v_mfma_f32_16x16x32_bf16 v[200:203], a[176:179], v[40:43], v[200:203]
  buffer_load_dwordx4 a[24:27], v1, s[28:31], s64 offen offset:2048 sc1
  v_mfma_f32_16x16x32_bf16 v[172:175], a[52:55], v[40:43], v[172:175]
  ds_read_b64_tr_b16 v[60:61], v17 offset:61440
  v_mfma_f32_16x16x32_bf16 v[172:175], a[60:63], v[44:47], v[172:175]
  v_mfma_f32_16x16x32_bf16 v[168:171], a[56:59], v[44:47], v[168:171]
  ds_read_b64_tr_b16 v[62:63], v17 offset:61952
  v_add_u32 v17, 0xffff0000, v17
  v_mfma_f32_16x16x32_bf16 v[168:171], a[48:51], v[40:43], v[168:171]
  s_waitcnt lgkmcnt(4)
  v_mfma_f32_16x16x32_bf16 v[176:179], a[48:51], v[48:51], v[176:179]
  ds_read_b64_tr_b16 v[32:33], v14 offset:0
  v_mfma_f32_16x16x32_bf16 v[176:179], a[56:59], v[52:55], v[176:179]
  buffer_load_dwordx4 a[152:155], v1, s[28:31], s65 offen offset:2048 sc1
  v_mfma_f32_16x16x32_bf16 v[180:183], a[60:63], v[52:55], v[180:183]
  ds_read_b64_tr_b16 v[34:35], v14 offset:512
  v_mfma_f32_16x16x32_bf16 v[180:183], a[52:55], v[48:51], v[180:183]
  v_mfma_f32_16x16x32_bf16 v[208:211], a[176:179], v[48:51], v[208:211]
  ds_read_b64_tr_b16 v[36:37], v14 offset:4096
  v_lshlrev_b32 v224, 16, v226
  v_mfma_f32_16x16x32_bf16 v[208:211], a[184:187], v[52:55], v[208:211]
  v_and_b32 v225, 0xffff0000, v226
  v_mfma_f32_16x16x32_bf16 v[212:215], a[188:191], v[52:55], v[212:215]
  ds_read_b64_tr_b16 v[38:39], v14 offset:4608
  v_mfma_f32_16x16x32_bf16 v[212:215], a[180:183], v[48:51], v[212:215]
  s_waitcnt lgkmcnt(4)
  buffer_load_dwordx4 a[28:31], v1, s[28:31], s64 offen offset:3072 sc1
  v_mfma_f32_16x16x32_bf16 v[220:223], a[180:183], v[56:59], v[220:223]
  ds_read_b64_tr_b16 v[40:41], v15 offset:0
  v_lshlrev_b32 v226, 16, v227
  v_mfma_f32_16x16x32_bf16 v[220:223], a[188:191], v[60:63], v[220:223]
  v_and_b32 v227, 0xffff0000, v227
  v_mfma_f32_16x16x32_bf16 v[216:219], a[184:187], v[60:63], v[216:219]
  ds_read_b64_tr_b16 v[42:43], v15 offset:512
  v_mfma_f32_16x16x32_bf16 v[216:219], a[176:179], v[56:59], v[216:219]
  v_lshlrev_b32 v228, 16, v230
  v_mfma_f32_16x16x32_bf16 v[188:191], a[52:55], v[56:59], v[188:191]
  ds_read_b64_tr_b16 v[44:45], v15 offset:4096
  v_mfma_f32_16x16x32_bf16 v[188:191], a[60:63], v[60:63], v[188:191]
  buffer_load_dwordx4 a[156:159], v1, s[28:31], s65 offen offset:3072 sc1
  v_mfma_f32_16x16x32_bf16 v[184:187], a[56:59], v[60:63], v[184:187]
  ds_read_b64_tr_b16 v[46:47], v15 offset:4608
  v_and_b32 v229, 0xffff0000, v230
  v_mfma_f32_16x16x32_bf16 v[184:187], a[48:51], v[56:59], v[184:187]
  s_waitcnt lgkmcnt(4)
  buffer_store_dwordx4 v[120:123], v1, s[28:31], s86 offen offset:3072
  v_mfma_f32_16x16x32_bf16 v[160:163], a[64:67], v[32:35], v[160:163]
  ds_read_b64_tr_b16 v[48:49], v16 offset:0
  v_mfma_f32_16x16x32_bf16 v[160:163], a[72:75], v[36:39], v[160:163]
  v_lshlrev_b32 v230, 16, v231
  v_mfma_f32_16x16x32_bf16 v[164:167], a[76:79], v[36:39], v[164:167]
  s_add_u32 s64, s92, s70
  ds_read_b64_tr_b16 v[50:51], v16 offset:512
  v_mfma_f32_16x16x32_bf16 v[164:167], a[68:71], v[32:35], v[164:167]
  s_add_u32 s65, s93, s70
  buffer_load_dwordx4 a[32:35], v1, s[28:31], s64 offen offset:0 sc1
  v_mfma_f32_16x16x32_bf16 v[192:195], a[192:195], v[32:35], v[192:195]
  s_add_u32 s70, s70, 4096
  ds_read_b64_tr_b16 v[52:53], v16 offset:4096
  v_and_b32 v231, 0xffff0000, v231
  v_mfma_f32_16x16x32_bf16 v[192:195], a[200:203], v[36:39], v[192:195]
  s_and_b32 s70, s70, 0x7fff
  v_lshlrev_b32 v232, 16, v234
  v_mfma_f32_16x16x32_bf16 v[196:199], a[204:207], v[36:39], v[196:199]
  ds_read_b64_tr_b16 v[54:55], v16 offset:4608
  v_mfma_f32_16x16x32_bf16 v[196:199], a[196:199], v[32:35], v[196:199]
  s_waitcnt lgkmcnt(4)
  v_and_b32 v233, 0xffff0000, v234
  v_mfma_f32_16x16x32_bf16 v[204:207], a[196:199], v[40:43], v[204:207]
  ds_read_b64_tr_b16 v[56:57], v17 offset:0
  v_mfma_f32_16x16x32_bf16 v[204:207], a[204:207], v[44:47], v[204:207]
  buffer_load_dwordx4 a[160:163], v1, s[28:31], s65 offen offset:0 sc1
  v_mfma_f32_16x16x32_bf16 v[200:203], a[200:203], v[44:47], v[200:203]
  ds_read_b64_tr_b16 v[58:59], v17 offset:512
  v_lshlrev_b32 v234, 16, v235
  v_mfma_f32_16x16x32_bf16 v[200:203], a[192:195], v[40:43], v[200:203]
  v_and_b32 v235, 0xffff0000, v235
  v_mfma_f32_16x16x32_bf16 v[172:175], a[68:71], v[40:43], v[172:175]
  ds_read_b64_tr_b16 v[60:61], v17 offset:4096
  v_mfma_f32_16x16x32_bf16 v[172:175], a[76:79], v[44:47], v[172:175]
  v_lshlrev_b32 v236, 16, v238
  v_mfma_f32_16x16x32_bf16 v[168:171], a[72:75], v[44:47], v[168:171]
  ds_read_b64_tr_b16 v[62:63], v17 offset:4608
  v_mfma_f32_16x16x32_bf16 v[168:171], a[64:67], v[40:43], v[168:171]
  s_waitcnt lgkmcnt(4)
  buffer_load_dwordx4 a[36:39], v1, s[28:31], s64 offen offset:1024 sc1
  v_mfma_f32_16x16x32_bf16 v[176:179], a[64:67], v[48:51], v[176:179]
  ds_read_b64_tr_b16 v[32:33], v14 offset:8192
  v_and_b32 v237, 0xffff0000, v238
  v_mfma_f32_16x16x32_bf16 v[176:179], a[72:75], v[52:55], v[176:179]
  v_lshlrev_b32 v238, 16, v239
  v_mfma_f32_16x16x32_bf16 v[180:183], a[76:79], v[52:55], v[180:183]
  ds_read_b64_tr_b16 v[34:35], v14 offset:8704
  v_mfma_f32_16x16x32_bf16 v[180:183], a[68:71], v[48:51], v[180:183]
  v_and_b32 v239, 0xffff0000, v239
  v_mfma_f32_16x16x32_bf16 v[208:211], a[192:195], v[48:51], v[208:211]
  ds_read_b64_tr_b16 v[36:37], v14 offset:12288
  v_mfma_f32_16x16x32_bf16 v[208:211], a[200:203], v[52:55], v[208:211]
  buffer_load_dwordx4 a[164:167], v1, s[28:31], s65 offen offset:1024 sc1
  v_mfma_f32_16x16x32_bf16 v[212:215], a[204:207], v[52:55], v[212:215]
  ds_read_b64_tr_b16 v[38:39], v14 offset:12800
  v_add_u32 v14, 0x20000, v14
  v_mfma_f32_16x16x32_bf16 v[212:215], a[196:199], v[48:51], v[212:215]
  s_waitcnt lgkmcnt(4)
  buffer_store_dwordx4 v[128:131], v1, s[28:31], s90 offen offset:0
  v_mfma_f32_16x16x32_bf16 v[220:223], a[196:199], v[56:59], v[220:223]
L_pad4:
  s_cbranch_execz L_pad8
  ds_read_b64_tr_b16 v[40:41], v15 offset:8192
  v_mfma_f32_16x16x32_bf16 v[220:223], a[204:207], v[60:63], v[220:223]
  v_mfma_f32_16x16x32_bf16 v[216:219], a[200:203], v[60:63], v[216:219]
  ds_read_b64_tr_b16 v[42:43], v15 offset:8704
  v_mfma_f32_16x16x32_bf16 v[216:219], a[192:195], v[56:59], v[216:219]
  v_mfma_f32_16x16x32_bf16 v[188:191], a[68:71], v[56:59], v[188:191]
  ds_read_b64_tr_b16 v[44:45], v15 offset:12288
  v_mfma_f32_16x16x32_bf16 v[188:191], a[76:79], v[60:63], v[188:191]
  buffer_load_dwordx4 a[40:43], v1, s[28:31], s64 offen offset:2048 sc1
  v_mfma_f32_16x16x32_bf16 v[184:187], a[72:75], v[60:63], v[184:187]
  ds_read_b64_tr_b16 v[46:47], v15 offset:12800
  v_add_u32 v15, 0x20000, v15
  v_mfma_f32_16x16x32_bf16 v[184:187], a[64:67], v[56:59], v[184:187]
  s_waitcnt lgkmcnt(4)
  v_mfma_f32_16x16x32_bf16 v[160:163], a[80:83], v[32:35], v[160:163]
  ds_read_b64_tr_b16 v[48:49], v16 offset:8192
  v_mfma_f32_16x16x32_bf16 v[160:163], a[88:91], v[36:39], v[160:163]
  v_mfma_f32_16x16x32_bf16 v[164:167], a[92:95], v[36:39], v[164:167]
  ds_read_b64_tr_b16 v[50:51], v16 offset:8704
  v_mfma_f32_16x16x32_bf16 v[164:167], a[84:87], v[32:35], v[164:167]
  buffer_load_dwordx4 a[168:171], v1, s[28:31], s65 offen offset:2048 sc1
  v_mfma_f32_16x16x32_bf16 v[192:195], a[208:211], v[32:35], v[192:195]
  ds_read_b64_tr_b16 v[52:53], v16 offset:12288
  v_mfma_f32_16x16x32_bf16 v[192:195], a[216:219], v[36:39], v[192:195]
  v_mfma_f32_16x16x32_bf16 v[196:199], a[220:223], v[36:39], v[196:199]
  ds_read_b64_tr_b16 v[54:55], v16 offset:12800
  v_add_u32 v16, 0x20000, v16
  v_mfma_f32_16x16x32_bf16 v[196:199], a[212:215], v[32:35], v[196:199]
  s_waitcnt lgkmcnt(4)
  v_mfma_f32_16x16x32_bf16 v[204:207], a[212:215], v[40:43], v[204:207]
  ds_read_b64_tr_b16 v[56:57], v17 offset:8192
  v_mfma_f32_16x16x32_bf16 v[204:207], a[220:223], v[44:47], v[204:207]
  buffer_load_dwordx4 a[44:47], v1, s[28:31], s64 offen offset:3072 sc1
  v_mfma_f32_16x16x32_bf16 v[200:203], a[216:219], v[44:47], v[200:203]
  ds_read_b64_tr_b16 v[58:59], v17 offset:8704
  v_mfma_f32_16x16x32_bf16 v[200:203], a[208:211], v[40:43], v[200:203]
  v_mfma_f32_16x16x32_bf16 v[172:175], a[84:87], v[40:43], v[172:175]
  ds_read_b64_tr_b16 v[60:61], v17 offset:12288
  v_mfma_f32_16x16x32_bf16 v[172:175], a[92:95], v[44:47], v[172:175]
  v_mfma_f32_16x16x32_bf16 v[168:171], a[88:91], v[44:47], v[168:171]
  ds_read_b64_tr_b16 v[62:63], v17 offset:12800
  v_add_u32 v17, 0x20000, v17
  v_mfma_f32_16x16x32_bf16 v[168:171], a[80:83], v[40:43], v[168:171]
  s_waitcnt lgkmcnt(4)
  buffer_load_dwordx4 a[172:175], v1, s[28:31], s65 offen offset:3072 sc1
  v_mfma_f32_16x16x32_bf16 v[176:179], a[80:83], v[48:51], v[176:179]
  ds_read_b64_tr_b16 v[32:33], v14 offset:0
  v_mfma_f32_16x16x32_bf16 v[176:179], a[88:91], v[52:55], v[176:179]
  buffer_store_dwordx4 v[136:139], v1, s[28:31], s90 offen offset:1024
  v_mfma_f32_16x16x32_bf16 v[180:183], a[92:95], v[52:55], v[180:183]
  ds_read_b64_tr_b16 v[34:35], v14 offset:512
  v_mfma_f32_16x16x32_bf16 v[180:183], a[84:87], v[48:51], v[180:183]
  v_mfma_f32_16x16x32_bf16 v[208:211], a[208:211], v[48:51], v[208:211]
  s_add_u32 s64, s92, s70
  ds_read_b64_tr_b16 v[36:37], v14 offset:4096
  v_mfma_f32_16x16x32_bf16 v[208:211], a[216:219], v[52:55], v[208:211]
  s_add_u32 s65, s93, s70
  buffer_load_dwordx4 a[48:51], v1, s[28:31], s64 offen offset:0 sc1
  v_mfma_f32_16x16x32_bf16 v[212:215], a[220:223], v[52:55], v[212:215]
  s_add_u32 s70, s70, 4096
  ds_read_b64_tr_b16 v[38:39], v14 offset:4608
  v_mfma_f32_16x16x32_bf16 v[212:215], a[212:215], v[48:51], v[212:215]
  s_waitcnt lgkmcnt(4)
  v_mfma_f32_16x16x32_bf16 v[220:223], a[212:215], v[56:59], v[220:223]
  s_and_b32 s70, s70, 0x7fff
  ds_read_b64_tr_b16 v[40:41], v15 offset:0
  v_mfma_f32_16x16x32_bf16 v[220:223], a[220:223], v[60:63], v[220:223]
  v_mfma_f32_16x16x32_bf16 v[216:219], a[216:219], v[60:63], v[216:219]
  ds_read_b64_tr_b16 v[42:43], v15 offset:512
  v_mfma_f32_16x16x32_bf16 v[216:219], a[208:211], v[56:59], v[216:219]
  buffer_load_dwordx4 a[176:179], v1, s[28:31], s65 offen offset:0 sc1
  v_mfma_f32_16x16x32_bf16 v[188:191], a[84:87], v[56:59], v[188:191]
  ds_read_b64_tr_b16 v[44:45], v15 offset:4096
  v_mfma_f32_16x16x32_bf16 v[188:191], a[92:95], v[60:63], v[188:191]
  v_mfma_f32_16x16x32_bf16 v[184:187], a[88:91], v[60:63], v[184:187]
  ds_read_b64_tr_b16 v[46:47], v15 offset:4608
  v_mfma_f32_16x16x32_bf16 v[184:187], a[80:83], v[56:59], v[184:187]
  s_waitcnt lgkmcnt(4)
  v_mfma_f32_16x16x32_bf16 v[160:163], a[96:99], v[32:35], v[160:163]
  ds_read_b64_tr_b16 v[48:49], v16 offset:0
  v_mfma_f32_16x16x32_bf16 v[160:163], a[104:107], v[36:39], v[160:163]
  buffer_load_dwordx4 a[52:55], v1, s[28:31], s64 offen offset:1024 sc1
  v_mfma_f32_16x16x32_bf16 v[164:167], a[108:111], v[36:39], v[164:167]
  ds_read_b64_tr_b16 v[50:51], v16 offset:512
  v_mfma_f32_16x16x32_bf16 v[164:167], a[100:103], v[32:35], v[164:167]
  v_mfma_f32_16x16x32_bf16 v[192:195], a[224:227], v[32:35], v[192:195]
  ds_read_b64_tr_b16 v[52:53], v16 offset:4096
  v_mfma_f32_16x16x32_bf16 v[192:195], a[232:235], v[36:39], v[192:195]
  v_mfma_f32_16x16x32_bf16 v[196:199], a[236:239], v[36:39], v[196:199]
  ds_read_b64_tr_b16 v[54:55], v16 offset:4608
  v_mfma_f32_16x16x32_bf16 v[196:199], a[228:231], v[32:35], v[196:199]
  s_waitcnt lgkmcnt(4)
  buffer_load_dwordx4 a[180:183], v1, s[28:31], s65 offen offset:1024 sc1
  v_mfma_f32_16x16x32_bf16 v[204:207], a[228:231], v[40:43], v[204:207]
  ds_read_b64_tr_b16 v[56:57], v17 offset:0
  v_mfma_f32_16x16x32_bf16 v[204:207], a[236:239], v[44:47], v[204:207]
  buffer_store_dwordx4 v[144:147], v1, s[28:31], s90 offen offset:2048
  v_mfma_f32_16x16x32_bf16 v[200:203], a[232:235], v[44:47], v[200:203]
  ds_read_b64_tr_b16 v[58:59], v17 offset:512
  v_mfma_f32_16x16x32_bf16 v[200:203], a[224:227], v[40:43], v[200:203]
  v_mfma_f32_16x16x32_bf16 v[172:175], a[100:103], v[40:43], v[172:175]
  ds_read_b64_tr_b16 v[60:61], v17 offset:4096
  v_mfma_f32_16x16x32_bf16 v[172:175], a[108:111], v[44:47], v[172:175]
  buffer_load_dwordx4 a[56:59], v1, s[28:31], s64 offen offset:2048 sc1
  v_mfma_f32_16x16x32_bf16 v[168:171], a[104:107], v[44:47], v[168:171]
  ds_read_b64_tr_b16 v[62:63], v17 offset:4608
  v_mfma_f32_16x16x32_bf16 v[168:171], a[96:99], v[40:43], v[168:171]
  s_waitcnt lgkmcnt(4)
  v_mfma_f32_16x16x32_bf16 v[176:179], a[96:99], v[48:51], v[176:179]
  ds_read_b64_tr_b16 v[32:33], v14 offset:8192
  v_mfma_f32_16x16x32_bf16 v[176:179], a[104:107], v[52:55], v[176:179]
  v_mfma_f32_16x16x32_bf16 v[180:183], a[108:111], v[52:55], v[180:183]
  ds_read_b64_tr_b16 v[34:35], v14 offset:8704
  v_mfma_f32_16x16x32_bf16 v[180:183], a[100:103], v[48:51], v[180:183]
  buffer_load_dwordx4 a[184:187], v1, s[28:31], s65 offen offset:2048 sc1
  v_mfma_f32_16x16x32_bf16 v[208:211], a[224:227], v[48:51], v[208:211]
  ds_read_b64_tr_b16 v[36:37], v14 offset:12288
  v_mfma_f32_16x16x32_bf16 v[208:211], a[232:235], v[52:55], v[208:211]
  v_mfma_f32_16x16x32_bf16 v[212:215], a[236:239], v[52:55], v[212:215]
  ds_read_b64_tr_b16 v[38:39], v14 offset:12800
  v_mfma_f32_16x16x32_bf16 v[212:215], a[228:231], v[48:51], v[212:215]
  s_waitcnt lgkmcnt(4)
  v_mfma_f32_16x16x32_bf16 v[220:223], a[228:231], v[56:59], v[220:223]
  ds_read_b64_tr_b16 v[40:41], v15 offset:8192
  v_mfma_f32_16x16x32_bf16 v[220:223], a[236:239], v[60:63], v[220:223]
  v_mfma_f32_16x16x32_bf16 v[216:219], a[232:235], v[60:63], v[216:219]
  ds_read_b64_tr_b16 v[42:43], v15 offset:8704
  v_mfma_f32_16x16x32_bf16 v[216:219], a[224:227], v[56:59], v[216:219]
  buffer_load_dwordx4 a[60:63], v1, s[28:31], s64 offen offset:3072 sc1
  v_mfma_f32_16x16x32_bf16 v[188:191], a[100:103], v[56:59], v[188:191]
  ds_read_b64_tr_b16 v[44:45], v15 offset:12288
  v_mfma_f32_16x16x32_bf16 v[188:191], a[108:111], v[60:63], v[188:191]
  v_mfma_f32_16x16x32_bf16 v[184:187], a[104:107], v[60:63], v[184:187]
  ds_read_b64_tr_b16 v[46:47], v15 offset:12800
  v_mfma_f32_16x16x32_bf16 v[184:187], a[96:99], v[56:59], v[184:187]
  s_waitcnt lgkmcnt(4)
  buffer_store_dwordx4 v[152:155], v1, s[28:31], s90 offen offset:3072
  v_mfma_f32_16x16x32_bf16 v[160:163], a[112:115], v[32:35], v[160:163]
  ds_read_b64_tr_b16 v[48:49], v16 offset:8192
  v_mfma_f32_16x16x32_bf16 v[160:163], a[120:123], v[36:39], v[160:163]
  buffer_load_dwordx4 a[188:191], v1, s[28:31], s65 offen offset:3072 sc1
  v_mfma_f32_16x16x32_bf16 v[164:167], a[124:127], v[36:39], v[164:167]
  ds_read_b64_tr_b16 v[50:51], v16 offset:8704
  v_mfma_f32_16x16x32_bf16 v[164:167], a[116:119], v[32:35], v[164:167]
  v_mfma_f32_16x16x32_bf16 v[192:195], a[240:243], v[32:35], v[192:195]
  ds_read_b64_tr_b16 v[52:53], v16 offset:12288
  v_mfma_f32_16x16x32_bf16 v[192:195], a[248:251], v[36:39], v[192:195]
  s_add_u32 s64, s92, s70
  v_mfma_f32_16x16x32_bf16 v[196:199], a[252:255], v[36:39], v[196:199]
  s_add_u32 s65, s93, s70
  ds_read_b64_tr_b16 v[54:55], v16 offset:12800
  v_mfma_f32_16x16x32_bf16 v[196:199], a[244:247], v[32:35], v[196:199]
  s_waitcnt lgkmcnt(4)
  buffer_load_dwordx4 a[64:67], v1, s[28:31], s64 offen offset:0 sc1
  v_mfma_f32_16x16x32_bf16 v[204:207], a[244:247], v[40:43], v[204:207]
  s_add_u32 s70, s70, 4096
  ds_read_b64_tr_b16 v[56:57], v17 offset:8192
  v_mfma_f32_16x16x32_bf16 v[204:207], a[252:255], v[44:47], v[204:207]
  s_and_b32 s70, s70, 0x7fff
  v_mfma_f32_16x16x32_bf16 v[200:203], a[248:251], v[44:47], v[200:203]
  ds_read_b64_tr_b16 v[58:59], v17 offset:8704
  v_mfma_f32_16x16x32_bf16 v[200:203], a[240:243], v[40:43], v[200:203]
  v_mfma_f32_16x16x32_bf16 v[172:175], a[116:119], v[40:43], v[172:175]
  ds_read_b64_tr_b16 v[60:61], v17 offset:12288
  v_mfma_f32_16x16x32_bf16 v[172:175], a[124:127], v[44:47], v[172:175]
  buffer_load_dwordx4 a[192:195], v1, s[28:31], s65 offen offset:0 sc1
  v_mfma_f32_16x16x32_bf16 v[168:171], a[120:123], v[44:47], v[168:171]
  ds_read_b64_tr_b16 v[62:63], v17 offset:12800
  v_mfma_f32_16x16x32_bf16 v[168:171], a[112:115], v[40:43], v[168:171]
  s_waitcnt lgkmcnt(4)
  v_mfma_f32_16x16x32_bf16 v[176:179], a[112:115], v[48:51], v[176:179]
  ds_read_b64_tr_b16 v[32:33], v14 offset:16384
  v_mfma_f32_16x16x32_bf16 v[176:179], a[120:123], v[52:55], v[176:179]
  v_mfma_f32_16x16x32_bf16 v[180:183], a[124:127], v[52:55], v[180:183]
  ds_read_b64_tr_b16 v[34:35], v14 offset:16896
  v_mfma_f32_16x16x32_bf16 v[180:183], a[116:119], v[48:51], v[180:183]
  buffer_load_dwordx4 a[68:71], v1, s[28:31], s64 offen offset:1024 sc1
  v_mfma_f32_16x16x32_bf16 v[208:211], a[240:243], v[48:51], v[208:211]
  ds_read_b64_tr_b16 v[36:37], v14 offset:20480
  v_mfma_f32_16x16x32_bf16 v[208:211], a[248:251], v[52:55], v[208:211]
  v_mfma_f32_16x16x32_bf16 v[212:215], a[252:255], v[52:55], v[212:215]
  ds_read_b64_tr_b16 v[38:39], v14 offset:20992
  v_mfma_f32_16x16x32_bf16 v[212:215], a[244:247], v[48:51], v[212:215]
  s_waitcnt lgkmcnt(4)
  v_mfma_f32_16x16x32_bf16 v[220:223], a[244:247], v[56:59], v[220:223]
  ds_read_b64_tr_b16 v[40:41], v15 offset:16384
  v_mfma_f32_16x16x32_bf16 v[220:223], a[252:255], v[60:63], v[220:223]
  buffer_load_dwordx4 a[196:199], v1, s[28:31], s65 offen offset:1024 sc1
  v_mfma_f32_16x16x32_bf16 v[216:219], a[248:251], v[60:63], v[216:219]
  ds_read_b64_tr_b16 v[42:43], v15 offset:16896
  v_mfma_f32_16x16x32_bf16 v[216:219], a[240:243], v[56:59], v[216:219]
  v_mfma_f32_16x16x32_bf16 v[188:191], a[116:119], v[56:59], v[188:191]
  ds_read_b64_tr_b16 v[44:45], v15 offset:20480
  v_mfma_f32_16x16x32_bf16 v[188:191], a[124:127], v[60:63], v[188:191]
  v_mfma_f32_16x16x32_bf16 v[184:187], a[120:123], v[60:63], v[184:187]
  ds_read_b64_tr_b16 v[46:47], v15 offset:20992
  v_mfma_f32_16x16x32_bf16 v[184:187], a[112:115], v[56:59], v[184:187]
  s_waitcnt vmcnt(35) lgkmcnt(4)
  buffer_load_dwordx4 a[72:75], v1, s[28:31], s64 offen offset:2048 sc1
  v_mfma_f32_16x16x32_bf16 v[96:99], v[32:35], a[0:3], v[224:227]
  ds_read_b64_tr_b16 v[48:49], v16 offset:16384
  v_mfma_f32_16x16x32_bf16 v[96:99], v[36:39], a[8:11], v[96:99]
  v_mfma_f32_16x16x32_bf16 v[104:107], v[36:39], a[12:15], v[224:227]
  ds_read_b64_tr_b16 v[50:51], v16 offset:16896
  v_cvt_pk_bf16_f32 v160, v160, v161
  v_mfma_f32_16x16x32_bf16 v[104:107], v[32:35], a[4:7], v[104:107]
  v_cvt_pk_bf16_f32 v161, v162, v163
  v_cvt_pk_bf16_f32 v162, v164, v165
  v_mfma_f32_16x16x32_bf16 v[112:115], v[32:35], a[128:131], v[224:227]
  ds_read_b64_tr_b16 v[52:53], v16 offset:20480
  v_cvt_pk_bf16_f32 v163, v166, v167
  v_mfma_f32_16x16x32_bf16 v[112:115], v[36:39], a[136:139], v[112:115]
  buffer_load_dwordx4 a[200:203], v1, s[28:31], s65 offen offset:2048 sc1
  v_mfma_f32_16x16x32_bf16 v[120:123], v[36:39], a[140:143], v[224:227]
  ds_read_b64_tr_b16 v[54:55], v16 offset:20992
  v_cvt_pk_bf16_f32 v168, v168, v169
  v_mfma_f32_16x16x32_bf16 v[120:123], v[32:35], a[132:135], v[120:123]
  s_waitcnt lgkmcnt(4)
  buffer_store_dwordx4 v[88:91], v1, s[28:31], s88 offen offset:1024
  v_mfma_f32_16x16x32_bf16 v[124:127], v[40:43], a[132:135], v[228:231]
  ds_read_b64_tr_b16 v[56:57], v17 offset:16384
  v_cvt_pk_bf16_f32 v169, v170, v171
  v_mfma_f32_16x16x32_bf16 v[124:127], v[44:47], a[140:143], v[124:127]
  v_cvt_pk_bf16_f32 v170, v172, v173
  v_mfma_f32_16x16x32_bf16 v[116:119], v[44:47], a[136:139], v[228:231]
  ds_read_b64_tr_b16 v[58:59], v17 offset:16896
  v_cvt_pk_bf16_f32 v171, v174, v175
  v_mfma_f32_16x16x32_bf16 v[116:119], v[40:43], a[128:131], v[116:119]
  buffer_load_dwordx4 a[76:79], v1, s[28:31], s64 offen offset:3072 sc1
  v_mfma_f32_16x16x32_bf16 v[108:111], v[40:43], a[4:7], v[228:231]
  ds_read_b64_tr_b16 v[60:61], v17 offset:20480
  v_cvt_pk_bf16_f32 v176, v176, v177
  v_mfma_f32_16x16x32_bf16 v[108:111], v[44:47], a[12:15], v[108:111]
  v_cvt_pk_bf16_f32 v177, v178, v179
  v_cvt_pk_bf16_f32 v178, v180, v181
  v_mfma_f32_16x16x32_bf16 v[100:103], v[44:47], a[8:11], v[228:231]
  ds_read_b64_tr_b16 v[62:63], v17 offset:20992
  v_mfma_f32_16x16x32_bf16 v[100:103], v[40:43], a[0:3], v[100:103]
  s_waitcnt lgkmcnt(4)
  v_cvt_pk_bf16_f32 v179, v182, v183
  v_cvt_pk_bf16_f32 v184, v184, v185
  v_mfma_f32_16x16x32_bf16 v[128:131], v[48:51], a[0:3], v[232:235]
  ds_read_b64_tr_b16 v[32:33], v14 offset:24576
  v_cvt_pk_bf16_f32 v185, v186, v187
  v_mfma_f32_16x16x32_bf16 v[128:131], v[52:55], a[8:11], v[128:131]
  buffer_load_dwordx4 a[204:207], v1, s[28:31], s65 offen offset:3072 sc1
  v_mfma_f32_16x16x32_bf16 v[136:139], v[52:55], a[12:15], v[232:235]
  ds_read_b64_tr_b16 v[34:35], v14 offset:25088
  v_cvt_pk_bf16_f32 v186, v188, v189
  v_mfma_f32_16x16x32_bf16 v[136:139], v[48:51], a[4:7], v[136:139]
  v_cvt_pk_bf16_f32 v187, v190, v191
  v_cvt_pk_bf16_f32 v192, v192, v193
  v_mfma_f32_16x16x32_bf16 v[144:147], v[48:51], a[128:131], v[232:235]
  ds_read_b64_tr_b16 v[36:37], v14 offset:28672
  v_mfma_f32_16x16x32_bf16 v[144:147], v[52:55], a[136:139], v[144:147]
  v_cvt_pk_bf16_f32 v193, v194, v195
  v_cvt_pk_bf16_f32 v194, v196, v197
  v_mfma_f32_16x16x32_bf16 v[152:155], v[52:55], a[140:143], v[232:235]
  ds_read_b64_tr_b16 v[38:39], v14 offset:29184
  v_add_u32 v14, 0xfffe0000, v14
  v_mfma_f32_16x16x32_bf16 v[152:155], v[48:51], a[132:135], v[152:155]
  s_waitcnt lgkmcnt(4)
  v_cvt_pk_bf16_f32 v195, v198, v199
  v_cvt_pk_bf16_f32 v200, v200, v201
  v_mfma_f32_16x16x32_bf16 v[156:159], v[56:59], a[132:135], v[236:239]
  s_add_u32 s64, s92, s70
  ds_read_b64_tr_b16 v[40:41], v15 offset:24576
  v_cvt_pk_bf16_f32 v201, v202, v203
  v_mfma_f32_16x16x32_bf16 v[156:159], v[60:63], a[140:143], v[156:159]
  s_add_u32 s65, s93, s70
  buffer_load_dwordx4 a[80:83], v1, s[28:31], s64 offen offset:0 sc1
  v_mfma_f32_16x16x32_bf16 v[148:151], v[60:63], a[136:139], v[236:239]
  s_add_u32 s70, s70, 4096
  ds_read_b64_tr_b16 v[42:43], v15 offset:25088
  v_mfma_f32_16x16x32_bf16 v[148:151], v[56:59], a[128:131], v[148:151]
  s_and_b32 s70, s70, 0x7fff
  v_cvt_pk_bf16_f32 v202, v204, v205
  v_cvt_pk_bf16_f32 v203, v206, v207
  v_mfma_f32_16x16x32_bf16 v[140:143], v[56:59], a[4:7], v[236:239]
  ds_read_b64_tr_b16 v[44:45], v15 offset:28672
  v_cvt_pk_bf16_f32 v208, v208, v209
  v_mfma_f32_16x16x32_bf16 v[140:143], v[60:63], a[12:15], v[140:143]
  v_cvt_pk_bf16_f32 v209, v210, v211
  v_cvt_pk_bf16_f32 v210, v212, v213
  v_mfma_f32_16x16x32_bf16 v[132:135], v[60:63], a[8:11], v[236:239]
  ds_read_b64_tr_b16 v[46:47], v15 offset:29184
  v_add_u32 v15, 0xfffe0000, v15
  v_mfma_f32_16x16x32_bf16 v[132:135], v[56:59], a[0:3], v[132:135]
  s_waitcnt vmcnt(31) lgkmcnt(4)
  buffer_load_dwordx4 a[208:211], v1, s[28:31], s65 offen offset:0 sc1
  v_mfma_f32_16x16x32_bf16 v[96:99], v[32:35], a[16:19], v[96:99]
  ds_read_b64_tr_b16 v[48:49], v16 offset:24576
  v_mfma_f32_16x16x32_bf16 v[96:99], v[36:39], a[24:27], v[96:99]
  buffer_store_dwordx4 v[92:95], v1, s[28:31], s89 offen offset:1024
  v_mfma_f32_16x16x32_bf16 v[104:107], v[36:39], a[28:31], v[104:107]
  ds_read_b64_tr_b16 v[50:51], v16 offset:25088
  v_cvt_pk_bf16_f32 v211, v214, v215
  v_mfma_f32_16x16x32_bf16 v[104:107], v[32:35], a[20:23], v[104:107]
  v_cvt_pk_bf16_f32 v216, v216, v217
  v_cvt_pk_bf16_f32 v217, v218, v219
  v_mfma_f32_16x16x32_bf16 v[112:115], v[32:35], a[144:147], v[112:115]
  ds_read_b64_tr_b16 v[52:53], v16 offset:28672
  v_cvt_pk_bf16_f32 v218, v220, v221
  v_mfma_f32_16x16x32_bf16 v[112:115], v[36:39], a[152:155], v[112:115]
  buffer_load_dwordx4 a[84:87], v1, s[28:31], s64 offen offset:1024 sc1
  v_mfma_f32_16x16x32_bf16 v[120:123], v[36:39], a[156:159], v[120:123]
  ds_read_b64_tr_b16 v[54:55], v16 offset:29184
  v_add_u32 v16, 0xfffe0000, v16
  v_mfma_f32_16x16x32_bf16 v[120:123], v[32:35], a[148:151], v[120:123]
  s_waitcnt lgkmcnt(4)
  v_cvt_pk_bf16_f32 v219, v222, v223
  v_mfma_f32_16x16x32_bf16 v[124:127], v[40:43], a[148:151], v[124:127]
  ds_read_b64_tr_b16 v[56:57], v17 offset:24576
  v_mfma_f32_16x16x32_bf16 v[124:127], v[44:47], a[156:159], v[124:127]
  v_mfma_f32_16x16x32_bf16 v[116:119], v[44:47], a[152:155], v[116:119]
  ds_read_b64_tr_b16 v[58:59], v17 offset:25088
  v_mfma_f32_16x16x32_bf16 v[116:119], v[40:43], a[144:147], v[116:119]
  buffer_load_dwordx4 a[212:215], v1, s[28:31], s65 offen offset:1024 sc1
  v_mfma_f32_16x16x32_bf16 v[108:111], v[40:43], a[20:23], v[108:111]
  ds_read_b64_tr_b16 v[60:61], v17 offset:28672
  v_mfma_f32_16x16x32_bf16 v[108:111], v[44:47], a[28:31], v[108:111]
  v_mfma_f32_16x16x32_bf16 v[100:103], v[44:47], a[24:27], v[100:103]
  ds_read_b64_tr_b16 v[62:63], v17 offset:29184
  v_add_u32 v17, 0xfffe0000, v17
  v_mfma_f32_16x16x32_bf16 v[100:103], v[40:43], a[16:19], v[100:103]
  s_waitcnt lgkmcnt(4)
  v_mfma_f32_16x16x32_bf16 v[128:131], v[48:51], a[16:19], v[128:131]
  ds_read_b64_tr_b16 v[32:33], v14 offset:16384
  v_mfma_f32_16x16x32_bf16 v[128:131], v[52:55], a[24:27], v[128:131]
  buffer_load_dwordx4 a[88:91], v1, s[28:31], s64 offen offset:2048 sc1
  v_mfma_f32_16x16x32_bf16 v[136:139], v[52:55], a[28:31], v[136:139]
  ds_read_b64_tr_b16 v[34:35], v14 offset:16896
  v_mfma_f32_16x16x32_bf16 v[136:139], v[48:51], a[20:23], v[136:139]
  v_mfma_f32_16x16x32_bf16 v[144:147], v[48:51], a[144:147], v[144:147]
  ds_read_b64_tr_b16 v[36:37], v14 offset:20480
  v_mfma_f32_16x16x32_bf16 v[144:147], v[52:55], a[152:155], v[144:147]
  v_mfma_f32_16x16x32_bf16 v[152:155], v[52:55], a[156:159], v[152:155]
  ds_read_b64_tr_b16 v[38:39], v14 offset:20992
  v_mfma_f32_16x16x32_bf16 v[152:155], v[48:51], a[148:151], v[152:155]
  s_waitcnt lgkmcnt(4)
  buffer_load_dwordx4 a[216:219], v1, s[28:31], s65 offen offset:2048 sc1
  v_mfma_f32_16x16x32_bf16 v[156:159], v[56:59], a[148:151], v[156:159]
  ds_read_b64_tr_b16 v[40:41], v15 offset:16384
  v_mfma_f32_16x16x32_bf16 v[156:159], v[60:63], a[156:159], v[156:159]
  buffer_store_dwordx4 v[160:163], v1, s[28:31], s87 offen offset:0
  v_mfma_f32_16x16x32_bf16 v[148:151], v[60:63], a[152:155], v[148:151]
  ds_read_b64_tr_b16 v[42:43], v15 offset:16896
  v_mfma_f32_16x16x32_bf16 v[148:151], v[56:59], a[144:147], v[148:151]
  v_mfma_f32_16x16x32_bf16 v[140:143], v[56:59], a[20:23], v[140:143]
  ds_read_b64_tr_b16 v[44:45], v15 offset:20480
  v_mfma_f32_16x16x32_bf16 v[140:143], v[60:63], a[28:31], v[140:143]
  buffer_load_dwordx4 a[92:95], v1, s[28:31], s64 offen offset:3072 sc1
  v_mfma_f32_16x16x32_bf16 v[132:135], v[60:63], a[24:27], v[132:135]
  ds_read_b64_tr_b16 v[46:47], v15 offset:20992
  v_mfma_f32_16x16x32_bf16 v[132:135], v[56:59], a[16:19], v[132:135]
  s_waitcnt vmcnt(29) lgkmcnt(4)
  v_mfma_f32_16x16x32_bf16 v[96:99], v[32:35], a[32:35], v[96:99]
  ds_read_b64_tr_b16 v[48:49], v16 offset:16384
  v_mfma_f32_16x16x32_bf16 v[96:99], v[36:39], a[40:43], v[96:99]
  v_mfma_f32_16x16x32_bf16 v[104:107], v[36:39], a[44:47], v[104:107]
  ds_read_b64_tr_b16 v[50:51], v16 offset:16896
  v_mfma_f32_16x16x32_bf16 v[104:107], v[32:35], a[36:39], v[104:107]
  buffer_load_dwordx4 a[220:223], v1, s[28:31], s65 offen offset:3072 sc1
  v_mfma_f32_16x16x32_bf16 v[112:115], v[32:35], a[160:163], v[112:115]
  ds_read_b64_tr_b16 v[52:53], v16 offset:20480
  v_mfma_f32_16x16x32_bf16 v[112:115], v[36:39], a[168:171], v[112:115]
  v_mfma_f32_16x16x32_bf16 v[120:123], v[36:39], a[172:175], v[120:123]
  ds_read_b64_tr_b16 v[54:55], v16 offset:20992
  v_mfma_f32_16x16x32_bf16 v[120:123], v[32:35], a[164:167], v[120:123]
  s_waitcnt lgkmcnt(4)
  v_mfma_f32_16x16x32_bf16 v[124:127], v[40:43], a[164:167], v[124:127]
  s_add_u32 s64, s92, s70
  ds_read_b64_tr_b16 v[56:57], v17 offset:16384
  v_mfma_f32_16x16x32_bf16 v[124:127], v[44:47], a[172:175], v[124:127]
  s_add_u32 s65, s93, s70
  buffer_load_dwordx4 a[96:99], v1, s[28:31], s64 offen offset:0 sc1
  v_mfma_f32_16x16x32_bf16 v[116:119], v[44:47], a[168:171], v[116:119]
  s_add_u32 s70, s70, 4096
  ds_read_b64_tr_b16 v[58:59], v17 offset:16896
  v_mfma_f32_16x16x32_bf16 v[116:119], v[40:43], a[160:163], v[116:119]
  s_and_b32 s70, s70, 0x7fff
  v_mfma_f32_16x16x32_bf16 v[108:111], v[40:43], a[36:39], v[108:111]
  ds_read_b64_tr_b16 v[60:61], v17 offset:20480
  v_mfma_f32_16x16x32_bf16 v[108:111], v[44:47], a[44:47], v[108:111]
  v_mfma_f32_16x16x32_bf16 v[100:103], v[44:47], a[40:43], v[100:103]
  ds_read_b64_tr_b16 v[62:63], v17 offset:20992
  v_mfma_f32_16x16x32_bf16 v[100:103], v[40:43], a[32:35], v[100:103]
  s_waitcnt lgkmcnt(4)
  buffer_load_dwordx4 a[224:227], v1, s[28:31], s65 offen offset:0 sc1
  v_mfma_f32_16x16x32_bf16 v[128:131], v[48:51], a[32:35], v[128:131]
  ds_read_b64_tr_b16 v[32:33], v14 offset:24576
  v_mfma_f32_16x16x32_bf16 v[128:131], v[52:55], a[40:43], v[128:131]
  buffer_store_dwordx4 v[168:171], v1, s[28:31], s87 offen offset:1024
  v_mfma_f32_16x16x32_bf16 v[136:139], v[52:55], a[44:47], v[136:139]
  ds_read_b64_tr_b16 v[34:35], v14 offset:25088
  v_mfma_f32_16x16x32_bf16 v[136:139], v[48:51], a[36:39], v[136:139]
  v_mfma_f32_16x16x32_bf16 v[144:147], v[48:51], a[160:163], v[144:147]
  ds_read_b64_tr_b16 v[36:37], v14 offset:28672
  v_mfma_f32_16x16x32_bf16 v[144:147], v[52:55], a[168:171], v[144:147]
  v_mfma_f32_16x16x32_bf16 v[152:155], v[52:55], a[172:175], v[152:155]
  ds_read_b64_tr_b16 v[38:39], v14 offset:29184
  v_mfma_f32_16x16x32_bf16 v[152:155], v[48:51], a[164:167], v[152:155]
  s_waitcnt lgkmcnt(4)
  buffer_load_dwordx4 a[100:103], v1, s[28:31], s64 offen offset:1024 sc1
  v_mfma_f32_16x16x32_bf16 v[156:159], v[56:59], a[164:167], v[156:159]
  ds_read_b64_tr_b16 v[40:41], v15 offset:24576
  v_mfma_f32_16x16x32_bf16 v[156:159], v[60:63], a[172:175], v[156:159]
  v_mfma_f32_16x16x32_bf16 v[148:151], v[60:63], a[168:171], v[148:151]
  ds_read_b64_tr_b16 v[42:43], v15 offset:25088
  v_mfma_f32_16x16x32_bf16 v[148:151], v[56:59], a[160:163], v[148:151]
  v_mfma_f32_16x16x32_bf16 v[140:143], v[56:59], a[36:39], v[140:143]
  ds_read_b64_tr_b16 v[44:45], v15 offset:28672
  v_mfma_f32_16x16x32_bf16 v[140:143], v[60:63], a[44:47], v[140:143]
  buffer_load_dwordx4 a[228:231], v1, s[28:31], s65 offen offset:1024 sc1
  v_mfma_f32_16x16x32_bf16 v[132:135], v[60:63], a[40:43], v[132:135]
  ds_read_b64_tr_b16 v[46:47], v15 offset:29184
  v_mfma_f32_16x16x32_bf16 v[132:135], v[56:59], a[32:35], v[132:135]
  s_waitcnt vmcnt(24) lgkmcnt(4)
  v_mfma_f32_16x16x32_bf16 v[96:99], v[32:35], a[48:51], v[96:99]
  ds_read_b64_tr_b16 v[48:49], v16 offset:24576
  v_mfma_f32_16x16x32_bf16 v[96:99], v[36:39], a[56:59], v[96:99]
  v_mfma_f32_16x16x32_bf16 v[104:107], v[36:39], a[60:63], v[104:107]
  ds_read_b64_tr_b16 v[50:51], v16 offset:25088
  v_mfma_f32_16x16x32_bf16 v[104:107], v[32:35], a[52:55], v[104:107]
  buffer_load_dwordx4 a[104:107], v1, s[28:31], s64 offen offset:2048 sc1
  v_mfma_f32_16x16x32_bf16 v[112:115], v[32:35], a[176:179], v[112:115]
  ds_read_b64_tr_b16 v[52:53], v16 offset:28672
  v_mfma_f32_16x16x32_bf16 v[112:115], v[36:39], a[184:187], v[112:115]
  v_mfma_f32_16x16x32_bf16 v[120:123], v[36:39], a[188:191], v[120:123]
  ds_read_b64_tr_b16 v[54:55], v16 offset:29184
  v_mfma_f32_16x16x32_bf16 v[120:123], v[32:35], a[180:183], v[120:123]
  s_waitcnt lgkmcnt(4)
  buffer_store_dwordx4 v[176:179], v1, s[28:31], s87 offen offset:2048
  v_mfma_f32_16x16x32_bf16 v[124:127], v[40:43], a[180:183], v[124:127]
  ds_read_b64_tr_b16 v[56:57], v17 offset:24576
  v_mfma_f32_16x16x32_bf16 v[124:127], v[44:47], a[188:191], v[124:127]
  buffer_load_dwordx4 a[232:235], v1, s[28:31], s65 offen offset:2048 sc1
  v_mfma_f32_16x16x32_bf16 v[116:119], v[44:47], a[184:187], v[116:119]
  ds_read_b64_tr_b16 v[58:59], v17 offset:25088
  v_mfma_f32_16x16x32_bf16 v[116:119], v[40:43], a[176:179], v[116:119]
  v_mfma_f32_16x16x32_bf16 v[108:111], v[40:43], a[52:55], v[108:111]
  ds_read_b64_tr_b16 v[60:61], v17 offset:28672
  v_mfma_f32_16x16x32_bf16 v[108:111], v[44:47], a[60:63], v[108:111]
  v_mfma_f32_16x16x32_bf16 v[100:103], v[44:47], a[56:59], v[100:103]
  ds_read_b64_tr_b16 v[62:63], v17 offset:29184
  v_mfma_f32_16x16x32_bf16 v[100:103], v[40:43], a[48:51], v[100:103]
  s_waitcnt lgkmcnt(4)
  buffer_load_dwordx4 a[108:111], v1, s[28:31], s64 offen offset:3072 sc1
  v_mfma_f32_16x16x32_bf16 v[128:131], v[48:51], a[48:51], v[128:131]
  ds_read_b64_tr_b16 v[32:33], v14 offset:32768
  v_mfma_f32_16x16x32_bf16 v[128:131], v[52:55], a[56:59], v[128:131]
  v_mfma_f32_16x16x32_bf16 v[136:139], v[52:55], a[60:63], v[136:139]
  ds_read_b64_tr_b16 v[34:35], v14 offset:33280
  v_mfma_f32_16x16x32_bf16 v[136:139], v[48:51], a[52:55], v[136:139]
  v_mfma_f32_16x16x32_bf16 v[144:147], v[48:51], a[176:179], v[144:147]
  ds_read_b64_tr_b16 v[36:37], v14 offset:36864
  v_mfma_f32_16x16x32_bf16 v[144:147], v[52:55], a[184:187], v[144:147]
  buffer_load_dwordx4 a[236:239], v1, s[28:31], s65 offen offset:3072 sc1
  v_mfma_f32_16x16x32_bf16 v[152:155], v[52:55], a[188:191], v[152:155]
  ds_read_b64_tr_b16 v[38:39], v14 offset:37376
  v_mfma_f32_16x16x32_bf16 v[152:155], v[48:51], a[180:183], v[152:155]
  s_waitcnt lgkmcnt(4)
  v_mfma_f32_16x16x32_bf16 v[156:159], v[56:59], a[180:183], v[156:159]
  ds_read_b64_tr_b16 v[40:41], v15 offset:32768
  v_mfma_f32_16x16x32_bf16 v[156:159], v[60:63], a[188:191], v[156:159]
  v_mfma_f32_16x16x32_bf16 v[148:151], v[60:63], a[184:187], v[148:151]
  s_add_u32 s64, s92, s70
  ds_read_b64_tr_b16 v[42:43], v15 offset:33280
  v_mfma_f32_16x16x32_bf16 v[148:151], v[56:59], a[176:179], v[148:151]
  s_add_u32 s65, s93, s70
  buffer_load_dwordx4 a[112:115], v1, s[28:31], s64 offen offset:0 sc1
  v_mfma_f32_16x16x32_bf16 v[140:143], v[56:59], a[52:55], v[140:143]
  s_add_u32 s70, s70, 4096
  ds_read_b64_tr_b16 v[44:45], v15 offset:36864
  v_mfma_f32_16x16x32_bf16 v[140:143], v[60:63], a[60:63], v[140:143]
  s_and_b32 s70, s70, 0x7fff
  v_mfma_f32_16x16x32_bf16 v[132:135], v[60:63], a[56:59], v[132:135]
  ds_read_b64_tr_b16 v[46:47], v15 offset:37376
  v_mfma_f32_16x16x32_bf16 v[132:135], v[56:59], a[48:51], v[132:135]
  s_waitcnt vmcnt(21) lgkmcnt(4)
  buffer_store_dwordx4 v[184:187], v1, s[28:31], s87 offen offset:3072
  v_mfma_f32_16x16x32_bf16 v[96:99], v[32:35], a[64:67], v[96:99]
  ds_read_b64_tr_b16 v[48:49], v16 offset:32768
  v_mfma_f32_16x16x32_bf16 v[96:99], v[36:39], a[72:75], v[96:99]
  buffer_load_dwordx4 a[240:243], v1, s[28:31], s65 offen offset:0 sc1
  v_mfma_f32_16x16x32_bf16 v[104:107], v[36:39], a[76:79], v[104:107]
  ds_read_b64_tr_b16 v[50:51], v16 offset:33280
  v_mfma_f32_16x16x32_bf16 v[104:107], v[32:35], a[68:71], v[104:107]
  v_mfma_f32_16x16x32_bf16 v[112:115], v[32:35], a[192:195], v[112:115]
  ds_read_b64_tr_b16 v[52:53], v16 offset:36864
  v_mfma_f32_16x16x32_bf16 v[112:115], v[36:39], a[200:203], v[112:115]
  v_mfma_f32_16x16x32_bf16 v[120:123], v[36:39], a[204:207], v[120:123]
  ds_read_b64_tr_b16 v[54:55], v16 offset:37376
  v_mfma_f32_16x16x32_bf16 v[120:123], v[32:35], a[196:199], v[120:123]
  s_waitcnt lgkmcnt(4)
  buffer_load_dwordx4 a[116:119], v1, s[28:31], s64 offen offset:1024 sc1
  v_mfma_f32_16x16x32_bf16 v[124:127], v[40:43], a[196:199], v[124:127]
  s_mov_b32 s8, s66
  ds_read_b64_tr_b16 v[56:57], v17 offset:32768
  v_mfma_f32_16x16x32_bf16 v[124:127], v[44:47], a[204:207], v[124:127]
  s_and_b32 s9, s67, 0xffff
  v_mfma_f32_16x16x32_bf16 v[116:119], v[44:47], a[200:203], v[116:119]
  s_mov_b32 s10, 1835008
  ds_read_b64_tr_b16 v[58:59], v17 offset:33280
  v_mfma_f32_16x16x32_bf16 v[116:119], v[40:43], a[192:195], v[116:119]
  s_mov_b32 s11, 0x20000
  v_mfma_f32_16x16x32_bf16 v[108:111], v[40:43], a[68:71], v[108:111]
  s_mov_b32 s12, s58
  ds_read_b64_tr_b16 v[60:61], v17 offset:36864
  v_mfma_f32_16x16x32_bf16 v[108:111], v[44:47], a[76:79], v[108:111]
  s_and_b32 s13, s59, 0xffff
  buffer_load_dwordx4 a[244:247], v1, s[28:31], s65 offen offset:1024 sc1
  v_mfma_f32_16x16x32_bf16 v[100:103], v[44:47], a[72:75], v[100:103]
  s_mov_b32 s14, 4194304
  ds_read_b64_tr_b16 v[62:63], v17 offset:37376
  v_mfma_f32_16x16x32_bf16 v[100:103], v[40:43], a[64:67], v[100:103]
  s_waitcnt lgkmcnt(4)
  v_mfma_f32_16x16x32_bf16 v[128:131], v[48:51], a[64:67], v[128:131]
  s_mov_b32 s15, 0x20000
  ds_read_b64_tr_b16 v[32:33], v14 offset:40960
  v_mfma_f32_16x16x32_bf16 v[128:131], v[52:55], a[72:75], v[128:131]
  s_mov_b32 s16, s68
  v_mfma_f32_16x16x32_bf16 v[136:139], v[52:55], a[76:79], v[136:139]
  s_and_b32 s17, s69, 0xffff
  ds_read_b64_tr_b16 v[34:35], v14 offset:41472
  v_mfma_f32_16x16x32_bf16 v[136:139], v[48:51], a[68:71], v[136:139]
  s_mov_b32 s18, 2097152
  v_mfma_f32_16x16x32_bf16 v[144:147], v[48:51], a[192:195], v[144:147]
  s_mov_b32 s19, 0x20000
  ds_read_b64_tr_b16 v[36:37], v14 offset:45056
  v_mfma_f32_16x16x32_bf16 v[144:147], v[52:55], a[200:203], v[144:147]
  s_mul_i32 s6, s4, 1048576
  buffer_load_dwordx4 a[120:123], v1, s[28:31], s64 offen offset:2048 sc1
  v_mfma_f32_16x16x32_bf16 v[152:155], v[52:55], a[204:207], v[152:155]
  s_add_u32 s6, s6, s77
  ds_read_b64_tr_b16 v[38:39], v14 offset:45568
L_pad5:
  s_cbranch_execz L_pad9
  v_mfma_f32_16x16x32_bf16 v[152:155], v[48:51], a[196:199], v[152:155]
  s_waitcnt lgkmcnt(4)
  buffer_store_dwordx4 v[192:195], v1, s[28:31], s91 offen offset:0
  v_mfma_f32_16x16x32_bf16 v[156:159], v[56:59], a[196:199], v[156:159]
  s_add_u32 s6, s6, 2097152
  ds_read_b64_tr_b16 v[40:41], v15 offset:40960
  v_mfma_f32_16x16x32_bf16 v[156:159], v[60:63], a[204:207], v[156:159]
  s_mov_b32 s38, 0x100000
  v_mfma_f32_16x16x32_bf16 v[148:151], v[60:63], a[200:203], v[148:151]
  s_add_u32 s36, s72, s6
  s_addc_u32 s37, s73, 0
  ds_read_b64_tr_b16 v[42:43], v15 offset:41472
  v_mfma_f32_16x16x32_bf16 v[148:151], v[56:59], a[192:195], v[148:151]
  s_and_b32 s37, s37, 0xffff
  buffer_load_dwordx4 a[248:251], v1, s[28:31], s65 offen offset:2048 sc1
  v_mfma_f32_16x16x32_bf16 v[140:143], v[56:59], a[68:71], v[140:143]
  s_lshl_b32 s82, s4, 5
  ds_read_b64_tr_b16 v[44:45], v15 offset:45056
  v_mfma_f32_16x16x32_bf16 v[140:143], v[60:63], a[76:79], v[140:143]
  s_add_u32 s82, s82, s48
  v_mfma_f32_16x16x32_bf16 v[132:135], v[60:63], a[72:75], v[132:135]
  s_lshl_b32 s82, s82, 2
  ds_read_b64_tr_b16 v[46:47], v15 offset:45568
  v_mfma_f32_16x16x32_bf16 v[132:135], v[56:59], a[64:67], v[132:135]
  s_waitcnt vmcnt(18) lgkmcnt(4)
  v_mfma_f32_16x16x32_bf16 v[96:99], v[32:35], a[80:83], v[96:99]
  s_add_u32 s82, s82, 60882944
  ds_read_b64_tr_b16 v[48:49], v16 offset:40960
  v_mfma_f32_16x16x32_bf16 v[96:99], v[36:39], a[88:91], v[96:99]
  s_and_b32 s80, s82, 0xffffff80
  buffer_load_dwordx4 a[124:127], v1, s[28:31], s64 offen offset:3072 sc1
  v_mfma_f32_16x16x32_bf16 v[104:107], v[36:39], a[92:95], v[104:107]
  s_mov_b32 s71, 0
  ds_read_b64_tr_b16 v[50:51], v16 offset:41472
  v_mfma_f32_16x16x32_bf16 v[104:107], v[32:35], a[84:87], v[104:107]
  s_mul_i32 s56, s2, 7168
  v_mfma_f32_16x16x32_bf16 v[112:115], v[32:35], a[208:211], v[112:115]
  s_cmp_eq_u32 s3, 2
  s_cselect_b32 s56, s56, 0x1000000
  ds_read_b64_tr_b16 v[52:53], v16 offset:45056
  v_mfma_f32_16x16x32_bf16 v[112:115], v[36:39], a[216:219], v[112:115]
  v_mfma_f32_16x16x32_bf16 v[120:123], v[36:39], a[220:223], v[120:123]
  ds_read_b64_tr_b16 v[54:55], v16 offset:45568
  v_mfma_f32_16x16x32_bf16 v[120:123], v[32:35], a[212:215], v[120:123]
  s_waitcnt lgkmcnt(4)
  buffer_load_dwordx4 a[252:255], v1, s[28:31], s65 offen offset:3072 sc1
  v_mfma_f32_16x16x32_bf16 v[124:127], v[40:43], a[212:215], v[124:127]
  ds_read_b64_tr_b16 v[56:57], v17 offset:40960
  v_mfma_f32_16x16x32_bf16 v[124:127], v[44:47], a[220:223], v[124:127]
  v_mfma_f32_16x16x32_bf16 v[116:119], v[44:47], a[216:219], v[116:119]
  ds_read_b64_tr_b16 v[58:59], v17 offset:41472
  v_mfma_f32_16x16x32_bf16 v[116:119], v[40:43], a[208:211], v[116:119]
  v_mfma_f32_16x16x32_bf16 v[108:111], v[40:43], a[84:87], v[108:111]
  ds_read_b64_tr_b16 v[60:61], v17 offset:45056
  v_mfma_f32_16x16x32_bf16 v[108:111], v[44:47], a[92:95], v[108:111]
  v_mfma_f32_16x16x32_bf16 v[100:103], v[44:47], a[88:91], v[100:103]
  ds_read_b64_tr_b16 v[62:63], v17 offset:45568
  v_mfma_f32_16x16x32_bf16 v[100:103], v[40:43], a[80:83], v[100:103]
  s_waitcnt lgkmcnt(4)
  buffer_store_dwordx4 v[200:203], v1, s[28:31], s91 offen offset:1024
  v_mfma_f32_16x16x32_bf16 v[128:131], v[48:51], a[80:83], v[128:131]
  ds_read_b64_tr_b16 v[32:33], v14 offset:49152
  v_mfma_f32_16x16x32_bf16 v[128:131], v[52:55], a[88:91], v[128:131]
  v_mfma_f32_16x16x32_bf16 v[136:139], v[52:55], a[92:95], v[136:139]
  ds_read_b64_tr_b16 v[34:35], v14 offset:49664
  v_mfma_f32_16x16x32_bf16 v[136:139], v[48:51], a[84:87], v[136:139]
  v_mfma_f32_16x16x32_bf16 v[144:147], v[48:51], a[208:211], v[144:147]
  ds_read_b64_tr_b16 v[36:37], v14 offset:53248
  v_mfma_f32_16x16x32_bf16 v[144:147], v[52:55], a[216:219], v[144:147]
  v_mfma_f32_16x16x32_bf16 v[152:155], v[52:55], a[220:223], v[152:155]
  ds_read_b64_tr_b16 v[38:39], v14 offset:53760
  v_mfma_f32_16x16x32_bf16 v[152:155], v[48:51], a[212:215], v[152:155]
  s_waitcnt lgkmcnt(4)
  v_mfma_f32_16x16x32_bf16 v[156:159], v[56:59], a[212:215], v[156:159]
  ds_read_b64_tr_b16 v[40:41], v15 offset:49152
  v_mfma_f32_16x16x32_bf16 v[156:159], v[60:63], a[220:223], v[156:159]
  v_mfma_f32_16x16x32_bf16 v[148:151], v[60:63], a[216:219], v[148:151]
  ds_read_b64_tr_b16 v[42:43], v15 offset:49664
  v_mfma_f32_16x16x32_bf16 v[148:151], v[56:59], a[208:211], v[148:151]
  v_mfma_f32_16x16x32_bf16 v[140:143], v[56:59], a[84:87], v[140:143]
  ds_read_b64_tr_b16 v[44:45], v15 offset:53248
  v_mfma_f32_16x16x32_bf16 v[140:143], v[60:63], a[92:95], v[140:143]
  v_mfma_f32_16x16x32_bf16 v[132:135], v[60:63], a[88:91], v[132:135]
  ds_read_b64_tr_b16 v[46:47], v15 offset:53760
  v_mfma_f32_16x16x32_bf16 v[132:135], v[56:59], a[80:83], v[132:135]
  s_waitcnt vmcnt(11) lgkmcnt(4)
  v_mfma_f32_16x16x32_bf16 v[96:99], v[32:35], a[96:99], v[96:99]
  ds_read_b64_tr_b16 v[48:49], v16 offset:49152
  v_mfma_f32_16x16x32_bf16 v[96:99], v[36:39], a[104:107], v[96:99]
  v_mfma_f32_16x16x32_bf16 v[104:107], v[36:39], a[108:111], v[104:107]
  ds_read_b64_tr_b16 v[50:51], v16 offset:49664
  v_and_b32 v27, 31, v0
  v_mfma_f32_16x16x32_bf16 v[104:107], v[32:35], a[100:103], v[104:107]
  v_mfma_f32_16x16x32_bf16 v[112:115], v[32:35], a[224:227], v[112:115]
  ds_read_b64_tr_b16 v[52:53], v16 offset:53248
  v_lshlrev_b32 v27, 2, v27
  v_mfma_f32_16x16x32_bf16 v[112:115], v[36:39], a[232:235], v[112:115]
  v_mfma_f32_16x16x32_bf16 v[120:123], v[36:39], a[236:239], v[120:123]
  ds_read_b64_tr_b16 v[54:55], v16 offset:53760
  v_lshlrev_b32 v26, 7, v0
  v_mfma_f32_16x16x32_bf16 v[120:123], v[32:35], a[228:231], v[120:123]
  s_waitcnt lgkmcnt(4)
  buffer_store_dwordx4 v[208:211], v1, s[28:31], s91 offen offset:2048
  v_mfma_f32_16x16x32_bf16 v[124:127], v[40:43], a[228:231], v[124:127]
  ds_read_b64_tr_b16 v[56:57], v17 offset:49152
  v_mfma_f32_16x16x32_bf16 v[124:127], v[44:47], a[236:239], v[124:127]
  v_mfma_f32_16x16x32_bf16 v[116:119], v[44:47], a[232:235], v[116:119]
  ds_read_b64_tr_b16 v[58:59], v17 offset:49664
  v_mfma_f32_16x16x32_bf16 v[116:119], v[40:43], a[224:227], v[116:119]
  v_mfma_f32_16x16x32_bf16 v[108:111], v[40:43], a[100:103], v[108:111]
  ds_read_b64_tr_b16 v[60:61], v17 offset:53248
  v_mfma_f32_16x16x32_bf16 v[108:111], v[44:47], a[108:111], v[108:111]
  buffer_load_dword v29, v27, s[28:31], s80 offen sc1
  v_mfma_f32_16x16x32_bf16 v[100:103], v[44:47], a[104:107], v[100:103]
  ds_read_b64_tr_b16 v[62:63], v17 offset:53760
  v_mfma_f32_16x16x32_bf16 v[100:103], v[40:43], a[96:99], v[100:103]
  s_waitcnt lgkmcnt(4)
  v_mfma_f32_16x16x32_bf16 v[128:131], v[48:51], a[96:99], v[128:131]
  ds_read_b64_tr_b16 v[32:33], v14 offset:57344
  v_mfma_f32_16x16x32_bf16 v[128:131], v[52:55], a[104:107], v[128:131]
  v_mfma_f32_16x16x32_bf16 v[136:139], v[52:55], a[108:111], v[136:139]
  ds_read_b64_tr_b16 v[34:35], v14 offset:57856
  v_mfma_f32_16x16x32_bf16 v[136:139], v[48:51], a[100:103], v[136:139]
  v_mfma_f32_16x16x32_bf16 v[144:147], v[48:51], a[224:227], v[144:147]
  ds_read_b64_tr_b16 v[36:37], v14 offset:61440
  v_mfma_f32_16x16x32_bf16 v[144:147], v[52:55], a[232:235], v[144:147]
  v_mfma_f32_16x16x32_bf16 v[152:155], v[52:55], a[236:239], v[152:155]
  ds_read_b64_tr_b16 v[38:39], v14 offset:61952
  v_add_u32 v14, 0x10000, v14
  v_mfma_f32_16x16x32_bf16 v[152:155], v[48:51], a[228:231], v[152:155]
  s_waitcnt lgkmcnt(4)
  v_mfma_f32_16x16x32_bf16 v[156:159], v[56:59], a[228:231], v[156:159]
  ds_read_b64_tr_b16 v[40:41], v15 offset:57344
  v_mfma_f32_16x16x32_bf16 v[156:159], v[60:63], a[236:239], v[156:159]
  v_mfma_f32_16x16x32_bf16 v[148:151], v[60:63], a[232:235], v[148:151]
  ds_read_b64_tr_b16 v[42:43], v15 offset:57856
  v_mfma_f32_16x16x32_bf16 v[148:151], v[56:59], a[224:227], v[148:151]
  v_mfma_f32_16x16x32_bf16 v[140:143], v[56:59], a[100:103], v[140:143]
  ds_read_b64_tr_b16 v[44:45], v15 offset:61440
  v_mfma_f32_16x16x32_bf16 v[140:143], v[60:63], a[108:111], v[140:143]
  v_mfma_f32_16x16x32_bf16 v[132:135], v[60:63], a[104:107], v[132:135]
  ds_read_b64_tr_b16 v[46:47], v15 offset:61952
  v_add_u32 v15, 0x10000, v15
  v_mfma_f32_16x16x32_bf16 v[132:135], v[56:59], a[96:99], v[132:135]
  s_waitcnt vmcnt(3) lgkmcnt(4)
  buffer_store_dwordx4 v[216:219], v1, s[28:31], s91 offen offset:3072
  v_mfma_f32_16x16x32_bf16 v[96:99], v[32:35], a[112:115], v[96:99]
  ds_read_b64_tr_b16 v[48:49], v16 offset:57344
  v_mfma_f32_16x16x32_bf16 v[96:99], v[36:39], a[120:123], v[96:99]
  v_mfma_f32_16x16x32_bf16 v[104:107], v[36:39], a[124:127], v[104:107]
  ds_read_b64_tr_b16 v[50:51], v16 offset:57856
  v_mfma_f32_16x16x32_bf16 v[104:107], v[32:35], a[116:119], v[104:107]
  v_mfma_f32_16x16x32_bf16 v[112:115], v[32:35], a[240:243], v[112:115]
  ds_read_b64_tr_b16 v[52:53], v16 offset:61440
  v_mfma_f32_16x16x32_bf16 v[112:115], v[36:39], a[248:251], v[112:115]
  v_mfma_f32_16x16x32_bf16 v[120:123], v[36:39], a[252:255], v[120:123]
  ds_read_b64_tr_b16 v[54:55], v16 offset:61952
  v_add_u32 v16, 0x10000, v16
  v_mfma_f32_16x16x32_bf16 v[120:123], v[32:35], a[244:247], v[120:123]
  s_waitcnt lgkmcnt(4)
  v_mfma_f32_16x16x32_bf16 v[124:127], v[40:43], a[244:247], v[124:127]
  ds_read_b64_tr_b16 v[56:57], v17 offset:57344
  v_mfma_f32_16x16x32_bf16 v[124:127], v[44:47], a[252:255], v[124:127]
  v_mfma_f32_16x16x32_bf16 v[116:119], v[44:47], a[248:251], v[116:119]
  ds_read_b64_tr_b16 v[58:59], v17 offset:57856
  v_mfma_f32_16x16x32_bf16 v[116:119], v[40:43], a[240:243], v[116:119]
  v_mfma_f32_16x16x32_bf16 v[108:111], v[40:43], a[116:119], v[108:111]
  ds_read_b64_tr_b16 v[60:61], v17 offset:61440
  v_mfma_f32_16x16x32_bf16 v[108:111], v[44:47], a[124:127], v[108:111]
  v_mfma_f32_16x16x32_bf16 v[100:103], v[44:47], a[120:123], v[100:103]
  s_barrier
  ds_read_b64_tr_b16 v[62:63], v17 offset:61952
  v_add_u32 v17, 0x10000, v17
  v_mfma_f32_16x16x32_bf16 v[100:103], v[40:43], a[112:115], v[100:103]
  s_waitcnt lgkmcnt(4)
  v_mfma_f32_16x16x32_bf16 v[128:131], v[48:51], a[112:115], v[128:131]
  ds_read_b64_tr_b16 v[32:33], v14 offset:0
  v_mfma_f32_16x16x32_bf16 v[128:131], v[52:55], a[120:123], v[128:131]
  v_mfma_f32_16x16x32_bf16 v[136:139], v[52:55], a[124:127], v[136:139]
  s_add_u32 m0, s77, 0
  ds_read_b64_tr_b16 v[34:35], v14 offset:512
  v_mfma_f32_16x16x32_bf16 v[136:139], v[48:51], a[116:119], v[136:139]
  s_add_u32 s81, s62, 0
  buffer_load_dwordx4 v6, s[24:27], s81 offen offset:0 lds
  v_mfma_f32_16x16x32_bf16 v[144:147], v[48:51], a[240:243], v[144:147]
  ds_read_b64_tr_b16 v[36:37], v14 offset:4096
  v_mfma_f32_16x16x32_bf16 v[144:147], v[52:55], a[248:251], v[144:147]
  v_mfma_f32_16x16x32_bf16 v[152:155], v[52:55], a[252:255], v[152:155]
  ds_read_b64_tr_b16 v[38:39], v14 offset:4608
  v_mfma_f32_16x16x32_bf16 v[152:155], v[48:51], a[244:247], v[152:155]
  s_waitcnt lgkmcnt(4)
  v_mfma_f32_16x16x32_bf16 v[156:159], v[56:59], a[244:247], v[156:159]
  s_waitcnt vmcnt(2)
  ds_read_b64_tr_b16 v[40:41], v15 offset:0
  v_and_b32 v29, 0xff, v29
  v_mfma_f32_16x16x32_bf16 v[156:159], v[60:63], a[252:255], v[156:159]
  buffer_load_dwordx4 v7, s[24:27], s81 offen offset:1024 lds
  v_mfma_f32_16x16x32_bf16 v[148:151], v[60:63], a[248:251], v[148:151]
  ds_read_b64_tr_b16 v[42:43], v15 offset:512
  v_cmp_ne_u32 vcc, s57, v29
  v_mfma_f32_16x16x32_bf16 v[148:151], v[56:59], a[240:243], v[148:151]
  v_mov_b32 v29, s57
  v_or_b32 v29, 0x100, v29
  v_mfma_f32_16x16x32_bf16 v[140:143], v[56:59], a[116:119], v[140:143]
  ds_read_b64_tr_b16 v[44:45], v15 offset:4096
  v_mfma_f32_16x16x32_bf16 v[140:143], v[60:63], a[124:127], v[140:143]
  v_mfma_f32_16x16x32_bf16 v[132:135], v[60:63], a[120:123], v[132:135]
  ds_read_b64_tr_b16 v[46:47], v15 offset:4608
  v_mfma_f32_16x16x32_bf16 v[132:135], v[56:59], a[112:115], v[132:135]
  s_waitcnt lgkmcnt(4)
  buffer_load_dwordx4 v8, s[24:27], s81 offen offset:2048 lds
  v_mfma_f32_16x16x32_bf16 v[160:163], v[32:35], a[0:3], 0
  ds_read_b64_tr_b16 v[48:49], v16 offset:0
  v_mfma_f32_16x16x32_bf16 v[160:163], v[36:39], a[8:11], v[160:163]
  v_mfma_f32_16x16x32_bf16 v[168:171], v[36:39], a[12:15], 0
  ds_read_b64_tr_b16 v[50:51], v16 offset:512
  v_mfma_f32_16x16x32_bf16 v[168:171], v[32:35], a[4:7], v[168:171]
  v_mul_f32 v20, 0x3fb8aa3b, v96
  v_exp_f32 v20, v20
  v_mfma_f32_16x16x32_bf16 v[176:179], v[32:35], a[128:131], 0
  ds_read_b64_tr_b16 v[52:53], v16 offset:4096
  v_mul_f32 v21, 0x3fb8aa3b, v97
  v_mfma_f32_16x16x32_bf16 v[176:179], v[36:39], a[136:139], v[176:179]
  buffer_load_dwordx4 v9, s[24:27], s81 offen offset:3072 lds
  v_mfma_f32_16x16x32_bf16 v[184:187], v[36:39], a[140:143], 0
  ds_read_b64_tr_b16 v[54:55], v16 offset:4608
  v_mfma_f32_16x16x32_bf16 v[184:187], v[32:35], a[132:135], v[184:187]
  s_waitcnt lgkmcnt(4)
  v_exp_f32 v21, v21
  v_mfma_f32_16x16x32_bf16 v[188:191], v[40:43], a[132:135], 0
  ds_read_b64_tr_b16 v[56:57], v17 offset:0
  v_fma_f32 v22, v20, 0.5, 1.0
  v_mfma_f32_16x16x32_bf16 v[188:191], v[44:47], a[140:143], v[188:191]
  v_fma_f32 v20, v20, v22, 1.0
  v_fma_f32 v23, v21, 0.5, 1.0
  v_mfma_f32_16x16x32_bf16 v[180:183], v[44:47], a[136:139], 0
  s_add_u32 m0, s77, 16384
  ds_read_b64_tr_b16 v[58:59], v17 offset:512
  v_fma_f32 v21, v21, v23, 1.0
  v_mfma_f32_16x16x32_bf16 v[180:183], v[40:43], a[128:131], v[180:183]
  s_add_u32 s81, s63, 0
  buffer_load_dwordx4 v6, s[24:27], s81 offen offset:0 lds
  v_mfma_f32_16x16x32_bf16 v[172:175], v[40:43], a[4:7], 0
  ds_read_b64_tr_b16 v[60:61], v17 offset:4096
  v_rcp_f32 v20, v20
  v_mfma_f32_16x16x32_bf16 v[172:175], v[44:47], a[12:15], v[172:175]
  v_rcp_f32 v21, v21
  v_mfma_f32_16x16x32_bf16 v[164:167], v[44:47], a[8:11], 0
  ds_read_b64_tr_b16 v[62:63], v17 offset:4608
  v_fma_f32 v24, -v96, v20, v96
  v_mfma_f32_16x16x32_bf16 v[164:167], v[40:43], a[0:3], v[164:167]
  s_waitcnt lgkmcnt(4)
  v_fma_f32 v25, -v97, v21, v97
  v_mul_f32 v20, 0x3fb8aa3b, v98
  v_mfma_f32_16x16x32_bf16 v[192:195], v[48:51], a[0:3], 0
  ds_read_b64_tr_b16 v[32:33], v14 offset:8192
  v_exp_f32 v20, v20
  v_mfma_f32_16x16x32_bf16 v[192:195], v[52:55], a[8:11], v[192:195]
  buffer_load_dwordx4 v7, s[24:27], s81 offen offset:1024 lds
  v_mfma_f32_16x16x32_bf16 v[200:203], v[52:55], a[12:15], 0
  ds_read_b64_tr_b16 v[34:35], v14 offset:8704
  v_mul_f32 v21, 0x3fb8aa3b, v99
  v_mfma_f32_16x16x32_bf16 v[200:203], v[48:51], a[4:7], v[200:203]
  v_exp_f32 v21, v21
  v_mfma_f32_16x16x32_bf16 v[208:211], v[48:51], a[128:131], 0
  s_waitcnt vmcnt(6)
  ds_read_b64_tr_b16 v[36:37], v14 offset:12288
  v_fma_f32 v22, v20, 0.5, 1.0
  v_mfma_f32_16x16x32_bf16 v[208:211], v[52:55], a[136:139], v[208:211]
  s_cbranch_vccnz L_xrel
L_xrel_back:
  v_fma_f32 v20, v20, v22, 1.0
  v_mfma_f32_16x16x32_bf16 v[216:219], v[52:55], a[140:143], 0
  ds_read_b64_tr_b16 v[38:39], v14 offset:12800
  v_fma_f32 v23, v21, 0.5, 1.0
  v_mfma_f32_16x16x32_bf16 v[216:219], v[48:51], a[132:135], v[216:219]
  s_waitcnt lgkmcnt(4)
  buffer_load_dwordx4 v8, s[24:27], s81 offen offset:2048 lds
  v_mfma_f32_16x16x32_bf16 v[220:223], v[56:59], a[132:135], 0
  ds_read_b64_tr_b16 v[40:41], v15 offset:8192
  v_fma_f32 v21, v21, v23, 1.0
  v_mfma_f32_16x16x32_bf16 v[220:223], v[60:63], a[140:143], v[220:223]
  buffer_store_dword v29, off, s[28:31], s82 sc1
  v_mfma_f32_16x16x32_bf16 v[212:215], v[60:63], a[136:139], 0
  ds_read_b64_tr_b16 v[42:43], v15 offset:8704
  v_rcp_f32 v20, v20
  v_mfma_f32_16x16x32_bf16 v[212:215], v[56:59], a[128:131], v[212:215]
  v_cvt_pk_bf16_f32 v96, v24, v25
  v_mfma_f32_16x16x32_bf16 v[204:207], v[56:59], a[4:7], 0
  ds_read_b64_tr_b16 v[44:45], v15 offset:12288
  v_rcp_f32 v21, v21
  v_mfma_f32_16x16x32_bf16 v[204:207], v[60:63], a[12:15], v[204:207]
  buffer_load_dwordx4 v9, s[24:27], s81 offen offset:3072 lds
  v_mfma_f32_16x16x32_bf16 v[196:199], v[60:63], a[8:11], 0
  ds_read_b64_tr_b16 v[46:47], v15 offset:12800
  v_fma_f32 v24, -v98, v20, v98
  v_mfma_f32_16x16x32_bf16 v[196:199], v[56:59], a[0:3], v[196:199]
  s_waitcnt lgkmcnt(4)
  v_fma_f32 v25, -v99, v21, v99
  v_mul_f32 v20, 0x3fb8aa3b, v100
  v_mfma_f32_16x16x32_bf16 v[160:163], v[32:35], a[16:19], v[160:163]
  ds_read_b64_tr_b16 v[48:49], v16 offset:8192
  v_exp_f32 v20, v20
  v_mfma_f32_16x16x32_bf16 v[160:163], v[36:39], a[24:27], v[160:163]
  v_mul_f32 v21, 0x3fb8aa3b, v101
  v_mfma_f32_16x16x32_bf16 v[168:171], v[36:39], a[28:31], v[168:171]
  ds_read_b64_tr_b16 v[50:51], v16 offset:8704
  v_exp_f32 v21, v21
  v_mfma_f32_16x16x32_bf16 v[168:171], v[32:35], a[20:23], v[168:171]
  v_fma_f32 v22, v20, 0.5, 1.0
  v_fma_f32 v20, v20, v22, 1.0
  v_mfma_f32_16x16x32_bf16 v[176:179], v[32:35], a[144:147], v[176:179]
  ds_read_b64_tr_b16 v[52:53], v16 offset:12288
  v_fma_f32 v23, v21, 0.5, 1.0
  v_mfma_f32_16x16x32_bf16 v[176:179], v[36:39], a[152:155], v[176:179]
  v_fma_f32 v21, v21, v23, 1.0
  v_mfma_f32_16x16x32_bf16 v[184:187], v[36:39], a[156:159], v[184:187]
  ds_read_b64_tr_b16 v[54:55], v16 offset:12800
  v_rcp_f32 v20, v20
  v_mfma_f32_16x16x32_bf16 v[184:187], v[32:35], a[148:151], v[184:187]
  s_waitcnt lgkmcnt(4)
  v_cvt_pk_bf16_f32 v97, v24, v25
  v_rcp_f32 v21, v21
  v_mfma_f32_16x16x32_bf16 v[188:191], v[40:43], a[148:151], v[188:191]
  ds_read_b64_tr_b16 v[56:57], v17 offset:8192
  v_fma_f32 v24, -v100, v20, v100
  v_mfma_f32_16x16x32_bf16 v[188:191], v[44:47], a[156:159], v[188:191]
  v_fma_f32 v25, -v101, v21, v101
  v_mul_f32 v20, 0x3fb8aa3b, v102
  v_mfma_f32_16x16x32_bf16 v[180:183], v[44:47], a[152:155], v[180:183]
  ds_read_b64_tr_b16 v[58:59], v17 offset:8704
  v_mfma_f32_16x16x32_bf16 v[180:183], v[40:43], a[144:147], v[180:183]
  v_exp_f32 v20, v20
  v_mfma_f32_16x16x32_bf16 v[172:175], v[40:43], a[20:23], v[172:175]
  ds_read_b64_tr_b16 v[60:61], v17 offset:12288
  v_mul_f32 v21, 0x3fb8aa3b, v103
  v_mfma_f32_16x16x32_bf16 v[172:175], v[44:47], a[28:31], v[172:175]
  v_exp_f32 v21, v21
  v_mfma_f32_16x16x32_bf16 v[164:167], v[44:47], a[24:27], v[164:167]
  s_barrier
  ds_read_b64_tr_b16 v[62:63], v17 offset:12800
  v_mfma_f32_16x16x32_bf16 v[164:167], v[40:43], a[16:19], v[164:167]
  s_waitcnt lgkmcnt(4)
  v_fma_f32 v22, v20, 0.5, 1.0
  v_fma_f32 v20, v20, v22, 1.0
  v_fma_f32 v23, v21, 0.5, 1.0
  v_mfma_f32_16x16x32_bf16 v[192:195], v[48:51], a[16:19], v[192:195]
  ds_read_b64_tr_b16 v[32:33], v14 offset:16384
  v_fma_f32 v21, v21, v23, 1.0
  v_mfma_f32_16x16x32_bf16 v[192:195], v[52:55], a[24:27], v[192:195]
  v_rcp_f32 v20, v20
  v_mfma_f32_16x16x32_bf16 v[200:203], v[52:55], a[28:31], v[200:203]
  s_add_u32 m0, s77, 98304
  ds_read_b64_tr_b16 v[34:35], v14 offset:16896
  v_cvt_pk_bf16_f32 v98, v24, v25
  v_mfma_f32_16x16x32_bf16 v[200:203], v[48:51], a[20:23], v[200:203]
  s_add_u32 s81, s60, 128
  buffer_load_dwordx4 v6, s[24:27], s81 offen offset:0 lds
  v_mfma_f32_16x16x32_bf16 v[208:211], v[48:51], a[144:147], v[208:211]
  ds_read_b64_tr_b16 v[36:37], v14 offset:20480
  v_rcp_f32 v21, v21
  v_mfma_f32_16x16x32_bf16 v[208:211], v[52:55], a[152:155], v[208:211]
  v_fma_f32 v24, -v102, v20, v102
  v_fma_f32 v25, -v103, v21, v103
  v_mfma_f32_16x16x32_bf16 v[216:219], v[52:55], a[156:159], v[216:219]
  ds_read_b64_tr_b16 v[38:39], v14 offset:20992
  v_mul_f32 v20, 0x3fb8aa3b, v104
  v_mfma_f32_16x16x32_bf16 v[216:219], v[48:51], a[148:151], v[216:219]
  s_waitcnt lgkmcnt(4)
  v_exp_f32 v20, v20
  v_mfma_f32_16x16x32_bf16 v[220:223], v[56:59], a[148:151], v[220:223]
  ds_read_b64_tr_b16 v[40:41], v15 offset:16384
  v_mul_f32 v21, 0x3fb8aa3b, v105
  v_mfma_f32_16x16x32_bf16 v[220:223], v[60:63], a[156:159], v[220:223]
  buffer_load_dwordx4 v7, s[24:27], s81 offen offset:1024 lds
  v_mfma_f32_16x16x32_bf16 v[212:215], v[60:63], a[152:155], v[212:215]
  ds_read_b64_tr_b16 v[42:43], v15 offset:16896
  v_exp_f32 v21, v21
  v_mfma_f32_16x16x32_bf16 v[212:215], v[56:59], a[144:147], v[212:215]
  v_fma_f32 v22, v20, 0.5, 1.0
  v_fma_f32 v20, v20, v22, 1.0
  v_mfma_f32_16x16x32_bf16 v[204:207], v[56:59], a[20:23], v[204:207]
  ds_read_b64_tr_b16 v[44:45], v15 offset:20480
  v_fma_f32 v23, v21, 0.5, 1.0
  v_mfma_f32_16x16x32_bf16 v[204:207], v[60:63], a[28:31], v[204:207]
  v_fma_f32 v21, v21, v23, 1.0
  v_mfma_f32_16x16x32_bf16 v[196:199], v[60:63], a[24:27], v[196:199]
  ds_read_b64_tr_b16 v[46:47], v15 offset:20992
  v_rcp_f32 v20, v20
  v_mfma_f32_16x16x32_bf16 v[196:199], v[56:59], a[16:19], v[196:199]
  s_waitcnt lgkmcnt(4)
  buffer_load_dwordx4 v8, s[24:27], s81 offen offset:2048 lds
  v_mfma_f32_16x16x32_bf16 v[160:163], v[32:35], a[32:35], v[160:163]
  ds_read_b64_tr_b16 v[48:49], v16 offset:16384
  v_cvt_pk_bf16_f32 v99, v24, v25
  v_mfma_f32_16x16x32_bf16 v[160:163], v[36:39], a[40:43], v[160:163]
  v_rcp_f32 v21, v21
  v_mfma_f32_16x16x32_bf16 v[168:171], v[36:39], a[44:47], v[168:171]
  ds_read_b64_tr_b16 v[50:51], v16 offset:16896
  v_fma_f32 v24, -v104, v20, v104
  v_mfma_f32_16x16x32_bf16 v[168:171], v[32:35], a[36:39], v[168:171]
  buffer_store_dwordx4 v[96:99], v1, s[44:47], s94 offen offset:0 sc1
  v_mfma_f32_16x16x32_bf16 v[176:179], v[32:35], a[160:163], v[176:179]
  ds_read_b64_tr_b16 v[52:53], v16 offset:20480
  v_fma_f32 v25, -v105, v21, v105
  v_mfma_f32_16x16x32_bf16 v[176:179], v[36:39], a[168:171], v[176:179]
  buffer_load_dwordx4 v9, s[24:27], s81 offen offset:3072 lds
  v_mfma_f32_16x16x32_bf16 v[184:187], v[36:39], a[172:175], v[184:187]
  ds_read_b64_tr_b16 v[54:55], v16 offset:20992
  v_mul_f32 v20, 0x3fb8aa3b, v106
  v_mfma_f32_16x16x32_bf16 v[184:187], v[32:35], a[164:167], v[184:187]
  s_waitcnt lgkmcnt(4)
  v_exp_f32 v20, v20
  v_mfma_f32_16x16x32_bf16 v[188:191], v[40:43], a[164:167], v[188:191]
  ds_read_b64_tr_b16 v[56:57], v17 offset:16384
  v_mul_f32 v21, 0x3fb8aa3b, v107
  v_mfma_f32_16x16x32_bf16 v[188:191], v[44:47], a[172:175], v[188:191]
  v_exp_f32 v21, v21
  v_mfma_f32_16x16x32_bf16 v[180:183], v[44:47], a[168:171], v[180:183]
  s_add_u32 m0, s77, 114688
  ds_read_b64_tr_b16 v[58:59], v17 offset:16896
  v_fma_f32 v22, v20, 0.5, 1.0
  v_mfma_f32_16x16x32_bf16 v[180:183], v[40:43], a[160:163], v[180:183]
  s_add_u32 s81, s61, 128
  buffer_load_dwordx4 v6, s[24:27], s81 offen offset:0 lds
  v_fma_f32 v20, v20, v22, 1.0
  v_mfma_f32_16x16x32_bf16 v[172:175], v[40:43], a[36:39], v[172:175]
  ds_read_b64_tr_b16 v[60:61], v17 offset:20480
  v_fma_f32 v23, v21, 0.5, 1.0
  v_mfma_f32_16x16x32_bf16 v[172:175], v[44:47], a[44:47], v[172:175]
  v_fma_f32 v21, v21, v23, 1.0
  v_rcp_f32 v20, v20
  v_mfma_f32_16x16x32_bf16 v[164:167], v[44:47], a[40:43], v[164:167]
  ds_read_b64_tr_b16 v[62:63], v17 offset:20992
  v_cvt_pk_bf16_f32 v104, v24, v25
  v_mfma_f32_16x16x32_bf16 v[164:167], v[40:43], a[32:35], v[164:167]
  s_waitcnt lgkmcnt(4)
  v_rcp_f32 v21, v21
  v_mfma_f32_16x16x32_bf16 v[192:195], v[48:51], a[32:35], v[192:195]
  ds_read_b64_tr_b16 v[32:33], v14 offset:24576
  v_fma_f32 v24, -v106, v20, v106
  v_mfma_f32_16x16x32_bf16 v[192:195], v[52:55], a[40:43], v[192:195]
  buffer_load_dwordx4 v7, s[24:27], s81 offen offset:1024 lds
  v_mfma_f32_16x16x32_bf16 v[200:203], v[52:55], a[44:47], v[200:203]
  ds_read_b64_tr_b16 v[34:35], v14 offset:25088
  v_fma_f32 v25, -v107, v21, v107
  v_mfma_f32_16x16x32_bf16 v[200:203], v[48:51], a[36:39], v[200:203]
  v_mul_f32 v20, 0x3fb8aa3b, v108
  v_mfma_f32_16x16x32_bf16 v[208:211], v[48:51], a[160:163], v[208:211]
  ds_read_b64_tr_b16 v[36:37], v14 offset:28672
  v_exp_f32 v20, v20
  v_mfma_f32_16x16x32_bf16 v[208:211], v[52:55], a[168:171], v[208:211]
  v_mul_f32 v21, 0x3fb8aa3b, v109
  v_exp_f32 v21, v21
  v_mfma_f32_16x16x32_bf16 v[216:219], v[52:55], a[172:175], v[216:219]
  ds_read_b64_tr_b16 v[38:39], v14 offset:29184
  v_add_u32 v14, 0xffff0000, v14
  v_mfma_f32_16x16x32_bf16 v[216:219], v[48:51], a[164:167], v[216:219]
  s_waitcnt lgkmcnt(4)
  buffer_load_dwordx4 v8, s[24:27], s81 offen offset:2048 lds
  v_mfma_f32_16x16x32_bf16 v[220:223], v[56:59], a[164:167], v[220:223]
  ds_read_b64_tr_b16 v[40:41], v15 offset:24576
  v_fma_f32 v22, v20, 0.5, 1.0
  v_mfma_f32_16x16x32_bf16 v[220:223], v[60:63], a[172:175], v[220:223]
  v_fma_f32 v20, v20, v22, 1.0
  v_fma_f32 v23, v21, 0.5, 1.0
  v_mfma_f32_16x16x32_bf16 v[212:215], v[60:63], a[168:171], v[212:215]
  ds_read_b64_tr_b16 v[42:43], v15 offset:25088
  v_fma_f32 v21, v21, v23, 1.0
  v_mfma_f32_16x16x32_bf16 v[212:215], v[56:59], a[160:163], v[212:215]
  v_rcp_f32 v20, v20
  v_mfma_f32_16x16x32_bf16 v[204:207], v[56:59], a[36:39], v[204:207]
  ds_read_b64_tr_b16 v[44:45], v15 offset:28672
  v_cvt_pk_bf16_f32 v105, v24, v25
  v_mfma_f32_16x16x32_bf16 v[204:207], v[60:63], a[44:47], v[204:207]
  buffer_load_dwordx4 v9, s[24:27], s81 offen offset:3072 lds
  v_mfma_f32_16x16x32_bf16 v[196:199], v[60:63], a[40:43], v[196:199]
  ds_read_b64_tr_b16 v[46:47], v15 offset:29184
  v_add_u32 v15, 0xffff0000, v15
  v_mfma_f32_16x16x32_bf16 v[196:199], v[56:59], a[32:35], v[196:199]
  s_waitcnt lgkmcnt(4)
  v_rcp_f32 v21, v21
  v_mfma_f32_16x16x32_bf16 v[160:163], v[32:35], a[48:51], v[160:163]
  ds_read_b64_tr_b16 v[48:49], v16 offset:24576
  v_fma_f32 v24, -v108, v20, v108
  v_mfma_f32_16x16x32_bf16 v[160:163], v[36:39], a[56:59], v[160:163]
  v_fma_f32 v25, -v109, v21, v109
  v_mul_f32 v20, 0x3fb8aa3b, v110
  v_mfma_f32_16x16x32_bf16 v[168:171], v[36:39], a[60:63], v[168:171]
  ds_read_b64_tr_b16 v[50:51], v16 offset:25088
  v_exp_f32 v20, v20
  v_mfma_f32_16x16x32_bf16 v[168:171], v[32:35], a[52:55], v[168:171]
  v_mul_f32 v21, 0x3fb8aa3b, v111
  v_mfma_f32_16x16x32_bf16 v[176:179], v[32:35], a[176:179], v[176:179]
  ds_read_b64_tr_b16 v[52:53], v16 offset:28672
  v_exp_f32 v21, v21
  v_mfma_f32_16x16x32_bf16 v[176:179], v[36:39], a[184:187], v[176:179]
  v_fma_f32 v22, v20, 0.5, 1.0
  v_fma_f32 v20, v20, v22, 1.0
  v_mfma_f32_16x16x32_bf16 v[184:187], v[36:39], a[188:191], v[184:187]
  ds_read_b64_tr_b16 v[54:55], v16 offset:29184
  v_add_u32 v16, 0xffff0000, v16
  v_mfma_f32_16x16x32_bf16 v[184:187], v[32:35], a[180:183], v[184:187]
  s_waitcnt lgkmcnt(4)
  v_fma_f32 v23, v21, 0.5, 1.0
  v_fma_f32 v21, v21, v23, 1.0
  v_mfma_f32_16x16x32_bf16 v[188:191], v[40:43], a[180:183], v[188:191]
  ds_read_b64_tr_b16 v[56:57], v17 offset:24576
  v_rcp_f32 v20, v20
  v_mfma_f32_16x16x32_bf16 v[188:191], v[44:47], a[188:191], v[188:191]
  v_cvt_pk_bf16_f32 v106, v24, v25
  v_mfma_f32_16x16x32_bf16 v[180:183], v[44:47], a[184:187], v[180:183]
  ds_read_b64_tr_b16 v[58:59], v17 offset:25088
  v_rcp_f32 v21, v21
  v_mfma_f32_16x16x32_bf16 v[180:183], v[40:43], a[176:179], v[180:183]
  v_fma_f32 v24, -v110, v20, v110
  v_fma_f32 v25, -v111, v21, v111
  v_mfma_f32_16x16x32_bf16 v[172:175], v[40:43], a[52:55], v[172:175]
  ds_read_b64_tr_b16 v[60:61], v17 offset:28672
  v_mul_f32 v20, 0x3fb8aa3b, v112
  v_mfma_f32_16x16x32_bf16 v[172:175], v[44:47], a[60:63], v[172:175]
  s_waitcnt vmcnt(9)
  v_exp_f32 v20, v20
  v_mfma_f32_16x16x32_bf16 v[164:167], v[44:47], a[56:59], v[164:167]
  s_barrier
  ds_read_b64_tr_b16 v[62:63], v17 offset:29184
  v_add_u32 v17, 0xffff0000, v17
  v_mfma_f32_16x16x32_bf16 v[164:167], v[40:43], a[48:51], v[164:167]
  s_waitcnt lgkmcnt(4)
  v_mul_f32 v21, 0x3fb8aa3b, v113
  v_exp_f32 v21, v21
  v_mfma_f32_16x16x32_bf16 v[192:195], v[48:51], a[48:51], v[192:195]
  ds_read_b64_tr_b16 v[32:33], v14 offset:0
  v_fma_f32 v22, v20, 0.5, 1.0
  v_mfma_f32_16x16x32_bf16 v[192:195], v[52:55], a[56:59], v[192:195]
  v_fma_f32 v20, v20, v22, 1.0
  v_fma_f32 v23, v21, 0.5, 1.0
  v_mfma_f32_16x16x32_bf16 v[200:203], v[52:55], a[60:63], v[200:203]
  s_add_u32 m0, s77, 131072
  ds_read_b64_tr_b16 v[34:35], v14 offset:512
  v_fma_f32 v21, v21, v23, 1.0
  v_mfma_f32_16x16x32_bf16 v[200:203], v[48:51], a[52:55], v[200:203]
  s_add_u32 s81, s62, 128
  buffer_load_dwordx4 v6, s[24:27], s81 offen offset:0 lds
  v_mfma_f32_16x16x32_bf16 v[208:211], v[48:51], a[176:179], v[208:211]
  ds_read_b64_tr_b16 v[36:37], v14 offset:4096
  v_mfma_f32_16x16x32_bf16 v[208:211], v[52:55], a[184:187], v[208:211]
  v_rcp_f32 v20, v20
  v_mfma_f32_16x16x32_bf16 v[216:219], v[52:55], a[188:191], v[216:219]
  ds_read_b64_tr_b16 v[38:39], v14 offset:4608
  v_cvt_pk_bf16_f32 v107, v24, v25
  v_mfma_f32_16x16x32_bf16 v[216:219], v[48:51], a[180:183], v[216:219]
  s_waitcnt lgkmcnt(4)
  v_rcp_f32 v21, v21
  v_mfma_f32_16x16x32_bf16 v[220:223], v[56:59], a[180:183], v[220:223]
L_pad6:
  s_cbranch_execz L_pad10
  ds_read_b64_tr_b16 v[40:41], v15 offset:0
  v_fma_f32 v24, -v112, v20, v112
  v_mfma_f32_16x16x32_bf16 v[220:223], v[60:63], a[188:191], v[220:223]
  buffer_load_dwordx4 v7, s[24:27], s81 offen offset:1024 lds
  v_mfma_f32_16x16x32_bf16 v[212:215], v[60:63], a[184:187], v[212:215]
  ds_read_b64_tr_b16 v[42:43], v15 offset:512
  buffer_store_dwordx4 v[104:107], v1, s[44:47], s94 offen offset:1024 sc1
  v_mfma_f32_16x16x32_bf16 v[212:215], v[56:59], a[176:179], v[212:215]
  v_fma_f32 v25, -v113, v21, v113
  v_mul_f32 v20, 0x3fb8aa3b, v114
  v_mfma_f32_16x16x32_bf16 v[204:207], v[56:59], a[52:55], v[204:207]
  ds_read_b64_tr_b16 v[44:45], v15 offset:4096
  v_exp_f32 v20, v20
  v_mfma_f32_16x16x32_bf16 v[204:207], v[60:63], a[60:63], v[204:207]
  v_mul_f32 v21, 0x3fb8aa3b, v115
  v_mfma_f32_16x16x32_bf16 v[196:199], v[60:63], a[56:59], v[196:199]
  ds_read_b64_tr_b16 v[46:47], v15 offset:4608
  v_exp_f32 v21, v21
  v_mfma_f32_16x16x32_bf16 v[196:199], v[56:59], a[48:51], v[196:199]
  s_waitcnt lgkmcnt(4)
  buffer_load_dwordx4 v8, s[24:27], s81 offen offset:2048 lds
  v_mfma_f32_16x16x32_bf16 v[160:163], v[32:35], a[64:67], v[160:163]
  ds_read_b64_tr_b16 v[48:49], v16 offset:0
  v_fma_f32 v22, v20, 0.5, 1.0
  v_mfma_f32_16x16x32_bf16 v[160:163], v[36:39], a[72:75], v[160:163]
  v_fma_f32 v20, v20, v22, 1.0
  v_fma_f32 v23, v21, 0.5, 1.0
  v_mfma_f32_16x16x32_bf16 v[168:171], v[36:39], a[76:79], v[168:171]
  ds_read_b64_tr_b16 v[50:51], v16 offset:512
  v_fma_f32 v21, v21, v23, 1.0
  v_mfma_f32_16x16x32_bf16 v[168:171], v[32:35], a[68:71], v[168:171]
  v_rcp_f32 v20, v20
  v_mfma_f32_16x16x32_bf16 v[176:179], v[32:35], a[192:195], v[176:179]
  ds_read_b64_tr_b16 v[52:53], v16 offset:4096
  v_cvt_pk_bf16_f32 v112, v24, v25
  v_mfma_f32_16x16x32_bf16 v[176:179], v[36:39], a[200:203], v[176:179]
  buffer_load_dwordx4 v9, s[24:27], s81 offen offset:3072 lds
  v_mfma_f32_16x16x32_bf16 v[184:187], v[36:39], a[204:207], v[184:187]
  ds_read_b64_tr_b16 v[54:55], v16 offset:4608
  v_rcp_f32 v21, v21
  v_mfma_f32_16x16x32_bf16 v[184:187], v[32:35], a[196:199], v[184:187]
  s_waitcnt lgkmcnt(4)
  v_fma_f32 v24, -v114, v20, v114
  v_fma_f32 v25, -v115, v21, v115
  v_mfma_f32_16x16x32_bf16 v[188:191], v[40:43], a[196:199], v[188:191]
  ds_read_b64_tr_b16 v[56:57], v17 offset:0
  v_mul_f32 v20, 0x3fb8aa3b, v116
  v_mfma_f32_16x16x32_bf16 v[188:191], v[44:47], a[204:207], v[188:191]
  v_exp_f32 v20, v20
  v_mfma_f32_16x16x32_bf16 v[180:183], v[44:47], a[200:203], v[180:183]
  s_add_u32 m0, s77, 147456
  ds_read_b64_tr_b16 v[58:59], v17 offset:512
  v_mul_f32 v21, 0x3fb8aa3b, v117
  v_mfma_f32_16x16x32_bf16 v[180:183], v[40:43], a[192:195], v[180:183]
  s_add_u32 s81, s63, 128
  buffer_load_dwordx4 v6, s[24:27], s81 offen offset:0 lds
  v_mfma_f32_16x16x32_bf16 v[172:175], v[40:43], a[68:71], v[172:175]
  ds_read_b64_tr_b16 v[60:61], v17 offset:4096
  v_exp_f32 v21, v21
  v_mfma_f32_16x16x32_bf16 v[172:175], v[44:47], a[76:79], v[172:175]
  v_fma_f32 v22, v20, 0.5, 1.0
  v_fma_f32 v20, v20, v22, 1.0
  v_mfma_f32_16x16x32_bf16 v[164:167], v[44:47], a[72:75], v[164:167]
  ds_read_b64_tr_b16 v[62:63], v17 offset:4608
  v_fma_f32 v23, v21, 0.5, 1.0
  v_mfma_f32_16x16x32_bf16 v[164:167], v[40:43], a[64:67], v[164:167]
  s_waitcnt lgkmcnt(4)
  v_fma_f32 v21, v21, v23, 1.0
  v_mfma_f32_16x16x32_bf16 v[192:195], v[48:51], a[64:67], v[192:195]
  ds_read_b64_tr_b16 v[32:33], v14 offset:8192
  v_rcp_f32 v20, v20
  v_mfma_f32_16x16x32_bf16 v[192:195], v[52:55], a[72:75], v[192:195]
  buffer_load_dwordx4 v7, s[24:27], s81 offen offset:1024 lds
  v_mfma_f32_16x16x32_bf16 v[200:203], v[52:55], a[76:79], v[200:203]
  ds_read_b64_tr_b16 v[34:35], v14 offset:8704
  v_cvt_pk_bf16_f32 v113, v24, v25
  v_mfma_f32_16x16x32_bf16 v[200:203], v[48:51], a[68:71], v[200:203]
  v_rcp_f32 v21, v21
  v_mfma_f32_16x16x32_bf16 v[208:211], v[48:51], a[192:195], v[208:211]
  ds_read_b64_tr_b16 v[36:37], v14 offset:12288
  v_fma_f32 v24, -v116, v20, v116
  v_mfma_f32_16x16x32_bf16 v[208:211], v[52:55], a[200:203], v[208:211]
  v_fma_f32 v25, -v117, v21, v117
  v_mul_f32 v20, 0x3fb8aa3b, v118
  v_mfma_f32_16x16x32_bf16 v[216:219], v[52:55], a[204:207], v[216:219]
  ds_read_b64_tr_b16 v[38:39], v14 offset:12800
  v_exp_f32 v20, v20
  v_mfma_f32_16x16x32_bf16 v[216:219], v[48:51], a[196:199], v[216:219]
  s_waitcnt lgkmcnt(4)
  buffer_load_dwordx4 v8, s[24:27], s81 offen offset:2048 lds
  v_mfma_f32_16x16x32_bf16 v[220:223], v[56:59], a[196:199], v[220:223]
  ds_read_b64_tr_b16 v[40:41], v15 offset:8192
  v_mul_f32 v21, 0x3fb8aa3b, v119
  v_mfma_f32_16x16x32_bf16 v[220:223], v[60:63], a[204:207], v[220:223]
  v_exp_f32 v21, v21
  v_mfma_f32_16x16x32_bf16 v[212:215], v[60:63], a[200:203], v[212:215]
  ds_read_b64_tr_b16 v[42:43], v15 offset:8704
  v_fma_f32 v22, v20, 0.5, 1.0
  v_mfma_f32_16x16x32_bf16 v[212:215], v[56:59], a[192:195], v[212:215]
  v_fma_f32 v20, v20, v22, 1.0
  v_fma_f32 v23, v21, 0.5, 1.0
  v_mfma_f32_16x16x32_bf16 v[204:207], v[56:59], a[68:71], v[204:207]
  ds_read_b64_tr_b16 v[44:45], v15 offset:12288
  v_fma_f32 v21, v21, v23, 1.0
  v_mfma_f32_16x16x32_bf16 v[204:207], v[60:63], a[76:79], v[204:207]
  buffer_load_dwordx4 v9, s[24:27], s81 offen offset:3072 lds
  v_mfma_f32_16x16x32_bf16 v[196:199], v[60:63], a[72:75], v[196:199]
  ds_read_b64_tr_b16 v[46:47], v15 offset:12800
  v_rcp_f32 v20, v20
  v_mfma_f32_16x16x32_bf16 v[196:199], v[56:59], a[64:67], v[196:199]
  s_waitcnt lgkmcnt(4)
  v_cvt_pk_bf16_f32 v114, v24, v25
  v_mfma_f32_16x16x32_bf16 v[160:163], v[32:35], a[80:83], v[160:163]
  ds_read_b64_tr_b16 v[48:49], v16 offset:8192
  v_rcp_f32 v21, v21
  v_mfma_f32_16x16x32_bf16 v[160:163], v[36:39], a[88:91], v[160:163]
  v_fma_f32 v24, -v118, v20, v118
  v_fma_f32 v25, -v119, v21, v119
  v_mfma_f32_16x16x32_bf16 v[168:171], v[36:39], a[92:95], v[168:171]
  ds_read_b64_tr_b16 v[50:51], v16 offset:8704
  v_mul_f32 v20, 0x3fb8aa3b, v120
  v_mfma_f32_16x16x32_bf16 v[168:171], v[32:35], a[84:87], v[168:171]
  v_exp_f32 v20, v20
  v_mfma_f32_16x16x32_bf16 v[176:179], v[32:35], a[208:211], v[176:179]
  ds_read_b64_tr_b16 v[52:53], v16 offset:12288
  v_mul_f32 v21, 0x3fb8aa3b, v121
  v_mfma_f32_16x16x32_bf16 v[176:179], v[36:39], a[216:219], v[176:179]
  buffer_load_dword v30, v26, s[8:11], s56 offen
  v_mfma_f32_16x16x32_bf16 v[184:187], v[36:39], a[220:223], v[184:187]
  ds_read_b64_tr_b16 v[54:55], v16 offset:12800
  v_exp_f32 v21, v21
  v_mfma_f32_16x16x32_bf16 v[184:187], v[32:35], a[212:215], v[184:187]
  s_waitcnt lgkmcnt(4)
  v_fma_f32 v22, v20, 0.5, 1.0
  v_fma_f32 v20, v20, v22, 1.0
  v_mfma_f32_16x16x32_bf16 v[188:191], v[40:43], a[212:215], v[188:191]
  ds_read_b64_tr_b16 v[56:57], v17 offset:8192
  v_fma_f32 v23, v21, 0.5, 1.0
  v_mfma_f32_16x16x32_bf16 v[188:191], v[44:47], a[220:223], v[188:191]
  v_fma_f32 v21, v21, v23, 1.0
  v_mfma_f32_16x16x32_bf16 v[180:183], v[44:47], a[216:219], v[180:183]
  ds_read_b64_tr_b16 v[58:59], v17 offset:8704
  v_rcp_f32 v20, v20
  v_mfma_f32_16x16x32_bf16 v[180:183], v[40:43], a[208:211], v[180:183]
  v_cvt_pk_bf16_f32 v115, v24, v25
  v_mfma_f32_16x16x32_bf16 v[172:175], v[40:43], a[84:87], v[172:175]
  ds_read_b64_tr_b16 v[60:61], v17 offset:12288
  v_rcp_f32 v21, v21
  v_mfma_f32_16x16x32_bf16 v[172:175], v[44:47], a[92:95], v[172:175]
  v_fma_f32 v24, -v120, v20, v120
  v_mfma_f32_16x16x32_bf16 v[164:167], v[44:47], a[88:91], v[164:167]
  ds_read_b64_tr_b16 v[62:63], v17 offset:12800
  buffer_store_dwordx4 v[112:115], v1, s[44:47], s95 offen offset:0 sc1
  v_mfma_f32_16x16x32_bf16 v[164:167], v[40:43], a[80:83], v[164:167]
  s_waitcnt lgkmcnt(4)
  v_fma_f32 v25, -v121, v21, v121
  v_mul_f32 v20, 0x3fb8aa3b, v122
  v_mfma_f32_16x16x32_bf16 v[192:195], v[48:51], a[80:83], v[192:195]
  ds_read_b64_tr_b16 v[32:33], v14 offset:16384
  v_exp_f32 v20, v20
  v_mfma_f32_16x16x32_bf16 v[192:195], v[52:55], a[88:91], v[192:195]
  v_mul_f32 v21, 0x3fb8aa3b, v123
  v_mfma_f32_16x16x32_bf16 v[200:203], v[52:55], a[92:95], v[200:203]
  ds_read_b64_tr_b16 v[34:35], v14 offset:16896
  v_exp_f32 v21, v21
  v_mfma_f32_16x16x32_bf16 v[200:203], v[48:51], a[84:87], v[200:203]
  v_fma_f32 v22, v20, 0.5, 1.0
  v_fma_f32 v20, v20, v22, 1.0
  v_mfma_f32_16x16x32_bf16 v[208:211], v[48:51], a[208:211], v[208:211]
  ds_read_b64_tr_b16 v[36:37], v14 offset:20480
  v_fma_f32 v23, v21, 0.5, 1.0
  v_mfma_f32_16x16x32_bf16 v[208:211], v[52:55], a[216:219], v[208:211]
  v_fma_f32 v21, v21, v23, 1.0
  v_mfma_f32_16x16x32_bf16 v[216:219], v[52:55], a[220:223], v[216:219]
  ds_read_b64_tr_b16 v[38:39], v14 offset:20992
  v_rcp_f32 v20, v20
  v_mfma_f32_16x16x32_bf16 v[216:219], v[48:51], a[212:215], v[216:219]
  s_waitcnt lgkmcnt(4)
  v_cvt_pk_bf16_f32 v120, v24, v25
  v_rcp_f32 v21, v21
  v_mfma_f32_16x16x32_bf16 v[220:223], v[56:59], a[212:215], v[220:223]
  ds_read_b64_tr_b16 v[40:41], v15 offset:16384
  v_fma_f32 v24, -v122, v20, v122
  v_mfma_f32_16x16x32_bf16 v[220:223], v[60:63], a[220:223], v[220:223]
  v_fma_f32 v25, -v123, v21, v123
  v_mul_f32 v20, 0x3fb8aa3b, v124
  v_mfma_f32_16x16x32_bf16 v[212:215], v[60:63], a[216:219], v[212:215]
  ds_read_b64_tr_b16 v[42:43], v15 offset:16896
  v_mfma_f32_16x16x32_bf16 v[212:215], v[56:59], a[208:211], v[212:215]
  v_exp_f32 v20, v20
  v_mfma_f32_16x16x32_bf16 v[204:207], v[56:59], a[84:87], v[204:207]
  ds_read_b64_tr_b16 v[44:45], v15 offset:20480
  v_mul_f32 v21, 0x3fb8aa3b, v125
  v_mfma_f32_16x16x32_bf16 v[204:207], v[60:63], a[92:95], v[204:207]
  v_exp_f32 v21, v21
  v_mfma_f32_16x16x32_bf16 v[196:199], v[60:63], a[88:91], v[196:199]
  ds_read_b64_tr_b16 v[46:47], v15 offset:20992
  v_fma_f32 v22, v20, 0.5, 1.0
  v_mfma_f32_16x16x32_bf16 v[196:199], v[56:59], a[80:83], v[196:199]
  s_waitcnt lgkmcnt(4)
  v_fma_f32 v20, v20, v22, 1.0
  v_fma_f32 v23, v21, 0.5, 1.0
  v_mfma_f32_16x16x32_bf16 v[160:163], v[32:35], a[96:99], v[160:163]
  ds_read_b64_tr_b16 v[48:49], v16 offset:16384
  v_fma_f32 v21, v21, v23, 1.0
  v_mfma_f32_16x16x32_bf16 v[160:163], v[36:39], a[104:107], v[160:163]
  v_rcp_f32 v20, v20
  v_cvt_pk_bf16_f32 v121, v24, v25
  v_mfma_f32_16x16x32_bf16 v[168:171], v[36:39], a[108:111], v[168:171]
  ds_read_b64_tr_b16 v[50:51], v16 offset:16896
  v_rcp_f32 v21, v21
  v_mfma_f32_16x16x32_bf16 v[168:171], v[32:35], a[100:103], v[168:171]
  v_fma_f32 v24, -v124, v20, v124
  v_fma_f32 v25, -v125, v21, v125
  v_mfma_f32_16x16x32_bf16 v[176:179], v[32:35], a[224:227], v[176:179]
  ds_read_b64_tr_b16 v[52:53], v16 offset:20480
  v_mul_f32 v20, 0x3fb8aa3b, v126
  v_mfma_f32_16x16x32_bf16 v[176:179], v[36:39], a[232:235], v[176:179]
  v_exp_f32 v20, v20
  v_mfma_f32_16x16x32_bf16 v[184:187], v[36:39], a[236:239], v[184:187]
  ds_read_b64_tr_b16 v[54:55], v16 offset:20992
  v_mul_f32 v21, 0x3fb8aa3b, v127
  v_mfma_f32_16x16x32_bf16 v[184:187], v[32:35], a[228:231], v[184:187]
  s_waitcnt lgkmcnt(4)
  v_exp_f32 v21, v21
  v_mfma_f32_16x16x32_bf16 v[188:191], v[40:43], a[228:231], v[188:191]
  ds_read_b64_tr_b16 v[56:57], v17 offset:16384
  v_fma_f32 v22, v20, 0.5, 1.0
  v_mfma_f32_16x16x32_bf16 v[188:191], v[44:47], a[236:239], v[188:191]
  v_fma_f32 v20, v20, v22, 1.0
  v_fma_f32 v23, v21, 0.5, 1.0
  v_mfma_f32_16x16x32_bf16 v[180:183], v[44:47], a[232:235], v[180:183]
  ds_read_b64_tr_b16 v[58:59], v17 offset:16896
  v_fma_f32 v21, v21, v23, 1.0
  v_mfma_f32_16x16x32_bf16 v[180:183], v[40:43], a[224:227], v[180:183]
  v_rcp_f32 v20, v20
  v_mfma_f32_16x16x32_bf16 v[172:175], v[40:43], a[100:103], v[172:175]
  ds_read_b64_tr_b16 v[60:61], v17 offset:20480
  v_cvt_pk_bf16_f32 v122, v24, v25
  v_mfma_f32_16x16x32_bf16 v[172:175], v[44:47], a[108:111], v[172:175]
  v_rcp_f32 v21, v21
  v_mfma_f32_16x16x32_bf16 v[164:167], v[44:47], a[104:107], v[164:167]
  ds_read_b64_tr_b16 v[62:63], v17 offset:20992
  v_fma_f32 v24, -v126, v20, v126
  v_mfma_f32_16x16x32_bf16 v[164:167], v[40:43], a[96:99], v[164:167]
  s_waitcnt lgkmcnt(4)
  v_fma_f32 v25, -v127, v21, v127
  v_mul_f32 v20, 0x3fb8aa3b, v128
  v_mfma_f32_16x16x32_bf16 v[192:195], v[48:51], a[96:99], v[192:195]
  ds_read_b64_tr_b16 v[32:33], v14 offset:24576
  v_exp_f32 v20, v20
  v_mfma_f32_16x16x32_bf16 v[192:195], v[52:55], a[104:107], v[192:195]
  v_mul_f32 v21, 0x3fb8aa3b, v129
  v_mfma_f32_16x16x32_bf16 v[200:203], v[52:55], a[108:111], v[200:203]
  ds_read_b64_tr_b16 v[34:35], v14 offset:25088
  v_exp_f32 v21, v21
  v_mfma_f32_16x16x32_bf16 v[200:203], v[48:51], a[100:103], v[200:203]
  v_fma_f32 v22, v20, 0.5, 1.0
  v_fma_f32 v20, v20, v22, 1.0
  v_mfma_f32_16x16x32_bf16 v[208:211], v[48:51], a[224:227], v[208:211]
  ds_read_b64_tr_b16 v[36:37], v14 offset:28672
  v_fma_f32 v23, v21, 0.5, 1.0
  v_mfma_f32_16x16x32_bf16 v[208:211], v[52:55], a[232:235], v[208:211]
  v_fma_f32 v21, v21, v23, 1.0
  v_rcp_f32 v20, v20
  v_mfma_f32_16x16x32_bf16 v[216:219], v[52:55], a[236:239], v[216:219]
  ds_read_b64_tr_b16 v[38:39], v14 offset:29184
  v_add_u32 v14, 0x10000, v14
  v_mfma_f32_16x16x32_bf16 v[216:219], v[48:51], a[228:231], v[216:219]
  s_waitcnt lgkmcnt(4)
  v_cvt_pk_bf16_f32 v123, v24, v25
  v_mfma_f32_16x16x32_bf16 v[220:223], v[56:59], a[228:231], v[220:223]
  ds_read_b64_tr_b16 v[40:41], v15 offset:24576
  v_rcp_f32 v21, v21
  v_mfma_f32_16x16x32_bf16 v[220:223], v[60:63], a[236:239], v[220:223]
  v_fma_f32 v24, -v128, v20, v128
  v_mfma_f32_16x16x32_bf16 v[212:215], v[60:63], a[232:235], v[212:215]
  ds_read_b64_tr_b16 v[42:43], v15 offset:25088
  buffer_store_dwordx4 v[120:123], v1, s[44:47], s95 offen offset:1024 sc1
  v_mfma_f32_16x16x32_bf16 v[212:215], v[56:59], a[224:227], v[212:215]
  v_fma_f32 v25, -v129, v21, v129
  v_mul_f32 v20, 0x3fb8aa3b, v130
  v_mfma_f32_16x16x32_bf16 v[204:207], v[56:59], a[100:103], v[204:207]
  ds_read_b64_tr_b16 v[44:45], v15 offset:28672
  v_exp_f32 v20, v20
  v_mfma_f32_16x16x32_bf16 v[204:207], v[60:63], a[108:111], v[204:207]
  v_mul_f32 v21, 0x3fb8aa3b, v131
  v_mfma_f32_16x16x32_bf16 v[196:199], v[60:63], a[104:107], v[196:199]
  ds_read_b64_tr_b16 v[46:47], v15 offset:29184
  v_add_u32 v15, 0x10000, v15
  v_mfma_f32_16x16x32_bf16 v[196:199], v[56:59], a[96:99], v[196:199]
  s_waitcnt lgkmcnt(4)
  v_exp_f32 v21, v21
  v_mfma_f32_16x16x32_bf16 v[160:163], v[32:35], a[112:115], v[160:163]
  ds_read_b64_tr_b16 v[48:49], v16 offset:24576
  v_fma_f32 v22, v20, 0.5, 1.0
  v_mfma_f32_16x16x32_bf16 v[160:163], v[36:39], a[120:123], v[160:163]
  v_fma_f32 v20, v20, v22, 1.0
  v_fma_f32 v23, v21, 0.5, 1.0
  v_mfma_f32_16x16x32_bf16 v[168:171], v[36:39], a[124:127], v[168:171]
  ds_read_b64_tr_b16 v[50:51], v16 offset:25088
  v_fma_f32 v21, v21, v23, 1.0
  v_mfma_f32_16x16x32_bf16 v[168:171], v[32:35], a[116:119], v[168:171]
  v_rcp_f32 v20, v20
  v_mfma_f32_16x16x32_bf16 v[176:179], v[32:35], a[240:243], v[176:179]
  ds_read_b64_tr_b16 v[52:53], v16 offset:28672
  v_cvt_pk_bf16_f32 v128, v24, v25
  v_mfma_f32_16x16x32_bf16 v[176:179], v[36:39], a[248:251], v[176:179]
  v_rcp_f32 v21, v21
  v_fma_f32 v24, -v130, v20, v130
  v_mfma_f32_16x16x32_bf16 v[184:187], v[36:39], a[252:255], v[184:187]
  ds_read_b64_tr_b16 v[54:55], v16 offset:29184
  v_add_u32 v16, 0x10000, v16
  v_mfma_f32_16x16x32_bf16 v[184:187], v[32:35], a[244:247], v[184:187]
  s_waitcnt lgkmcnt(4)
  v_fma_f32 v25, -v131, v21, v131
  v_mul_f32 v20, 0x3fb8aa3b, v132
  v_mfma_f32_16x16x32_bf16 v[188:191], v[40:43], a[244:247], v[188:191]
  ds_read_b64_tr_b16 v[56:57], v17 offset:24576
  v_exp_f32 v20, v20
  v_mfma_f32_16x16x32_bf16 v[188:191], v[44:47], a[252:255], v[188:191]
  v_mul_f32 v21, 0x3fb8aa3b, v133
  v_mfma_f32_16x16x32_bf16 v[180:183], v[44:47], a[248:251], v[180:183]
  ds_read_b64_tr_b16 v[58:59], v17 offset:25088
  v_exp_f32 v21, v21
  v_mfma_f32_16x16x32_bf16 v[180:183], v[40:43], a[240:243], v[180:183]
  v_fma_f32 v22, v20, 0.5, 1.0
  v_fma_f32 v20, v20, v22, 1.0
  v_mfma_f32_16x16x32_bf16 v[172:175], v[40:43], a[116:119], v[172:175]
  ds_read_b64_tr_b16 v[60:61], v17 offset:28672
  v_fma_f32 v23, v21, 0.5, 1.0
  v_mfma_f32_16x16x32_bf16 v[172:175], v[44:47], a[124:127], v[172:175]
  s_waitcnt vmcnt(16)
  v_fma_f32 v21, v21, v23, 1.0
  v_rcp_f32 v20, v20
  v_mfma_f32_16x16x32_bf16 v[164:167], v[44:47], a[120:123], v[164:167]
  s_barrier
  ds_read_b64_tr_b16 v[62:63], v17 offset:29184
  v_add_u32 v17, 0x10000, v17
  v_mfma_f32_16x16x32_bf16 v[164:167], v[40:43], a[112:115], v[164:167]
  s_waitcnt lgkmcnt(4)
  v_cvt_pk_bf16_f32 v129, v24, v25
  v_mfma_f32_16x16x32_bf16 v[192:195], v[48:51], a[112:115], v[192:195]
  ds_read_b64_tr_b16 v[32:33], v14 offset:32768
  v_rcp_f32 v21, v21
  v_mfma_f32_16x16x32_bf16 v[192:195], v[52:55], a[120:123], v[192:195]
  v_fma_f32 v24, -v132, v20, v132
  v_fma_f32 v25, -v133, v21, v133
  v_mfma_f32_16x16x32_bf16 v[200:203], v[52:55], a[124:127], v[200:203]
  ds_read_b64_tr_b16 v[34:35], v14 offset:33280
  v_mul_f32 v20, 0x3fb8aa3b, v134
  v_mfma_f32_16x16x32_bf16 v[200:203], v[48:51], a[116:119], v[200:203]
  v_exp_f32 v20, v20
  v_mfma_f32_16x16x32_bf16 v[208:211], v[48:51], a[240:243], v[208:211]
  ds_read_b64_tr_b16 v[36:37], v14 offset:36864
  v_mul_f32 v21, 0x3fb8aa3b, v135
  v_mfma_f32_16x16x32_bf16 v[208:211], v[52:55], a[248:251], v[208:211]
  v_exp_f32 v21, v21
  v_mfma_f32_16x16x32_bf16 v[216:219], v[52:55], a[252:255], v[216:219]
  ds_read_b64_tr_b16 v[38:39], v14 offset:37376
  v_fma_f32 v22, v20, 0.5, 1.0
  v_mfma_f32_16x16x32_bf16 v[216:219], v[48:51], a[244:247], v[216:219]
  s_waitcnt lgkmcnt(4)
  v_fma_f32 v20, v20, v22, 1.0
  v_fma_f32 v23, v21, 0.5, 1.0
  v_mfma_f32_16x16x32_bf16 v[220:223], v[56:59], a[244:247], v[220:223]
  ds_read_b64_tr_b16 v[40:41], v15 offset:32768
  v_fma_f32 v21, v21, v23, 1.0
  v_mfma_f32_16x16x32_bf16 v[220:223], v[60:63], a[252:255], v[220:223]
  v_rcp_f32 v20, v20
  v_mfma_f32_16x16x32_bf16 v[212:215], v[60:63], a[248:251], v[212:215]
  ds_read_b64_tr_b16 v[42:43], v15 offset:33280
  v_cvt_pk_bf16_f32 v130, v24, v25
  v_mfma_f32_16x16x32_bf16 v[212:215], v[56:59], a[240:243], v[212:215]
  v_rcp_f32 v21, v21
  v_mfma_f32_16x16x32_bf16 v[204:207], v[56:59], a[116:119], v[204:207]
  ds_read_b64_tr_b16 v[44:45], v15 offset:36864
  v_fma_f32 v24, -v134, v20, v134
  v_mfma_f32_16x16x32_bf16 v[204:207], v[60:63], a[124:127], v[204:207]
  v_fma_f32 v25, -v135, v21, v135
  v_mul_f32 v20, 0x3fb8aa3b, v136
  v_mfma_f32_16x16x32_bf16 v[196:199], v[60:63], a[120:123], v[196:199]
  ds_read_b64_tr_b16 v[46:47], v15 offset:37376
  v_exp_f32 v20, v20
  v_mfma_f32_16x16x32_bf16 v[196:199], v[56:59], a[112:115], v[196:199]
  s_waitcnt lgkmcnt(4)
  v_mul_f32 v21, 0x3fb8aa3b, v137
  v_exp_f32 v21, v21
  v_mfma_f32_16x16x32_bf16 v[64:67], v[32:35], a[0:3], 0
  ds_read_b64_tr_b16 v[48:49], v16 offset:32768
  v_fma_f32 v22, v20, 0.5, 1.0
  v_mfma_f32_16x16x32_bf16 v[64:67], v[36:39], a[8:11], v[64:67]
  v_fma_f32 v20, v20, v22, 1.0
  v_fma_f32 v23, v21, 0.5, 1.0
  v_mfma_f32_16x16x32_bf16 v[72:75], v[36:39], a[12:15], 0
  ds_read_b64_tr_b16 v[50:51], v16 offset:33280
  v_fma_f32 v21, v21, v23, 1.0
  v_mfma_f32_16x16x32_bf16 v[72:75], v[32:35], a[4:7], v[72:75]
  v_rcp_f32 v20, v20
  v_mfma_f32_16x16x32_bf16 v[80:83], v[32:35], a[128:131], 0
  ds_read_b64_tr_b16 v[52:53], v16 offset:36864
  v_cvt_pk_bf16_f32 v131, v24, v25
  v_mfma_f32_16x16x32_bf16 v[80:83], v[36:39], a[136:139], v[80:83]
  buffer_load_dword v29, v27, s[28:31], s80 offen sc1
  v_mfma_f32_16x16x32_bf16 v[88:91], v[36:39], a[140:143], 0
  ds_read_b64_tr_b16 v[54:55], v16 offset:37376
  v_mfma_f32_16x16x32_bf16 v[88:91], v[32:35], a[132:135], v[88:91]
  s_waitcnt lgkmcnt(4)
  v_rcp_f32 v21, v21
  v_mfma_f32_16x16x32_bf16 v[92:95], v[40:43], a[132:135], 0
  s_mul_i32 s7, s4, 37
  ds_read_b64_tr_b16 v[56:57], v17 offset:32768
  v_fma_f32 v24, -v136, v20, v136
  v_mfma_f32_16x16x32_bf16 v[92:95], v[44:47], a[140:143], v[92:95]
  s_lshr_b32 s7, s7, 8
  buffer_store_dwordx4 v[128:131], v1, s[44:47], s94 offen offset:2048 sc1
  v_fma_f32 v25, -v137, v21, v137
  v_mfma_f32_16x16x32_bf16 v[84:87], v[44:47], a[136:139], 0
  s_mul_i32 s7, s7, 25
  ds_read_b64_tr_b16 v[58:59], v17 offset:33280
  v_mul_f32 v20, 0x3fb8aa3b, v138
  v_mfma_f32_16x16x32_bf16 v[84:87], v[40:43], a[128:131], v[84:87]
  s_lshl_b32 s78, s48, 7
  v_exp_f32 v20, v20
  v_mfma_f32_16x16x32_bf16 v[76:79], v[40:43], a[4:7], 0
  s_add_u32 s78, s78, s7
  ds_read_b64_tr_b16 v[60:61], v17 offset:36864
  v_mul_f32 v21, 0x3fb8aa3b, v139
  v_mfma_f32_16x16x32_bf16 v[76:79], v[44:47], a[12:15], v[76:79]
  s_add_u32 s78, s78, s4
  v_exp_f32 v21, v21
  v_mfma_f32_16x16x32_bf16 v[68:71], v[44:47], a[8:11], 0
  s_lshl_b32 s78, s78, 2
  ds_read_b64_tr_b16 v[62:63], v17 offset:37376
  v_fma_f32 v22, v20, 0.5, 1.0
  v_mfma_f32_16x16x32_bf16 v[68:71], v[40:43], a[0:3], v[68:71]
  s_waitcnt lgkmcnt(4)
  v_fma_f32 v20, v20, v22, 1.0
  v_fma_f32 v23, v21, 0.5, 1.0
  v_mfma_f32_16x16x32_bf16 v[224:227], v[48:51], a[0:3], 0
  s_add_u32 s78, s78, 60817440
  ds_read_b64_tr_b16 v[32:33], v14 offset:40960
  v_fma_f32 v21, v21, v23, 1.0
  v_mfma_f32_16x16x32_bf16 v[224:227], v[52:55], a[8:11], v[224:227]
  s_mul_i32 s7, s4, 37
  v_rcp_f32 v20, v20
  v_cvt_pk_bf16_f32 v136, v24, v25
  v_mfma_f32_16x16x32_bf16 v[232:235], v[52:55], a[12:15], 0
  s_lshr_b32 s7, s7, 8
  ds_read_b64_tr_b16 v[34:35], v14 offset:41472
  v_rcp_f32 v21, v21
  v_mfma_f32_16x16x32_bf16 v[232:235], v[48:51], a[4:7], v[232:235]
  s_mul_i32 s7, s7, 25
  v_fma_f32 v24, -v138, v20, v138
  v_fma_f32 v25, -v139, v21, v139
  v_mfma_f32_16x16x32_bf16 v[240:243], v[48:51], a[128:131], 0
  s_lshl_b32 s79, s49, 7
  ds_read_b64_tr_b16 v[36:37], v14 offset:45056
  v_mul_f32 v20, 0x3fb8aa3b, v140
  v_mfma_f32_16x16x32_bf16 v[240:243], v[52:55], a[136:139], v[240:243]
  s_add_u32 s79, s79, s7
  v_exp_f32 v20, v20
  v_mfma_f32_16x16x32_bf16 v[248:251], v[52:55], a[140:143], 0
  s_add_u32 s79, s79, s4
  ds_read_b64_tr_b16 v[38:39], v14 offset:45568
  v_mul_f32 v21, 0x3fb8aa3b, v141
  v_mfma_f32_16x16x32_bf16 v[248:251], v[48:51], a[132:135], v[248:251]
  s_waitcnt lgkmcnt(4)
  v_exp_f32 v21, v21
  v_mfma_f32_16x16x32_bf16 v[252:255], v[56:59], a[132:135], 0
  s_lshl_b32 s79, s79, 2
  ds_read_b64_tr_b16 v[40:41], v15 offset:40960
  v_fma_f32 v22, v20, 0.5, 1.0
  v_mfma_f32_16x16x32_bf16 v[252:255], v[60:63], a[140:143], v[252:255]
  s_add_u32 s79, s79, 60817440
  v_fma_f32 v20, v20, v22, 1.0
  v_fma_f32 v23, v21, 0.5, 1.0
  v_mfma_f32_16x16x32_bf16 v[244:247], v[60:63], a[136:139], 0
  s_add_u32 s63, s77, 0x20000
  ds_read_b64_tr_b16 v[42:43], v15 offset:41472
  v_fma_f32 v21, v21, v23, 1.0
  v_mfma_f32_16x16x32_bf16 v[244:247], v[56:59], a[128:131], v[244:247]
  v_rcp_f32 v20, v20
  v_mfma_f32_16x16x32_bf16 v[236:239], v[56:59], a[4:7], 0
  ds_read_b64_tr_b16 v[44:45], v15 offset:45056
  v_cvt_pk_bf16_f32 v137, v24, v25
  v_mfma_f32_16x16x32_bf16 v[236:239], v[60:63], a[12:15], v[236:239]
  v_rcp_f32 v21, v21
  v_mfma_f32_16x16x32_bf16 v[228:231], v[60:63], a[8:11], 0
  ds_read_b64_tr_b16 v[46:47], v15 offset:45568
  v_fma_f32 v24, -v140, v20, v140
  v_mfma_f32_16x16x32_bf16 v[228:231], v[56:59], a[0:3], v[228:231]
  s_waitcnt lgkmcnt(4)
  v_fma_f32 v25, -v141, v21, v141
  v_mul_f32 v20, 0x3fb8aa3b, v142
  v_mfma_f32_16x16x32_bf16 v[64:67], v[32:35], a[16:19], v[64:67]
  ds_read_b64_tr_b16 v[48:49], v16 offset:40960
  v_exp_f32 v20, v20
  v_mfma_f32_16x16x32_bf16 v[64:67], v[36:39], a[24:27], v[64:67]
  v_mul_f32 v21, 0x3fb8aa3b, v143
  v_mfma_f32_16x16x32_bf16 v[72:75], v[36:39], a[28:31], v[72:75]
  ds_read_b64_tr_b16 v[50:51], v16 offset:41472
  v_exp_f32 v21, v21
  v_mfma_f32_16x16x32_bf16 v[72:75], v[32:35], a[20:23], v[72:75]
  v_fma_f32 v22, v20, 0.5, 1.0
  v_fma_f32 v20, v20, v22, 1.0
  v_mfma_f32_16x16x32_bf16 v[80:83], v[32:35], a[144:147], v[80:83]
  ds_read_b64_tr_b16 v[52:53], v16 offset:45056
  v_fma_f32 v23, v21, 0.5, 1.0
  v_mfma_f32_16x16x32_bf16 v[80:83], v[36:39], a[152:155], v[80:83]
  v_fma_f32 v21, v21, v23, 1.0
  v_rcp_f32 v20, v20
  v_mfma_f32_16x16x32_bf16 v[88:91], v[36:39], a[156:159], v[88:91]
  ds_read_b64_tr_b16 v[54:55], v16 offset:45568
  v_cvt_pk_bf16_f32 v138, v24, v25
  v_mfma_f32_16x16x32_bf16 v[88:91], v[32:35], a[148:151], v[88:91]
  s_waitcnt lgkmcnt(4)
  v_rcp_f32 v21, v21
  v_mfma_f32_16x16x32_bf16 v[92:95], v[40:43], a[148:151], v[92:95]
  ds_read_b64_tr_b16 v[56:57], v17 offset:40960
  v_fma_f32 v24, -v142, v20, v142
  v_mfma_f32_16x16x32_bf16 v[92:95], v[44:47], a[156:159], v[92:95]
  v_fma_f32 v25, -v143, v21, v143
  v_mul_f32 v20, 0x3fb8aa3b, v144
  v_mfma_f32_16x16x32_bf16 v[84:87], v[44:47], a[152:155], v[84:87]
  ds_read_b64_tr_b16 v[58:59], v17 offset:41472
  v_mfma_f32_16x16x32_bf16 v[84:87], v[40:43], a[144:147], v[84:87]
  v_exp_f32 v20, v20
  v_mfma_f32_16x16x32_bf16 v[76:79], v[40:43], a[20:23], v[76:79]
  ds_read_b64_tr_b16 v[60:61], v17 offset:45056
  v_mul_f32 v21, 0x3fb8aa3b, v145
  v_mfma_f32_16x16x32_bf16 v[76:79], v[44:47], a[28:31], v[76:79]
  s_waitcnt vmcnt(9)
  v_exp_f32 v21, v21
  v_fma_f32 v22, v20, 0.5, 1.0
  v_mfma_f32_16x16x32_bf16 v[68:71], v[44:47], a[24:27], v[68:71]
  s_barrier
  ds_read_b64_tr_b16 v[62:63], v17 offset:45568
  v_mfma_f32_16x16x32_bf16 v[68:71], v[40:43], a[16:19], v[68:71]
  s_waitcnt lgkmcnt(4)
  v_fma_f32 v20, v20, v22, 1.0
  v_fma_f32 v23, v21, 0.5, 1.0
  v_mfma_f32_16x16x32_bf16 v[224:227], v[48:51], a[16:19], v[224:227]
  ds_read_b64_tr_b16 v[32:33], v14 offset:49152
  v_fma_f32 v21, v21, v23, 1.0
  v_mfma_f32_16x16x32_bf16 v[224:227], v[52:55], a[24:27], v[224:227]
  v_rcp_f32 v20, v20
  v_mfma_f32_16x16x32_bf16 v[232:235], v[52:55], a[28:31], v[232:235]
  s_waitcnt vmcnt(1)
  ds_read_b64_tr_b16 v[34:35], v14 offset:49664
  v_cmp_gt_u32 vcc, 0x100, v29
  v_mfma_f32_16x16x32_bf16 v[232:235], v[48:51], a[20:23], v[232:235]
  v_cvt_pk_bf16_f32 v139, v24, v25
  v_rcp_f32 v21, v21
  v_mfma_f32_16x16x32_bf16 v[240:243], v[48:51], a[144:147], v[240:243]
  ds_read_b64_tr_b16 v[36:37], v14 offset:53248
  v_fma_f32 v24, -v144, v20, v144
  v_mfma_f32_16x16x32_bf16 v[240:243], v[52:55], a[152:155], v[240:243]
  s_cbranch_vccnz L_pollKV
L_pollKV_back:
  buffer_store_dwordx4 v[136:139], v1, s[44:47], s94 offen offset:3072 sc1
  v_mfma_f32_16x16x32_bf16 v[248:251], v[52:55], a[156:159], v[248:251]
L_pad7:
  s_cbranch_execz L_pad11
  ds_read_b64_tr_b16 v[38:39], v14 offset:53760
  v_fma_f32 v25, -v145, v21, v145
  v_mfma_f32_16x16x32_bf16 v[248:251], v[48:51], a[148:151], v[248:251]
  s_waitcnt lgkmcnt(4)
  v_mul_f32 v20, 0x3fb8aa3b, v146
  v_mfma_f32_16x16x32_bf16 v[252:255], v[56:59], a[148:151], v[252:255]
  s_cmp_lg_u32 s71, 0
  s_cbranch_scc1 L_xacq
L_xacq_back:
  ds_read_b64_tr_b16 v[40:41], v15 offset:49152
  v_mfma_f32_16x16x32_bf16 v[252:255], v[60:63], a[156:159], v[252:255]
  v_exp_f32 v20, v20
  v_mfma_f32_16x16x32_bf16 v[244:247], v[60:63], a[152:155], v[244:247]
  s_and_b32 s6, s2, 1
  ds_read_b64_tr_b16 v[42:43], v15 offset:49664
  v_mul_f32 v21, 0x3fb8aa3b, v147
  v_mfma_f32_16x16x32_bf16 v[244:247], v[56:59], a[144:147], v[244:247]
  s_lshl_b32 s6, s6, 5
  v_exp_f32 v21, v21
  v_mfma_f32_16x16x32_bf16 v[236:239], v[56:59], a[20:23], v[236:239]
  s_sub_u32 m0, s63, 131072
  ds_read_b64_tr_b16 v[44:45], v15 offset:53248
  v_fma_f32 v22, v20, 0.5, 1.0
  v_mfma_f32_16x16x32_bf16 v[236:239], v[60:63], a[28:31], v[236:239]
  s_mov_b32 s97, 0
  buffer_load_dwordx4 v1, s[36:39], s97 offen offset:0 sc1 lds
  v_mfma_f32_16x16x32_bf16 v[228:231], v[60:63], a[24:27], v[228:231]
  s_add_u32 s6, s6, s48
  ds_read_b64_tr_b16 v[46:47], v15 offset:53760
  v_fma_f32 v20, v20, v22, 1.0
  v_fma_f32 v23, v21, 0.5, 1.0
  v_mfma_f32_16x16x32_bf16 v[228:231], v[56:59], a[16:19], v[228:231]
  s_waitcnt lgkmcnt(4)
  v_fma_f32 v21, v21, v23, 1.0
  v_rcp_f32 v20, v20
  v_mfma_f32_16x16x32_bf16 v[64:67], v[32:35], a[32:35], v[64:67]
  s_lshr_b32 s71, s2, 1
  ds_read_b64_tr_b16 v[48:49], v16 offset:49152
  v_cvt_pk_bf16_f32 v144, v24, v25
  v_mfma_f32_16x16x32_bf16 v[64:67], v[36:39], a[40:43], v[64:67]
  s_and_b32 s71, s71, 3
  v_rcp_f32 v21, v21
  v_mfma_f32_16x16x32_bf16 v[72:75], v[36:39], a[44:47], v[72:75]
  s_lshl_b32 s101, s6, 2
  ds_read_b64_tr_b16 v[50:51], v16 offset:49664
  v_fma_f32 v24, -v146, v20, v146
  v_mfma_f32_16x16x32_bf16 v[72:75], v[32:35], a[36:39], v[72:75]
  s_add_u32 s101, s101, s71
  v_fma_f32 v25, -v147, v21, v147
  v_mul_f32 v20, 0x3fb8aa3b, v148
  v_mfma_f32_16x16x32_bf16 v[80:83], v[32:35], a[160:163], v[80:83]
  s_lshl_b32 s101, s101, 7
  ds_read_b64_tr_b16 v[52:53], v16 offset:53248
  v_mfma_f32_16x16x32_bf16 v[80:83], v[36:39], a[168:171], v[80:83]
  s_add_u32 s101, s101, 60817440
  buffer_load_dwordx4 v1, s[36:39], s97 offen offset:1024 sc1 lds
  v_mfma_f32_16x16x32_bf16 v[88:91], v[36:39], a[172:175], v[88:91]
  s_mul_i32 s7, s71, 28
  ds_read_b64_tr_b16 v[54:55], v16 offset:53760
  v_exp_f32 v20, v20
  v_mfma_f32_16x16x32_bf16 v[88:91], v[32:35], a[164:167], v[88:91]
  s_waitcnt lgkmcnt(4)
  v_mul_f32 v21, 0x3fb8aa3b, v149
  v_exp_f32 v21, v21
  v_mfma_f32_16x16x32_bf16 v[92:95], v[40:43], a[164:167], v[92:95]
  s_mul_i32 s6, s6, 376832
  ds_read_b64_tr_b16 v[56:57], v17 offset:49152
  v_fma_f32 v22, v20, 0.5, 1.0
  v_mfma_f32_16x16x32_bf16 v[92:95], v[44:47], a[172:175], v[92:95]
  s_add_u32 s6, s6, 35651584
  v_fma_f32 v20, v20, v22, 1.0
  v_fma_f32 v23, v21, 0.5, 1.0
  v_mfma_f32_16x16x32_bf16 v[84:87], v[44:47], a[168:171], v[84:87]
  s_lshl_b32 s7, s7, 10
  ds_read_b64_tr_b16 v[58:59], v17 offset:49664
  v_fma_f32 v21, v21, v23, 1.0
  v_mfma_f32_16x16x32_bf16 v[84:87], v[40:43], a[160:163], v[84:87]
  s_add_u32 s57, s6, s7
  v_rcp_f32 v20, v20
  v_mfma_f32_16x16x32_bf16 v[76:79], v[40:43], a[36:39], v[76:79]
  s_add_u32 s57, s57, 262144
  ds_read_b64_tr_b16 v[60:61], v17 offset:53248
  v_cvt_pk_bf16_f32 v145, v24, v25
  v_mfma_f32_16x16x32_bf16 v[76:79], v[44:47], a[44:47], v[76:79]
  s_lshl_b32 s7, s71, 16
  buffer_load_dwordx4 v1, s[36:39], s97 offen offset:2048 sc1 lds
  v_mfma_f32_16x16x32_bf16 v[68:71], v[44:47], a[40:43], v[68:71]
  s_add_u32 s58, s6, s7
  ds_read_b64_tr_b16 v[62:63], v17 offset:53760
  v_mfma_f32_16x16x32_bf16 v[68:71], v[40:43], a[32:35], v[68:71]
  s_waitcnt lgkmcnt(4)
  v_rcp_f32 v21, v21
  v_mfma_f32_16x16x32_bf16 v[224:227], v[48:51], a[32:35], v[224:227]
  s_xor_b32 s6, s71, s3
  ds_read_b64_tr_b16 v[32:33], v14 offset:57344
  v_fma_f32 v24, -v148, v20, v148
  v_fma_f32 v25, -v149, v21, v149
  v_mfma_f32_16x16x32_bf16 v[224:227], v[52:55], a[40:43], v[224:227]
  s_xor_b32 s6, s6, 3
  v_mul_f32 v20, 0x3fb8aa3b, v150
  v_exp_f32 v20, v20
  v_mfma_f32_16x16x32_bf16 v[232:235], v[52:55], a[44:47], v[232:235]
  s_lshr_b32 s6, s6, 1
  ds_read_b64_tr_b16 v[34:35], v14 offset:57856
  v_mul_f32 v21, 0x3fb8aa3b, v151
  v_mfma_f32_16x16x32_bf16 v[232:235], v[48:51], a[36:39], v[232:235]
  s_lshl_b32 s6, s6, 7
  v_exp_f32 v21, v21
  v_mfma_f32_16x16x32_bf16 v[240:243], v[48:51], a[160:163], v[240:243]
  s_lshr_b32 s7, s2, 6
  ds_read_b64_tr_b16 v[36:37], v14 offset:61440
  v_fma_f32 v22, v20, 0.5, 1.0
  v_mfma_f32_16x16x32_bf16 v[240:243], v[52:55], a[168:171], v[240:243]
  s_lshl_b32 s7, s7, 8
  buffer_load_dwordx4 v1, s[36:39], s97 offen offset:3072 sc1 lds
  v_mfma_f32_16x16x32_bf16 v[248:251], v[52:55], a[172:175], v[248:251]
  s_add_u32 s6, s6, s7
  ds_read_b64_tr_b16 v[38:39], v14 offset:61952
  v_add_u32 v14, 0x10000, v14
  v_mfma_f32_16x16x32_bf16 v[248:251], v[48:51], a[164:167], v[248:251]
  s_waitcnt lgkmcnt(4)
  v_fma_f32 v20, v20, v22, 1.0
  v_fma_f32 v23, v21, 0.5, 1.0
  v_mfma_f32_16x16x32_bf16 v[252:255], v[56:59], a[164:167], v[252:255]
  s_and_b32 s7, s3, 1
  ds_read_b64_tr_b16 v[40:41], v15 offset:57344
  v_fma_f32 v21, v21, v23, 1.0
  v_mfma_f32_16x16x32_bf16 v[252:255], v[60:63], a[172:175], v[252:255]
  s_lshl_b32 s7, s7, 15
  v_rcp_f32 v20, v20
  v_mfma_f32_16x16x32_bf16 v[244:247], v[60:63], a[168:171], v[244:247]
  s_add_u32 s6, s6, s7
  ds_read_b64_tr_b16 v[42:43], v15 offset:57856
  v_cvt_pk_bf16_f32 v146, v24, v25
  v_mfma_f32_16x16x32_bf16 v[244:247], v[56:59], a[160:163], v[244:247]
  s_mul_i32 s7, s71, 458752
  v_rcp_f32 v21, v21
  v_mfma_f32_16x16x32_bf16 v[236:239], v[56:59], a[36:39], v[236:239]
  s_sub_u32 m0, s63, 114688
  ds_read_b64_tr_b16 v[44:45], v15 offset:61440
  v_fma_f32 v24, -v150, v20, v150
  v_mfma_f32_16x16x32_bf16 v[236:239], v[60:63], a[44:47], v[236:239]
  s_mov_b32 s97, 16384
  buffer_load_dwordx4 v1, s[36:39], s97 offen offset:0 sc1 lds
  v_mfma_f32_16x16x32_bf16 v[228:231], v[60:63], a[40:43], v[228:231]
  s_add_u32 s59, s6, s7
  ds_read_b64_tr_b16 v[46:47], v15 offset:61952
  v_add_u32 v15, 0x10000, v15
  v_mfma_f32_16x16x32_bf16 v[228:231], v[56:59], a[32:35], v[228:231]
  s_waitcnt lgkmcnt(4)
  v_fma_f32 v25, -v151, v21, v151
  v_mul_f32 v20, 0x3fb8aa3b, v152
  v_mfma_f32_16x16x32_bf16 v[64:67], v[32:35], a[48:51], v[64:67]
  s_lshl_b32 s7, s71, 20
  ds_read_b64_tr_b16 v[48:49], v16 offset:57344
  v_exp_f32 v20, v20
  v_mfma_f32_16x16x32_bf16 v[64:67], v[36:39], a[56:59], v[64:67]
  s_add_u32 s60, s6, s7
  v_mul_f32 v21, 0x3fb8aa3b, v153
  v_mfma_f32_16x16x32_bf16 v[72:75], v[36:39], a[60:63], v[72:75]
  s_and_b32 s6, s5, 1
  ds_read_b64_tr_b16 v[50:51], v16 offset:57856
  v_exp_f32 v21, v21
  v_mfma_f32_16x16x32_bf16 v[72:75], v[32:35], a[52:55], v[72:75]
  s_lshl_b32 s6, s6, 16
  v_fma_f32 v22, v20, 0.5, 1.0
  v_fma_f32 v20, v20, v22, 1.0
  v_mfma_f32_16x16x32_bf16 v[80:83], v[32:35], a[176:179], v[80:83]
  s_add_u32 s61, s77, s6
  ds_read_b64_tr_b16 v[52:53], v16 offset:61440
  v_fma_f32 v23, v21, 0.5, 1.0
  v_mfma_f32_16x16x32_bf16 v[80:83], v[36:39], a[184:187], v[80:83]
  s_xor_b32 s62, s61, 0x10000
  buffer_load_dwordx4 v1, s[36:39], s97 offen offset:1024 sc1 lds
  v_mfma_f32_16x16x32_bf16 v[88:91], v[36:39], a[188:191], v[88:91]
  s_add_u32 s54, s77, 81920
  ds_read_b64_tr_b16 v[54:55], v16 offset:61952
  v_add_u32 v16, 0x10000, v16
  v_mfma_f32_16x16x32_bf16 v[88:91], v[32:35], a[180:183], v[88:91]
  s_waitcnt lgkmcnt(4)
  v_fma_f32 v21, v21, v23, 1.0
  v_rcp_f32 v20, v20
  v_mfma_f32_16x16x32_bf16 v[92:95], v[40:43], a[180:183], v[92:95]
  s_and_b32 s75, s71, 1
  ds_read_b64_tr_b16 v[56:57], v17 offset:57344
  v_cvt_pk_bf16_f32 v147, v24, v25
  v_mfma_f32_16x16x32_bf16 v[92:95], v[44:47], a[188:191], v[92:95]
  s_xor_b32 s75, s75, 1
  v_rcp_f32 v21, v21
  v_mfma_f32_16x16x32_bf16 v[84:87], v[44:47], a[184:187], v[84:87]
  s_lshl_b32 s75, s75, 6
  ds_read_b64_tr_b16 v[58:59], v17 offset:57856
  v_fma_f32 v24, -v152, v20, v152
  v_mfma_f32_16x16x32_bf16 v[84:87], v[40:43], a[176:179], v[84:87]
  s_mov_b32 s52, 0x4000
  buffer_store_dwordx4 v[144:147], v1, s[44:47], s95 offen offset:2048 sc1
  v_mfma_f32_16x16x32_bf16 v[76:79], v[40:43], a[52:55], v[76:79]
  s_mov_b32 s55, s48
  ds_read_b64_tr_b16 v[60:61], v17 offset:61440
  v_fma_f32 v25, -v153, v21, v153
  v_mfma_f32_16x16x32_bf16 v[76:79], v[44:47], a[60:63], v[76:79]
  s_sub_u32 s56, 30, s48
  buffer_load_dwordx4 v1, s[36:39], s97 offen offset:2048 sc1 lds
  v_mfma_f32_16x16x32_bf16 v[68:71], v[44:47], a[56:59], v[68:71]
  s_sub_u32 s41, s5, 2
  ds_read_b64_tr_b16 v[62:63], v17 offset:61952
  v_add_u32 v17, 0x10000, v17
  v_mfma_f32_16x16x32_bf16 v[68:71], v[40:43], a[48:51], v[68:71]
  s_waitcnt lgkmcnt(4)
  v_mul_f32 v20, 0x3fb8aa3b, v154
  v_exp_f32 v20, v20
  v_mfma_f32_16x16x32_bf16 v[224:227], v[48:51], a[48:51], v[224:227]
  s_lshl_b32 s41, s41, 5
  ds_read_b64_tr_b16 v[32:33], v14 offset:0
  v_mul_f32 v21, 0x3fb8aa3b, v155
  v_mfma_f32_16x16x32_bf16 v[224:227], v[52:55], a[56:59], v[224:227]
  s_add_u32 s41, s41, s4
  v_exp_f32 v21, v21
  v_mfma_f32_16x16x32_bf16 v[232:235], v[52:55], a[60:63], v[232:235]
  s_lshl_b32 s41, s41, 2
  ds_read_b64_tr_b16 v[34:35], v14 offset:512
  v_fma_f32 v22, v20, 0.5, 1.0
  v_mfma_f32_16x16x32_bf16 v[232:235], v[48:51], a[52:55], v[232:235]
  s_add_u32 s41, s41, s3
  v_fma_f32 v20, v20, v22, 1.0
  v_fma_f32 v23, v21, 0.5, 1.0
  v_mfma_f32_16x16x32_bf16 v[240:243], v[48:51], a[176:179], v[240:243]
  s_lshl_b32 s41, s41, 13
  ds_read_b64_tr_b16 v[36:37], v14 offset:4096
  v_fma_f32 v21, v21, v23, 1.0
  v_mfma_f32_16x16x32_bf16 v[240:243], v[52:55], a[184:187], v[240:243]
  s_mov_b32 s20, s12
  buffer_load_dwordx4 v1, s[36:39], s97 offen offset:3072 sc1 lds
  v_mfma_f32_16x16x32_bf16 v[248:251], v[52:55], a[188:191], v[248:251]
  s_mov_b32 s21, s13
  ds_read_b64_tr_b16 v[38:39], v14 offset:4608
  v_rcp_f32 v20, v20
  v_mfma_f32_16x16x32_bf16 v[248:251], v[48:51], a[180:183], v[248:251]
  s_waitcnt lgkmcnt(4)
  v_cvt_pk_bf16_f32 v152, v24, v25
  v_mfma_f32_16x16x32_bf16 v[252:255], v[56:59], a[180:183], v[252:255]
  s_mov_b32 s22, s14
  ds_read_b64_tr_b16 v[40:41], v15 offset:0
  v_rcp_f32 v21, v21
  v_mfma_f32_16x16x32_bf16 v[252:255], v[60:63], a[188:191], v[252:255]
  s_mov_b32 s64, 0xf0000
  v_fma_f32 v24, -v154, v20, v154
  v_fma_f32 v25, -v155, v21, v155
  v_mfma_f32_16x16x32_bf16 v[244:247], v[60:63], a[184:187], v[244:247]
  s_mov_b32 s65, 0xfff00ff
  ds_read_b64_tr_b16 v[42:43], v15 offset:512
  v_mul_f32 v20, 0x3fb8aa3b, v156
  v_mfma_f32_16x16x32_bf16 v[244:247], v[56:59], a[176:179], v[244:247]
  s_mov_b32 s66, 0x1f0001
  v_exp_f32 v20, v20
  v_mfma_f32_16x16x32_bf16 v[236:239], v[56:59], a[52:55], v[236:239]
  s_sub_u32 m0, s63, 98304
  ds_read_b64_tr_b16 v[44:45], v15 offset:4096
  v_mul_f32 v21, 0x3fb8aa3b, v157
  v_mfma_f32_16x16x32_bf16 v[236:239], v[60:63], a[60:63], v[236:239]
  s_mov_b32 s97, 32768
  buffer_load_dwordx4 v1, s[36:39], s97 offen offset:0 sc1 lds
  v_mfma_f32_16x16x32_bf16 v[228:231], v[60:63], a[56:59], v[228:231]
  s_mov_b32 s67, 0x1fff01ff
  ds_read_b64_tr_b16 v[46:47], v15 offset:4608
  v_exp_f32 v21, v21
  v_mfma_f32_16x16x32_bf16 v[228:231], v[56:59], a[48:51], v[228:231]
  s_waitcnt lgkmcnt(4)
  v_fma_f32 v22, v20, 0.5, 1.0
  v_fma_f32 v20, v20, v22, 1.0
  v_mfma_f32_16x16x32_bf16 v[64:67], v[32:35], a[64:67], v[64:67]
  s_mov_b32 s68, 0x3f0003
  ds_read_b64_tr_b16 v[48:49], v16 offset:0
  v_fma_f32 v23, v21, 0.5, 1.0
  v_mfma_f32_16x16x32_bf16 v[64:67], v[36:39], a[72:75], v[64:67]
  s_mov_b32 s69, 0x3fff03ff
  v_fma_f32 v21, v21, v23, 1.0
  v_mfma_f32_16x16x32_bf16 v[72:75], v[36:39], a[76:79], v[72:75]
  s_mov_b32 s70, 0x7f0007
  ds_read_b64_tr_b16 v[50:51], v16 offset:512
  v_rcp_f32 v20, v20
  v_mfma_f32_16x16x32_bf16 v[72:75], v[32:35], a[68:71], v[72:75]
  s_mov_b32 s71, 0x7fff07ff
  v_cvt_pk_bf16_f32 v153, v24, v25
  v_mfma_f32_16x16x32_bf16 v[80:83], v[32:35], a[192:195], v[80:83]
  ds_read_b64_tr_b16 v[52:53], v16 offset:4096
  v_rcp_f32 v21, v21
  v_mfma_f32_16x16x32_bf16 v[80:83], v[36:39], a[200:203], v[80:83]
  buffer_load_dwordx4 v1, s[36:39], s97 offen offset:1024 sc1 lds
  v_mfma_f32_16x16x32_bf16 v[88:91], v[36:39], a[204:207], v[88:91]
  ds_read_b64_tr_b16 v[54:55], v16 offset:4608
  v_fma_f32 v24, -v156, v20, v156
  v_mfma_f32_16x16x32_bf16 v[88:91], v[32:35], a[196:199], v[88:91]
  s_waitcnt lgkmcnt(4)
  v_fma_f32 v25, -v157, v21, v157
  v_mul_f32 v20, 0x3fb8aa3b, v158
  v_mfma_f32_16x16x32_bf16 v[92:95], v[40:43], a[196:199], v[92:95]
  ds_read_b64_tr_b16 v[56:57], v17 offset:0
  v_exp_f32 v20, v20
  v_mfma_f32_16x16x32_bf16 v[92:95], v[44:47], a[204:207], v[92:95]
  v_mul_f32 v21, 0x3fb8aa3b, v159
  v_mfma_f32_16x16x32_bf16 v[84:87], v[44:47], a[200:203], v[84:87]
  ds_read_b64_tr_b16 v[58:59], v17 offset:512
  v_exp_f32 v21, v21
  v_mfma_f32_16x16x32_bf16 v[84:87], v[40:43], a[192:195], v[84:87]
  v_fma_f32 v22, v20, 0.5, 1.0
  v_fma_f32 v20, v20, v22, 1.0
  v_mfma_f32_16x16x32_bf16 v[76:79], v[40:43], a[68:71], v[76:79]
  ds_read_b64_tr_b16 v[60:61], v17 offset:4096
  v_fma_f32 v23, v21, 0.5, 1.0
  v_mfma_f32_16x16x32_bf16 v[76:79], v[44:47], a[76:79], v[76:79]
  buffer_load_dwordx4 v1, s[36:39], s97 offen offset:2048 sc1 lds
  v_mfma_f32_16x16x32_bf16 v[68:71], v[44:47], a[72:75], v[68:71]
  ds_read_b64_tr_b16 v[62:63], v17 offset:4608
  v_fma_f32 v21, v21, v23, 1.0
  v_mfma_f32_16x16x32_bf16 v[68:71], v[40:43], a[64:67], v[68:71]
  s_waitcnt lgkmcnt(4)
  v_rcp_f32 v20, v20
  v_mfma_f32_16x16x32_bf16 v[224:227], v[48:51], a[64:67], v[224:227]
  ds_read_b64_tr_b16 v[32:33], v14 offset:8192
  v_cvt_pk_bf16_f32 v154, v24, v25
  v_mfma_f32_16x16x32_bf16 v[224:227], v[52:55], a[72:75], v[224:227]
  v_rcp_f32 v21, v21
  v_mfma_f32_16x16x32_bf16 v[232:235], v[52:55], a[76:79], v[232:235]
  ds_read_b64_tr_b16 v[34:35], v14 offset:8704
  v_fma_f32 v24, -v158, v20, v158
  v_mfma_f32_16x16x32_bf16 v[232:235], v[48:51], a[68:71], v[232:235]
  v_fma_f32 v25, -v159, v21, v159
  v_cvt_pk_bf16_f32 v155, v24, v25
  v_mfma_f32_16x16x32_bf16 v[240:243], v[48:51], a[192:195], v[240:243]
  ds_read_b64_tr_b16 v[36:37], v14 offset:12288
  buffer_store_dwordx4 v[152:155], v1, s[44:47], s95 offen offset:3072 sc1
  v_mfma_f32_16x16x32_bf16 v[240:243], v[52:55], a[200:203], v[240:243]
  buffer_load_dwordx4 v1, s[36:39], s97 offen offset:3072 sc1 lds
  v_mfma_f32_16x16x32_bf16 v[248:251], v[52:55], a[204:207], v[248:251]
  ds_read_b64_tr_b16 v[38:39], v14 offset:12800
  v_lshrrev_b32 v20, 3, v0
  v_mfma_f32_16x16x32_bf16 v[248:251], v[48:51], a[196:199], v[248:251]
  s_waitcnt lgkmcnt(4)
  v_and_b32 v21, 7, v0
  v_bfe_u32 v22, v0, 4, 2
  v_mfma_f32_16x16x32_bf16 v[252:255], v[56:59], a[196:199], v[252:255]
  ds_read_b64_tr_b16 v[40:41], v15 offset:8192
  v_lshlrev_b32 v22, 1, v22
  v_mfma_f32_16x16x32_bf16 v[252:255], v[60:63], a[204:207], v[252:255]
  v_xor_b32 v21, v21, v22
  v_lshlrev_b32 v21, 4, v21
  v_mfma_f32_16x16x32_bf16 v[244:247], v[60:63], a[200:203], v[244:247]
  ds_read_b64_tr_b16 v[42:43], v15 offset:8704
  v_xor_b32 v21, s75, v21
  v_mfma_f32_16x16x32_bf16 v[244:247], v[56:59], a[192:195], v[244:247]
  v_lshl_add_u32 v10, v20, 10, v21
  v_add_u32 v11, 7168, v10
  v_mfma_f32_16x16x32_bf16 v[236:239], v[56:59], a[68:71], v[236:239]
  s_sub_u32 m0, s63, 81920
  ds_read_b64_tr_b16 v[44:45], v15 offset:12288
  v_add_u32 v12, 14336, v10
  v_mfma_f32_16x16x32_bf16 v[236:239], v[60:63], a[76:79], v[236:239]
  s_mov_b32 s97, 49152
  buffer_load_dwordx4 v1, s[36:39], s97 offen offset:0 sc1 lds
  v_mfma_f32_16x16x32_bf16 v[228:231], v[60:63], a[72:75], v[228:231]
  ds_read_b64_tr_b16 v[46:47], v15 offset:12800
  v_add_u32 v13, 21504, v10
  v_mfma_f32_16x16x32_bf16 v[228:231], v[56:59], a[64:67], v[228:231]
  s_waitcnt lgkmcnt(4)
  v_min_u32 v27, 6, v0
  v_lshlrev_b32 v27, 2, v27
  v_mfma_f32_16x16x32_bf16 v[64:67], v[32:35], a[80:83], v[64:67]
  ds_read_b64_tr_b16 v[48:49], v16 offset:8192
  v_mov_b32 v4, 0x1c000
  v_mfma_f32_16x16x32_bf16 v[64:67], v[36:39], a[88:91], v[64:67]
  v_mov_b32 v6, 0x40004000
  v_mov_b32 v7, 0xff800000
  v_mov_b32 v2, v1
  v_mfma_f32_16x16x32_bf16 v[72:75], v[36:39], a[92:95], v[72:75]
  ds_read_b64_tr_b16 v[50:51], v16 offset:8704
  v_and_b32 v25, 3, v0
  v_mfma_f32_16x16x32_bf16 v[72:75], v[32:35], a[84:87], v[72:75]
  v_add_u32 v25, -1, v25
  v_ashrrev_i32 v25, 31, v25
  v_mfma_f32_16x16x32_bf16 v[80:83], v[32:35], a[208:211], v[80:83]
  ds_read_b64_tr_b16 v[52:53], v16 offset:12288
  v_and_b32 v25, 0x3f803f80, v25
  v_mfma_f32_16x16x32_bf16 v[80:83], v[36:39], a[216:219], v[80:83]
  buffer_load_dwordx4 v1, s[36:39], s97 offen offset:1024 sc1 lds
  v_mfma_f32_16x16x32_bf16 v[88:91], v[36:39], a[220:223], v[88:91]
  ds_read_b64_tr_b16 v[54:55], v16 offset:12800
  v_mov_b32 v96, 0
  v_mfma_f32_16x16x32_bf16 v[88:91], v[32:35], a[212:215], v[88:91]
  s_waitcnt lgkmcnt(4)
  v_mov_b32 v97, 0
  v_mov_b32 v98, 0
  v_mfma_f32_16x16x32_bf16 v[92:95], v[40:43], a[212:215], v[92:95]
  ds_read_b64_tr_b16 v[56:57], v17 offset:8192
  v_mov_b32 v99, 0
  v_mfma_f32_16x16x32_bf16 v[92:95], v[44:47], a[220:223], v[92:95]
  v_mov_b32 v100, 0
  v_mov_b32 v101, 0
  v_mfma_f32_16x16x32_bf16 v[84:87], v[44:47], a[216:219], v[84:87]
  ds_read_b64_tr_b16 v[58:59], v17 offset:8704
  v_mov_b32 v102, 0
  v_mov_b32 v103, 0
  v_mfma_f32_16x16x32_bf16 v[84:87], v[40:43], a[208:211], v[84:87]
  v_mov_b32 v104, 0
  v_mov_b32 v105, 0
  v_mfma_f32_16x16x32_bf16 v[76:79], v[40:43], a[84:87], v[76:79]
  ds_read_b64_tr_b16 v[60:61], v17 offset:12288
  v_mov_b32 v106, 0
  v_mfma_f32_16x16x32_bf16 v[76:79], v[44:47], a[92:95], v[76:79]
  s_waitcnt vmcnt(12)
  buffer_load_dwordx4 v1, s[36:39], s97 offen offset:2048 sc1 lds
  v_mfma_f32_16x16x32_bf16 v[68:71], v[44:47], a[88:91], v[68:71]
  s_barrier
  ds_read_b64_tr_b16 v[62:63], v17 offset:12800
  v_mfma_f32_16x16x32_bf16 v[68:71], v[40:43], a[80:83], v[68:71]
  s_waitcnt lgkmcnt(4)
  v_mov_b32 v107, 0
  v_mov_b32 v108, 0
  v_mfma_f32_16x16x32_bf16 v[224:227], v[48:51], a[80:83], v[224:227]
  ds_read_b64_tr_b16 v[32:33], v14 offset:16384
  v_mov_b32 v109, 0
  v_mfma_f32_16x16x32_bf16 v[224:227], v[52:55], a[88:91], v[224:227]
  v_mov_b32 v110, 0
  v_mov_b32 v111, 0
  v_mfma_f32_16x16x32_bf16 v[232:235], v[52:55], a[92:95], v[232:235]
  ds_read_b64_tr_b16 v[34:35], v14 offset:16896
  ds_read_b128 a[128:131], v1 offset:0
  v_mfma_f32_16x16x32_bf16 v[232:235], v[48:51], a[84:87], v[232:235]
  v_mov_b32 v128, 0
  v_mov_b32 v129, 0
  v_mov_b32 v130, 0
  v_mfma_f32_16x16x32_bf16 v[240:243], v[48:51], a[208:211], v[240:243]
  ds_read_b64_tr_b16 v[36:37], v14 offset:20480
  v_mov_b32 v131, 0
  v_mfma_f32_16x16x32_bf16 v[240:243], v[52:55], a[216:219], v[240:243]
  buffer_load_dwordx4 v1, s[36:39], s97 offen offset:3072 sc1 lds
  v_mfma_f32_16x16x32_bf16 v[248:251], v[52:55], a[220:223], v[248:251]
  ds_read_b64_tr_b16 v[38:39], v14 offset:20992
  ds_read_b128 a[132:135], v1 offset:1024
  v_mfma_f32_16x16x32_bf16 v[248:251], v[48:51], a[212:215], v[248:251]
  s_waitcnt lgkmcnt(6)
  v_mul_f32 v160, 0x3e0293ee, v160
  v_mul_f32 v161, 0x3e0293ee, v161
  v_mfma_f32_16x16x32_bf16 v[252:255], v[56:59], a[212:215], v[252:255]
  ds_read_b64_tr_b16 v[40:41], v15 offset:16384
  v_cvt_pk_bf16_f32 v160, v160, v161
  v_mfma_f32_16x16x32_bf16 v[252:255], v[60:63], a[220:223], v[252:255]
  v_mul_f32 v162, 0x3e0293ee, v162
  v_mul_f32 v163, 0x3e0293ee, v163
  v_mfma_f32_16x16x32_bf16 v[244:247], v[60:63], a[216:219], v[244:247]
  ds_read_b64_tr_b16 v[42:43], v15 offset:16896
  ds_read_b128 a[136:139], v1 offset:2048
  v_mfma_f32_16x16x32_bf16 v[244:247], v[56:59], a[208:211], v[244:247]
  v_cvt_pk_bf16_f32 v161, v162, v163
  v_mul_f32 v164, 0x3e0293ee, v164
  v_mfma_f32_16x16x32_bf16 v[236:239], v[56:59], a[84:87], v[236:239]
  s_sub_u32 m0, s63, 65536
  ds_read_b64_tr_b16 v[44:45], v15 offset:20480
  v_mul_f32 v165, 0x3e0293ee, v165
  v_cvt_pk_bf16_f32 v162, v164, v165
  v_mfma_f32_16x16x32_bf16 v[236:239], v[60:63], a[92:95], v[236:239]
  s_mov_b32 s97, 65536
  buffer_load_dwordx4 v1, s[36:39], s97 offen offset:0 sc1 lds
  v_mfma_f32_16x16x32_bf16 v[228:231], v[60:63], a[88:91], v[228:231]
  ds_read_b64_tr_b16 v[46:47], v15 offset:20992
  ds_read_b128 a[140:143], v1 offset:3072
  v_mfma_f32_16x16x32_bf16 v[228:231], v[56:59], a[80:83], v[228:231]
  s_waitcnt lgkmcnt(7)
  v_mul_f32 v166, 0x3e0293ee, v166
  v_mul_f32 v167, 0x3e0293ee, v167
  v_mfma_f32_16x16x32_bf16 v[64:67], v[32:35], a[96:99], v[64:67]
  ds_read_b64_tr_b16 v[48:49], v16 offset:16384
  v_cvt_pk_bf16_f32 v163, v166, v167
  v_mfma_f32_16x16x32_bf16 v[64:67], v[36:39], a[104:107], v[64:67]
  v_mul_f32 v168, 0x3e0293ee, v168
  v_mul_f32 v169, 0x3e0293ee, v169
  v_mfma_f32_16x16x32_bf16 v[72:75], v[36:39], a[108:111], v[72:75]
  ds_read_b64_tr_b16 v[50:51], v16 offset:16896
  ds_read_b128 a[144:147], v1 offset:4096
  v_mfma_f32_16x16x32_bf16 v[72:75], v[32:35], a[100:103], v[72:75]
  v_cvt_pk_bf16_f32 v164, v168, v169
  v_mul_f32 v170, 0x3e0293ee, v170
  v_mfma_f32_16x16x32_bf16 v[80:83], v[32:35], a[224:227], v[80:83]
  ds_read_b64_tr_b16 v[52:53], v16 offset:20480
  v_mul_f32 v171, 0x3e0293ee, v171
  v_mfma_f32_16x16x32_bf16 v[80:83], v[36:39], a[232:235], v[80:83]
  buffer_load_dwordx4 v1, s[36:39], s97 offen offset:1024 sc1 lds
  v_cvt_pk_bf16_f32 v165, v170, v171
  v_mfma_f32_16x16x32_bf16 v[88:91], v[36:39], a[236:239], v[88:91]
  ds_read_b64_tr_b16 v[54:55], v16 offset:20992
  ds_read_b128 a[148:151], v1 offset:5120
  v_mfma_f32_16x16x32_bf16 v[88:91], v[32:35], a[228:231], v[88:91]
  s_waitcnt lgkmcnt(7)
  v_mul_f32 v172, 0x3e0293ee, v172
  v_mul_f32 v173, 0x3e0293ee, v173
  v_mfma_f32_16x16x32_bf16 v[92:95], v[40:43], a[228:231], v[92:95]
  s_waitcnt vmcnt(7)
  ds_read_b64_tr_b16 v[56:57], v17 offset:16384
  v_cvt_pk_bf16_f32 v166, v172, v173
  v_mfma_f32_16x16x32_bf16 v[92:95], v[44:47], a[236:239], v[92:95]
  buffer_store_dword v28, off, s[44:47], s78 sc1
  v_mfma_f32_16x16x32_bf16 v[84:87], v[44:47], a[232:235], v[84:87]
  ds_read_b64_tr_b16 v[58:59], v17 offset:16896
  ds_read_b128 a[152:155], v1 offset:6144
  v_mfma_f32_16x16x32_bf16 v[84:87], v[40:43], a[224:227], v[84:87]
  buffer_store_dword v28, off, s[44:47], s79 sc1
  v_mfma_f32_16x16x32_bf16 v[76:79], v[40:43], a[100:103], v[76:79]
  ds_read_b64_tr_b16 v[60:61], v17 offset:20480
  v_mul_f32 v174, 0x3e0293ee, v174
  v_mfma_f32_16x16x32_bf16 v[76:79], v[44:47], a[108:111], v[76:79]
  buffer_load_dwordx4 v1, s[36:39], s97 offen offset:2048 sc1 lds
  v_mfma_f32_16x16x32_bf16 v[68:71], v[44:47], a[104:107], v[68:71]
  ds_read_b64_tr_b16 v[62:63], v17 offset:20992
  ds_read_b128 a[156:159], v1 offset:7168
  v_mul_f32 v175, 0x3e0293ee, v175
  v_mfma_f32_16x16x32_bf16 v[68:71], v[40:43], a[96:99], v[68:71]
  s_waitcnt lgkmcnt(7)
  v_cvt_pk_bf16_f32 v167, v174, v175
  v_mul_f32 v176, 0x3e0293ee, v176
  v_mfma_f32_16x16x32_bf16 v[224:227], v[48:51], a[96:99], v[224:227]
  ds_read_b64_tr_b16 v[32:33], v14 offset:24576
  v_mul_f32 v177, 0x3e0293ee, v177
  v_mfma_f32_16x16x32_bf16 v[224:227], v[52:55], a[104:107], v[224:227]
  v_cvt_pk_bf16_f32 v168, v176, v177
  v_mul_f32 v178, 0x3e0293ee, v178
  v_mfma_f32_16x16x32_bf16 v[232:235], v[52:55], a[108:111], v[232:235]
  ds_read_b64_tr_b16 v[34:35], v14 offset:25088
  ds_read_b128 a[160:163], v1 offset:8192
  v_mfma_f32_16x16x32_bf16 v[232:235], v[48:51], a[100:103], v[232:235]
  v_mul_f32 v179, 0x3e0293ee, v179
  v_cvt_pk_bf16_f32 v169, v178, v179
  v_mfma_f32_16x16x32_bf16 v[240:243], v[48:51], a[224:227], v[240:243]
  ds_read_b64_tr_b16 v[36:37], v14 offset:28672
  v_mul_f32 v180, 0x3e0293ee, v180
  v_mfma_f32_16x16x32_bf16 v[240:243], v[52:55], a[232:235], v[240:243]
  buffer_load_dwordx4 v1, s[36:39], s97 offen offset:3072 sc1 lds
  v_mfma_f32_16x16x32_bf16 v[248:251], v[52:55], a[236:239], v[248:251]
  ds_read_b64_tr_b16 v[38:39], v14 offset:29184
  ds_read_b128 a[164:167], v1 offset:9216
  v_mfma_f32_16x16x32_bf16 v[248:251], v[48:51], a[228:231], v[248:251]
  s_waitcnt lgkmcnt(7)
  v_mul_f32 v181, 0x3e0293ee, v181
  v_cvt_pk_bf16_f32 v170, v180, v181
  v_mul_f32 v182, 0x3e0293ee, v182
  v_mfma_f32_16x16x32_bf16 v[252:255], v[56:59], a[228:231], v[252:255]
  ds_read_b64_tr_b16 v[40:41], v15 offset:24576
  v_mul_f32 v183, 0x3e0293ee, v183
  v_mfma_f32_16x16x32_bf16 v[252:255], v[60:63], a[236:239], v[252:255]
  v_cvt_pk_bf16_f32 v171, v182, v183
  v_mul_f32 v184, 0x3e0293ee, v184
  v_mfma_f32_16x16x32_bf16 v[244:247], v[60:63], a[232:235], v[244:247]
  ds_read_b64_tr_b16 v[42:43], v15 offset:25088
  ds_read_b128 a[168:171], v1 offset:10240
  v_mfma_f32_16x16x32_bf16 v[244:247], v[56:59], a[224:227], v[244:247]
  v_mul_f32 v185, 0x3e0293ee, v185
  v_cvt_pk_bf16_f32 v172, v184, v185
  v_mfma_f32_16x16x32_bf16 v[236:239], v[56:59], a[100:103], v[236:239]
  ds_read_b64_tr_b16 v[44:45], v15 offset:28672
  v_mul_f32 v186, 0x3e0293ee, v186
  v_mfma_f32_16x16x32_bf16 v[236:239], v[60:63], a[108:111], v[236:239]
  v_mul_f32 v187, 0x3e0293ee, v187
  v_cvt_pk_bf16_f32 v173, v186, v187
  v_mfma_f32_16x16x32_bf16 v[228:231], v[60:63], a[104:107], v[228:231]
  ds_read_b64_tr_b16 v[46:47], v15 offset:29184
  ds_read_b128 a[172:175], v1 offset:11264
  v_mfma_f32_16x16x32_bf16 v[228:231], v[56:59], a[96:99], v[228:231]
  s_waitcnt lgkmcnt(7)
  v_mul_f32 v188, 0x3e0293ee, v188
  v_mul_f32 v189, 0x3e0293ee, v189
  v_mfma_f32_16x16x32_bf16 v[64:67], v[32:35], a[112:115], v[64:67]
  ds_read_b64_tr_b16 v[48:49], v16 offset:24576
  v_cvt_pk_bf16_f32 v174, v188, v189
  v_mul_f32 v190, 0x3e0293ee, v190
  v_mfma_f32_16x16x32_bf16 v[64:67], v[36:39], a[120:123], v[64:67]
  v_mul_f32 v191, 0x3e0293ee, v191
  v_cvt_pk_bf16_f32 v175, v190, v191
  v_mfma_f32_16x16x32_bf16 v[72:75], v[36:39], a[124:127], v[72:75]
  ds_read_b64_tr_b16 v[50:51], v16 offset:25088
  v_mul_f32 v192, 0x3e0293ee, v192
  v_mfma_f32_16x16x32_bf16 v[72:75], v[32:35], a[116:119], v[72:75]
L_pad8:
  s_cbranch_execz L_pad12
  v_mul_f32 v193, 0x3e0293ee, v193
  v_cvt_pk_bf16_f32 v176, v192, v193
  v_mfma_f32_16x16x32_bf16 v[80:83], v[32:35], a[240:243], v[80:83]
  ds_read_b64_tr_b16 v[52:53], v16 offset:28672
  v_mul_f32 v194, 0x3e0293ee, v194
  v_mfma_f32_16x16x32_bf16 v[80:83], v[36:39], a[248:251], v[80:83]
  v_mul_f32 v195, 0x3e0293ee, v195
  v_cvt_pk_bf16_f32 v177, v194, v195
  v_mfma_f32_16x16x32_bf16 v[88:91], v[36:39], a[252:255], v[88:91]
  ds_read_b64_tr_b16 v[54:55], v16 offset:29184
  v_mul_f32 v196, 0x3e0293ee, v196
  v_mfma_f32_16x16x32_bf16 v[88:91], v[32:35], a[244:247], v[88:91]
  s_waitcnt lgkmcnt(5)
  v_mul_f32 v197, 0x3e0293ee, v197
  v_cvt_pk_bf16_f32 v178, v196, v197
  v_mfma_f32_16x16x32_bf16 v[92:95], v[40:43], a[244:247], v[92:95]
  s_add_u32 s36, s36, 65536
  s_addc_u32 s37, s37, 0
  ds_read_b64_tr_b16 v[56:57], v17 offset:24576
  v_mul_f32 v198, 0x3e0293ee, v198
  v_mfma_f32_16x16x32_bf16 v[92:95], v[44:47], a[252:255], v[92:95]
  s_lshl_b32 s7, s5, 2
  v_mul_f32 v199, 0x3e0293ee, v199
  v_cvt_pk_bf16_f32 v179, v198, v199
  v_mul_f32 v200, 0x3e0293ee, v200
  v_mfma_f32_16x16x32_bf16 v[84:87], v[44:47], a[248:251], v[84:87]
  s_sub_u32 s7, 60, s7
  ds_read_b64_tr_b16 v[58:59], v17 offset:25088
  v_mul_f32 v201, 0x3e0293ee, v201
  v_mfma_f32_16x16x32_bf16 v[84:87], v[40:43], a[240:243], v[84:87]
  s_lshl_b32 s38, s7, 14
  v_cvt_pk_bf16_f32 v180, v200, v201
  v_mul_f32 v202, 0x3e0293ee, v202
  v_mfma_f32_16x16x32_bf16 v[76:79], v[40:43], a[116:119], v[76:79]
  s_mov_b32 m0, s54
  ds_read_b64_tr_b16 v[60:61], v17 offset:28672
  v_mul_f32 v203, 0x3e0293ee, v203
  v_mfma_f32_16x16x32_bf16 v[76:79], v[44:47], a[124:127], v[76:79]
  v_cvt_pk_bf16_f32 v181, v202, v203
  v_mul_f32 v204, 0x3e0293ee, v204
  v_mfma_f32_16x16x32_bf16 v[68:71], v[44:47], a[120:123], v[68:71]
  ds_read_b64_tr_b16 v[62:63], v17 offset:29184
  v_mul_f32 v205, 0x3e0293ee, v205
  v_mfma_f32_16x16x32_bf16 v[68:71], v[40:43], a[112:115], v[68:71]
  s_waitcnt lgkmcnt(4)
  v_cvt_pk_bf16_f32 v182, v204, v205
  v_mul_f32 v206, 0x3e0293ee, v206
  v_mfma_f32_16x16x32_bf16 v[224:227], v[48:51], a[112:115], v[224:227]
  v_mul_f32 v207, 0x3e0293ee, v207
  v_cvt_pk_bf16_f32 v183, v206, v207
  v_mfma_f32_16x16x32_bf16 v[224:227], v[52:55], a[120:123], v[224:227]
  v_mul_f32 v208, 0x3e0293ee, v208
  v_mul_f32 v209, 0x3e0293ee, v209
  v_mfma_f32_16x16x32_bf16 v[232:235], v[52:55], a[124:127], v[232:235]
  v_cvt_pk_bf16_f32 v184, v208, v209
  v_mul_f32 v210, 0x3e0293ee, v210
  v_mul_f32 v211, 0x3e0293ee, v211
  v_mfma_f32_16x16x32_bf16 v[232:235], v[48:51], a[116:119], v[232:235]
  v_cvt_pk_bf16_f32 v185, v210, v211
  v_mul_f32 v212, 0x3e0293ee, v212
  v_mfma_f32_16x16x32_bf16 v[240:243], v[48:51], a[240:243], v[240:243]
  v_mul_f32 v213, 0x3e0293ee, v213
  v_cvt_pk_bf16_f32 v186, v212, v213
  v_mfma_f32_16x16x32_bf16 v[240:243], v[52:55], a[248:251], v[240:243]
  v_mul_f32 v214, 0x3e0293ee, v214
  v_mul_f32 v215, 0x3e0293ee, v215
  v_mfma_f32_16x16x32_bf16 v[248:251], v[52:55], a[252:255], v[248:251]
  v_cvt_pk_bf16_f32 v187, v214, v215
  v_mul_f32 v216, 0x3e0293ee, v216
  v_mfma_f32_16x16x32_bf16 v[248:251], v[48:51], a[244:247], v[248:251]
  s_waitcnt lgkmcnt(0)
  v_mul_f32 v217, 0x3e0293ee, v217
  v_cvt_pk_bf16_f32 v188, v216, v217
  v_mfma_f32_16x16x32_bf16 v[252:255], v[56:59], a[244:247], v[252:255]
  v_mul_f32 v218, 0x3e0293ee, v218
  v_mul_f32 v219, 0x3e0293ee, v219
  v_mfma_f32_16x16x32_bf16 v[252:255], v[60:63], a[252:255], v[252:255]
  v_cvt_pk_bf16_f32 v189, v218, v219
  v_mul_f32 v220, 0x3e0293ee, v220
  v_mfma_f32_16x16x32_bf16 v[244:247], v[60:63], a[248:251], v[244:247]
  v_mul_f32 v221, 0x3e0293ee, v221
  v_cvt_pk_bf16_f32 v190, v220, v221
  v_mfma_f32_16x16x32_bf16 v[244:247], v[56:59], a[240:243], v[244:247]
  v_mul_f32 v222, 0x3e0293ee, v222
  v_mul_f32 v223, 0x3e0293ee, v223
  v_cvt_pk_bf16_f32 v191, v222, v223
  v_mfma_f32_16x16x32_bf16 v[236:239], v[56:59], a[116:119], v[236:239]
  s_cmp_eq_u32 s55, 0
  s_cbranch_scc1 L_mask0
L_mask0_back:
  v_mfma_f32_16x16x32_bf16 v[236:239], v[60:63], a[124:127], v[236:239]
  v_mfma_f32_16x16x32_bf16 v[228:231], v[60:63], a[120:123], v[228:231]
  v_mfma_f32_16x16x32_bf16 v[228:231], v[56:59], a[112:115], v[228:231]
  v_mfma_f32_16x16x32_bf16 v[208:211], a[128:131], v[168:171], 0
  v_mul_f32 v80, 0x3e0293ee, v80
  v_mul_f32 v81, 0x3e0293ee, v81
  v_cvt_pk_bf16_f32 v80, v80, v81
  v_mfma_f32_16x16x32_bf16 v[216:219], a[128:131], v[172:175], 0
  v_mul_f32 v82, 0x3e0293ee, v82
  v_mul_f32 v83, 0x3e0293ee, v83
  v_cvt_pk_bf16_f32 v81, v82, v83
  v_mfma_f32_16x16x32_bf16 v[212:215], a[144:147], v[168:171], 0
  v_mul_f32 v84, 0x3e0293ee, v84
  v_mul_f32 v85, 0x3e0293ee, v85
  v_cvt_pk_bf16_f32 v82, v84, v85
  v_mfma_f32_16x16x32_bf16 v[220:223], a[144:147], v[172:175], 0
  v_mul_f32 v86, 0x3e0293ee, v86
  v_mul_f32 v87, 0x3e0293ee, v87
  v_cvt_pk_bf16_f32 v83, v86, v87
  v_mfma_f32_16x16x32_bf16 v[208:211], a[132:135], v[184:187], v[208:211]
  v_mul_f32 v88, 0x3e0293ee, v88
  v_mul_f32 v89, 0x3e0293ee, v89
  v_cvt_pk_bf16_f32 v88, v88, v89
  v_mfma_f32_16x16x32_bf16 v[216:219], a[132:135], v[188:191], v[216:219]
  v_mul_f32 v90, 0x3e0293ee, v90
  v_mul_f32 v91, 0x3e0293ee, v91
  v_cvt_pk_bf16_f32 v89, v90, v91
  v_mfma_f32_16x16x32_bf16 v[212:215], a[148:151], v[184:187], v[212:215]
  v_mul_f32 v92, 0x3e0293ee, v92
  v_mul_f32 v93, 0x3e0293ee, v93
  v_cvt_pk_bf16_f32 v90, v92, v93
  v_mfma_f32_16x16x32_bf16 v[220:223], a[148:151], v[188:191], v[220:223]
  v_mul_f32 v94, 0x3e0293ee, v94
  v_mul_f32 v95, 0x3e0293ee, v95
  v_cvt_pk_bf16_f32 v91, v94, v95
  v_mfma_f32_16x16x32_bf16 v[192:195], a[128:131], v[160:163], v[96:99]
  v_mul_f32 v240, 0x3e0293ee, v240
  v_mul_f32 v241, 0x3e0293ee, v241
  v_cvt_pk_bf16_f32 v240, v240, v241
  v_mfma_f32_16x16x32_bf16 v[200:203], a[128:131], v[164:167], v[104:107]
  v_mul_f32 v242, 0x3e0293ee, v242
  v_mul_f32 v243, 0x3e0293ee, v243
  v_cvt_pk_bf16_f32 v241, v242, v243
  v_mfma_f32_16x16x32_bf16 v[196:199], a[144:147], v[160:163], v[100:103]
  v_mul_f32 v244, 0x3e0293ee, v244
  v_mul_f32 v245, 0x3e0293ee, v245
  v_cvt_pk_bf16_f32 v242, v244, v245
  v_mfma_f32_16x16x32_bf16 v[204:207], a[144:147], v[164:167], v[108:111]
  v_mul_f32 v246, 0x3e0293ee, v246
  v_mul_f32 v247, 0x3e0293ee, v247
  v_cvt_pk_bf16_f32 v243, v246, v247
  v_mfma_f32_16x16x32_bf16 v[192:195], a[132:135], v[176:179], v[192:195]
  v_mul_f32 v248, 0x3e0293ee, v248
  v_mul_f32 v249, 0x3e0293ee, v249
  v_cvt_pk_bf16_f32 v248, v248, v249
  v_mfma_f32_16x16x32_bf16 v[200:203], a[132:135], v[180:183], v[200:203]
  v_mul_f32 v250, 0x3e0293ee, v250
  v_mul_f32 v251, 0x3e0293ee, v251
  v_cvt_pk_bf16_f32 v249, v250, v251
  v_mfma_f32_16x16x32_bf16 v[196:199], a[148:151], v[176:179], v[196:199]
  v_mul_f32 v252, 0x3e0293ee, v252
  v_mul_f32 v253, 0x3e0293ee, v253
  v_cvt_pk_bf16_f32 v250, v252, v253
  v_mfma_f32_16x16x32_bf16 v[204:207], a[148:151], v[180:183], v[204:207]
  v_mul_f32 v254, 0x3e0293ee, v254
  v_mul_f32 v255, 0x3e0293ee, v255
  v_cvt_pk_bf16_f32 v251, v254, v255
  s_nop 0
  v_mfma_f32_16x16x32_bf16 v[208:211], a[136:139], v[80:83], v[208:211]
  v_mul_f32 v64, 0x3e0293ee, v64
  v_mul_f32 v65, 0x3e0293ee, v65
  v_cvt_pk_bf16_f32 v64, v64, v65
  v_mul_f32 v66, 0x3e0293ee, v66
  v_mul_f32 v67, 0x3e0293ee, v67
  v_cvt_pk_bf16_f32 v65, v66, v67
  v_mfma_f32_16x16x32_bf16 v[216:219], a[136:139], v[88:91], v[216:219]
  v_mul_f32 v68, 0x3e0293ee, v68
  v_mul_f32 v69, 0x3e0293ee, v69
  v_cvt_pk_bf16_f32 v66, v68, v69
  v_mul_f32 v70, 0x3e0293ee, v70
  v_mul_f32 v71, 0x3e0293ee, v71
  v_cvt_pk_bf16_f32 v67, v70, v71
  v_mfma_f32_16x16x32_bf16 v[212:215], a[152:155], v[80:83], v[212:215]
  v_mul_f32 v72, 0x3e0293ee, v72
  v_mul_f32 v73, 0x3e0293ee, v73
  v_cvt_pk_bf16_f32 v72, v72, v73
  v_mul_f32 v74, 0x3e0293ee, v74
  v_mul_f32 v75, 0x3e0293ee, v75
  v_cvt_pk_bf16_f32 v73, v74, v75
  v_mfma_f32_16x16x32_bf16 v[220:223], a[152:155], v[88:91], v[220:223]
  v_mul_f32 v76, 0x3e0293ee, v76
  v_mul_f32 v77, 0x3e0293ee, v77
  v_cvt_pk_bf16_f32 v74, v76, v77
  v_mul_f32 v78, 0x3e0293ee, v78
  v_mul_f32 v79, 0x3e0293ee, v79
  v_cvt_pk_bf16_f32 v75, v78, v79
  v_mfma_f32_16x16x32_bf16 v[208:211], a[140:143], v[240:243], v[208:211]
  v_mul_f32 v224, 0x3e0293ee, v224
  v_mul_f32 v225, 0x3e0293ee, v225
  v_cvt_pk_bf16_f32 v224, v224, v225
  v_mul_f32 v226, 0x3e0293ee, v226
  v_mul_f32 v227, 0x3e0293ee, v227
  v_cvt_pk_bf16_f32 v225, v226, v227
  v_mfma_f32_16x16x32_bf16 v[216:219], a[140:143], v[248:251], v[216:219]
  v_mul_f32 v228, 0x3e0293ee, v228
  v_mul_f32 v229, 0x3e0293ee, v229
  v_cvt_pk_bf16_f32 v226, v228, v229
  v_mul_f32 v230, 0x3e0293ee, v230
  v_mul_f32 v231, 0x3e0293ee, v231
  v_cvt_pk_bf16_f32 v227, v230, v231
  v_mfma_f32_16x16x32_bf16 v[212:215], a[156:159], v[240:243], v[212:215]
  v_mul_f32 v232, 0x3e0293ee, v232
  v_mul_f32 v233, 0x3e0293ee, v233
  v_cvt_pk_bf16_f32 v232, v232, v233
  v_mul_f32 v234, 0x3e0293ee, v234
  v_mul_f32 v235, 0x3e0293ee, v235
  v_cvt_pk_bf16_f32 v233, v234, v235
  v_mfma_f32_16x16x32_bf16 v[220:223], a[156:159], v[248:251], v[220:223]
  v_mul_f32 v236, 0x3e0293ee, v236
  v_mul_f32 v237, 0x3e0293ee, v237
  v_cvt_pk_bf16_f32 v234, v236, v237
  v_mul_f32 v238, 0x3e0293ee, v238
  v_mul_f32 v239, 0x3e0293ee, v239
  v_cvt_pk_bf16_f32 v235, v238, v239
  s_nop 0
  v_mfma_f32_16x16x32_bf16 v[192:195], a[136:139], v[64:67], v[192:195]
  v_mfma_f32_16x16x32_bf16 v[200:203], a[136:139], v[72:75], v[200:203]
  v_mfma_f32_16x16x32_bf16 v[196:199], a[152:155], v[64:67], v[196:199]
  v_max3_f32 v20, v210, v208, v209
  v_max3_f32 v21, v218, v216, v217
  v_max3_f32 v20, v20, v211, v212
  v_mfma_f32_16x16x32_bf16 v[204:207], a[152:155], v[72:75], v[204:207]
  v_max3_f32 v21, v21, v219, v220
  v_max3_f32 v20, v20, v213, v214
  v_max3_f32 v21, v21, v221, v222
  v_max_f32 v20, v20, v215
  v_mfma_f32_16x16x32_bf16 v[192:195], a[140:143], v[224:227], v[192:195]
  v_max_f32 v21, v21, v223
  v_mov_b32 v22, v20
  v_mov_b32 v23, v21
  s_nop 0
  v_mfma_f32_16x16x32_bf16 v[200:203], a[140:143], v[232:235], v[200:203]
  v_permlane16_swap_b32 v20, v22
  v_permlane16_swap_b32 v21, v23
  v_max_f32 v20, v20, v22
  v_mfma_f32_16x16x32_bf16 v[196:199], a[156:159], v[224:227], v[196:199]
  v_max_f32 v21, v21, v23
  v_mov_b32 v22, v20
  v_mov_b32 v23, v21
  s_nop 0
  v_mfma_f32_16x16x32_bf16 v[204:207], a[156:159], v[232:235], v[204:207]
  v_permlane32_swap_b32 v20, v22
  v_permlane32_swap_b32 v21, v23
  v_max_f32 v20, v20, v22
  v_max_f32 v21, v21, v23
  v_mfma_f32_32x32x16_bf16 a[0:15], v[128:131], v[128:131], 0
  v_sub_f32 v112, 0xc2200000, v20
  v_sub_f32 v113, 0xc2200000, v20
  v_sub_f32 v114, 0xc2200000, v20
  v_sub_f32 v115, 0xc2200000, v20
  v_sub_f32 v116, 0xc2200000, v20
  v_sub_f32 v117, 0xc2200000, v20
  v_sub_f32 v118, 0xc2200000, v20
  v_mfma_f32_32x32x16_bf16 a[16:31], v[128:131], v[128:131], 0
  v_sub_f32 v119, 0xc2200000, v20
  v_sub_f32 v120, 0xc2200000, v21
  v_sub_f32 v121, 0xc2200000, v21
  v_sub_f32 v122, 0xc2200000, v21
  v_sub_f32 v123, 0xc2200000, v21
  v_sub_f32 v124, 0xc2200000, v21
  v_sub_f32 v125, 0xc2200000, v21
  v_mfma_f32_32x32x16_bf16 a[32:47], v[128:131], v[128:131], 0
  v_sub_f32 v126, 0xc2200000, v21
  v_sub_f32 v127, 0xc2200000, v21
  v_max3_f32 v20, v194, v192, v193
  v_max3_f32 v21, v202, v200, v201
  v_max3_f32 v20, v20, v195, v196
  v_max3_f32 v21, v21, v203, v204
  v_max3_f32 v20, v20, v197, v198
  v_mfma_f32_32x32x16_bf16 a[48:63], v[128:131], v[128:131], 0
  v_max3_f32 v21, v21, v205, v206
  v_max_f32 v20, v20, v199
  v_max_f32 v21, v21, v207
  v_mov_b32 v22, v20
  v_mov_b32 v23, v21
  s_nop 0
  v_permlane16_swap_b32 v20, v22
  v_mfma_f32_32x32x16_bf16 a[64:79], v[128:131], v[128:131], 0
  v_permlane16_swap_b32 v21, v23
  v_max_f32 v20, v20, v22
  v_max_f32 v21, v21, v23
  v_mov_b32 v22, v20
  v_mov_b32 v23, v21
  s_nop 0
  v_permlane32_swap_b32 v20, v22
  v_mfma_f32_32x32x16_bf16 a[80:95], v[128:131], v[128:131], 0
  v_permlane32_swap_b32 v21, v23
  v_max_f32 v20, v20, v22
  v_max_f32 v21, v21, v23
  v_add_f32 v20, 0x42200000, v20
  v_add_f32 v21, 0x42200000, v21
  v_sub_f32 v192, v192, v20
  v_sub_f32 v193, v193, v20
  v_mfma_f32_32x32x16_bf16 a[96:111], v[128:131], v[128:131], 0
  v_sub_f32 v194, v194, v20
  v_sub_f32 v195, v195, v20
  v_sub_f32 v196, v196, v20
  v_sub_f32 v197, v197, v20
  v_sub_f32 v198, v198, v20
  v_sub_f32 v199, v199, v20
  v_sub_f32 v200, v200, v21
  v_mfma_f32_32x32x16_bf16 a[112:127], v[128:131], v[128:131], 0
  v_sub_f32 v201, v201, v21
  v_sub_f32 v202, v202, v21
  v_sub_f32 v203, v203, v21
  v_sub_f32 v204, v204, v21
  v_sub_f32 v205, v205, v21
  v_sub_f32 v206, v206, v21
  v_sub_f32 v207, v207, v21
  v_sub_f32 v96, 0, v20
  v_sub_f32 v97, 0, v20
  v_sub_f32 v98, 0, v20
  v_sub_f32 v99, 0, v20
  v_sub_f32 v100, 0, v20
  v_sub_f32 v101, 0, v20
  v_sub_f32 v102, 0, v20
  v_sub_f32 v103, 0, v20
  v_sub_f32 v104, 0, v21
  v_sub_f32 v105, 0, v21
  v_sub_f32 v106, 0, v21
  v_sub_f32 v107, 0, v21
  v_sub_f32 v108, 0, v21
  v_sub_f32 v109, 0, v21
  v_sub_f32 v110, 0, v21
  v_sub_f32 v111, 0, v21
  v_exp_f32 v128, v192
  v_exp_f32 v129, v193
  v_exp_f32 v130, v194
  v_exp_f32 v131, v195
  v_exp_f32 v132, v196
  v_exp_f32 v133, v197
  v_exp_f32 v134, v198
  v_cvt_pk_bf16_f32 v144, v128, v129
  v_exp_f32 v135, v199
  v_cvt_pk_bf16_f32 v145, v130, v131
  v_exp_f32 v136, v200
  v_cvt_pk_bf16_f32 v146, v132, v133
  v_exp_f32 v137, v201
  v_cvt_pk_bf16_f32 v147, v134, v135
  v_exp_f32 v138, v202
  v_exp_f32 v139, v203
  v_or3_b32 v5, v144, v145, v146
  v_cvt_pk_bf16_f32 v148, v136, v137
  v_mov_b32 v68, 0
  v_mov_b32 v69, 0
  v_mov_b32 v70, 0
  v_mov_b32 v71, 0
  v_mov_b32 v76, 0
  v_mov_b32 v77, 0
  v_mov_b32 v78, 0
  v_mov_b32 v79, 0
  v_mov_b32 v84, 0
  v_mov_b32 v85, 0
  v_mov_b32 v86, 0
  v_mov_b32 v87, 0
  v_mov_b32 v92, 0
  v_mov_b32 v93, 0
  v_mov_b32 v94, 0
  v_mov_b32 v95, 0
  v_mov_b32 v228, v25
  v_mov_b32 v229, v25
  v_mov_b32 v230, v25
  v_mov_b32 v231, v25
  s_waitcnt vmcnt(10)
  v_mfma_f32_16x16x32_bf16 v[208:211], a[128:131], v[168:171], v[112:115]
  s_barrier
  ds_read_b128 a[176:179], v2 offset:12288
  v_mfma_f32_16x16x32_bf16 v[208:211], a[132:135], v[184:187], v[208:211]
  v_exp_f32 v140, v204
  v_mfma_f32_16x16x32_bf16 v[208:211], a[136:139], v[80:83], v[208:211]
  ds_read_b128 a[180:183], v2 offset:13312
  v_mfma_f32_16x16x32_bf16 v[208:211], a[140:143], v[240:243], v[208:211]
  v_exp_f32 v141, v205
  v_mfma_f32_16x16x32_bf16 v[216:219], a[140:143], v[248:251], v[120:123]
  ds_read_b128 a[184:187], v2 offset:14336
  v_mfma_f32_16x16x32_bf16 v[216:219], a[136:139], v[88:91], v[216:219]
  v_exp_f32 v142, v206
  v_mfma_f32_16x16x32_bf16 v[216:219], a[132:135], v[188:191], v[216:219]
  ds_read_b128 a[188:191], v2 offset:15360
  v_and_or_b32 v2, s52, v4, v1
  v_mfma_f32_16x16x32_bf16 v[216:219], a[128:131], v[172:175], v[216:219]
  buffer_load_dwordx4 v1, s[36:39], s52 offen offset:0 sc1 lds
  v_mfma_f32_16x16x32_bf16 v[220:223], a[144:147], v[172:175], v[124:127]
  ds_read_b128 a[128:131], v2 offset:0
  v_or3_b32 v5, v5, v147, v148
  v_mfma_f32_16x16x32_bf16 v[220:223], a[148:151], v[188:191], v[220:223]
  s_cmp_ge_u32 s55, 2
  v_exp_f32 v143, v207
  v_mfma_f32_16x16x32_bf16 v[220:223], a[152:155], v[88:91], v[220:223]
  ds_read_b128 a[132:135], v2 offset:1024
  v_cvt_pk_bf16_f32 v149, v138, v139
  v_mfma_f32_16x16x32_bf16 v[220:223], a[156:159], v[248:251], v[220:223]
  v_cvt_pk_bf16_f32 v150, v140, v141
  v_or3_b32 v5, v5, v149, v150
  v_mfma_f32_16x16x32_bf16 v[212:215], a[156:159], v[240:243], v[116:119]
  v_cvt_pk_bf16_f32 v151, v142, v143
  v_bitop3_b32 v5, v5, v151, v6 bitop3:0xa8
  v_mfma_f32_16x16x32_bf16 v[212:215], a[152:155], v[80:83], v[212:215]
  v_cmp_ne_u32 vcc, 0, v5
  v_mfma_f32_16x16x32_bf16 v[212:215], a[148:151], v[184:187], v[212:215]
  buffer_load_dwordx4 v1, s[36:39], s52 offen offset:1024 sc1 lds
  v_mfma_f32_16x16x32_bf16 v[212:215], a[144:147], v[168:171], v[212:215]
  s_cbranch_vccnz L_site9
L_back9:
  ds_read_b128 a[136:139], v2 offset:2048
  v_mfma_f32_16x16x32_bf16 v[76:79], v[228:231], v[148:151], v[76:79]
  s_cbranch_scc0 L_Xx
.p2align 5
L_X:
  v_mfma_f32_16x16x32_bf16 v[68:71], v[228:231], v[144:147], v[68:71]
  s_waitcnt lgkmcnt(3)
  v_exp_f32 v128, v208
  v_mfma_f32_16x16x32_bf16 a[0:3], a[160:163], v[144:147], a[0:3]
  ds_read_b128 a[140:143], v2 offset:3072
  ds_read_b128 a[144:147], v2 offset:4096
  v_mfma_f32_16x16x32_bf16 a[8:11], a[160:163], v[148:151], a[8:11]
  v_exp_f32 v129, v209
  v_mfma_f32_16x16x32_bf16 a[12:15], a[164:167], v[148:151], a[12:15]
  ds_read_b128 a[148:151], v2 offset:5120
  ds_read_b128 a[152:155], v2 offset:6144
  v_mfma_f32_16x16x32_bf16 a[4:7], a[164:167], v[144:147], a[4:7]
  v_exp_f32 v130, v210
  v_mfma_f32_16x16x32_bf16 a[16:19], a[168:171], v[144:147], a[16:19]
  ds_read_b128 a[156:159], v2 offset:7168
  v_cvt_pk_bf16_f32 v152, v128, v129
  v_mfma_f32_16x16x32_bf16 a[24:27], a[168:171], v[148:151], a[24:27]
  buffer_load_dwordx4 v1, s[36:39], s52 offen offset:2048 sc1 lds
  v_mfma_f32_16x16x32_bf16 a[28:31], a[172:175], v[148:151], a[28:31]
  v_exp_f32 v131, v211
  v_mfma_f32_16x16x32_bf16 a[20:23], a[172:175], v[144:147], a[20:23]
  v_exp_f32 v132, v212
  v_mfma_f32_16x16x32_bf16 a[32:35], a[176:179], v[144:147], a[32:35]
  v_exp_f32 v133, v213
  v_mfma_f32_16x16x32_bf16 a[40:43], a[176:179], v[148:151], a[40:43]
  v_cvt_pk_bf16_f32 v153, v130, v131
  v_cvt_pk_bf16_f32 v154, v132, v133
  v_mfma_f32_16x16x32_bf16 a[44:47], a[180:183], v[148:151], a[44:47]
  v_exp_f32 v134, v214
  v_mfma_f32_16x16x32_bf16 a[36:39], a[180:183], v[144:147], a[36:39]
  v_exp_f32 v135, v215
  v_mfma_f32_16x16x32_bf16 a[48:51], a[184:187], v[144:147], a[48:51]
  v_exp_f32 v136, v216
  v_mfma_f32_16x16x32_bf16 a[56:59], a[184:187], v[148:151], a[56:59]
  buffer_load_dwordx4 v1, s[36:39], s52 offen offset:3072 sc1 lds
  v_mfma_f32_16x16x32_bf16 a[60:63], a[188:191], v[148:151], a[60:63]
  v_or3_b32 v5, v152, v153, v154
  v_cvt_pk_bf16_f32 v155, v134, v135
  v_mfma_f32_16x16x32_bf16 a[52:55], a[188:191], v[144:147], a[52:55]
  s_waitcnt lgkmcnt(0)
  v_exp_f32 v137, v217
  v_mfma_f32_16x16x32_bf16 v[192:195], a[128:131], v[160:163], v[96:99]
  v_exp_f32 v138, v218
  v_mfma_f32_16x16x32_bf16 v[192:195], a[132:135], v[176:179], v[192:195]
  v_exp_f32 v139, v219
  v_mfma_f32_16x16x32_bf16 v[192:195], a[136:139], v[64:67], v[192:195]
  v_cvt_pk_bf16_f32 v156, v136, v137
  v_or3_b32 v5, v5, v155, v156
  v_mfma_f32_16x16x32_bf16 v[192:195], a[140:143], v[224:227], v[192:195]
  v_exp_f32 v140, v220
  v_mfma_f32_16x16x32_bf16 v[200:203], a[140:143], v[232:235], v[104:107]
  v_exp_f32 v141, v221
  v_mfma_f32_16x16x32_bf16 v[200:203], a[136:139], v[72:75], v[200:203]
  v_exp_f32 v142, v222
  v_mfma_f32_16x16x32_bf16 v[200:203], a[132:135], v[180:183], v[200:203]
  v_cvt_pk_bf16_f32 v157, v138, v139
  v_mfma_f32_16x16x32_bf16 v[200:203], a[128:131], v[164:167], v[200:203]
  v_exp_f32 v143, v223
  v_mfma_f32_16x16x32_bf16 v[204:207], a[144:147], v[164:167], v[108:111]
  v_cvt_pk_bf16_f32 v158, v140, v141
  v_mfma_f32_16x16x32_bf16 v[204:207], a[148:151], v[180:183], v[204:207]
  v_or3_b32 v5, v5, v157, v158
  v_cvt_pk_bf16_f32 v159, v142, v143
  v_mfma_f32_16x16x32_bf16 v[204:207], a[152:155], v[72:75], v[204:207]
  v_bitop3_b32 v5, v5, v159, v6 bitop3:0xa8
  v_mfma_f32_16x16x32_bf16 v[204:207], a[156:159], v[232:235], v[204:207]
  v_cmp_ne_u32 vcc, 0, v5
  v_mfma_f32_16x16x32_bf16 v[196:199], a[156:159], v[224:227], v[100:103]
  v_mfma_f32_16x16x32_bf16 v[196:199], a[152:155], v[64:67], v[196:199]
  s_cmp_eq_u32 s55, 5
  v_mfma_f32_16x16x32_bf16 v[196:199], a[148:151], v[176:179], v[196:199]
  s_cbranch_scc1 L_wo
L_wo_back:
  v_mfma_f32_16x16x32_bf16 v[196:199], a[144:147], v[160:163], v[196:199]
  s_cbranch_vccnz L_site1
L_back1:
  v_mfma_f32_16x16x32_bf16 v[92:95], v[228:231], v[156:159], v[92:95]
  v_mfma_f32_16x16x32_bf16 v[84:87], v[228:231], v[152:155], v[84:87]
  v_exp_f32 v128, v192
  v_mfma_f32_16x16x32_bf16 a[64:67], a[160:163], v[152:155], a[64:67]
  s_add_u32 s54, s54, 0x4000
  v_exp_f32 v129, v193
  v_mfma_f32_16x16x32_bf16 a[72:75], a[160:163], v[156:159], a[72:75]
  s_bitset0_b32 s54, 17
  v_exp_f32 v130, v194
  v_mfma_f32_16x16x32_bf16 a[76:79], a[164:167], v[156:159], a[76:79]
  s_add_u32 s52, s52, 0x4000
  v_exp_f32 v131, v195
  v_mfma_f32_16x16x32_bf16 a[68:71], a[164:167], v[152:155], a[68:71]
  s_sub_u32 s55, s55, 1
  v_exp_f32 v132, v196
  v_mfma_f32_16x16x32_bf16 a[80:83], a[168:171], v[152:155], a[80:83]
  s_cmp_lt_u32 s52, s38
  v_exp_f32 v133, v197
  v_mfma_f32_16x16x32_bf16 a[88:91], a[168:171], v[156:159], a[88:91]
  s_cselect_b32 m0, s54, 0x30000
  v_exp_f32 v134, v198
  v_mfma_f32_16x16x32_bf16 a[92:95], a[172:175], v[156:159], a[92:95]
  ds_read_b128 a[160:163], v2 offset:8192
  v_cvt_pk_bf16_f32 v144, v128, v129
  v_mfma_f32_16x16x32_bf16 a[84:87], a[172:175], v[152:155], a[84:87]
  v_exp_f32 v135, v199
  v_mfma_f32_16x16x32_bf16 a[96:99], a[176:179], v[152:155], a[96:99]
  ds_read_b128 a[164:167], v2 offset:9216
  v_cvt_pk_bf16_f32 v145, v130, v131
  v_mfma_f32_16x16x32_bf16 a[104:107], a[176:179], v[156:159], a[104:107]
  v_exp_f32 v136, v200
  v_mfma_f32_16x16x32_bf16 a[108:111], a[180:183], v[156:159], a[108:111]
  s_waitcnt vmcnt(8)
  ds_read_b128 a[168:171], v2 offset:10240
  v_cvt_pk_bf16_f32 v146, v132, v133
  v_mfma_f32_16x16x32_bf16 a[100:103], a[180:183], v[152:155], a[100:103]
  v_exp_f32 v137, v201
  v_mfma_f32_16x16x32_bf16 a[112:115], a[184:187], v[152:155], a[112:115]
  ds_read_b128 a[172:175], v2 offset:11264
  v_cvt_pk_bf16_f32 v147, v134, v135
  v_mfma_f32_16x16x32_bf16 a[120:123], a[184:187], v[156:159], a[120:123]
  v_exp_f32 v138, v202
  v_mfma_f32_16x16x32_bf16 a[124:127], a[188:191], v[156:159], a[124:127]
  v_exp_f32 v139, v203
  v_mfma_f32_16x16x32_bf16 a[116:119], a[188:191], v[152:155], a[116:119]
  v_or3_b32 v5, v144, v145, v146
  v_cvt_pk_bf16_f32 v148, v136, v137
  v_mfma_f32_16x16x32_bf16 v[208:211], a[128:131], v[168:171], v[112:115]
  s_barrier
  ds_read_b128 a[176:179], v2 offset:12288
  v_mfma_f32_16x16x32_bf16 v[208:211], a[132:135], v[184:187], v[208:211]
  v_exp_f32 v140, v204
  v_mfma_f32_16x16x32_bf16 v[208:211], a[136:139], v[80:83], v[208:211]
  ds_read_b128 a[180:183], v2 offset:13312
  v_mfma_f32_16x16x32_bf16 v[208:211], a[140:143], v[240:243], v[208:211]
  v_exp_f32 v141, v205
  v_mfma_f32_16x16x32_bf16 v[216:219], a[140:143], v[248:251], v[120:123]
  ds_read_b128 a[184:187], v2 offset:14336
  v_mfma_f32_16x16x32_bf16 v[216:219], a[136:139], v[88:91], v[216:219]
  v_exp_f32 v142, v206
  v_mfma_f32_16x16x32_bf16 v[216:219], a[132:135], v[188:191], v[216:219]
  ds_read_b128 a[188:191], v2 offset:15360
  v_and_or_b32 v2, s52, v4, v1
  v_mfma_f32_16x16x32_bf16 v[216:219], a[128:131], v[172:175], v[216:219]
  buffer_load_dwordx4 v1, s[36:39], s52 offen offset:0 sc1 lds
  v_mfma_f32_16x16x32_bf16 v[220:223], a[144:147], v[172:175], v[124:127]
  ds_read_b128 a[128:131], v2 offset:0
  v_or3_b32 v5, v5, v147, v148
  v_mfma_f32_16x16x32_bf16 v[220:223], a[148:151], v[188:191], v[220:223]
  s_cmp_ge_u32 s55, 2
  v_exp_f32 v143, v207
  v_mfma_f32_16x16x32_bf16 v[220:223], a[152:155], v[88:91], v[220:223]
  ds_read_b128 a[132:135], v2 offset:1024
  v_cvt_pk_bf16_f32 v149, v138, v139
  v_mfma_f32_16x16x32_bf16 v[220:223], a[156:159], v[248:251], v[220:223]
  v_cvt_pk_bf16_f32 v150, v140, v141
  v_or3_b32 v5, v5, v149, v150
  v_mfma_f32_16x16x32_bf16 v[212:215], a[156:159], v[240:243], v[116:119]
  v_cvt_pk_bf16_f32 v151, v142, v143
  v_bitop3_b32 v5, v5, v151, v6 bitop3:0xa8
  v_mfma_f32_16x16x32_bf16 v[212:215], a[152:155], v[80:83], v[212:215]
  v_cmp_ne_u32 vcc, 0, v5
  v_mfma_f32_16x16x32_bf16 v[212:215], a[148:151], v[184:187], v[212:215]
  buffer_load_dwordx4 v1, s[36:39], s52 offen offset:1024 sc1 lds
  v_mfma_f32_16x16x32_bf16 v[212:215], a[144:147], v[168:171], v[212:215]
  s_cbranch_vccnz L_site0
L_back0:
  ds_read_b128 a[136:139], v2 offset:2048
  v_mfma_f32_16x16x32_bf16 v[76:79], v[228:231], v[148:151], v[76:79]
  s_cbranch_scc1 L_X
L_Xx:
  s_cmp_eq_u32 s55, 0
  s_cbranch_scc1 L_Xo
  v_cndmask_b32 v96, v96, v7, s[64:65]
  v_cndmask_b32 v97, v97, v7, s[66:67]
  v_cndmask_b32 v98, v98, v7, s[68:69]
  v_cndmask_b32 v99, v99, v7, s[70:71]
  v_cndmask_b32 v108, v108, v7, s[64:65]
  v_cndmask_b32 v109, v109, v7, s[66:67]
  v_cndmask_b32 v110, v110, v7, s[68:69]
  v_cndmask_b32 v111, v111, v7, s[70:71]
  v_mov_b32 v100, v7
  v_mov_b32 v101, v7
  v_mov_b32 v102, v7
  v_mov_b32 v103, v7
  s_nop 1
  s_branch L_X
L_wo:
  buffer_load_dword v30, v26, s[20:23], s41 offen
  s_branch L_wo_back
L_Xo:
  s_cmp_eq_u32 s56, -1
  s_cbranch_scc1 L_mB0
L_mB0_back:
  v_mov_b32 v29, 0
  s_mov_b64 exec, 0x7f
  buffer_atomic_or v29, v27, s[28:31], s101 offen sc0
  s_mov_b64 exec, -1
  v_mfma_f32_16x16x32_bf16 v[68:71], v[228:231], v[144:147], v[68:71]
  s_waitcnt lgkmcnt(3)
  v_exp_f32 v128, v208
  v_mfma_f32_16x16x32_bf16 a[0:3], a[160:163], v[144:147], a[0:3]
L_pad9:
  s_cbranch_execz L_pad13
  ds_read_b128 a[140:143], v2 offset:3072
  ds_read_b128 a[144:147], v2 offset:4096
  v_mfma_f32_16x16x32_bf16 a[8:11], a[160:163], v[148:151], a[8:11]
  v_exp_f32 v129, v209
  v_mfma_f32_16x16x32_bf16 a[12:15], a[164:167], v[148:151], a[12:15]
  ds_read_b128 a[148:151], v2 offset:5120
  ds_read_b128 a[152:155], v2 offset:6144
  v_mfma_f32_16x16x32_bf16 a[4:7], a[164:167], v[144:147], a[4:7]
  v_exp_f32 v130, v210
  v_mfma_f32_16x16x32_bf16 a[16:19], a[168:171], v[144:147], a[16:19]
  ds_read_b128 a[156:159], v2 offset:7168
  v_cvt_pk_bf16_f32 v152, v128, v129
  v_mfma_f32_16x16x32_bf16 a[24:27], a[168:171], v[148:151], a[24:27]
  buffer_load_dwordx4 v1, s[36:39], s52 offen offset:2048 sc1 lds
  v_mfma_f32_16x16x32_bf16 a[28:31], a[172:175], v[148:151], a[28:31]
  v_exp_f32 v131, v211
  v_mfma_f32_16x16x32_bf16 a[20:23], a[172:175], v[144:147], a[20:23]
  v_exp_f32 v132, v212
  v_mfma_f32_16x16x32_bf16 a[32:35], a[176:179], v[144:147], a[32:35]
  v_exp_f32 v133, v213
  v_mfma_f32_16x16x32_bf16 a[40:43], a[176:179], v[148:151], a[40:43]
  v_cvt_pk_bf16_f32 v153, v130, v131
  v_cvt_pk_bf16_f32 v154, v132, v133
  v_mfma_f32_16x16x32_bf16 a[44:47], a[180:183], v[148:151], a[44:47]
  v_exp_f32 v134, v214
  v_mfma_f32_16x16x32_bf16 a[36:39], a[180:183], v[144:147], a[36:39]
  v_exp_f32 v135, v215
  v_mfma_f32_16x16x32_bf16 a[48:51], a[184:187], v[144:147], a[48:51]
  v_exp_f32 v136, v216
  v_mfma_f32_16x16x32_bf16 a[56:59], a[184:187], v[148:151], a[56:59]
  buffer_load_dwordx4 v1, s[36:39], s52 offen offset:3072 sc1 lds
  v_mfma_f32_16x16x32_bf16 a[60:63], a[188:191], v[148:151], a[60:63]
  v_or3_b32 v5, v152, v153, v154
  v_cvt_pk_bf16_f32 v155, v134, v135
  v_mfma_f32_16x16x32_bf16 a[52:55], a[188:191], v[144:147], a[52:55]
  s_waitcnt lgkmcnt(0)
  v_exp_f32 v137, v217
  v_mfma_f32_16x16x32_bf16 v[192:195], a[128:131], v[168:171], v[112:115]
  s_add_u32 s53, s52, 0x4000
  v_exp_f32 v138, v218
  v_mfma_f32_16x16x32_bf16 v[192:195], a[132:135], v[184:187], v[192:195]
  s_add_u32 s54, s54, 0x4000
  v_exp_f32 v139, v219
  v_mfma_f32_16x16x32_bf16 v[192:195], a[136:139], v[80:83], v[192:195]
  s_add_u32 s52, s52, 0x8000
  v_cvt_pk_bf16_f32 v156, v136, v137
  v_or3_b32 v5, v5, v155, v156
  v_mfma_f32_16x16x32_bf16 v[192:195], a[140:143], v[240:243], v[192:195]
  s_sub_u32 s36, s36, 0x4000
  s_subb_u32 s37, s37, 0
  v_exp_f32 v140, v220
  v_mfma_f32_16x16x32_bf16 v[200:203], a[140:143], v[248:251], v[120:123]
  s_add_u32 s38, s38, 0x4000
  v_exp_f32 v141, v221
  v_mfma_f32_16x16x32_bf16 v[200:203], a[136:139], v[88:91], v[200:203]
  s_bitset0_b32 s54, 17
  v_exp_f32 v142, v222
  v_mfma_f32_16x16x32_bf16 v[200:203], a[132:135], v[188:191], v[200:203]
  v_and_or_b32 v3, s53, v4, v1
  v_cvt_pk_bf16_f32 v157, v138, v139
  v_mfma_f32_16x16x32_bf16 v[200:203], a[128:131], v[172:175], v[200:203]
  v_exp_f32 v143, v223
  v_mfma_f32_16x16x32_bf16 v[204:207], a[144:147], v[172:175], v[124:127]
  ds_read_b128 a[128:131], v3 offset:0
  v_cvt_pk_bf16_f32 v158, v140, v141
  v_mfma_f32_16x16x32_bf16 v[204:207], a[148:151], v[188:191], v[204:207]
  v_or3_b32 v5, v5, v157, v158
  v_cvt_pk_bf16_f32 v159, v142, v143
  v_mfma_f32_16x16x32_bf16 v[204:207], a[152:155], v[88:91], v[204:207]
  ds_read_b128 a[132:135], v3 offset:1024
  v_bitop3_b32 v5, v5, v159, v6 bitop3:0xa8
  v_mfma_f32_16x16x32_bf16 v[204:207], a[156:159], v[248:251], v[204:207]
  v_cmp_ne_u32 vcc, 0, v5
  v_mfma_f32_16x16x32_bf16 v[196:199], a[156:159], v[240:243], v[116:119]
  ds_read_b128 a[136:139], v3 offset:2048
  v_mfma_f32_16x16x32_bf16 v[196:199], a[152:155], v[80:83], v[196:199]
  ds_read_b128 a[140:143], v3 offset:3072
  v_mfma_f32_16x16x32_bf16 v[196:199], a[148:151], v[184:187], v[196:199]
  v_mfma_f32_16x16x32_bf16 v[196:199], a[144:147], v[168:171], v[196:199]
  s_cbranch_vccnz L_site3
L_back3:
  ds_read_b128 a[144:147], v3 offset:4096
  v_mfma_f32_16x16x32_bf16 v[92:95], v[228:231], v[156:159], v[92:95]
  v_exp_f32 v128, v192
  v_mfma_f32_16x16x32_bf16 v[84:87], v[228:231], v[152:155], v[84:87]
  v_exp_f32 v129, v193
  v_mfma_f32_16x16x32_bf16 a[64:67], a[160:163], v[152:155], a[64:67]
  ds_read_b128 a[148:151], v3 offset:5120
  v_exp_f32 v130, v194
  v_mfma_f32_16x16x32_bf16 a[72:75], a[160:163], v[156:159], a[72:75]
  v_exp_f32 v131, v195
  v_mfma_f32_16x16x32_bf16 a[76:79], a[164:167], v[156:159], a[76:79]
  ds_read_b128 a[152:155], v3 offset:6144
  v_cvt_pk_bf16_f32 v144, v128, v129
  v_mfma_f32_16x16x32_bf16 a[68:71], a[164:167], v[152:155], a[68:71]
  v_exp_f32 v132, v196
  v_mfma_f32_16x16x32_bf16 a[80:83], a[168:171], v[152:155], a[80:83]
  ds_read_b128 a[156:159], v3 offset:7168
  v_cvt_pk_bf16_f32 v145, v130, v131
  v_mfma_f32_16x16x32_bf16 a[88:91], a[168:171], v[156:159], a[88:91]
  v_mfma_f32_16x16x32_bf16 a[92:95], a[172:175], v[156:159], a[92:95]
  ds_read_b128 a[160:163], v2 offset:8192
  v_exp_f32 v133, v197
  v_mfma_f32_16x16x32_bf16 a[84:87], a[172:175], v[152:155], a[84:87]
  v_exp_f32 v134, v198
  v_mfma_f32_16x16x32_bf16 a[96:99], a[176:179], v[152:155], a[96:99]
  ds_read_b128 a[164:167], v2 offset:9216
  v_cvt_pk_bf16_f32 v146, v132, v133
  v_mfma_f32_16x16x32_bf16 a[104:107], a[176:179], v[156:159], a[104:107]
  v_exp_f32 v135, v199
  v_mfma_f32_16x16x32_bf16 a[108:111], a[180:183], v[156:159], a[108:111]
  s_waitcnt vmcnt(8)
  ds_read_b128 a[168:171], v2 offset:10240
  v_exp_f32 v136, v200
  v_mfma_f32_16x16x32_bf16 a[100:103], a[180:183], v[152:155], a[100:103]
  v_exp_f32 v137, v201
  v_mfma_f32_16x16x32_bf16 a[112:115], a[184:187], v[152:155], a[112:115]
  s_waitcnt vmcnt(2)
  ds_read_b128 a[172:175], v2 offset:11264
  v_cvt_pk_bf16_f32 v147, v134, v135
  v_mfma_f32_16x16x32_bf16 a[120:123], a[184:187], v[156:159], a[120:123]
  v_cmp_ne_u32 vcc, 1, v29
  v_mfma_f32_16x16x32_bf16 a[124:127], a[188:191], v[156:159], a[124:127]
  v_exp_f32 v138, v202
  v_mfma_f32_16x16x32_bf16 a[116:119], a[188:191], v[152:155], a[116:119]
  s_waitcnt lgkmcnt(4)
  v_exp_f32 v139, v203
  s_and_b32 s96, vcc_lo, 0x7f
  s_cbranch_scc1 L_pollACT
L_pollACT_back:
  s_cmp_ge_u32 s48, 30
  s_cbranch_scc1 L_noA
  v_mfma_f32_16x16x32_bf16 v[208:211], a[128:131], v[168:171], v[112:115]
  s_barrier
  ds_read_b128 a[176:179], v2 offset:12288
  v_or3_b32 v5, v144, v145, v146
  v_mfma_f32_16x16x32_bf16 v[208:211], a[132:135], v[184:187], v[208:211]
  s_cmp_lt_u32 s52, s38
  v_exp_f32 v140, v204
  v_mfma_f32_16x16x32_bf16 v[208:211], a[136:139], v[80:83], v[208:211]
  ds_read_b128 a[180:183], v2 offset:13312
  v_cvt_pk_bf16_f32 v148, v136, v137
  v_mfma_f32_16x16x32_bf16 v[208:211], a[140:143], v[240:243], v[208:211]
  s_cselect_b32 m0, s54, 0x30000
  v_exp_f32 v141, v205
  v_mfma_f32_16x16x32_bf16 v[216:219], a[140:143], v[248:251], v[120:123]
  ds_read_b128 a[184:187], v2 offset:14336
  v_or3_b32 v5, v5, v147, v148
  v_mfma_f32_16x16x32_bf16 v[216:219], a[136:139], v[88:91], v[216:219]
  v_exp_f32 v142, v206
  v_mfma_f32_16x16x32_bf16 v[216:219], a[132:135], v[188:191], v[216:219]
  ds_read_b128 a[188:191], v2 offset:15360
  v_and_or_b32 v2, s52, v4, v1
  v_mfma_f32_16x16x32_bf16 v[216:219], a[128:131], v[172:175], v[216:219]
  buffer_load_dwordx4 v1, s[36:39], s52 offen offset:0 sc1 lds
  v_mfma_f32_16x16x32_bf16 v[220:223], a[144:147], v[172:175], v[124:127]
  ds_read_b128 a[128:131], v2 offset:0
  v_cvt_pk_bf16_f32 v149, v138, v139
  v_mfma_f32_16x16x32_bf16 v[220:223], a[148:151], v[188:191], v[220:223]
  s_sub_u32 s56, s56, 1
  v_exp_f32 v143, v207
  v_mfma_f32_16x16x32_bf16 v[220:223], a[152:155], v[88:91], v[220:223]
  ds_read_b128 a[132:135], v2 offset:1024
  v_cvt_pk_bf16_f32 v150, v140, v141
  v_mfma_f32_16x16x32_bf16 v[220:223], a[156:159], v[248:251], v[220:223]
  v_or3_b32 v5, v5, v149, v150
  v_cvt_pk_bf16_f32 v151, v142, v143
  v_mfma_f32_16x16x32_bf16 v[212:215], a[156:159], v[240:243], v[116:119]
  v_bitop3_b32 v5, v5, v151, v6 bitop3:0xa8
  v_cmp_ne_u32 vcc, 0, v5
  v_mfma_f32_16x16x32_bf16 v[212:215], a[152:155], v[80:83], v[212:215]
  ds_read_b128 a[136:139], v2 offset:2048
  ds_read_b128 a[140:143], v2 offset:3072
  v_mfma_f32_16x16x32_bf16 v[212:215], a[148:151], v[184:187], v[212:215]
  buffer_load_dwordx4 v1, s[36:39], s52 offen offset:1024 sc1 lds
  v_mfma_f32_16x16x32_bf16 v[212:215], a[144:147], v[168:171], v[212:215]
  s_cbranch_vccnz L_site10
L_back10:
  ds_read_b128 a[144:147], v2 offset:4096
  v_mfma_f32_16x16x32_bf16 v[92:95], v[228:231], v[148:151], v[92:95]
  v_mfma_f32_16x16x32_bf16 v[84:87], v[228:231], v[144:147], v[84:87]
  s_waitcnt lgkmcnt(5)
  v_exp_f32 v128, v208
  v_mfma_f32_16x16x32_bf16 a[64:67], a[160:163], v[144:147], a[64:67]
  s_add_u32 s54, s54, 0x4000
  ds_read_b128 a[148:151], v2 offset:5120
  v_exp_f32 v129, v209
  v_mfma_f32_16x16x32_bf16 a[72:75], a[160:163], v[148:151], a[72:75]
  s_bitset0_b32 s54, 17
  v_exp_f32 v130, v210
  v_mfma_f32_16x16x32_bf16 a[76:79], a[164:167], v[148:151], a[76:79]
  s_add_u32 s53, s53, 0x8000
  ds_read_b128 a[152:155], v2 offset:6144
  v_cvt_pk_bf16_f32 v152, v128, v129
  v_mfma_f32_16x16x32_bf16 a[68:71], a[164:167], v[144:147], a[68:71]
  v_exp_f32 v131, v211
  v_mfma_f32_16x16x32_bf16 a[80:83], a[168:171], v[144:147], a[80:83]
  ds_read_b128 a[156:159], v2 offset:7168
  v_exp_f32 v132, v212
  v_mfma_f32_16x16x32_bf16 a[88:91], a[168:171], v[148:151], a[88:91]
  buffer_load_dwordx4 v1, s[36:39], s52 offen offset:2048 sc1 lds
  v_mfma_f32_16x16x32_bf16 a[92:95], a[172:175], v[148:151], a[92:95]
  ds_read_b128 a[160:163], v3 offset:8192
  v_cvt_pk_bf16_f32 v153, v130, v131
  v_mfma_f32_16x16x32_bf16 a[84:87], a[172:175], v[144:147], a[84:87]
  v_exp_f32 v133, v213
  v_mfma_f32_16x16x32_bf16 a[96:99], a[176:179], v[144:147], a[96:99]
  ds_read_b128 a[164:167], v3 offset:9216
  v_exp_f32 v134, v214
  v_mfma_f32_16x16x32_bf16 a[104:107], a[176:179], v[148:151], a[104:107]
  v_exp_f32 v135, v215
  v_mfma_f32_16x16x32_bf16 a[108:111], a[180:183], v[148:151], a[108:111]
  s_waitcnt vmcnt(7)
  ds_read_b128 a[168:171], v3 offset:10240
  v_cvt_pk_bf16_f32 v154, v132, v133
  v_mfma_f32_16x16x32_bf16 a[100:103], a[180:183], v[144:147], a[100:103]
  v_exp_f32 v136, v216
  v_mfma_f32_16x16x32_bf16 a[112:115], a[184:187], v[144:147], a[112:115]
  ds_read_b128 a[172:175], v3 offset:11264
  v_cvt_pk_bf16_f32 v155, v134, v135
  v_mfma_f32_16x16x32_bf16 a[120:123], a[184:187], v[148:151], a[120:123]
  buffer_load_dwordx4 v1, s[36:39], s52 offen offset:3072 sc1 lds
  v_mfma_f32_16x16x32_bf16 a[124:127], a[188:191], v[148:151], a[124:127]
  v_exp_f32 v137, v217
  v_mfma_f32_16x16x32_bf16 a[116:119], a[188:191], v[144:147], a[116:119]
  s_waitcnt lgkmcnt(4)
  v_exp_f32 v138, v218
  v_rcp_f32 v68, v68
  v_rcp_f32 v76, v76
  s_lshl_b32 s6, s4, 13
  s_add_u32 s6, s6, s50
  s_add_u32 s7, s6, 4096
  s_add_u32 s100, s57, 0
  buffer_load_dwordx4 a[192:195], v1, s[28:31], s100 offen offset:0 sc1
  buffer_load_dwordx4 a[196:199], v1, s[28:31], s100 offen offset:1024 sc1
  buffer_load_dwordx4 a[200:203], v1, s[28:31], s100 offen offset:2048 sc1
  buffer_load_dwordx4 a[204:207], v1, s[28:31], s100 offen offset:3072 sc1
  v_accvgpr_read_b32 v96, a0
  v_accvgpr_read_b32 v97, a1
  v_accvgpr_read_b32 v98, a2
  v_accvgpr_read_b32 v99, a3
  v_accvgpr_read_b32 v100, a4
  v_accvgpr_read_b32 v101, a5
  v_accvgpr_read_b32 v102, a6
  v_accvgpr_read_b32 v103, a7
  v_pk_mul_f32 v[96:97], v[96:97], v[68:69] op_sel_hi:[1,0]
  v_pk_mul_f32 v[98:99], v[98:99], v[68:69] op_sel_hi:[1,0]
  v_pk_mul_f32 v[100:101], v[100:101], v[68:69] op_sel_hi:[1,0]
  v_pk_mul_f32 v[102:103], v[102:103], v[68:69] op_sel_hi:[1,0]
  v_cvt_pk_bf16_f32 v96, v96, v97
  v_cvt_pk_bf16_f32 v97, v98, v99
  v_cvt_pk_bf16_f32 v98, v100, v101
  v_cvt_pk_bf16_f32 v99, v102, v103
  buffer_store_dwordx4 v[96:99], v1, s[28:31], s6 offen offset:0 sc1
  s_add_u32 s100, s57, 4096
  buffer_load_dwordx4 a[208:211], v1, s[28:31], s100 offen offset:0 sc1
  buffer_load_dwordx4 a[212:215], v1, s[28:31], s100 offen offset:1024 sc1
  buffer_load_dwordx4 a[216:219], v1, s[28:31], s100 offen offset:2048 sc1
  buffer_load_dwordx4 a[220:223], v1, s[28:31], s100 offen offset:3072 sc1
  v_accvgpr_read_b32 v104, a8
  v_accvgpr_read_b32 v105, a9
  v_accvgpr_read_b32 v106, a10
  v_accvgpr_read_b32 v107, a11
  v_accvgpr_read_b32 v108, a12
  v_accvgpr_read_b32 v109, a13
  v_accvgpr_read_b32 v110, a14
  v_accvgpr_read_b32 v111, a15
  v_pk_mul_f32 v[104:105], v[104:105], v[76:77] op_sel_hi:[1,0]
  v_pk_mul_f32 v[106:107], v[106:107], v[76:77] op_sel_hi:[1,0]
  v_pk_mul_f32 v[108:109], v[108:109], v[76:77] op_sel_hi:[1,0]
  v_pk_mul_f32 v[110:111], v[110:111], v[76:77] op_sel_hi:[1,0]
  v_cvt_pk_bf16_f32 v104, v104, v105
  v_cvt_pk_bf16_f32 v105, v106, v107
  v_cvt_pk_bf16_f32 v106, v108, v109
  v_cvt_pk_bf16_f32 v107, v110, v111
  buffer_store_dwordx4 v[104:107], v1, s[28:31], s6 offen offset:1024 sc1
  s_add_u32 s100, s57, 8192
  buffer_load_dwordx4 a[224:227], v1, s[28:31], s100 offen offset:0 sc1
  buffer_load_dwordx4 a[228:231], v1, s[28:31], s100 offen offset:1024 sc1
  buffer_load_dwordx4 a[232:235], v1, s[28:31], s100 offen offset:2048 sc1
  buffer_load_dwordx4 a[236:239], v1, s[28:31], s100 offen offset:3072 sc1
  v_accvgpr_read_b32 v96, a16
  v_accvgpr_read_b32 v97, a17
  v_accvgpr_read_b32 v98, a18
  v_accvgpr_read_b32 v99, a19
  v_accvgpr_read_b32 v100, a20
  v_accvgpr_read_b32 v101, a21
  v_accvgpr_read_b32 v102, a22
  v_accvgpr_read_b32 v103, a23
  v_pk_mul_f32 v[96:97], v[96:97], v[68:69] op_sel_hi:[1,0]
  v_pk_mul_f32 v[98:99], v[98:99], v[68:69] op_sel_hi:[1,0]
  v_pk_mul_f32 v[100:101], v[100:101], v[68:69] op_sel_hi:[1,0]
  v_pk_mul_f32 v[102:103], v[102:103], v[68:69] op_sel_hi:[1,0]
  v_cvt_pk_bf16_f32 v96, v96, v97
  v_cvt_pk_bf16_f32 v97, v98, v99
  v_cvt_pk_bf16_f32 v98, v100, v101
  v_cvt_pk_bf16_f32 v99, v102, v103
  buffer_store_dwordx4 v[96:99], v1, s[28:31], s6 offen offset:2048 sc1
  s_add_u32 s100, s57, 12288
  buffer_load_dwordx4 a[240:243], v1, s[28:31], s100 offen offset:0 sc1
  buffer_load_dwordx4 a[244:247], v1, s[28:31], s100 offen offset:1024 sc1
  buffer_load_dwordx4 a[248:251], v1, s[28:31], s100 offen offset:2048 sc1
  buffer_load_dwordx4 a[252:255], v1, s[28:31], s100 offen offset:3072 sc1
  v_accvgpr_read_b32 v104, a24
  v_accvgpr_read_b32 v105, a25
  v_accvgpr_read_b32 v106, a26
  v_accvgpr_read_b32 v107, a27
  v_accvgpr_read_b32 v108, a28
  v_accvgpr_read_b32 v109, a29
  v_accvgpr_read_b32 v110, a30
  v_accvgpr_read_b32 v111, a31
  v_pk_mul_f32 v[104:105], v[104:105], v[76:77] op_sel_hi:[1,0]
  v_pk_mul_f32 v[106:107], v[106:107], v[76:77] op_sel_hi:[1,0]
  v_pk_mul_f32 v[108:109], v[108:109], v[76:77] op_sel_hi:[1,0]
  v_pk_mul_f32 v[110:111], v[110:111], v[76:77] op_sel_hi:[1,0]
  v_cvt_pk_bf16_f32 v104, v104, v105
  v_cvt_pk_bf16_f32 v105, v106, v107
  v_cvt_pk_bf16_f32 v106, v108, v109
  v_cvt_pk_bf16_f32 v107, v110, v111
  buffer_store_dwordx4 v[104:107], v1, s[28:31], s6 offen offset:3072 sc1
  s_cmp_ge_u32 s3, 2
  s_cbranch_scc1 L_w01_0
  s_add_u32 m0, s63, 0
  s_add_u32 s97, s59, 0
  buffer_load_dwordx4 v10, s[8:11], s97 offen offset:0 lds
  buffer_load_dwordx4 v11, s[8:11], s97 offen offset:1024 lds
  buffer_load_dwordx4 v12, s[8:11], s97 offen offset:2048 lds
  buffer_load_dwordx4 v13, s[8:11], s97 offen offset:3072 lds
  s_xor_b32 m0, m0, 0x2000
  s_xor_b32 s97, s97, 0x80
  buffer_load_dwordx4 v10, s[8:11], s97 offen offset:0 lds
  buffer_load_dwordx4 v11, s[8:11], s97 offen offset:1024 lds
  buffer_load_dwordx4 v12, s[8:11], s97 offen offset:2048 lds
  buffer_load_dwordx4 v13, s[8:11], s97 offen offset:3072 lds
L_w01_0:
  v_mfma_f32_16x16x32_bf16 v[192:195], a[128:131], v[168:171], v[112:115]
  s_barrier
  ds_read_b128 a[176:179], v3 offset:12288
  v_or3_b32 v5, v152, v153, v154
  v_mfma_f32_16x16x32_bf16 v[192:195], a[132:135], v[184:187], v[192:195]
  s_cmp_lt_u32 s53, s38
  v_exp_f32 v139, v219
  v_mfma_f32_16x16x32_bf16 v[192:195], a[136:139], v[80:83], v[192:195]
  ds_read_b128 a[180:183], v3 offset:13312
  v_cvt_pk_bf16_f32 v156, v136, v137
  v_mfma_f32_16x16x32_bf16 v[192:195], a[140:143], v[240:243], v[192:195]
  s_cselect_b32 m0, s54, 0x30000
  v_exp_f32 v140, v220
  v_mfma_f32_16x16x32_bf16 v[200:203], a[140:143], v[248:251], v[120:123]
  ds_read_b128 a[184:187], v3 offset:14336
  v_or3_b32 v5, v5, v155, v156
  v_mfma_f32_16x16x32_bf16 v[200:203], a[136:139], v[88:91], v[200:203]
  v_exp_f32 v141, v221
  v_mfma_f32_16x16x32_bf16 v[200:203], a[132:135], v[188:191], v[200:203]
  ds_read_b128 a[188:191], v3 offset:15360
  v_and_or_b32 v3, s53, v4, v1
  v_mfma_f32_16x16x32_bf16 v[200:203], a[128:131], v[172:175], v[200:203]
  buffer_load_dwordx4 v1, s[36:39], s53 offen offset:0 sc1 lds
  v_mfma_f32_16x16x32_bf16 v[204:207], a[144:147], v[172:175], v[124:127]
  ds_read_b128 a[128:131], v3 offset:0
  v_cvt_pk_bf16_f32 v157, v138, v139
  v_exp_f32 v142, v222
  v_mfma_f32_16x16x32_bf16 v[204:207], a[148:151], v[188:191], v[204:207]
  v_exp_f32 v143, v223
  v_mfma_f32_16x16x32_bf16 v[204:207], a[152:155], v[88:91], v[204:207]
  ds_read_b128 a[132:135], v3 offset:1024
  v_cvt_pk_bf16_f32 v158, v140, v141
  v_mfma_f32_16x16x32_bf16 v[204:207], a[156:159], v[248:251], v[204:207]
  v_or3_b32 v5, v5, v157, v158
  v_cvt_pk_bf16_f32 v159, v142, v143
  v_mfma_f32_16x16x32_bf16 v[196:199], a[156:159], v[240:243], v[116:119]
  v_bitop3_b32 v5, v5, v159, v6 bitop3:0xa8
  v_cmp_ne_u32 vcc, 0, v5
  v_mfma_f32_16x16x32_bf16 v[196:199], a[152:155], v[80:83], v[196:199]
  ds_read_b128 a[136:139], v3 offset:2048
  ds_read_b128 a[140:143], v3 offset:3072
  v_mfma_f32_16x16x32_bf16 v[196:199], a[148:151], v[184:187], v[196:199]
  buffer_load_dwordx4 v1, s[36:39], s53 offen offset:1024 sc1 lds
  v_mfma_f32_16x16x32_bf16 v[196:199], a[144:147], v[168:171], v[196:199]
  s_cbranch_vccnz L_site11
L_back11:
  ds_read_b128 a[144:147], v3 offset:4096
  v_mfma_f32_16x16x32_bf16 v[92:95], v[228:231], v[156:159], v[92:95]
  v_exp_f32 v128, v192
  v_mfma_f32_16x16x32_bf16 v[84:87], v[228:231], v[152:155], v[84:87]
  s_waitcnt lgkmcnt(5)
  v_exp_f32 v129, v193
  v_mfma_f32_16x16x32_bf16 a[64:67], a[160:163], v[152:155], a[64:67]
  s_add_u32 s54, s54, 0x4000
  ds_read_b128 a[148:151], v3 offset:5120
  v_exp_f32 v130, v194
  v_mfma_f32_16x16x32_bf16 a[72:75], a[160:163], v[156:159], a[72:75]
  s_bitset0_b32 s54, 17
  v_exp_f32 v131, v195
  v_mfma_f32_16x16x32_bf16 a[76:79], a[164:167], v[156:159], a[76:79]
  s_add_u32 s52, s52, 0x8000
  ds_read_b128 a[152:155], v3 offset:6144
  v_cvt_pk_bf16_f32 v144, v128, v129
  v_mfma_f32_16x16x32_bf16 a[68:71], a[164:167], v[152:155], a[68:71]
  v_exp_f32 v132, v196
  v_mfma_f32_16x16x32_bf16 a[80:83], a[168:171], v[152:155], a[80:83]
  ds_read_b128 a[156:159], v3 offset:7168
  v_cvt_pk_bf16_f32 v145, v130, v131
  v_mfma_f32_16x16x32_bf16 a[88:91], a[168:171], v[156:159], a[88:91]
  buffer_load_dwordx4 v1, s[36:39], s53 offen offset:2048 sc1 lds
  v_mfma_f32_16x16x32_bf16 a[92:95], a[172:175], v[156:159], a[92:95]
  ds_read_b128 a[160:163], v2 offset:8192
  v_exp_f32 v133, v197
  v_mfma_f32_16x16x32_bf16 a[84:87], a[172:175], v[152:155], a[84:87]
  v_exp_f32 v134, v198
  v_mfma_f32_16x16x32_bf16 a[96:99], a[176:179], v[152:155], a[96:99]
  ds_read_b128 a[164:167], v2 offset:9216
  v_cvt_pk_bf16_f32 v146, v132, v133
  v_mfma_f32_16x16x32_bf16 a[104:107], a[176:179], v[156:159], a[104:107]
  v_exp_f32 v135, v199
  v_mfma_f32_16x16x32_bf16 a[108:111], a[180:183], v[156:159], a[108:111]
  s_waitcnt vmcnt(27)
  ds_read_b128 a[168:171], v2 offset:10240
  v_exp_f32 v136, v200
  v_mfma_f32_16x16x32_bf16 a[100:103], a[180:183], v[152:155], a[100:103]
  v_exp_f32 v137, v201
  v_mfma_f32_16x16x32_bf16 a[112:115], a[184:187], v[152:155], a[112:115]
  ds_read_b128 a[172:175], v2 offset:11264
  v_cvt_pk_bf16_f32 v147, v134, v135
  v_mfma_f32_16x16x32_bf16 a[120:123], a[184:187], v[156:159], a[120:123]
  buffer_load_dwordx4 v1, s[36:39], s53 offen offset:3072 sc1 lds
  v_mfma_f32_16x16x32_bf16 a[124:127], a[188:191], v[156:159], a[124:127]
  v_exp_f32 v138, v202
  v_mfma_f32_16x16x32_bf16 a[116:119], a[188:191], v[152:155], a[116:119]
  s_waitcnt lgkmcnt(4)
  v_exp_f32 v139, v203
  s_add_u32 s100, s57, 16384
  buffer_load_dwordx4 v[32:35], v1, s[28:31], s100 offen offset:0 sc1
  buffer_load_dwordx4 v[36:39], v1, s[28:31], s100 offen offset:1024 sc1
  buffer_load_dwordx4 v[40:43], v1, s[28:31], s100 offen offset:2048 sc1
  v_accvgpr_read_b32 v96, a32
  v_accvgpr_read_b32 v97, a33
  v_accvgpr_read_b32 v98, a34
  v_accvgpr_read_b32 v99, a35
  v_accvgpr_read_b32 v100, a36
  v_accvgpr_read_b32 v101, a37
  v_accvgpr_read_b32 v102, a38
  v_accvgpr_read_b32 v103, a39
  v_pk_mul_f32 v[96:97], v[96:97], v[68:69] op_sel_hi:[1,0]
  v_pk_mul_f32 v[98:99], v[98:99], v[68:69] op_sel_hi:[1,0]
  v_pk_mul_f32 v[100:101], v[100:101], v[68:69] op_sel_hi:[1,0]
  v_pk_mul_f32 v[102:103], v[102:103], v[68:69] op_sel_hi:[1,0]
  v_cvt_pk_bf16_f32 v96, v96, v97
  v_cvt_pk_bf16_f32 v97, v98, v99
  v_cvt_pk_bf16_f32 v98, v100, v101
  v_cvt_pk_bf16_f32 v99, v102, v103
  buffer_store_dwordx4 v[96:99], v1, s[28:31], s7 offen offset:0 sc1
  buffer_load_dwordx4 v[44:47], v1, s[28:31], s100 offen offset:3072 sc1
  s_add_u32 s100, s57, 20480
  buffer_load_dwordx4 v[48:51], v1, s[28:31], s100 offen offset:0 sc1
  buffer_load_dwordx4 v[52:55], v1, s[28:31], s100 offen offset:1024 sc1
  v_accvgpr_read_b32 v104, a40
  v_accvgpr_read_b32 v105, a41
  v_accvgpr_read_b32 v106, a42
  v_accvgpr_read_b32 v107, a43
  v_accvgpr_read_b32 v108, a44
  v_accvgpr_read_b32 v109, a45
  v_accvgpr_read_b32 v110, a46
  v_accvgpr_read_b32 v111, a47
  v_pk_mul_f32 v[104:105], v[104:105], v[76:77] op_sel_hi:[1,0]
  v_pk_mul_f32 v[106:107], v[106:107], v[76:77] op_sel_hi:[1,0]
  v_pk_mul_f32 v[108:109], v[108:109], v[76:77] op_sel_hi:[1,0]
  v_pk_mul_f32 v[110:111], v[110:111], v[76:77] op_sel_hi:[1,0]
  v_cvt_pk_bf16_f32 v104, v104, v105
  v_cvt_pk_bf16_f32 v105, v106, v107
  v_cvt_pk_bf16_f32 v106, v108, v109
  v_cvt_pk_bf16_f32 v107, v110, v111
  buffer_store_dwordx4 v[104:107], v1, s[28:31], s7 offen offset:1024 sc1
  buffer_load_dwordx4 v[56:59], v1, s[28:31], s100 offen offset:2048 sc1
  buffer_load_dwordx4 v[60:63], v1, s[28:31], s100 offen offset:3072 sc1
  s_add_u32 s100, s57, 24576
  buffer_load_dwordx4 v[224:227], v1, s[28:31], s100 offen offset:0 sc1
  v_accvgpr_read_b32 v96, a48
  v_accvgpr_read_b32 v97, a49
  v_accvgpr_read_b32 v98, a50
  v_accvgpr_read_b32 v99, a51
  v_accvgpr_read_b32 v100, a52
  v_accvgpr_read_b32 v101, a53
  v_accvgpr_read_b32 v102, a54
  v_accvgpr_read_b32 v103, a55
  v_pk_mul_f32 v[96:97], v[96:97], v[68:69] op_sel_hi:[1,0]
  v_pk_mul_f32 v[98:99], v[98:99], v[68:69] op_sel_hi:[1,0]
  v_pk_mul_f32 v[100:101], v[100:101], v[68:69] op_sel_hi:[1,0]
  v_pk_mul_f32 v[102:103], v[102:103], v[68:69] op_sel_hi:[1,0]
  v_cvt_pk_bf16_f32 v96, v96, v97
  v_cvt_pk_bf16_f32 v97, v98, v99
  v_cvt_pk_bf16_f32 v98, v100, v101
  v_cvt_pk_bf16_f32 v99, v102, v103
  buffer_store_dwordx4 v[96:99], v1, s[28:31], s7 offen offset:2048 sc1
  buffer_load_dwordx4 v[232:235], v1, s[28:31], s100 offen offset:1024 sc1
  buffer_load_dwordx4 v[236:239], v1, s[28:31], s100 offen offset:2048 sc1
  buffer_load_dwordx4 v[244:247], v1, s[28:31], s100 offen offset:3072 sc1
  v_accvgpr_read_b32 v104, a56
  v_accvgpr_read_b32 v105, a57
  v_accvgpr_read_b32 v106, a58
  v_accvgpr_read_b32 v107, a59
  v_accvgpr_read_b32 v108, a60
  v_accvgpr_read_b32 v109, a61
  v_accvgpr_read_b32 v110, a62
  v_accvgpr_read_b32 v111, a63
  v_pk_mul_f32 v[104:105], v[104:105], v[76:77] op_sel_hi:[1,0]
  v_pk_mul_f32 v[106:107], v[106:107], v[76:77] op_sel_hi:[1,0]
  v_pk_mul_f32 v[108:109], v[108:109], v[76:77] op_sel_hi:[1,0]
  v_pk_mul_f32 v[110:111], v[110:111], v[76:77] op_sel_hi:[1,0]
  v_cvt_pk_bf16_f32 v104, v104, v105
  v_cvt_pk_bf16_f32 v105, v106, v107
  v_cvt_pk_bf16_f32 v106, v108, v109
  v_cvt_pk_bf16_f32 v107, v110, v111
  buffer_store_dwordx4 v[104:107], v1, s[28:31], s7 offen offset:3072 sc1
  s_cmp_ge_u32 s3, 2
  s_cbranch_scc1 L_w01_1
  s_add_u32 m0, s63, 16384
  s_add_u32 s97, s59, 65536
  buffer_load_dwordx4 v10, s[8:11], s97 offen offset:0 lds
  buffer_load_dwordx4 v11, s[8:11], s97 offen offset:1024 lds
  buffer_load_dwordx4 v12, s[8:11], s97 offen offset:2048 lds
  buffer_load_dwordx4 v13, s[8:11], s97 offen offset:3072 lds
  s_xor_b32 m0, m0, 0x2000
  s_xor_b32 s97, s97, 0x80
  buffer_load_dwordx4 v10, s[8:11], s97 offen offset:0 lds
  buffer_load_dwordx4 v11, s[8:11], s97 offen offset:1024 lds
  buffer_load_dwordx4 v12, s[8:11], s97 offen offset:2048 lds
  buffer_load_dwordx4 v13, s[8:11], s97 offen offset:3072 lds
L_w01_1:
L_noA:
  s_cmp_eq_u32 s56, -1
  s_cbranch_scc1 L_F
  v_mfma_f32_16x16x32_bf16 v[208:211], a[128:131], v[168:171], v[112:115]
  s_barrier
  ds_read_b128 a[176:179], v2 offset:12288
  v_or3_b32 v5, v144, v145, v146
  v_mfma_f32_16x16x32_bf16 v[208:211], a[132:135], v[184:187], v[208:211]
  s_cmp_lt_u32 s52, s38
  v_exp_f32 v140, v204
  v_mfma_f32_16x16x32_bf16 v[208:211], a[136:139], v[80:83], v[208:211]
  ds_read_b128 a[180:183], v2 offset:13312
  v_cvt_pk_bf16_f32 v148, v136, v137
  v_mfma_f32_16x16x32_bf16 v[208:211], a[140:143], v[240:243], v[208:211]
  s_cselect_b32 m0, s54, 0x30000
  v_exp_f32 v141, v205
  v_mfma_f32_16x16x32_bf16 v[216:219], a[140:143], v[248:251], v[120:123]
  ds_read_b128 a[184:187], v2 offset:14336
  v_or3_b32 v5, v5, v147, v148
  v_mfma_f32_16x16x32_bf16 v[216:219], a[136:139], v[88:91], v[216:219]
  v_exp_f32 v142, v206
  v_mfma_f32_16x16x32_bf16 v[216:219], a[132:135], v[188:191], v[216:219]
  ds_read_b128 a[188:191], v2 offset:15360
  v_and_or_b32 v2, s52, v4, v1
  v_mfma_f32_16x16x32_bf16 v[216:219], a[128:131], v[172:175], v[216:219]
  buffer_load_dwordx4 v1, s[36:39], s52 offen offset:0 sc1 lds
  v_mfma_f32_16x16x32_bf16 v[220:223], a[144:147], v[172:175], v[124:127]
  ds_read_b128 a[128:131], v2 offset:0
  v_cvt_pk_bf16_f32 v149, v138, v139
  v_mfma_f32_16x16x32_bf16 v[220:223], a[148:151], v[188:191], v[220:223]
  s_sub_u32 s56, s56, 1
  v_exp_f32 v143, v207
  v_mfma_f32_16x16x32_bf16 v[220:223], a[152:155], v[88:91], v[220:223]
  ds_read_b128 a[132:135], v2 offset:1024
  v_cvt_pk_bf16_f32 v150, v140, v141
  v_mfma_f32_16x16x32_bf16 v[220:223], a[156:159], v[248:251], v[220:223]
  v_or3_b32 v5, v5, v149, v150
  v_cvt_pk_bf16_f32 v151, v142, v143
  v_mfma_f32_16x16x32_bf16 v[212:215], a[156:159], v[240:243], v[116:119]
  v_bitop3_b32 v5, v5, v151, v6 bitop3:0xa8
  v_cmp_ne_u32 vcc, 0, v5
  v_mfma_f32_16x16x32_bf16 v[212:215], a[152:155], v[80:83], v[212:215]
  ds_read_b128 a[136:139], v2 offset:2048
  ds_read_b128 a[140:143], v2 offset:3072
  v_mfma_f32_16x16x32_bf16 v[212:215], a[148:151], v[184:187], v[212:215]
L_pad10:
  s_cbranch_execz L_pad14
  buffer_load_dwordx4 v1, s[36:39], s52 offen offset:1024 sc1 lds
  v_mfma_f32_16x16x32_bf16 v[212:215], a[144:147], v[168:171], v[212:215]
  s_cbranch_vccnz L_site12
L_back12:
  ds_read_b128 a[144:147], v2 offset:4096
  v_mfma_f32_16x16x32_bf16 v[92:95], v[228:231], v[148:151], v[92:95]
  s_cbranch_scc1 L_Zx
  s_cmp_eq_u32 s3, 1
  s_cbranch_scc1 L_Z1
  s_cmp_eq_u32 s3, 2
  s_cbranch_scc1 L_Z2
  s_cmp_eq_u32 s3, 3
  s_cbranch_scc1 L_Z3
.p2align 5
L_Z:
  v_mfma_f32_16x16x32_bf16 v[84:87], v[228:231], v[144:147], v[84:87]
  s_waitcnt lgkmcnt(5)
  v_exp_f32 v128, v208
  v_mfma_f32_16x16x32_bf16 a[64:67], a[160:163], v[144:147], a[64:67]
  s_add_u32 s54, s54, 0x4000
  ds_read_b128 a[148:151], v2 offset:5120
  v_exp_f32 v129, v209
  v_mfma_f32_16x16x32_bf16 a[72:75], a[160:163], v[148:151], a[72:75]
  s_bitset0_b32 s54, 17
  v_exp_f32 v130, v210
  v_mfma_f32_16x16x32_bf16 a[76:79], a[164:167], v[148:151], a[76:79]
  s_add_u32 s53, s53, 0x8000
  ds_read_b128 a[152:155], v2 offset:6144
  v_cvt_pk_bf16_f32 v152, v128, v129
  v_mfma_f32_16x16x32_bf16 a[68:71], a[164:167], v[144:147], a[68:71]
  v_exp_f32 v131, v211
  v_mfma_f32_16x16x32_bf16 a[80:83], a[168:171], v[144:147], a[80:83]
  ds_read_b128 a[156:159], v2 offset:7168
  v_exp_f32 v132, v212
  v_mfma_f32_16x16x32_bf16 a[88:91], a[168:171], v[148:151], a[88:91]
  buffer_load_dwordx4 v1, s[36:39], s52 offen offset:2048 sc1 lds
  v_mfma_f32_16x16x32_bf16 a[92:95], a[172:175], v[148:151], a[92:95]
  ds_read_b128 a[160:163], v3 offset:8192
  v_cvt_pk_bf16_f32 v153, v130, v131
  v_mfma_f32_16x16x32_bf16 a[84:87], a[172:175], v[144:147], a[84:87]
  v_exp_f32 v133, v213
  v_mfma_f32_16x16x32_bf16 a[96:99], a[176:179], v[144:147], a[96:99]
  ds_read_b128 a[164:167], v3 offset:9216
  v_exp_f32 v134, v214
  v_mfma_f32_16x16x32_bf16 a[104:107], a[176:179], v[148:151], a[104:107]
  v_exp_f32 v135, v215
  v_mfma_f32_16x16x32_bf16 a[108:111], a[180:183], v[148:151], a[108:111]
  s_waitcnt vmcnt(7)
  ds_read_b128 a[168:171], v3 offset:10240
  v_cvt_pk_bf16_f32 v154, v132, v133
  v_mfma_f32_16x16x32_bf16 a[100:103], a[180:183], v[144:147], a[100:103]
  v_exp_f32 v136, v216
  v_mfma_f32_16x16x32_bf16 a[112:115], a[184:187], v[144:147], a[112:115]
  ds_read_b128 a[172:175], v3 offset:11264
  v_cvt_pk_bf16_f32 v155, v134, v135
  v_mfma_f32_16x16x32_bf16 a[120:123], a[184:187], v[148:151], a[120:123]
  buffer_load_dwordx4 v1, s[36:39], s52 offen offset:3072 sc1 lds
  v_mfma_f32_16x16x32_bf16 a[124:127], a[188:191], v[148:151], a[124:127]
  v_exp_f32 v137, v217
  v_mfma_f32_16x16x32_bf16 a[116:119], a[188:191], v[144:147], a[116:119]
  s_waitcnt lgkmcnt(4)
  v_exp_f32 v138, v218
  v_mfma_f32_16x16x32_bf16 v[192:195], a[128:131], v[168:171], v[112:115]
  s_barrier
  ds_read_b128 a[176:179], v3 offset:12288
  v_or3_b32 v5, v152, v153, v154
  v_mfma_f32_16x16x32_bf16 v[192:195], a[132:135], v[184:187], v[192:195]
  s_cmp_lt_u32 s53, s38
  v_exp_f32 v139, v219
  v_mfma_f32_16x16x32_bf16 v[192:195], a[136:139], v[80:83], v[192:195]
  ds_read_b128 a[180:183], v3 offset:13312
  v_cvt_pk_bf16_f32 v156, v136, v137
  v_mfma_f32_16x16x32_bf16 v[192:195], a[140:143], v[240:243], v[192:195]
  s_cselect_b32 m0, s54, 0x30000
  v_exp_f32 v140, v220
  v_mfma_f32_16x16x32_bf16 v[200:203], a[140:143], v[248:251], v[120:123]
  ds_read_b128 a[184:187], v3 offset:14336
  v_or3_b32 v5, v5, v155, v156
  v_mfma_f32_16x16x32_bf16 v[200:203], a[136:139], v[88:91], v[200:203]
  v_exp_f32 v141, v221
  v_mfma_f32_16x16x32_bf16 v[200:203], a[132:135], v[188:191], v[200:203]
  ds_read_b128 a[188:191], v3 offset:15360
  v_and_or_b32 v3, s53, v4, v1
  v_mfma_f32_16x16x32_bf16 v[200:203], a[128:131], v[172:175], v[200:203]
  buffer_load_dwordx4 v1, s[36:39], s53 offen offset:0 sc1 lds
  v_mfma_f32_16x16x32_bf16 v[204:207], a[144:147], v[172:175], v[124:127]
  ds_read_b128 a[128:131], v3 offset:0
  v_cvt_pk_bf16_f32 v157, v138, v139
  v_exp_f32 v142, v222
  v_mfma_f32_16x16x32_bf16 v[204:207], a[148:151], v[188:191], v[204:207]
  v_exp_f32_e64 v143, v223
  v_mfma_f32_16x16x32_bf16 v[204:207], a[152:155], v[88:91], v[204:207]
  ds_read_b128 a[132:135], v3 offset:1024
  v_cvt_pk_bf16_f32 v158, v140, v141
  v_mfma_f32_16x16x32_bf16 v[204:207], a[156:159], v[248:251], v[204:207]
  v_or3_b32 v5, v5, v157, v158
  v_cvt_pk_bf16_f32 v159, v142, v143
  v_mfma_f32_16x16x32_bf16 v[196:199], a[156:159], v[240:243], v[116:119]
  v_bitop3_b32 v5, v5, v159, v6 bitop3:0xa8
  v_cmp_ne_u32 vcc, 0, v5
  v_mfma_f32_16x16x32_bf16 v[196:199], a[152:155], v[80:83], v[196:199]
  ds_read_b128 a[136:139], v3 offset:2048
  ds_read_b128 a[140:143], v3 offset:3072
  v_mfma_f32_16x16x32_bf16 v[196:199], a[148:151], v[184:187], v[196:199]
  buffer_load_dwordx4 v1, s[36:39], s53 offen offset:1024 sc1 lds
  v_mfma_f32_16x16x32_bf16 v[196:199], a[144:147], v[168:171], v[196:199]
  s_cbranch_vccnz L_site5
L_back5:
  ds_read_b128 a[144:147], v3 offset:4096
  v_mfma_f32_16x16x32_bf16 v[92:95], v[228:231], v[156:159], v[92:95]
  v_exp_f32 v128, v192
  v_mfma_f32_16x16x32_bf16 v[84:87], v[228:231], v[152:155], v[84:87]
  s_waitcnt lgkmcnt(5)
  v_exp_f32 v129, v193
  v_mfma_f32_16x16x32_bf16 a[64:67], a[160:163], v[152:155], a[64:67]
  s_add_u32 s54, s54, 0x4000
  ds_read_b128 a[148:151], v3 offset:5120
  v_exp_f32 v130, v194
  v_mfma_f32_16x16x32_bf16 a[72:75], a[160:163], v[156:159], a[72:75]
  s_bitset0_b32 s54, 17
  v_exp_f32 v131, v195
  v_mfma_f32_16x16x32_bf16 a[76:79], a[164:167], v[156:159], a[76:79]
  s_add_u32 s52, s52, 0x8000
  ds_read_b128 a[152:155], v3 offset:6144
  v_cvt_pk_bf16_f32 v144, v128, v129
  v_mfma_f32_16x16x32_bf16 a[68:71], a[164:167], v[152:155], a[68:71]
  v_exp_f32 v132, v196
  v_mfma_f32_16x16x32_bf16 a[80:83], a[168:171], v[152:155], a[80:83]
  ds_read_b128 a[156:159], v3 offset:7168
  v_cvt_pk_bf16_f32 v145, v130, v131
  v_mfma_f32_16x16x32_bf16 a[88:91], a[168:171], v[156:159], a[88:91]
  buffer_load_dwordx4 v1, s[36:39], s53 offen offset:2048 sc1 lds
  v_mfma_f32_16x16x32_bf16 a[92:95], a[172:175], v[156:159], a[92:95]
  ds_read_b128 a[160:163], v2 offset:8192
  v_exp_f32 v133, v197
  v_mfma_f32_16x16x32_bf16 a[84:87], a[172:175], v[152:155], a[84:87]
  v_exp_f32 v134, v198
  v_mfma_f32_16x16x32_bf16 a[96:99], a[176:179], v[152:155], a[96:99]
  ds_read_b128 a[164:167], v2 offset:9216
  v_cvt_pk_bf16_f32 v146, v132, v133
  v_mfma_f32_16x16x32_bf16 a[104:107], a[176:179], v[156:159], a[104:107]
  v_exp_f32 v135, v199
  v_mfma_f32_16x16x32_bf16 a[108:111], a[180:183], v[156:159], a[108:111]
  s_waitcnt vmcnt(7)
  ds_read_b128 a[168:171], v2 offset:10240
  v_exp_f32 v136, v200
  v_mfma_f32_16x16x32_bf16 a[100:103], a[180:183], v[152:155], a[100:103]
  v_exp_f32 v137, v201
  v_mfma_f32_16x16x32_bf16 a[112:115], a[184:187], v[152:155], a[112:115]
  ds_read_b128 a[172:175], v2 offset:11264
  v_cvt_pk_bf16_f32 v147, v134, v135
  v_mfma_f32_16x16x32_bf16 a[120:123], a[184:187], v[156:159], a[120:123]
  buffer_load_dwordx4 v1, s[36:39], s53 offen offset:3072 sc1 lds
  v_mfma_f32_16x16x32_bf16 a[124:127], a[188:191], v[156:159], a[124:127]
  v_exp_f32 v138, v202
  v_mfma_f32_16x16x32_bf16 a[116:119], a[188:191], v[152:155], a[116:119]
  s_waitcnt lgkmcnt(4)
  v_exp_f32 v139, v203
  v_mfma_f32_16x16x32_bf16 v[208:211], a[128:131], v[168:171], v[112:115]
  s_barrier
  ds_read_b128 a[176:179], v2 offset:12288
  v_or3_b32 v5, v144, v145, v146
  v_mfma_f32_16x16x32_bf16 v[208:211], a[132:135], v[184:187], v[208:211]
  s_cmp_lt_u32 s52, s38
  v_exp_f32 v140, v204
  v_mfma_f32_16x16x32_bf16 v[208:211], a[136:139], v[80:83], v[208:211]
  ds_read_b128 a[180:183], v2 offset:13312
  v_cvt_pk_bf16_f32 v148, v136, v137
  v_mfma_f32_16x16x32_bf16 v[208:211], a[140:143], v[240:243], v[208:211]
  s_cselect_b32 m0, s54, 0x30000
  v_exp_f32_e64 v141, v205
  v_mfma_f32_16x16x32_bf16 v[216:219], a[140:143], v[248:251], v[120:123]
  ds_read_b128 a[184:187], v2 offset:14336
  v_or3_b32 v5, v5, v147, v148
  v_mfma_f32_16x16x32_bf16 v[216:219], a[136:139], v[88:91], v[216:219]
  v_exp_f32_e64 v142, v206
  v_mfma_f32_16x16x32_bf16 v[216:219], a[132:135], v[188:191], v[216:219]
  ds_read_b128 a[188:191], v2 offset:15360
  v_and_or_b32 v2, s52, v4, v1
  v_mfma_f32_16x16x32_bf16 v[216:219], a[128:131], v[172:175], v[216:219]
  buffer_load_dwordx4 v1, s[36:39], s52 offen offset:0 sc1 lds
  v_mfma_f32_16x16x32_bf16 v[220:223], a[144:147], v[172:175], v[124:127]
  ds_read_b128 a[128:131], v2 offset:0
  v_cvt_pk_bf16_f32 v149, v138, v139
  v_mfma_f32_16x16x32_bf16 v[220:223], a[148:151], v[188:191], v[220:223]
  s_sub_u32 s56, s56, 1
  v_exp_f32_e64 v143, v207
  v_mfma_f32_16x16x32_bf16 v[220:223], a[152:155], v[88:91], v[220:223]
  ds_read_b128 a[132:135], v2 offset:1024
  v_cvt_pk_bf16_f32 v150, v140, v141
  v_mfma_f32_16x16x32_bf16 v[220:223], a[156:159], v[248:251], v[220:223]
  v_or3_b32 v5, v5, v149, v150
  v_cvt_pk_bf16_f32 v151, v142, v143
  v_mfma_f32_16x16x32_bf16 v[212:215], a[156:159], v[240:243], v[116:119]
  v_bitop3_b32 v5, v5, v151, v6 bitop3:0xa8
  v_cmp_ne_u32 vcc, 0, v5
  v_mfma_f32_16x16x32_bf16 v[212:215], a[152:155], v[80:83], v[212:215]
  ds_read_b128 a[136:139], v2 offset:2048
  ds_read_b128 a[140:143], v2 offset:3072
  v_mfma_f32_16x16x32_bf16 v[212:215], a[148:151], v[184:187], v[212:215]
  buffer_load_dwordx4 v1, s[36:39], s52 offen offset:1024 sc1 lds
  v_mfma_f32_16x16x32_bf16 v[212:215], a[144:147], v[168:171], v[212:215]
  s_cbranch_vccnz L_site4
L_back4:
  ds_read_b128 a[144:147], v2 offset:4096
  v_mfma_f32_16x16x32_bf16 v[92:95], v[228:231], v[148:151], v[92:95]
  s_cbranch_scc0 L_Z
L_Zx:
  v_cndmask_b32 v112, v112, v7, s[64:65]
  v_cndmask_b32 v113, v113, v7, s[66:67]
  v_cndmask_b32 v114, v114, v7, s[68:69]
  v_cndmask_b32 v115, v115, v7, s[70:71]
  v_cndmask_b32 v124, v124, v7, s[64:65]
  v_cndmask_b32 v125, v125, v7, s[66:67]
  v_cndmask_b32 v126, v126, v7, s[68:69]
  v_cndmask_b32 v127, v127, v7, s[70:71]
  v_mov_b32 v116, v7
  v_mov_b32 v117, v7
  v_mov_b32 v118, v7
  v_mov_b32 v119, v7
  s_nop 1
  v_mfma_f32_16x16x32_bf16 v[84:87], v[228:231], v[144:147], v[84:87]
  s_waitcnt lgkmcnt(5)
  v_exp_f32 v128, v208
  v_mfma_f32_16x16x32_bf16 a[64:67], a[160:163], v[144:147], a[64:67]
  s_add_u32 s54, s54, 0x4000
  ds_read_b128 a[148:151], v2 offset:5120
  v_exp_f32 v129, v209
  v_mfma_f32_16x16x32_bf16 a[72:75], a[160:163], v[148:151], a[72:75]
  s_bitset0_b32 s54, 17
  v_exp_f32 v130, v210
  v_mfma_f32_16x16x32_bf16 a[76:79], a[164:167], v[148:151], a[76:79]
  s_add_u32 s53, s53, 0x8000
  ds_read_b128 a[152:155], v2 offset:6144
  v_cvt_pk_bf16_f32 v152, v128, v129
  v_mfma_f32_16x16x32_bf16 a[68:71], a[164:167], v[144:147], a[68:71]
  v_exp_f32 v131, v211
  v_mfma_f32_16x16x32_bf16 a[80:83], a[168:171], v[144:147], a[80:83]
  ds_read_b128 a[156:159], v2 offset:7168
  v_exp_f32 v132, v212
  v_mfma_f32_16x16x32_bf16 a[88:91], a[168:171], v[148:151], a[88:91]
  buffer_load_dwordx4 v1, s[36:39], s52 offen offset:2048 sc1 lds
  v_mfma_f32_16x16x32_bf16 a[92:95], a[172:175], v[148:151], a[92:95]
  ds_read_b128 a[160:163], v3 offset:8192
  v_cvt_pk_bf16_f32 v153, v130, v131
  v_mfma_f32_16x16x32_bf16 a[84:87], a[172:175], v[144:147], a[84:87]
  v_exp_f32 v133, v213
  v_mfma_f32_16x16x32_bf16 a[96:99], a[176:179], v[144:147], a[96:99]
  ds_read_b128 a[164:167], v3 offset:9216
  v_exp_f32 v134, v214
  v_mfma_f32_16x16x32_bf16 a[104:107], a[176:179], v[148:151], a[104:107]
  v_exp_f32 v135, v215
  v_mfma_f32_16x16x32_bf16 a[108:111], a[180:183], v[148:151], a[108:111]
  s_waitcnt vmcnt(7)
  ds_read_b128 a[168:171], v3 offset:10240
  v_cvt_pk_bf16_f32 v154, v132, v133
  v_mfma_f32_16x16x32_bf16 a[100:103], a[180:183], v[144:147], a[100:103]
  v_exp_f32 v136, v216
  v_mfma_f32_16x16x32_bf16 a[112:115], a[184:187], v[144:147], a[112:115]
  ds_read_b128 a[172:175], v3 offset:11264
  v_cvt_pk_bf16_f32 v155, v134, v135
  v_mfma_f32_16x16x32_bf16 a[120:123], a[184:187], v[148:151], a[120:123]
  buffer_load_dwordx4 v1, s[36:39], s52 offen offset:3072 sc1 lds
  v_mfma_f32_16x16x32_bf16 a[124:127], a[188:191], v[148:151], a[124:127]
  v_exp_f32 v137, v217
  v_mfma_f32_16x16x32_bf16 a[116:119], a[188:191], v[144:147], a[116:119]
  s_waitcnt lgkmcnt(4)
  v_exp_f32 v138, v218
  v_mfma_f32_16x16x32_bf16 v[192:195], a[128:131], v[168:171], v[112:115]
  s_cmp_lt_u32 s3, 1
  s_cbranch_scc1 L_nb1
  s_barrier
L_nb1:
  ds_read_b128 a[176:179], v3 offset:12288
  v_or3_b32 v5, v152, v153, v154
  v_mfma_f32_16x16x32_bf16 v[192:195], a[132:135], v[184:187], v[192:195]
  v_exp_f32 v139, v219
  v_mfma_f32_16x16x32_bf16 v[192:195], a[136:139], v[80:83], v[192:195]
  ds_read_b128 a[180:183], v3 offset:13312
  v_cvt_pk_bf16_f32 v156, v136, v137
  v_mfma_f32_16x16x32_bf16 v[192:195], a[140:143], v[240:243], v[192:195]
  v_exp_f32 v140, v220
  v_mfma_f32_16x16x32_bf16 v[200:203], a[140:143], v[248:251], v[120:123]
  ds_read_b128 a[184:187], v3 offset:14336
  v_or3_b32 v5, v5, v155, v156
  v_mfma_f32_16x16x32_bf16 v[200:203], a[136:139], v[88:91], v[200:203]
  v_exp_f32 v141, v221
  v_mfma_f32_16x16x32_bf16 v[200:203], a[132:135], v[188:191], v[200:203]
  ds_read_b128 a[188:191], v3 offset:15360
  v_and_or_b32 v3, s53, v4, v1
  v_mfma_f32_16x16x32_bf16 v[200:203], a[128:131], v[172:175], v[200:203]
  v_mfma_f32_16x16x32_bf16 v[204:207], a[144:147], v[172:175], v[124:127]
  ds_read_b128 a[128:131], v3 offset:0
  v_cvt_pk_bf16_f32 v157, v138, v139
  v_exp_f32 v142, v222
  v_mfma_f32_16x16x32_bf16 v[204:207], a[148:151], v[188:191], v[204:207]
  v_exp_f32 v143, v223
  v_mfma_f32_16x16x32_bf16 v[204:207], a[152:155], v[88:91], v[204:207]
  ds_read_b128 a[132:135], v3 offset:1024
  v_cvt_pk_bf16_f32 v158, v140, v141
  v_mfma_f32_16x16x32_bf16 v[204:207], a[156:159], v[248:251], v[204:207]
  v_or3_b32 v5, v5, v157, v158
  v_cvt_pk_bf16_f32 v159, v142, v143
  v_mfma_f32_16x16x32_bf16 v[196:199], a[156:159], v[240:243], v[116:119]
  v_bitop3_b32 v5, v5, v159, v6 bitop3:0xa8
  v_cmp_ne_u32 vcc, 0, v5
  v_mfma_f32_16x16x32_bf16 v[196:199], a[152:155], v[80:83], v[196:199]
  ds_read_b128 a[136:139], v3 offset:2048
  ds_read_b128 a[140:143], v3 offset:3072
  v_mfma_f32_16x16x32_bf16 v[196:199], a[148:151], v[184:187], v[196:199]
  v_mfma_f32_16x16x32_bf16 v[196:199], a[144:147], v[168:171], v[196:199]
  s_cbranch_vccnz L_site7
L_back7:
  ds_read_b128 a[144:147], v3 offset:4096
  v_mfma_f32_16x16x32_bf16 v[92:95], v[228:231], v[156:159], v[92:95]
  v_exp_f32 v128, v192
  v_mfma_f32_16x16x32_bf16 v[84:87], v[228:231], v[152:155], v[84:87]
  s_waitcnt lgkmcnt(5)
  v_exp_f32 v129, v193
  v_mfma_f32_16x16x32_bf16 a[64:67], a[160:163], v[152:155], a[64:67]
  s_add_u32 s54, s54, 0x4000
  ds_read_b128 a[148:151], v3 offset:5120
  v_exp_f32 v130, v194
  v_mfma_f32_16x16x32_bf16 a[72:75], a[160:163], v[156:159], a[72:75]
  s_bitset0_b32 s54, 17
  v_exp_f32 v131, v195
  v_mfma_f32_16x16x32_bf16 a[76:79], a[164:167], v[156:159], a[76:79]
  s_add_u32 s52, s52, 0x8000
  ds_read_b128 a[152:155], v3 offset:6144
  v_cvt_pk_bf16_f32 v144, v128, v129
  v_mfma_f32_16x16x32_bf16 a[68:71], a[164:167], v[152:155], a[68:71]
  v_exp_f32 v132, v196
  v_mfma_f32_16x16x32_bf16 a[80:83], a[168:171], v[152:155], a[80:83]
  ds_read_b128 a[156:159], v3 offset:7168
  v_cvt_pk_bf16_f32 v145, v130, v131
  v_mfma_f32_16x16x32_bf16 a[88:91], a[168:171], v[156:159], a[88:91]
  v_mfma_f32_16x16x32_bf16 a[92:95], a[172:175], v[156:159], a[92:95]
  ds_read_b128 a[160:163], v2 offset:8192
  v_exp_f32 v133, v197
  v_mfma_f32_16x16x32_bf16 a[84:87], a[172:175], v[152:155], a[84:87]
  v_exp_f32 v134, v198
  v_mfma_f32_16x16x32_bf16 a[96:99], a[176:179], v[152:155], a[96:99]
  ds_read_b128 a[164:167], v2 offset:9216
  v_cvt_pk_bf16_f32 v146, v132, v133
  v_mfma_f32_16x16x32_bf16 a[104:107], a[176:179], v[156:159], a[104:107]
  v_exp_f32 v135, v199
  v_mfma_f32_16x16x32_bf16 a[108:111], a[180:183], v[156:159], a[108:111]
  s_waitcnt vmcnt(0)
  ds_read_b128 a[168:171], v2 offset:10240
  v_exp_f32 v136, v200
  v_mfma_f32_16x16x32_bf16 a[100:103], a[180:183], v[152:155], a[100:103]
  v_exp_f32 v137, v201
  v_mfma_f32_16x16x32_bf16 a[112:115], a[184:187], v[152:155], a[112:115]
  ds_read_b128 a[172:175], v2 offset:11264
  v_cvt_pk_bf16_f32 v147, v134, v135
  v_mfma_f32_16x16x32_bf16 a[120:123], a[184:187], v[156:159], a[120:123]
  v_mfma_f32_16x16x32_bf16 a[124:127], a[188:191], v[156:159], a[124:127]
  v_exp_f32 v138, v202
  v_mfma_f32_16x16x32_bf16 a[116:119], a[188:191], v[152:155], a[116:119]
  s_waitcnt lgkmcnt(4)
  v_exp_f32 v139, v203
L_F:
  s_cmp_lt_u32 s3, 2
  s_cbranch_scc1 L_nb2
  s_barrier
L_nb2:
  ds_read_b128 a[176:179], v2 offset:12288
  v_or3_b32 v5, v144, v145, v146
  v_exp_f32 v140, v204
  ds_read_b128 a[180:183], v2 offset:13312
  v_cvt_pk_bf16_f32 v148, v136, v137
  v_exp_f32 v141, v205
  ds_read_b128 a[184:187], v2 offset:14336
  v_or3_b32 v5, v5, v147, v148
  v_exp_f32 v142, v206
  ds_read_b128 a[188:191], v2 offset:15360
  s_nop 0
  v_cvt_pk_bf16_f32 v149, v138, v139
  v_exp_f32 v143, v207
  v_cvt_pk_bf16_f32 v150, v140, v141
  v_or3_b32 v5, v5, v149, v150
  v_cvt_pk_bf16_f32 v151, v142, v143
  v_bitop3_b32 v5, v5, v151, v6 bitop3:0xa8
  v_cmp_ne_u32 vcc, 0, v5
  s_cbranch_vccnz L_site8
L_back8:
  v_mfma_f32_16x16x32_bf16 v[92:95], v[228:231], v[148:151], v[92:95]
  v_mfma_f32_16x16x32_bf16 v[84:87], v[228:231], v[144:147], v[84:87]
  s_waitcnt lgkmcnt(0)
  v_mfma_f32_16x16x32_bf16 a[64:67], a[160:163], v[144:147], a[64:67]
  v_mfma_f32_16x16x32_bf16 a[72:75], a[160:163], v[148:151], a[72:75]
  v_mfma_f32_16x16x32_bf16 a[76:79], a[164:167], v[148:151], a[76:79]
  v_mfma_f32_16x16x32_bf16 a[68:71], a[164:167], v[144:147], a[68:71]
  v_mfma_f32_16x16x32_bf16 a[80:83], a[168:171], v[144:147], a[80:83]
  v_mfma_f32_16x16x32_bf16 a[88:91], a[168:171], v[148:151], a[88:91]
  v_mfma_f32_16x16x32_bf16 a[92:95], a[172:175], v[148:151], a[92:95]
  v_mfma_f32_16x16x32_bf16 a[84:87], a[172:175], v[144:147], a[84:87]
  v_mfma_f32_16x16x32_bf16 a[96:99], a[176:179], v[144:147], a[96:99]
  v_mfma_f32_16x16x32_bf16 a[104:107], a[176:179], v[148:151], a[104:107]
  v_mfma_f32_16x16x32_bf16 a[108:111], a[180:183], v[148:151], a[108:111]
  v_mfma_f32_16x16x32_bf16 a[100:103], a[180:183], v[144:147], a[100:103]
  v_mfma_f32_16x16x32_bf16 a[112:115], a[184:187], v[144:147], a[112:115]
  v_mfma_f32_16x16x32_bf16 a[120:123], a[184:187], v[148:151], a[120:123]
  v_mfma_f32_16x16x32_bf16 a[124:127], a[188:191], v[148:151], a[124:127]
  v_mfma_f32_16x16x32_bf16 a[116:119], a[188:191], v[144:147], a[116:119]
  s_cmp_lt_u32 s3, 2
  s_cbranch_scc1 L_epiB
  s_cmp_lt_u32 s3, 3
  s_cbranch_scc1 L_nb3
  s_barrier
L_nb3:
  s_add_u32 m0, s61, 0
  s_add_u32 s97, s59, 131072
  buffer_load_dwordx4 v10, s[8:11], s97 offen offset:0 lds
  buffer_load_dwordx4 v11, s[8:11], s97 offen offset:1024 lds
  buffer_load_dwordx4 v12, s[8:11], s97 offen offset:2048 lds
  buffer_load_dwordx4 v13, s[8:11], s97 offen offset:3072 lds
  s_xor_b32 m0, m0, 0x2000
  s_xor_b32 s97, s97, 0x80
  buffer_load_dwordx4 v10, s[8:11], s97 offen offset:0 lds
  buffer_load_dwordx4 v11, s[8:11], s97 offen offset:1024 lds
  buffer_load_dwordx4 v12, s[8:11], s97 offen offset:2048 lds
  buffer_load_dwordx4 v13, s[8:11], s97 offen offset:3072 lds
  s_add_u32 m0, s61, 16384
  s_add_u32 s97, s59, 196608
  buffer_load_dwordx4 v10, s[8:11], s97 offen offset:0 lds
  buffer_load_dwordx4 v11, s[8:11], s97 offen offset:1024 lds
  buffer_load_dwordx4 v12, s[8:11], s97 offen offset:2048 lds
  buffer_load_dwordx4 v13, s[8:11], s97 offen offset:3072 lds
  s_xor_b32 m0, m0, 0x2000
  s_xor_b32 s97, s97, 0x80
  buffer_load_dwordx4 v10, s[8:11], s97 offen offset:0 lds
  buffer_load_dwordx4 v11, s[8:11], s97 offen offset:1024 lds
  buffer_load_dwordx4 v12, s[8:11], s97 offen offset:2048 lds
  buffer_load_dwordx4 v13, s[8:11], s97 offen offset:3072 lds
  s_add_u32 m0, s61, 32768
  s_add_u32 s97, s59, 262144
  buffer_load_dwordx4 v10, s[8:11], s97 offen offset:0 lds
  buffer_load_dwordx4 v11, s[8:11], s97 offen offset:1024 lds
  buffer_load_dwordx4 v12, s[8:11], s97 offen offset:2048 lds
  buffer_load_dwordx4 v13, s[8:11], s97 offen offset:3072 lds
  s_xor_b32 m0, m0, 0x2000
  s_xor_b32 s97, s97, 0x80
  buffer_load_dwordx4 v10, s[8:11], s97 offen offset:0 lds
  buffer_load_dwordx4 v11, s[8:11], s97 offen offset:1024 lds
  buffer_load_dwordx4 v12, s[8:11], s97 offen offset:2048 lds
  buffer_load_dwordx4 v13, s[8:11], s97 offen offset:3072 lds
  s_add_u32 m0, s61, 49152
  s_add_u32 s97, s59, 327680
  buffer_load_dwordx4 v10, s[8:11], s97 offen offset:0 lds
  buffer_load_dwordx4 v11, s[8:11], s97 offen offset:1024 lds
  buffer_load_dwordx4 v12, s[8:11], s97 offen offset:2048 lds
  buffer_load_dwordx4 v13, s[8:11], s97 offen offset:3072 lds
  s_xor_b32 m0, m0, 0x2000
  s_xor_b32 s97, s97, 0x80
  buffer_load_dwordx4 v10, s[8:11], s97 offen offset:0 lds
  buffer_load_dwordx4 v11, s[8:11], s97 offen offset:1024 lds
  buffer_load_dwordx4 v12, s[8:11], s97 offen offset:2048 lds
  buffer_load_dwordx4 v13, s[8:11], s97 offen offset:3072 lds
  s_cmp_ge_u32 s48, 30
  s_cbranch_scc1 L_lateA
L_epiB:
  v_rcp_f32 v84, v84
  v_rcp_f32 v92, v92
  s_lshl_b32 s6, s4, 13
  s_add_u32 s6, s6, s51
  s_add_u32 s7, s6, 4096
  v_accvgpr_read_b32 v96, a64
  v_accvgpr_read_b32 v97, a65
  v_accvgpr_read_b32 v98, a66
  v_accvgpr_read_b32 v99, a67
  v_accvgpr_read_b32 v100, a68
  v_accvgpr_read_b32 v101, a69
  v_accvgpr_read_b32 v102, a70
  v_accvgpr_read_b32 v103, a71
  v_pk_mul_f32 v[96:97], v[96:97], v[84:85] op_sel_hi:[1,0]
  v_pk_mul_f32 v[98:99], v[98:99], v[84:85] op_sel_hi:[1,0]
  v_pk_mul_f32 v[100:101], v[100:101], v[84:85] op_sel_hi:[1,0]
  v_pk_mul_f32 v[102:103], v[102:103], v[84:85] op_sel_hi:[1,0]
  v_cvt_pk_bf16_f32 v96, v96, v97
  v_cvt_pk_bf16_f32 v97, v98, v99
  v_cvt_pk_bf16_f32 v98, v100, v101
  v_cvt_pk_bf16_f32 v99, v102, v103
  buffer_store_dwordx4 v[96:99], v1, s[28:31], s6 offen offset:0 sc1
  v_accvgpr_read_b32 v104, a72
  v_accvgpr_read_b32 v105, a73
  v_accvgpr_read_b32 v106, a74
  v_accvgpr_read_b32 v107, a75
  v_accvgpr_read_b32 v108, a76
  v_accvgpr_read_b32 v109, a77
  v_accvgpr_read_b32 v110, a78
  v_accvgpr_read_b32 v111, a79
  v_pk_mul_f32 v[104:105], v[104:105], v[92:93] op_sel_hi:[1,0]
  v_pk_mul_f32 v[106:107], v[106:107], v[92:93] op_sel_hi:[1,0]
  v_pk_mul_f32 v[108:109], v[108:109], v[92:93] op_sel_hi:[1,0]
  v_pk_mul_f32 v[110:111], v[110:111], v[92:93] op_sel_hi:[1,0]
  v_cvt_pk_bf16_f32 v104, v104, v105
  v_cvt_pk_bf16_f32 v105, v106, v107
  v_cvt_pk_bf16_f32 v106, v108, v109
  v_cvt_pk_bf16_f32 v107, v110, v111
  buffer_store_dwordx4 v[104:107], v1, s[28:31], s6 offen offset:1024 sc1
  v_accvgpr_read_b32 v96, a80
  v_accvgpr_read_b32 v97, a81
  v_accvgpr_read_b32 v98, a82
  v_accvgpr_read_b32 v99, a83
  v_accvgpr_read_b32 v100, a84
  v_accvgpr_read_b32 v101, a85
  v_accvgpr_read_b32 v102, a86
  v_accvgpr_read_b32 v103, a87
  v_pk_mul_f32 v[96:97], v[96:97], v[84:85] op_sel_hi:[1,0]
  v_pk_mul_f32 v[98:99], v[98:99], v[84:85] op_sel_hi:[1,0]
  v_pk_mul_f32 v[100:101], v[100:101], v[84:85] op_sel_hi:[1,0]
  v_pk_mul_f32 v[102:103], v[102:103], v[84:85] op_sel_hi:[1,0]
  v_cvt_pk_bf16_f32 v96, v96, v97
  v_cvt_pk_bf16_f32 v97, v98, v99
  v_cvt_pk_bf16_f32 v98, v100, v101
  v_cvt_pk_bf16_f32 v99, v102, v103
  buffer_store_dwordx4 v[96:99], v1, s[28:31], s6 offen offset:2048 sc1
  v_accvgpr_read_b32 v104, a88
  v_accvgpr_read_b32 v105, a89
  v_accvgpr_read_b32 v106, a90
  v_accvgpr_read_b32 v107, a91
  v_accvgpr_read_b32 v108, a92
  v_accvgpr_read_b32 v109, a93
  v_accvgpr_read_b32 v110, a94
  v_accvgpr_read_b32 v111, a95
  v_pk_mul_f32 v[104:105], v[104:105], v[92:93] op_sel_hi:[1,0]
  v_pk_mul_f32 v[106:107], v[106:107], v[92:93] op_sel_hi:[1,0]
  v_pk_mul_f32 v[108:109], v[108:109], v[92:93] op_sel_hi:[1,0]
  v_pk_mul_f32 v[110:111], v[110:111], v[92:93] op_sel_hi:[1,0]
  v_cvt_pk_bf16_f32 v104, v104, v105
  v_cvt_pk_bf16_f32 v105, v106, v107
  v_cvt_pk_bf16_f32 v106, v108, v109
  v_cvt_pk_bf16_f32 v107, v110, v111
  buffer_store_dwordx4 v[104:107], v1, s[28:31], s6 offen offset:3072 sc1
  v_accvgpr_read_b32 v96, a96
  v_accvgpr_read_b32 v97, a97
  v_accvgpr_read_b32 v98, a98
  v_accvgpr_read_b32 v99, a99
  v_accvgpr_read_b32 v100, a100
  v_accvgpr_read_b32 v101, a101
  v_accvgpr_read_b32 v102, a102
  v_accvgpr_read_b32 v103, a103
  v_pk_mul_f32 v[96:97], v[96:97], v[84:85] op_sel_hi:[1,0]
  v_pk_mul_f32 v[98:99], v[98:99], v[84:85] op_sel_hi:[1,0]
  v_pk_mul_f32 v[100:101], v[100:101], v[84:85] op_sel_hi:[1,0]
  v_pk_mul_f32 v[102:103], v[102:103], v[84:85] op_sel_hi:[1,0]
  v_cvt_pk_bf16_f32 v96, v96, v97
  v_cvt_pk_bf16_f32 v97, v98, v99
  v_cvt_pk_bf16_f32 v98, v100, v101
  v_cvt_pk_bf16_f32 v99, v102, v103
  buffer_store_dwordx4 v[96:99], v1, s[28:31], s7 offen offset:0 sc1
  v_accvgpr_read_b32 v104, a104
  v_accvgpr_read_b32 v105, a105
  v_accvgpr_read_b32 v106, a106
  v_accvgpr_read_b32 v107, a107
  v_accvgpr_read_b32 v108, a108
  v_accvgpr_read_b32 v109, a109
  v_accvgpr_read_b32 v110, a110
  v_accvgpr_read_b32 v111, a111
  v_pk_mul_f32 v[104:105], v[104:105], v[92:93] op_sel_hi:[1,0]
  v_pk_mul_f32 v[106:107], v[106:107], v[92:93] op_sel_hi:[1,0]
  v_pk_mul_f32 v[108:109], v[108:109], v[92:93] op_sel_hi:[1,0]
  v_pk_mul_f32 v[110:111], v[110:111], v[92:93] op_sel_hi:[1,0]
  v_cvt_pk_bf16_f32 v104, v104, v105
  v_cvt_pk_bf16_f32 v105, v106, v107
  v_cvt_pk_bf16_f32 v106, v108, v109
  v_cvt_pk_bf16_f32 v107, v110, v111
  buffer_store_dwordx4 v[104:107], v1, s[28:31], s7 offen offset:1024 sc1
  v_accvgpr_read_b32 v96, a112
  v_accvgpr_read_b32 v97, a113
  v_accvgpr_read_b32 v98, a114
  v_accvgpr_read_b32 v99, a115
  v_accvgpr_read_b32 v100, a116
  v_accvgpr_read_b32 v101, a117
  v_accvgpr_read_b32 v102, a118
  v_accvgpr_read_b32 v103, a119
  v_pk_mul_f32 v[96:97], v[96:97], v[84:85] op_sel_hi:[1,0]
  v_pk_mul_f32 v[98:99], v[98:99], v[84:85] op_sel_hi:[1,0]
  v_pk_mul_f32 v[100:101], v[100:101], v[84:85] op_sel_hi:[1,0]
  v_pk_mul_f32 v[102:103], v[102:103], v[84:85] op_sel_hi:[1,0]
  v_cvt_pk_bf16_f32 v96, v96, v97
  v_cvt_pk_bf16_f32 v97, v98, v99
  v_cvt_pk_bf16_f32 v98, v100, v101
  v_cvt_pk_bf16_f32 v99, v102, v103
  buffer_store_dwordx4 v[96:99], v1, s[28:31], s7 offen offset:2048 sc1
  v_accvgpr_read_b32 v104, a120
  v_accvgpr_read_b32 v105, a121
L_pad11:
  s_cbranch_execz L_pad15
  v_accvgpr_read_b32 v106, a122
  v_accvgpr_read_b32 v107, a123
  v_accvgpr_read_b32 v108, a124
  v_accvgpr_read_b32 v109, a125
  v_accvgpr_read_b32 v110, a126
  v_accvgpr_read_b32 v111, a127
  v_pk_mul_f32 v[104:105], v[104:105], v[92:93] op_sel_hi:[1,0]
  v_pk_mul_f32 v[106:107], v[106:107], v[92:93] op_sel_hi:[1,0]
  v_pk_mul_f32 v[108:109], v[108:109], v[92:93] op_sel_hi:[1,0]
  v_pk_mul_f32 v[110:111], v[110:111], v[92:93] op_sel_hi:[1,0]
  v_cvt_pk_bf16_f32 v104, v104, v105
  v_cvt_pk_bf16_f32 v105, v106, v107
  v_cvt_pk_bf16_f32 v106, v108, v109
  v_cvt_pk_bf16_f32 v107, v110, v111
  buffer_store_dwordx4 v[104:107], v1, s[28:31], s7 offen offset:3072 sc1
  s_waitcnt vmcnt(8)
L_P4:
  v_lshrrev_b32 v20, 2, v0
  v_lshlrev_b32 v20, 7, v20
  v_and_b32 v21, 3, v0
  v_lshl_add_u32 v20, v21, 3, v20
  v_bfe_u32 v21, v0, 3, 2
  v_lshl_add_u32 v20, v21, 5, v20
  s_and_b32 s6, s61, 0x10000
  v_add_u32 v208, 0x20000, v20
  v_add_u32 v200, s6, v20
  v_xor_b32 v209, 32, v208
  v_xor_b32 v210, 64, v208
  v_xor_b32 v211, 96, v208
  s_barrier
  ds_read_b64_tr_b16 v[64:65], v208 offset:0
  ds_read_b64_tr_b16 v[66:67], v208 offset:2048
  ds_read_b64_tr_b16 v[68:69], v208 offset:4096
  ds_read_b64_tr_b16 v[70:71], v208 offset:6144
  ds_read_b64_tr_b16 v[72:73], v209 offset:0
  ds_read_b64_tr_b16 v[74:75], v209 offset:2048
  ds_read_b64_tr_b16 v[76:77], v209 offset:4096
  ds_read_b64_tr_b16 v[78:79], v209 offset:6144
  ds_read_b64_tr_b16 v[80:81], v210 offset:0
  ds_read_b64_tr_b16 v[82:83], v210 offset:2048
  ds_read_b64_tr_b16 v[84:85], v210 offset:4096
  ds_read_b64_tr_b16 v[86:87], v210 offset:6144
  ds_read_b64_tr_b16 v[88:89], v211 offset:0
  ds_read_b64_tr_b16 v[90:91], v211 offset:2048
  ds_read_b64_tr_b16 v[92:93], v211 offset:4096
  ds_read_b64_tr_b16 v[94:95], v211 offset:6144
  s_waitcnt lgkmcnt(8)
  v_mfma_f32_16x16x32_bf16 v[128:131], v[64:67], a[192:195], 0
  ds_read_b64_tr_b16 v[96:97], v208 offset:8192
  ds_read_b64_tr_b16 v[98:99], v208 offset:10240
  v_mfma_f32_16x16x32_bf16 v[128:131], v[68:71], a[200:203], v[128:131]
  v_xor_b32 v201, 32, v200
  v_xor_b32 v202, 64, v200
  v_mfma_f32_16x16x32_bf16 v[136:139], v[68:71], a[204:207], 0
  ds_read_b64_tr_b16 v[100:101], v208 offset:12288
  ds_read_b64_tr_b16 v[102:103], v208 offset:14336
  v_mfma_f32_16x16x32_bf16 v[136:139], v[64:67], a[196:199], v[136:139]
  v_xor_b32 v203, 96, v200
  v_xor_b32 v204, 0x10000, v200
  v_mfma_f32_16x16x32_bf16 v[140:143], v[72:75], a[196:199], 0
  s_add_u32 m0, s62, 0
  ds_read_b64_tr_b16 v[104:105], v209 offset:8192
  ds_read_b64_tr_b16 v[106:107], v209 offset:10240
  v_mfma_f32_16x16x32_bf16 v[140:143], v[76:79], a[204:207], v[140:143]
  s_add_u32 s97, s59, 393216
  buffer_load_dwordx4 v10, s[8:11], s97 offen offset:0 lds
  v_mfma_f32_16x16x32_bf16 v[132:135], v[76:79], a[200:203], 0
  s_lshl_b32 s64, s48, 2
  ds_read_b64_tr_b16 v[108:109], v209 offset:12288
  ds_read_b64_tr_b16 v[110:111], v209 offset:14336
  v_mfma_f32_16x16x32_bf16 v[132:135], v[72:75], a[192:195], v[132:135]
  s_waitcnt lgkmcnt(8)
  v_xor_b32 v205, 0x10000, v201
  v_xor_b32 v206, 0x10000, v202
  v_mfma_f32_16x16x32_bf16 v[144:147], v[80:83], a[192:195], 0
  s_lshr_b32 s7, s4, 3
  ds_read_b64_tr_b16 v[112:113], v210 offset:8192
  ds_read_b64_tr_b16 v[114:115], v210 offset:10240
  v_mfma_f32_16x16x32_bf16 v[144:147], v[84:87], a[200:203], v[144:147]
  s_add_u32 s64, s64, s7
  v_xor_b32 v207, 0x10000, v203
  v_and_b32 v27, 7, v0
  v_mfma_f32_16x16x32_bf16 v[152:155], v[84:87], a[204:207], 0
  s_lshl_b32 s64, s64, 5
  ds_read_b64_tr_b16 v[116:117], v210 offset:12288
  ds_read_b64_tr_b16 v[118:119], v210 offset:14336
  v_mfma_f32_16x16x32_bf16 v[152:155], v[80:83], a[196:199], v[152:155]
  s_and_b32 s7, s4, 7
  buffer_load_dwordx4 v11, s[8:11], s97 offen offset:1024 lds
  v_mfma_f32_16x16x32_bf16 v[156:159], v[88:91], a[196:199], 0
  s_add_u32 s64, s64, s7
  ds_read_b64_tr_b16 v[120:121], v211 offset:8192
  ds_read_b64_tr_b16 v[122:123], v211 offset:10240
  v_mfma_f32_16x16x32_bf16 v[156:159], v[92:95], a[204:207], v[156:159]
  s_lshl_b32 s64, s64, 2
  v_lshlrev_b32 v27, 2, v27
  v_mfma_f32_16x16x32_bf16 v[148:151], v[92:95], a[200:203], 0
  s_add_u32 s64, s64, 60817408
  ds_read_b64_tr_b16 v[124:125], v211 offset:12288
  ds_read_b64_tr_b16 v[126:127], v211 offset:14336
  v_mfma_f32_16x16x32_bf16 v[148:151], v[88:91], a[192:195], v[148:151]
  s_waitcnt lgkmcnt(8)
  v_mfma_f32_16x16x32_bf16 v[160:163], v[96:99], a[192:195], 0
  s_lshl_b32 s65, s49, 2
  ds_read_b64_tr_b16 v[64:65], v208 offset:16384
  ds_read_b64_tr_b16 v[66:67], v208 offset:18432
  v_mfma_f32_16x16x32_bf16 v[160:163], v[100:103], a[200:203], v[160:163]
  s_lshr_b32 s7, s4, 3
  buffer_load_dwordx4 v12, s[8:11], s97 offen offset:2048 lds
  v_mfma_f32_16x16x32_bf16 v[168:171], v[100:103], a[204:207], 0
  s_add_u32 s65, s65, s7
  ds_read_b64_tr_b16 v[68:69], v208 offset:20480
  ds_read_b64_tr_b16 v[70:71], v208 offset:22528
  v_mfma_f32_16x16x32_bf16 v[168:171], v[96:99], a[196:199], v[168:171]
  s_lshl_b32 s65, s65, 5
  v_mfma_f32_16x16x32_bf16 v[172:175], v[104:107], a[196:199], 0
  s_and_b32 s7, s4, 7
  ds_read_b64_tr_b16 v[72:73], v209 offset:16384
  ds_read_b64_tr_b16 v[74:75], v209 offset:18432
  v_mfma_f32_16x16x32_bf16 v[172:175], v[108:111], a[204:207], v[172:175]
  s_add_u32 s65, s65, s7
  v_mfma_f32_16x16x32_bf16 v[164:167], v[108:111], a[200:203], 0
  s_lshl_b32 s65, s65, 2
  ds_read_b64_tr_b16 v[76:77], v209 offset:20480
  ds_read_b64_tr_b16 v[78:79], v209 offset:22528
  v_mfma_f32_16x16x32_bf16 v[164:167], v[104:107], a[192:195], v[164:167]
  s_waitcnt lgkmcnt(8)
  buffer_load_dwordx4 v13, s[8:11], s97 offen offset:3072 lds
  v_mfma_f32_16x16x32_bf16 v[176:179], v[112:115], a[192:195], 0
  s_add_u32 s65, s65, 60817408
  ds_read_b64_tr_b16 v[80:81], v210 offset:16384
  ds_read_b64_tr_b16 v[82:83], v210 offset:18432
  v_mfma_f32_16x16x32_bf16 v[176:179], v[116:119], a[200:203], v[176:179]
  s_and_b32 s66, s2, 1
  v_mfma_f32_16x16x32_bf16 v[184:187], v[116:119], a[204:207], 0
  s_lshl_b32 s66, s66, 5
  ds_read_b64_tr_b16 v[84:85], v210 offset:20480
  ds_read_b64_tr_b16 v[86:87], v210 offset:22528
  v_mfma_f32_16x16x32_bf16 v[184:187], v[112:115], a[196:199], v[184:187]
  s_add_u32 s66, s66, s48
  v_mfma_f32_16x16x32_bf16 v[188:191], v[120:123], a[196:199], 0
  s_add_u32 m0, s62, 16384
  ds_read_b64_tr_b16 v[88:89], v211 offset:16384
  ds_read_b64_tr_b16 v[90:91], v211 offset:18432
  v_mfma_f32_16x16x32_bf16 v[188:191], v[124:127], a[204:207], v[188:191]
  s_add_u32 s97, s60, 0
  buffer_load_dwordx4 v10, s[12:15], s97 offen offset:0 lds
  v_mfma_f32_16x16x32_bf16 v[180:183], v[124:127], a[200:203], 0
  s_lshl_b32 s66, s66, 2
  ds_read_b64_tr_b16 v[92:93], v211 offset:20480
  ds_read_b64_tr_b16 v[94:95], v211 offset:22528
  v_mfma_f32_16x16x32_bf16 v[180:183], v[120:123], a[192:195], v[180:183]
  s_waitcnt lgkmcnt(8)
  v_mfma_f32_16x16x32_bf16 v[128:131], v[64:67], a[208:211], v[128:131]
  s_lshr_b32 s67, s2, 1
  ds_read_b64_tr_b16 v[96:97], v208 offset:24576
  ds_read_b64_tr_b16 v[98:99], v208 offset:26624
  v_mfma_f32_16x16x32_bf16 v[128:131], v[68:71], a[216:219], v[128:131]
  s_and_b32 s67, s67, 3
  v_mfma_f32_16x16x32_bf16 v[136:139], v[68:71], a[220:223], v[136:139]
  s_add_u32 s66, s66, s67
  ds_read_b64_tr_b16 v[100:101], v208 offset:28672
  ds_read_b64_tr_b16 v[102:103], v208 offset:30720
  v_mfma_f32_16x16x32_bf16 v[136:139], v[64:67], a[212:215], v[136:139]
  s_lshl_b32 s66, s66, 7
  buffer_load_dwordx4 v11, s[12:15], s97 offen offset:1024 lds
  v_mfma_f32_16x16x32_bf16 v[140:143], v[72:75], a[212:215], v[140:143]
  s_add_u32 s66, s66, 60817408
  ds_read_b64_tr_b16 v[104:105], v209 offset:24576
  ds_read_b64_tr_b16 v[106:107], v209 offset:26624
  v_mfma_f32_16x16x32_bf16 v[140:143], v[76:79], a[220:223], v[140:143]
  v_mfma_f32_16x16x32_bf16 v[132:135], v[76:79], a[216:219], v[132:135]
  ds_read_b64_tr_b16 v[108:109], v209 offset:28672
  ds_read_b64_tr_b16 v[110:111], v209 offset:30720
  v_mfma_f32_16x16x32_bf16 v[132:135], v[72:75], a[208:211], v[132:135]
  s_waitcnt lgkmcnt(8)
  v_mfma_f32_16x16x32_bf16 v[144:147], v[80:83], a[208:211], v[144:147]
  ds_read_b64_tr_b16 v[112:113], v210 offset:24576
  ds_read_b64_tr_b16 v[114:115], v210 offset:26624
  v_mfma_f32_16x16x32_bf16 v[144:147], v[84:87], a[216:219], v[144:147]
  buffer_load_dwordx4 v12, s[12:15], s97 offen offset:2048 lds
  v_mfma_f32_16x16x32_bf16 v[152:155], v[84:87], a[220:223], v[152:155]
  ds_read_b64_tr_b16 v[116:117], v210 offset:28672
  ds_read_b64_tr_b16 v[118:119], v210 offset:30720
  v_mfma_f32_16x16x32_bf16 v[152:155], v[80:83], a[212:215], v[152:155]
  v_mfma_f32_16x16x32_bf16 v[156:159], v[88:91], a[212:215], v[156:159]
  ds_read_b64_tr_b16 v[120:121], v211 offset:24576
  ds_read_b64_tr_b16 v[122:123], v211 offset:26624
  v_mfma_f32_16x16x32_bf16 v[156:159], v[92:95], a[220:223], v[156:159]
  s_barrier
  v_mfma_f32_16x16x32_bf16 v[148:151], v[92:95], a[216:219], v[148:151]
  ds_read_b64_tr_b16 v[124:125], v211 offset:28672
  ds_read_b64_tr_b16 v[126:127], v211 offset:30720
  v_mfma_f32_16x16x32_bf16 v[148:151], v[88:91], a[208:211], v[148:151]
  s_waitcnt lgkmcnt(8)
  buffer_load_dwordx4 v13, s[12:15], s97 offen offset:3072 lds
  v_mfma_f32_16x16x32_bf16 v[160:163], v[96:99], a[208:211], v[160:163]
  ds_read_b64_tr_b16 v[64:65], v200 offset:0
  ds_read_b64_tr_b16 v[66:67], v200 offset:2048
  v_mfma_f32_16x16x32_bf16 v[160:163], v[100:103], a[216:219], v[160:163]
  v_mfma_f32_16x16x32_bf16 v[168:171], v[100:103], a[220:223], v[168:171]
  ds_read_b64_tr_b16 v[68:69], v200 offset:4096
  ds_read_b64_tr_b16 v[70:71], v200 offset:6144
  v_mfma_f32_16x16x32_bf16 v[168:171], v[96:99], a[212:215], v[168:171]
  v_mfma_f32_16x16x32_bf16 v[172:175], v[104:107], a[212:215], v[172:175]
  s_add_u32 m0, s62, 32768
  ds_read_b64_tr_b16 v[72:73], v201 offset:0
  ds_read_b64_tr_b16 v[74:75], v201 offset:2048
  v_mfma_f32_16x16x32_bf16 v[172:175], v[108:111], a[220:223], v[172:175]
  s_add_u32 s97, s60, 65536
  buffer_load_dwordx4 v10, s[12:15], s97 offen offset:0 lds
  v_mfma_f32_16x16x32_bf16 v[164:167], v[108:111], a[216:219], v[164:167]
  ds_read_b64_tr_b16 v[76:77], v201 offset:4096
  ds_read_b64_tr_b16 v[78:79], v201 offset:6144
  v_mfma_f32_16x16x32_bf16 v[164:167], v[104:107], a[208:211], v[164:167]
  s_waitcnt lgkmcnt(8)
  v_mfma_f32_16x16x32_bf16 v[176:179], v[112:115], a[208:211], v[176:179]
  ds_read_b64_tr_b16 v[80:81], v202 offset:0
  ds_read_b64_tr_b16 v[82:83], v202 offset:2048
  v_mfma_f32_16x16x32_bf16 v[176:179], v[116:119], a[216:219], v[176:179]
  v_mfma_f32_16x16x32_bf16 v[184:187], v[116:119], a[220:223], v[184:187]
  ds_read_b64_tr_b16 v[84:85], v202 offset:4096
  ds_read_b64_tr_b16 v[86:87], v202 offset:6144
  v_mfma_f32_16x16x32_bf16 v[184:187], v[112:115], a[212:215], v[184:187]
  buffer_load_dwordx4 v11, s[12:15], s97 offen offset:1024 lds
  v_mfma_f32_16x16x32_bf16 v[188:191], v[120:123], a[212:215], v[188:191]
  s_waitcnt vmcnt(10)
  ds_read_b64_tr_b16 v[88:89], v203 offset:0
  ds_read_b64_tr_b16 v[90:91], v203 offset:2048
  v_mfma_f32_16x16x32_bf16 v[188:191], v[124:127], a[220:223], v[188:191]
  buffer_store_dword v28, off, s[28:31], s65 sc1
  v_mfma_f32_16x16x32_bf16 v[180:183], v[124:127], a[216:219], v[180:183]
  ds_read_b64_tr_b16 v[92:93], v203 offset:4096
  ds_read_b64_tr_b16 v[94:95], v203 offset:6144
  v_mfma_f32_16x16x32_bf16 v[180:183], v[120:123], a[208:211], v[180:183]
  s_waitcnt lgkmcnt(8)
  buffer_store_dword v28, off, s[28:31], s64 sc1
  v_mfma_f32_16x16x32_bf16 v[128:131], v[64:67], a[224:227], v[128:131]
  ds_read_b64_tr_b16 v[96:97], v200 offset:8192
  ds_read_b64_tr_b16 v[98:99], v200 offset:10240
  v_mfma_f32_16x16x32_bf16 v[128:131], v[68:71], a[232:235], v[128:131]
  buffer_load_dwordx4 v12, s[12:15], s97 offen offset:2048 lds
  v_mfma_f32_16x16x32_bf16 v[136:139], v[68:71], a[236:239], v[136:139]
  ds_read_b64_tr_b16 v[100:101], v200 offset:12288
  ds_read_b64_tr_b16 v[102:103], v200 offset:14336
  v_mfma_f32_16x16x32_bf16 v[136:139], v[64:67], a[228:231], v[136:139]
  v_mfma_f32_16x16x32_bf16 v[140:143], v[72:75], a[228:231], v[140:143]
  ds_read_b64_tr_b16 v[104:105], v201 offset:8192
  ds_read_b64_tr_b16 v[106:107], v201 offset:10240
  v_mfma_f32_16x16x32_bf16 v[140:143], v[76:79], a[236:239], v[140:143]
  v_mfma_f32_16x16x32_bf16 v[132:135], v[76:79], a[232:235], v[132:135]
  ds_read_b64_tr_b16 v[108:109], v201 offset:12288
  ds_read_b64_tr_b16 v[110:111], v201 offset:14336
  v_mfma_f32_16x16x32_bf16 v[132:135], v[72:75], a[224:227], v[132:135]
  s_waitcnt lgkmcnt(8)
  buffer_load_dwordx4 v13, s[12:15], s97 offen offset:3072 lds
  v_mfma_f32_16x16x32_bf16 v[144:147], v[80:83], a[224:227], v[144:147]
  ds_read_b64_tr_b16 v[112:113], v202 offset:8192
  ds_read_b64_tr_b16 v[114:115], v202 offset:10240
  v_mfma_f32_16x16x32_bf16 v[144:147], v[84:87], a[232:235], v[144:147]
  v_mfma_f32_16x16x32_bf16 v[152:155], v[84:87], a[236:239], v[152:155]
  ds_read_b64_tr_b16 v[116:117], v202 offset:12288
  ds_read_b64_tr_b16 v[118:119], v202 offset:14336
  v_mfma_f32_16x16x32_bf16 v[152:155], v[80:83], a[228:231], v[152:155]
  v_mfma_f32_16x16x32_bf16 v[156:159], v[88:91], a[228:231], v[156:159]
  s_add_u32 m0, s62, 49152
  ds_read_b64_tr_b16 v[120:121], v203 offset:8192
  ds_read_b64_tr_b16 v[122:123], v203 offset:10240
  v_mfma_f32_16x16x32_bf16 v[156:159], v[92:95], a[236:239], v[156:159]
  s_add_u32 s97, s60, 131072
  buffer_load_dwordx4 v10, s[12:15], s97 offen offset:0 lds
  v_mfma_f32_16x16x32_bf16 v[148:151], v[92:95], a[232:235], v[148:151]
  ds_read_b64_tr_b16 v[124:125], v203 offset:12288
  ds_read_b64_tr_b16 v[126:127], v203 offset:14336
  v_mfma_f32_16x16x32_bf16 v[148:151], v[88:91], a[224:227], v[148:151]
  s_waitcnt lgkmcnt(8)
  v_mfma_f32_16x16x32_bf16 v[160:163], v[96:99], a[224:227], v[160:163]
  ds_read_b64_tr_b16 v[64:65], v200 offset:16384
  ds_read_b64_tr_b16 v[66:67], v200 offset:18432
  v_mfma_f32_16x16x32_bf16 v[160:163], v[100:103], a[232:235], v[160:163]
  v_mfma_f32_16x16x32_bf16 v[168:171], v[100:103], a[236:239], v[168:171]
  ds_read_b64_tr_b16 v[68:69], v200 offset:20480
  ds_read_b64_tr_b16 v[70:71], v200 offset:22528
  v_mfma_f32_16x16x32_bf16 v[168:171], v[96:99], a[228:231], v[168:171]
  buffer_load_dwordx4 v11, s[12:15], s97 offen offset:1024 lds
  v_mfma_f32_16x16x32_bf16 v[172:175], v[104:107], a[228:231], v[172:175]
  ds_read_b64_tr_b16 v[72:73], v201 offset:16384
  ds_read_b64_tr_b16 v[74:75], v201 offset:18432
  v_mfma_f32_16x16x32_bf16 v[172:175], v[108:111], a[236:239], v[172:175]
  v_mfma_f32_16x16x32_bf16 v[164:167], v[108:111], a[232:235], v[164:167]
  ds_read_b64_tr_b16 v[76:77], v201 offset:20480
  ds_read_b64_tr_b16 v[78:79], v201 offset:22528
  v_mfma_f32_16x16x32_bf16 v[164:167], v[104:107], a[224:227], v[164:167]
  s_waitcnt lgkmcnt(8)
  v_mfma_f32_16x16x32_bf16 v[176:179], v[112:115], a[224:227], v[176:179]
  ds_read_b64_tr_b16 v[80:81], v202 offset:16384
  ds_read_b64_tr_b16 v[82:83], v202 offset:18432
  v_mfma_f32_16x16x32_bf16 v[176:179], v[116:119], a[232:235], v[176:179]
  buffer_load_dwordx4 v12, s[12:15], s97 offen offset:2048 lds
  v_mfma_f32_16x16x32_bf16 v[184:187], v[116:119], a[236:239], v[184:187]
  ds_read_b64_tr_b16 v[84:85], v202 offset:20480
  ds_read_b64_tr_b16 v[86:87], v202 offset:22528
  v_mfma_f32_16x16x32_bf16 v[184:187], v[112:115], a[228:231], v[184:187]
  v_mfma_f32_16x16x32_bf16 v[188:191], v[120:123], a[228:231], v[188:191]
  ds_read_b64_tr_b16 v[88:89], v203 offset:16384
  ds_read_b64_tr_b16 v[90:91], v203 offset:18432
  v_mfma_f32_16x16x32_bf16 v[188:191], v[124:127], a[236:239], v[188:191]
  v_mfma_f32_16x16x32_bf16 v[180:183], v[124:127], a[232:235], v[180:183]
  ds_read_b64_tr_b16 v[92:93], v203 offset:20480
  ds_read_b64_tr_b16 v[94:95], v203 offset:22528
  v_mfma_f32_16x16x32_bf16 v[180:183], v[120:123], a[224:227], v[180:183]
  s_waitcnt lgkmcnt(8)
  buffer_load_dwordx4 v13, s[12:15], s97 offen offset:3072 lds
  v_mfma_f32_16x16x32_bf16 v[128:131], v[64:67], a[240:243], v[128:131]
  ds_read_b64_tr_b16 v[96:97], v200 offset:24576
  ds_read_b64_tr_b16 v[98:99], v200 offset:26624
  v_mfma_f32_16x16x32_bf16 v[128:131], v[68:71], a[248:251], v[128:131]
  v_mfma_f32_16x16x32_bf16 v[136:139], v[68:71], a[252:255], v[136:139]
  ds_read_b64_tr_b16 v[100:101], v200 offset:28672
  ds_read_b64_tr_b16 v[102:103], v200 offset:30720
  v_mfma_f32_16x16x32_bf16 v[136:139], v[64:67], a[244:247], v[136:139]
  v_mfma_f32_16x16x32_bf16 v[140:143], v[72:75], a[244:247], v[140:143]
  ds_read_b64_tr_b16 v[104:105], v201 offset:24576
  ds_read_b64_tr_b16 v[106:107], v201 offset:26624
  v_mfma_f32_16x16x32_bf16 v[140:143], v[76:79], a[252:255], v[140:143]
  v_mfma_f32_16x16x32_bf16 v[132:135], v[76:79], a[248:251], v[132:135]
  ds_read_b64_tr_b16 v[108:109], v201 offset:28672
  ds_read_b64_tr_b16 v[110:111], v201 offset:30720
  v_mfma_f32_16x16x32_bf16 v[132:135], v[72:75], a[240:243], v[132:135]
  s_waitcnt lgkmcnt(8)
  v_mfma_f32_16x16x32_bf16 v[144:147], v[80:83], a[240:243], v[144:147]
  ds_read_b64_tr_b16 v[112:113], v202 offset:24576
  ds_read_b64_tr_b16 v[114:115], v202 offset:26624
  v_mfma_f32_16x16x32_bf16 v[144:147], v[84:87], a[248:251], v[144:147]
  v_mfma_f32_16x16x32_bf16 v[152:155], v[84:87], a[252:255], v[152:155]
  ds_read_b64_tr_b16 v[116:117], v202 offset:28672
  ds_read_b64_tr_b16 v[118:119], v202 offset:30720
  v_mfma_f32_16x16x32_bf16 v[152:155], v[80:83], a[244:247], v[152:155]
  v_mfma_f32_16x16x32_bf16 v[156:159], v[88:91], a[244:247], v[156:159]
  ds_read_b64_tr_b16 v[120:121], v203 offset:24576
  ds_read_b64_tr_b16 v[122:123], v203 offset:26624
  v_mfma_f32_16x16x32_bf16 v[156:159], v[92:95], a[252:255], v[156:159]
  s_barrier
  v_mfma_f32_16x16x32_bf16 v[148:151], v[92:95], a[248:251], v[148:151]
  ds_read_b64_tr_b16 v[124:125], v203 offset:28672
  ds_read_b64_tr_b16 v[126:127], v203 offset:30720
  v_mfma_f32_16x16x32_bf16 v[148:151], v[88:91], a[240:243], v[148:151]
  s_waitcnt lgkmcnt(8)
  v_mfma_f32_16x16x32_bf16 v[160:163], v[96:99], a[240:243], v[160:163]
  ds_read_b64_tr_b16 v[64:65], v200 offset:32768
  ds_read_b64_tr_b16 v[66:67], v200 offset:34816
  v_mfma_f32_16x16x32_bf16 v[160:163], v[100:103], a[248:251], v[160:163]
  v_mov_b32 v29, 0
  v_mfma_f32_16x16x32_bf16 v[168:171], v[100:103], a[252:255], v[168:171]
  ds_read_b64_tr_b16 v[68:69], v200 offset:36864
  ds_read_b64_tr_b16 v[70:71], v200 offset:38912
  v_mfma_f32_16x16x32_bf16 v[168:171], v[96:99], a[244:247], v[168:171]
  v_mfma_f32_16x16x32_bf16 v[172:175], v[104:107], a[244:247], v[172:175]
  s_add_u32 m0, s63, 0
  ds_read_b64_tr_b16 v[72:73], v201 offset:32768
  ds_read_b64_tr_b16 v[74:75], v201 offset:34816
  v_mfma_f32_16x16x32_bf16 v[172:175], v[108:111], a[252:255], v[172:175]
  s_add_u32 s97, s60, 196608
  buffer_load_dwordx4 v10, s[12:15], s97 offen offset:0 lds
  v_mfma_f32_16x16x32_bf16 v[164:167], v[108:111], a[248:251], v[164:167]
  ds_read_b64_tr_b16 v[76:77], v201 offset:36864
  ds_read_b64_tr_b16 v[78:79], v201 offset:38912
  v_mfma_f32_16x16x32_bf16 v[164:167], v[104:107], a[240:243], v[164:167]
  s_waitcnt lgkmcnt(8)
  v_mfma_f32_16x16x32_bf16 v[176:179], v[112:115], a[240:243], v[176:179]
  ds_read_b64_tr_b16 v[80:81], v202 offset:32768
  ds_read_b64_tr_b16 v[82:83], v202 offset:34816
  v_mfma_f32_16x16x32_bf16 v[176:179], v[116:119], a[248:251], v[176:179]
  s_mov_b64 exec, 0xff
  buffer_atomic_or v29, v27, s[28:31], s66 offen sc0
  s_mov_b64 exec, -1
  v_mfma_f32_16x16x32_bf16 v[184:187], v[116:119], a[252:255], v[184:187]
  ds_read_b64_tr_b16 v[84:85], v202 offset:36864
  ds_read_b64_tr_b16 v[86:87], v202 offset:38912
  v_mfma_f32_16x16x32_bf16 v[184:187], v[112:115], a[244:247], v[184:187]
  buffer_load_dwordx4 v11, s[12:15], s97 offen offset:1024 lds
  v_mfma_f32_16x16x32_bf16 v[188:191], v[120:123], a[244:247], v[188:191]
  ds_read_b64_tr_b16 v[88:89], v203 offset:32768
  ds_read_b64_tr_b16 v[90:91], v203 offset:34816
  v_mfma_f32_16x16x32_bf16 v[188:191], v[124:127], a[252:255], v[188:191]
  v_mfma_f32_16x16x32_bf16 v[180:183], v[124:127], a[248:251], v[180:183]
  ds_read_b64_tr_b16 v[92:93], v203 offset:36864
  ds_read_b64_tr_b16 v[94:95], v203 offset:38912
  v_mfma_f32_16x16x32_bf16 v[180:183], v[120:123], a[240:243], v[180:183]
  s_waitcnt lgkmcnt(8)
  v_mfma_f32_16x16x32_bf16 v[128:131], v[64:67], v[32:35], v[128:131]
  ds_read_b64_tr_b16 v[96:97], v200 offset:40960
  ds_read_b64_tr_b16 v[98:99], v200 offset:43008
  v_mfma_f32_16x16x32_bf16 v[128:131], v[68:71], v[40:43], v[128:131]
  buffer_load_dwordx4 v12, s[12:15], s97 offen offset:2048 lds
  v_mfma_f32_16x16x32_bf16 v[136:139], v[68:71], v[44:47], v[136:139]
  ds_read_b64_tr_b16 v[100:101], v200 offset:45056
  ds_read_b64_tr_b16 v[102:103], v200 offset:47104
  v_mfma_f32_16x16x32_bf16 v[136:139], v[64:67], v[36:39], v[136:139]
  v_mfma_f32_16x16x32_bf16 v[140:143], v[72:75], v[36:39], v[140:143]
  ds_read_b64_tr_b16 v[104:105], v201 offset:40960
  ds_read_b64_tr_b16 v[106:107], v201 offset:43008
  v_mfma_f32_16x16x32_bf16 v[140:143], v[76:79], v[44:47], v[140:143]
  v_mfma_f32_16x16x32_bf16 v[132:135], v[76:79], v[40:43], v[132:135]
  ds_read_b64_tr_b16 v[108:109], v201 offset:45056
  ds_read_b64_tr_b16 v[110:111], v201 offset:47104
  v_mfma_f32_16x16x32_bf16 v[132:135], v[72:75], v[32:35], v[132:135]
  s_waitcnt lgkmcnt(8)
  buffer_load_dwordx4 v13, s[12:15], s97 offen offset:3072 lds
  v_mfma_f32_16x16x32_bf16 v[144:147], v[80:83], v[32:35], v[144:147]
  ds_read_b64_tr_b16 v[112:113], v202 offset:40960
  ds_read_b64_tr_b16 v[114:115], v202 offset:43008
  v_mfma_f32_16x16x32_bf16 v[144:147], v[84:87], v[40:43], v[144:147]
  v_mfma_f32_16x16x32_bf16 v[152:155], v[84:87], v[44:47], v[152:155]
  ds_read_b64_tr_b16 v[116:117], v202 offset:45056
  ds_read_b64_tr_b16 v[118:119], v202 offset:47104
  v_mfma_f32_16x16x32_bf16 v[152:155], v[80:83], v[36:39], v[152:155]
  v_mfma_f32_16x16x32_bf16 v[156:159], v[88:91], v[36:39], v[156:159]
  s_add_u32 m0, s63, 16384
  ds_read_b64_tr_b16 v[120:121], v203 offset:40960
  ds_read_b64_tr_b16 v[122:123], v203 offset:43008
  v_mfma_f32_16x16x32_bf16 v[156:159], v[92:95], v[44:47], v[156:159]
  s_add_u32 s97, s60, 262144
  buffer_load_dwordx4 v10, s[12:15], s97 offen offset:0 lds
  v_mfma_f32_16x16x32_bf16 v[148:151], v[92:95], v[40:43], v[148:151]
  ds_read_b64_tr_b16 v[124:125], v203 offset:45056
  ds_read_b64_tr_b16 v[126:127], v203 offset:47104
  v_mfma_f32_16x16x32_bf16 v[148:151], v[88:91], v[32:35], v[148:151]
  s_waitcnt lgkmcnt(8)
  v_mfma_f32_16x16x32_bf16 v[160:163], v[96:99], v[32:35], v[160:163]
  ds_read_b64_tr_b16 v[64:65], v200 offset:49152
  ds_read_b64_tr_b16 v[66:67], v200 offset:51200
  v_mfma_f32_16x16x32_bf16 v[160:163], v[100:103], v[40:43], v[160:163]
  v_mfma_f32_16x16x32_bf16 v[168:171], v[100:103], v[44:47], v[168:171]
  ds_read_b64_tr_b16 v[68:69], v200 offset:53248
  ds_read_b64_tr_b16 v[70:71], v200 offset:55296
  v_mfma_f32_16x16x32_bf16 v[168:171], v[96:99], v[36:39], v[168:171]
  buffer_load_dwordx4 v11, s[12:15], s97 offen offset:1024 lds
  v_mfma_f32_16x16x32_bf16 v[172:175], v[104:107], v[36:39], v[172:175]
  ds_read_b64_tr_b16 v[72:73], v201 offset:49152
  ds_read_b64_tr_b16 v[74:75], v201 offset:51200
  v_mfma_f32_16x16x32_bf16 v[172:175], v[108:111], v[44:47], v[172:175]
  v_mfma_f32_16x16x32_bf16 v[164:167], v[108:111], v[40:43], v[164:167]
  ds_read_b64_tr_b16 v[76:77], v201 offset:53248
  ds_read_b64_tr_b16 v[78:79], v201 offset:55296
  v_mfma_f32_16x16x32_bf16 v[164:167], v[104:107], v[32:35], v[164:167]
  s_waitcnt lgkmcnt(8)
  v_mfma_f32_16x16x32_bf16 v[176:179], v[112:115], v[32:35], v[176:179]
  ds_read_b64_tr_b16 v[80:81], v202 offset:49152
  ds_read_b64_tr_b16 v[82:83], v202 offset:51200
  v_mfma_f32_16x16x32_bf16 v[176:179], v[116:119], v[40:43], v[176:179]
  buffer_load_dwordx4 v12, s[12:15], s97 offen offset:2048 lds
  v_mfma_f32_16x16x32_bf16 v[184:187], v[116:119], v[44:47], v[184:187]
  ds_read_b64_tr_b16 v[84:85], v202 offset:53248
  ds_read_b64_tr_b16 v[86:87], v202 offset:55296
  v_mfma_f32_16x16x32_bf16 v[184:187], v[112:115], v[36:39], v[184:187]
  v_mfma_f32_16x16x32_bf16 v[188:191], v[120:123], v[36:39], v[188:191]
  ds_read_b64_tr_b16 v[88:89], v203 offset:49152
  ds_read_b64_tr_b16 v[90:91], v203 offset:51200
  v_mfma_f32_16x16x32_bf16 v[188:191], v[124:127], v[44:47], v[188:191]
  v_mfma_f32_16x16x32_bf16 v[180:183], v[124:127], v[40:43], v[180:183]
  ds_read_b64_tr_b16 v[92:93], v203 offset:53248
  ds_read_b64_tr_b16 v[94:95], v203 offset:55296
  v_mfma_f32_16x16x32_bf16 v[180:183], v[120:123], v[32:35], v[180:183]
  s_waitcnt lgkmcnt(8)
  buffer_load_dwordx4 v13, s[12:15], s97 offen offset:3072 lds
  v_mfma_f32_16x16x32_bf16 v[128:131], v[64:67], v[48:51], v[128:131]
  ds_read_b64_tr_b16 v[96:97], v200 offset:57344
  ds_read_b64_tr_b16 v[98:99], v200 offset:59392
  v_mfma_f32_16x16x32_bf16 v[128:131], v[68:71], v[56:59], v[128:131]
  v_mfma_f32_16x16x32_bf16 v[136:139], v[68:71], v[60:63], v[136:139]
  ds_read_b64_tr_b16 v[100:101], v200 offset:61440
  ds_read_b64_tr_b16 v[102:103], v200 offset:63488
  v_mfma_f32_16x16x32_bf16 v[136:139], v[64:67], v[52:55], v[136:139]
  s_waitcnt vmcnt(7)
  v_cmp_ne_u32 vcc, 1, v29
  v_mfma_f32_16x16x32_bf16 v[140:143], v[72:75], v[52:55], v[140:143]
  ds_read_b64_tr_b16 v[104:105], v201 offset:57344
  ds_read_b64_tr_b16 v[106:107], v201 offset:59392
  v_mfma_f32_16x16x32_bf16 v[140:143], v[76:79], v[60:63], v[140:143]
  s_and_b32 s96, vcc_lo, 0xff
  s_cbranch_scc1 L_pollCTX
L_pollCTX_back:
  v_mfma_f32_16x16x32_bf16 v[132:135], v[76:79], v[56:59], v[132:135]
  ds_read_b64_tr_b16 v[108:109], v201 offset:61440
  ds_read_b64_tr_b16 v[110:111], v201 offset:63488
  v_mfma_f32_16x16x32_bf16 v[132:135], v[72:75], v[48:51], v[132:135]
  s_waitcnt lgkmcnt(8)
  s_add_u32 s100, s58, 0
  buffer_load_dwordx4 a[144:147], v1, s[28:31], s100 offen offset:0 sc1
  v_mfma_f32_16x16x32_bf16 v[144:147], v[80:83], v[48:51], v[144:147]
  ds_read_b64_tr_b16 v[112:113], v202 offset:57344
  ds_read_b64_tr_b16 v[114:115], v202 offset:59392
  v_mfma_f32_16x16x32_bf16 v[144:147], v[84:87], v[56:59], v[144:147]
  buffer_load_dwordx4 a[148:151], v1, s[28:31], s100 offen offset:1024 sc1
  v_mfma_f32_16x16x32_bf16 v[152:155], v[84:87], v[60:63], v[152:155]
  ds_read_b64_tr_b16 v[116:117], v202 offset:61440
  ds_read_b64_tr_b16 v[118:119], v202 offset:63488
  v_mfma_f32_16x16x32_bf16 v[152:155], v[80:83], v[52:55], v[152:155]
  buffer_load_dwordx4 a[152:155], v1, s[28:31], s100 offen offset:2048 sc1
  v_mfma_f32_16x16x32_bf16 v[156:159], v[88:91], v[52:55], v[156:159]
  ds_read_b64_tr_b16 v[120:121], v203 offset:57344
  ds_read_b64_tr_b16 v[122:123], v203 offset:59392
  v_mfma_f32_16x16x32_bf16 v[156:159], v[92:95], v[60:63], v[156:159]
  s_barrier
  v_mfma_f32_16x16x32_bf16 v[148:151], v[92:95], v[56:59], v[148:151]
  ds_read_b64_tr_b16 v[124:125], v203 offset:61440
  ds_read_b64_tr_b16 v[126:127], v203 offset:63488
  v_mfma_f32_16x16x32_bf16 v[148:151], v[88:91], v[48:51], v[148:151]
  s_waitcnt lgkmcnt(8)
  buffer_load_dwordx4 a[156:159], v1, s[28:31], s100 offen offset:3072 sc1
  v_mfma_f32_16x16x32_bf16 v[160:163], v[96:99], v[48:51], v[160:163]
  ds_read_b64_tr_b16 v[64:65], v204 offset:0
  ds_read_b64_tr_b16 v[66:67], v204 offset:2048
  v_mfma_f32_16x16x32_bf16 v[160:163], v[100:103], v[56:59], v[160:163]
  s_add_u32 s100, s58, 4096
  buffer_load_dwordx4 a[160:163], v1, s[28:31], s100 offen offset:0 sc1
  v_mfma_f32_16x16x32_bf16 v[168:171], v[100:103], v[60:63], v[168:171]
  ds_read_b64_tr_b16 v[68:69], v204 offset:4096
  ds_read_b64_tr_b16 v[70:71], v204 offset:6144
  v_mfma_f32_16x16x32_bf16 v[168:171], v[96:99], v[52:55], v[168:171]
  buffer_load_dwordx4 a[164:167], v1, s[28:31], s100 offen offset:1024 sc1
  v_mfma_f32_16x16x32_bf16 v[172:175], v[104:107], v[52:55], v[172:175]
  ds_read_b64_tr_b16 v[72:73], v205 offset:0
  ds_read_b64_tr_b16 v[74:75], v205 offset:2048
  v_mfma_f32_16x16x32_bf16 v[172:175], v[108:111], v[60:63], v[172:175]
  buffer_load_dwordx4 a[168:171], v1, s[28:31], s100 offen offset:2048 sc1
  v_mfma_f32_16x16x32_bf16 v[164:167], v[108:111], v[56:59], v[164:167]
  ds_read_b64_tr_b16 v[76:77], v205 offset:4096
  ds_read_b64_tr_b16 v[78:79], v205 offset:6144
  v_mfma_f32_16x16x32_bf16 v[164:167], v[104:107], v[48:51], v[164:167]
  s_waitcnt lgkmcnt(8)
  buffer_load_dwordx4 a[172:175], v1, s[28:31], s100 offen offset:3072 sc1
  v_mfma_f32_16x16x32_bf16 v[176:179], v[112:115], v[48:51], v[176:179]
  ds_read_b64_tr_b16 v[80:81], v206 offset:0
  ds_read_b64_tr_b16 v[82:83], v206 offset:2048
  v_mfma_f32_16x16x32_bf16 v[176:179], v[116:119], v[56:59], v[176:179]
  v_mfma_f32_16x16x32_bf16 v[184:187], v[116:119], v[60:63], v[184:187]
  ds_read_b64_tr_b16 v[84:85], v206 offset:4096
  ds_read_b64_tr_b16 v[86:87], v206 offset:6144
  v_mfma_f32_16x16x32_bf16 v[184:187], v[112:115], v[52:55], v[184:187]
  v_mfma_f32_16x16x32_bf16 v[188:191], v[120:123], v[52:55], v[188:191]
  s_add_u32 s100, s58, 8192
  ds_read_b64_tr_b16 v[88:89], v207 offset:0
  ds_read_b64_tr_b16 v[90:91], v207 offset:2048
  v_mfma_f32_16x16x32_bf16 v[188:191], v[124:127], v[60:63], v[188:191]
  s_add_u32 m0, s61, 0
  buffer_load_dwordx4 a[176:179], v1, s[28:31], s100 offen offset:0 sc1
  v_mfma_f32_16x16x32_bf16 v[180:183], v[124:127], v[56:59], v[180:183]
L_pad12:
  s_cbranch_execz L_pad16
  s_add_u32 s97, s60, 327680
  ds_read_b64_tr_b16 v[92:93], v207 offset:4096
  ds_read_b64_tr_b16 v[94:95], v207 offset:6144
  v_mfma_f32_16x16x32_bf16 v[180:183], v[120:123], v[48:51], v[180:183]
  s_waitcnt lgkmcnt(8)
  buffer_load_dwordx4 v10, s[12:15], s97 offen offset:0 lds
  v_mfma_f32_16x16x32_bf16 v[128:131], v[64:67], v[224:227], v[128:131]
  ds_read_b64_tr_b16 v[96:97], v204 offset:8192
  ds_read_b64_tr_b16 v[98:99], v204 offset:10240
  v_mfma_f32_16x16x32_bf16 v[128:131], v[68:71], v[236:239], v[128:131]
  v_mfma_f32_16x16x32_bf16 v[136:139], v[68:71], v[244:247], v[136:139]
  ds_read_b64_tr_b16 v[100:101], v204 offset:12288
  ds_read_b64_tr_b16 v[102:103], v204 offset:14336
  v_mfma_f32_16x16x32_bf16 v[136:139], v[64:67], v[232:235], v[136:139]
  v_mfma_f32_16x16x32_bf16 v[140:143], v[72:75], v[232:235], v[140:143]
  ds_read_b64_tr_b16 v[104:105], v205 offset:8192
  ds_read_b64_tr_b16 v[106:107], v205 offset:10240
  v_mfma_f32_16x16x32_bf16 v[140:143], v[76:79], v[244:247], v[140:143]
  buffer_load_dwordx4 a[180:183], v1, s[28:31], s100 offen offset:1024 sc1
  v_mfma_f32_16x16x32_bf16 v[132:135], v[76:79], v[236:239], v[132:135]
  ds_read_b64_tr_b16 v[108:109], v205 offset:12288
  ds_read_b64_tr_b16 v[110:111], v205 offset:14336
  v_mfma_f32_16x16x32_bf16 v[132:135], v[72:75], v[224:227], v[132:135]
  s_waitcnt lgkmcnt(8)
  v_mfma_f32_16x16x32_bf16 v[144:147], v[80:83], v[224:227], v[144:147]
  ds_read_b64_tr_b16 v[112:113], v206 offset:8192
  ds_read_b64_tr_b16 v[114:115], v206 offset:10240
  v_mfma_f32_16x16x32_bf16 v[144:147], v[84:87], v[236:239], v[144:147]
  buffer_load_dwordx4 v11, s[12:15], s97 offen offset:1024 lds
  v_mfma_f32_16x16x32_bf16 v[152:155], v[84:87], v[244:247], v[152:155]
  ds_read_b64_tr_b16 v[116:117], v206 offset:12288
  ds_read_b64_tr_b16 v[118:119], v206 offset:14336
  v_mfma_f32_16x16x32_bf16 v[152:155], v[80:83], v[232:235], v[152:155]
  v_mfma_f32_16x16x32_bf16 v[156:159], v[88:91], v[232:235], v[156:159]
  ds_read_b64_tr_b16 v[120:121], v207 offset:8192
  ds_read_b64_tr_b16 v[122:123], v207 offset:10240
  v_mfma_f32_16x16x32_bf16 v[156:159], v[92:95], v[244:247], v[156:159]
  buffer_load_dwordx4 a[184:187], v1, s[28:31], s100 offen offset:2048 sc1
  v_mfma_f32_16x16x32_bf16 v[148:151], v[92:95], v[236:239], v[148:151]
  ds_read_b64_tr_b16 v[124:125], v207 offset:12288
  ds_read_b64_tr_b16 v[126:127], v207 offset:14336
  v_mfma_f32_16x16x32_bf16 v[148:151], v[88:91], v[224:227], v[148:151]
  s_waitcnt lgkmcnt(8)
  v_mfma_f32_16x16x32_bf16 v[160:163], v[96:99], v[224:227], v[160:163]
  ds_read_b64_tr_b16 v[64:65], v204 offset:16384
  ds_read_b64_tr_b16 v[66:67], v204 offset:18432
  v_mfma_f32_16x16x32_bf16 v[160:163], v[100:103], v[236:239], v[160:163]
  v_mfma_f32_16x16x32_bf16 v[168:171], v[100:103], v[244:247], v[168:171]
  ds_read_b64_tr_b16 v[68:69], v204 offset:20480
  ds_read_b64_tr_b16 v[70:71], v204 offset:22528
  v_mfma_f32_16x16x32_bf16 v[168:171], v[96:99], v[232:235], v[168:171]
  buffer_load_dwordx4 v12, s[12:15], s97 offen offset:2048 lds
  v_mfma_f32_16x16x32_bf16 v[172:175], v[104:107], v[232:235], v[172:175]
  ds_read_b64_tr_b16 v[72:73], v205 offset:16384
  ds_read_b64_tr_b16 v[74:75], v205 offset:18432
  v_mfma_f32_16x16x32_bf16 v[172:175], v[108:111], v[244:247], v[172:175]
  buffer_load_dwordx4 a[188:191], v1, s[28:31], s100 offen offset:3072 sc1
  v_mfma_f32_16x16x32_bf16 v[164:167], v[108:111], v[236:239], v[164:167]
  ds_read_b64_tr_b16 v[76:77], v205 offset:20480
  ds_read_b64_tr_b16 v[78:79], v205 offset:22528
  v_mfma_f32_16x16x32_bf16 v[164:167], v[104:107], v[224:227], v[164:167]
  s_waitcnt lgkmcnt(8)
  v_mfma_f32_16x16x32_bf16 v[176:179], v[112:115], v[224:227], v[176:179]
  ds_read_b64_tr_b16 v[80:81], v206 offset:16384
  ds_read_b64_tr_b16 v[82:83], v206 offset:18432
  v_mfma_f32_16x16x32_bf16 v[176:179], v[116:119], v[236:239], v[176:179]
  v_mfma_f32_16x16x32_bf16 v[184:187], v[116:119], v[244:247], v[184:187]
  ds_read_b64_tr_b16 v[84:85], v206 offset:20480
  ds_read_b64_tr_b16 v[86:87], v206 offset:22528
  v_mfma_f32_16x16x32_bf16 v[184:187], v[112:115], v[232:235], v[184:187]
  v_mfma_f32_16x16x32_bf16 v[188:191], v[120:123], v[232:235], v[188:191]
  ds_read_b64_tr_b16 v[88:89], v207 offset:16384
  ds_read_b64_tr_b16 v[90:91], v207 offset:18432
  v_mfma_f32_16x16x32_bf16 v[188:191], v[124:127], v[244:247], v[188:191]
  buffer_load_dwordx4 v13, s[12:15], s97 offen offset:3072 lds
  v_mfma_f32_16x16x32_bf16 v[180:183], v[124:127], v[236:239], v[180:183]
  s_add_u32 s100, s58, 12288
  ds_read_b64_tr_b16 v[92:93], v207 offset:20480
  ds_read_b64_tr_b16 v[94:95], v207 offset:22528
  v_mfma_f32_16x16x32_bf16 v[180:183], v[120:123], v[224:227], v[180:183]
  s_waitcnt vmcnt(12) lgkmcnt(8)
  buffer_load_dwordx4 a[192:195], v1, s[28:31], s100 offen offset:0 sc1
  v_mfma_f32_16x16x32_bf16 v[128:131], v[64:67], a[144:147], v[128:131]
  ds_read_b64_tr_b16 v[96:97], v204 offset:24576
  ds_read_b64_tr_b16 v[98:99], v204 offset:26624
  v_mfma_f32_16x16x32_bf16 v[128:131], v[68:71], a[152:155], v[128:131]
  v_mfma_f32_16x16x32_bf16 v[136:139], v[68:71], a[156:159], v[136:139]
  ds_read_b64_tr_b16 v[100:101], v204 offset:28672
  ds_read_b64_tr_b16 v[102:103], v204 offset:30720
  v_mfma_f32_16x16x32_bf16 v[136:139], v[64:67], a[148:151], v[136:139]
  v_mfma_f32_16x16x32_bf16 v[140:143], v[72:75], a[148:151], v[140:143]
  ds_read_b64_tr_b16 v[104:105], v205 offset:24576
  ds_read_b64_tr_b16 v[106:107], v205 offset:26624
  v_mfma_f32_16x16x32_bf16 v[140:143], v[76:79], a[156:159], v[140:143]
  s_add_u32 m0, s61, 16384
  buffer_load_dwordx4 a[196:199], v1, s[28:31], s100 offen offset:1024 sc1
  v_mfma_f32_16x16x32_bf16 v[132:135], v[76:79], a[152:155], v[132:135]
  s_add_u32 s97, s60, 393216
  ds_read_b64_tr_b16 v[108:109], v205 offset:28672
  ds_read_b64_tr_b16 v[110:111], v205 offset:30720
  v_mfma_f32_16x16x32_bf16 v[132:135], v[72:75], a[144:147], v[132:135]
  s_waitcnt lgkmcnt(8)
  buffer_load_dwordx4 v10, s[12:15], s97 offen offset:0 lds
  v_mfma_f32_16x16x32_bf16 v[144:147], v[80:83], a[144:147], v[144:147]
  ds_read_b64_tr_b16 v[112:113], v206 offset:24576
  ds_read_b64_tr_b16 v[114:115], v206 offset:26624
  v_mfma_f32_16x16x32_bf16 v[144:147], v[84:87], a[152:155], v[144:147]
  v_mfma_f32_16x16x32_bf16 v[152:155], v[84:87], a[156:159], v[152:155]
  ds_read_b64_tr_b16 v[116:117], v206 offset:28672
  ds_read_b64_tr_b16 v[118:119], v206 offset:30720
  v_mfma_f32_16x16x32_bf16 v[152:155], v[80:83], a[148:151], v[152:155]
  v_mfma_f32_16x16x32_bf16 v[156:159], v[88:91], a[148:151], v[156:159]
  ds_read_b64_tr_b16 v[120:121], v207 offset:24576
  ds_read_b64_tr_b16 v[122:123], v207 offset:26624
  v_mfma_f32_16x16x32_bf16 v[156:159], v[92:95], a[156:159], v[156:159]
  s_barrier
  v_mfma_f32_16x16x32_bf16 v[148:151], v[92:95], a[152:155], v[148:151]
  ds_read_b64_tr_b16 v[124:125], v207 offset:28672
  ds_read_b64_tr_b16 v[126:127], v207 offset:30720
  v_mfma_f32_16x16x32_bf16 v[148:151], v[88:91], a[144:147], v[148:151]
  s_waitcnt lgkmcnt(8)
  buffer_load_dwordx4 a[200:203], v1, s[28:31], s100 offen offset:2048 sc1
  v_mfma_f32_16x16x32_bf16 v[160:163], v[96:99], a[144:147], v[160:163]
  ds_read_b64_tr_b16 v[64:65], v204 offset:32768
  ds_read_b64_tr_b16 v[66:67], v204 offset:34816
  v_mfma_f32_16x16x32_bf16 v[160:163], v[100:103], a[152:155], v[160:163]
  buffer_load_dwordx4 v11, s[12:15], s97 offen offset:1024 lds
  v_mfma_f32_16x16x32_bf16 v[168:171], v[100:103], a[156:159], v[168:171]
  ds_read_b64_tr_b16 v[68:69], v204 offset:36864
  ds_read_b64_tr_b16 v[70:71], v204 offset:38912
  v_mfma_f32_16x16x32_bf16 v[168:171], v[96:99], a[148:151], v[168:171]
  v_mfma_f32_16x16x32_bf16 v[172:175], v[104:107], a[148:151], v[172:175]
  ds_read_b64_tr_b16 v[72:73], v205 offset:32768
  ds_read_b64_tr_b16 v[74:75], v205 offset:34816
  v_mfma_f32_16x16x32_bf16 v[172:175], v[108:111], a[156:159], v[172:175]
  buffer_load_dwordx4 a[204:207], v1, s[28:31], s100 offen offset:3072 sc1
  v_mfma_f32_16x16x32_bf16 v[164:167], v[108:111], a[152:155], v[164:167]
  ds_read_b64_tr_b16 v[76:77], v205 offset:36864
  ds_read_b64_tr_b16 v[78:79], v205 offset:38912
  v_mfma_f32_16x16x32_bf16 v[164:167], v[104:107], a[144:147], v[164:167]
  s_waitcnt lgkmcnt(8)
  v_mfma_f32_16x16x32_bf16 v[176:179], v[112:115], a[144:147], v[176:179]
  ds_read_b64_tr_b16 v[80:81], v206 offset:32768
  ds_read_b64_tr_b16 v[82:83], v206 offset:34816
  v_mfma_f32_16x16x32_bf16 v[176:179], v[116:119], a[152:155], v[176:179]
  v_mfma_f32_16x16x32_bf16 v[184:187], v[116:119], a[156:159], v[184:187]
  ds_read_b64_tr_b16 v[84:85], v206 offset:36864
  ds_read_b64_tr_b16 v[86:87], v206 offset:38912
  v_mfma_f32_16x16x32_bf16 v[184:187], v[112:115], a[148:151], v[184:187]
  buffer_load_dwordx4 v12, s[12:15], s97 offen offset:2048 lds
  v_mfma_f32_16x16x32_bf16 v[188:191], v[120:123], a[148:151], v[188:191]
  ds_read_b64_tr_b16 v[88:89], v207 offset:32768
  ds_read_b64_tr_b16 v[90:91], v207 offset:34816
  v_mfma_f32_16x16x32_bf16 v[188:191], v[124:127], a[156:159], v[188:191]
  s_add_u32 s100, s58, 16384
  buffer_load_dwordx4 a[208:211], v1, s[28:31], s100 offen offset:0 sc1
  v_mfma_f32_16x16x32_bf16 v[180:183], v[124:127], a[152:155], v[180:183]
  ds_read_b64_tr_b16 v[92:93], v207 offset:36864
  ds_read_b64_tr_b16 v[94:95], v207 offset:38912
  v_mfma_f32_16x16x32_bf16 v[180:183], v[120:123], a[144:147], v[180:183]
  s_waitcnt vmcnt(16) lgkmcnt(8)
  v_mfma_f32_16x16x32_bf16 v[128:131], v[64:67], a[160:163], v[128:131]
  ds_read_b64_tr_b16 v[96:97], v204 offset:40960
  ds_read_b64_tr_b16 v[98:99], v204 offset:43008
  v_mfma_f32_16x16x32_bf16 v[128:131], v[68:71], a[168:171], v[128:131]
  v_mfma_f32_16x16x32_bf16 v[136:139], v[68:71], a[172:175], v[136:139]
  ds_read_b64_tr_b16 v[100:101], v204 offset:45056
  ds_read_b64_tr_b16 v[102:103], v204 offset:47104
  v_mfma_f32_16x16x32_bf16 v[136:139], v[64:67], a[164:167], v[136:139]
  v_mfma_f32_16x16x32_bf16 v[140:143], v[72:75], a[164:167], v[140:143]
  ds_read_b64_tr_b16 v[104:105], v205 offset:40960
  ds_read_b64_tr_b16 v[106:107], v205 offset:43008
  v_mfma_f32_16x16x32_bf16 v[140:143], v[76:79], a[172:175], v[140:143]
  buffer_load_dwordx4 v13, s[12:15], s97 offen offset:3072 lds
  v_mfma_f32_16x16x32_bf16 v[132:135], v[76:79], a[168:171], v[132:135]
  ds_read_b64_tr_b16 v[108:109], v205 offset:45056
  ds_read_b64_tr_b16 v[110:111], v205 offset:47104
  v_mfma_f32_16x16x32_bf16 v[132:135], v[72:75], a[160:163], v[132:135]
  s_waitcnt lgkmcnt(8)
  buffer_load_dwordx4 a[212:215], v1, s[28:31], s100 offen offset:1024 sc1
  v_mfma_f32_16x16x32_bf16 v[144:147], v[80:83], a[160:163], v[144:147]
  ds_read_b64_tr_b16 v[112:113], v206 offset:40960
  ds_read_b64_tr_b16 v[114:115], v206 offset:43008
  v_mfma_f32_16x16x32_bf16 v[144:147], v[84:87], a[168:171], v[144:147]
  v_mfma_f32_16x16x32_bf16 v[152:155], v[84:87], a[172:175], v[152:155]
  ds_read_b64_tr_b16 v[116:117], v206 offset:45056
  ds_read_b64_tr_b16 v[118:119], v206 offset:47104
  v_mfma_f32_16x16x32_bf16 v[152:155], v[80:83], a[164:167], v[152:155]
  v_mfma_f32_16x16x32_bf16 v[156:159], v[88:91], a[164:167], v[156:159]
  ds_read_b64_tr_b16 v[120:121], v207 offset:40960
  ds_read_b64_tr_b16 v[122:123], v207 offset:43008
  v_mfma_f32_16x16x32_bf16 v[156:159], v[92:95], a[172:175], v[156:159]
  s_add_u32 m0, s61, 32768
  buffer_load_dwordx4 a[216:219], v1, s[28:31], s100 offen offset:2048 sc1
  v_mfma_f32_16x16x32_bf16 v[148:151], v[92:95], a[168:171], v[148:151]
  s_add_u32 s97, s60, 458752
  ds_read_b64_tr_b16 v[124:125], v207 offset:45056
  ds_read_b64_tr_b16 v[126:127], v207 offset:47104
  v_mfma_f32_16x16x32_bf16 v[148:151], v[88:91], a[160:163], v[148:151]
  s_waitcnt lgkmcnt(8)
  buffer_load_dwordx4 v10, s[12:15], s97 offen offset:0 lds
  v_mfma_f32_16x16x32_bf16 v[160:163], v[96:99], a[160:163], v[160:163]
  ds_read_b64_tr_b16 v[64:65], v204 offset:49152
  ds_read_b64_tr_b16 v[66:67], v204 offset:51200
  v_mfma_f32_16x16x32_bf16 v[160:163], v[100:103], a[168:171], v[160:163]
  v_mfma_f32_16x16x32_bf16 v[168:171], v[100:103], a[172:175], v[168:171]
  ds_read_b64_tr_b16 v[68:69], v204 offset:53248
  ds_read_b64_tr_b16 v[70:71], v204 offset:55296
  v_mfma_f32_16x16x32_bf16 v[168:171], v[96:99], a[164:167], v[168:171]
  v_mfma_f32_16x16x32_bf16 v[172:175], v[104:107], a[164:167], v[172:175]
  ds_read_b64_tr_b16 v[72:73], v205 offset:49152
  ds_read_b64_tr_b16 v[74:75], v205 offset:51200
  v_mfma_f32_16x16x32_bf16 v[172:175], v[108:111], a[172:175], v[172:175]
  buffer_load_dwordx4 a[220:223], v1, s[28:31], s100 offen offset:3072 sc1
  v_mfma_f32_16x16x32_bf16 v[164:167], v[108:111], a[168:171], v[164:167]
  ds_read_b64_tr_b16 v[76:77], v205 offset:53248
  ds_read_b64_tr_b16 v[78:79], v205 offset:55296
  v_mfma_f32_16x16x32_bf16 v[164:167], v[104:107], a[160:163], v[164:167]
  s_waitcnt lgkmcnt(8)
  v_mfma_f32_16x16x32_bf16 v[176:179], v[112:115], a[160:163], v[176:179]
  ds_read_b64_tr_b16 v[80:81], v206 offset:49152
  ds_read_b64_tr_b16 v[82:83], v206 offset:51200
  v_mfma_f32_16x16x32_bf16 v[176:179], v[116:119], a[168:171], v[176:179]
  buffer_load_dwordx4 v11, s[12:15], s97 offen offset:1024 lds
  v_mfma_f32_16x16x32_bf16 v[184:187], v[116:119], a[172:175], v[184:187]
  ds_read_b64_tr_b16 v[84:85], v206 offset:53248
  ds_read_b64_tr_b16 v[86:87], v206 offset:55296
  v_mfma_f32_16x16x32_bf16 v[184:187], v[112:115], a[164:167], v[184:187]
  v_mfma_f32_16x16x32_bf16 v[188:191], v[120:123], a[164:167], v[188:191]
  ds_read_b64_tr_b16 v[88:89], v207 offset:49152
  ds_read_b64_tr_b16 v[90:91], v207 offset:51200
  v_mfma_f32_16x16x32_bf16 v[188:191], v[124:127], a[172:175], v[188:191]
  s_add_u32 s100, s58, 20480
  buffer_load_dwordx4 a[224:227], v1, s[28:31], s100 offen offset:0 sc1
  v_mfma_f32_16x16x32_bf16 v[180:183], v[124:127], a[168:171], v[180:183]
  ds_read_b64_tr_b16 v[92:93], v207 offset:53248
  ds_read_b64_tr_b16 v[94:95], v207 offset:55296
  v_mfma_f32_16x16x32_bf16 v[180:183], v[120:123], a[160:163], v[180:183]
  s_waitcnt vmcnt(16) lgkmcnt(8)
  v_mfma_f32_16x16x32_bf16 v[128:131], v[64:67], a[176:179], v[128:131]
  ds_read_b64_tr_b16 v[96:97], v204 offset:57344
  ds_read_b64_tr_b16 v[98:99], v204 offset:59392
  v_mfma_f32_16x16x32_bf16 v[128:131], v[68:71], a[184:187], v[128:131]
  v_mfma_f32_16x16x32_bf16 v[136:139], v[68:71], a[188:191], v[136:139]
  ds_read_b64_tr_b16 v[100:101], v204 offset:61440
  ds_read_b64_tr_b16 v[102:103], v204 offset:63488
  v_mfma_f32_16x16x32_bf16 v[136:139], v[64:67], a[180:183], v[136:139]
  buffer_load_dwordx4 v12, s[12:15], s97 offen offset:2048 lds
  v_mfma_f32_16x16x32_bf16 v[140:143], v[72:75], a[180:183], v[140:143]
  ds_read_b64_tr_b16 v[104:105], v205 offset:57344
  ds_read_b64_tr_b16 v[106:107], v205 offset:59392
  v_mfma_f32_16x16x32_bf16 v[140:143], v[76:79], a[188:191], v[140:143]
  buffer_load_dwordx4 a[228:231], v1, s[28:31], s100 offen offset:1024 sc1
  v_mfma_f32_16x16x32_bf16 v[132:135], v[76:79], a[184:187], v[132:135]
  ds_read_b64_tr_b16 v[108:109], v205 offset:61440
  ds_read_b64_tr_b16 v[110:111], v205 offset:63488
  v_mfma_f32_16x16x32_bf16 v[132:135], v[72:75], a[176:179], v[132:135]
  s_waitcnt lgkmcnt(8)
  v_mfma_f32_16x16x32_bf16 v[144:147], v[80:83], a[176:179], v[144:147]
  ds_read_b64_tr_b16 v[112:113], v206 offset:57344
  ds_read_b64_tr_b16 v[114:115], v206 offset:59392
  v_mfma_f32_16x16x32_bf16 v[144:147], v[84:87], a[184:187], v[144:147]
  v_mfma_f32_16x16x32_bf16 v[152:155], v[84:87], a[188:191], v[152:155]
  ds_read_b64_tr_b16 v[116:117], v206 offset:61440
  ds_read_b64_tr_b16 v[118:119], v206 offset:63488
  v_mfma_f32_16x16x32_bf16 v[152:155], v[80:83], a[180:183], v[152:155]
  v_mfma_f32_16x16x32_bf16 v[156:159], v[88:91], a[180:183], v[156:159]
  ds_read_b64_tr_b16 v[120:121], v207 offset:57344
  ds_read_b64_tr_b16 v[122:123], v207 offset:59392
  v_mfma_f32_16x16x32_bf16 v[156:159], v[92:95], a[188:191], v[156:159]
  s_barrier
  v_mfma_f32_16x16x32_bf16 v[148:151], v[92:95], a[184:187], v[148:151]
  ds_read_b64_tr_b16 v[124:125], v207 offset:61440
  ds_read_b64_tr_b16 v[126:127], v207 offset:63488
  v_mfma_f32_16x16x32_bf16 v[148:151], v[88:91], a[176:179], v[148:151]
  s_waitcnt lgkmcnt(8)
  buffer_load_dwordx4 v13, s[12:15], s97 offen offset:3072 lds
  v_mfma_f32_16x16x32_bf16 v[160:163], v[96:99], a[176:179], v[160:163]
  ds_read_b64_tr_b16 v[64:65], v208 offset:0
  ds_read_b64_tr_b16 v[66:67], v208 offset:2048
  v_mfma_f32_16x16x32_bf16 v[160:163], v[100:103], a[184:187], v[160:163]
  buffer_load_dwordx4 a[232:235], v1, s[28:31], s100 offen offset:2048 sc1
  v_mfma_f32_16x16x32_bf16 v[168:171], v[100:103], a[188:191], v[168:171]
  ds_read_b64_tr_b16 v[68:69], v208 offset:4096
  ds_read_b64_tr_b16 v[70:71], v208 offset:6144
  v_mfma_f32_16x16x32_bf16 v[168:171], v[96:99], a[180:183], v[168:171]
  v_mfma_f32_16x16x32_bf16 v[172:175], v[104:107], a[180:183], v[172:175]
  ds_read_b64_tr_b16 v[72:73], v209 offset:0
  ds_read_b64_tr_b16 v[74:75], v209 offset:2048
  v_mfma_f32_16x16x32_bf16 v[172:175], v[108:111], a[188:191], v[172:175]
  s_add_u32 m0, s61, 49152
  buffer_load_dwordx4 a[236:239], v1, s[28:31], s100 offen offset:3072 sc1
  v_mfma_f32_16x16x32_bf16 v[164:167], v[108:111], a[184:187], v[164:167]
  s_add_u32 s97, s60, 524288
  ds_read_b64_tr_b16 v[76:77], v209 offset:4096
  ds_read_b64_tr_b16 v[78:79], v209 offset:6144
  v_mfma_f32_16x16x32_bf16 v[164:167], v[104:107], a[176:179], v[164:167]
  s_waitcnt lgkmcnt(8)
  buffer_load_dwordx4 v10, s[12:15], s97 offen offset:0 lds
  v_mfma_f32_16x16x32_bf16 v[176:179], v[112:115], a[176:179], v[176:179]
  ds_read_b64_tr_b16 v[80:81], v210 offset:0
  ds_read_b64_tr_b16 v[82:83], v210 offset:2048
  v_mfma_f32_16x16x32_bf16 v[176:179], v[116:119], a[184:187], v[176:179]
  v_mfma_f32_16x16x32_bf16 v[184:187], v[116:119], a[188:191], v[184:187]
  ds_read_b64_tr_b16 v[84:85], v210 offset:4096
  ds_read_b64_tr_b16 v[86:87], v210 offset:6144
  v_mfma_f32_16x16x32_bf16 v[184:187], v[112:115], a[180:183], v[184:187]
  v_mfma_f32_16x16x32_bf16 v[188:191], v[120:123], a[180:183], v[188:191]
  ds_read_b64_tr_b16 v[88:89], v211 offset:0
  ds_read_b64_tr_b16 v[90:91], v211 offset:2048
  v_mfma_f32_16x16x32_bf16 v[188:191], v[124:127], a[188:191], v[188:191]
  s_add_u32 s100, s58, 24576
  buffer_load_dwordx4 a[240:243], v1, s[28:31], s100 offen offset:0 sc1
  v_mfma_f32_16x16x32_bf16 v[180:183], v[124:127], a[184:187], v[180:183]
  ds_read_b64_tr_b16 v[92:93], v211 offset:4096
  ds_read_b64_tr_b16 v[94:95], v211 offset:6144
  v_mfma_f32_16x16x32_bf16 v[180:183], v[120:123], a[176:179], v[180:183]
  s_waitcnt vmcnt(16) lgkmcnt(8)
  v_mfma_f32_16x16x32_bf16 v[128:131], v[64:67], a[192:195], v[128:131]
  ds_read_b64_tr_b16 v[96:97], v208 offset:8192
  ds_read_b64_tr_b16 v[98:99], v208 offset:10240
  v_mfma_f32_16x16x32_bf16 v[128:131], v[68:71], a[200:203], v[128:131]
  buffer_load_dwordx4 v11, s[12:15], s97 offen offset:1024 lds
  v_mfma_f32_16x16x32_bf16 v[136:139], v[68:71], a[204:207], v[136:139]
  ds_read_b64_tr_b16 v[100:101], v208 offset:12288
  ds_read_b64_tr_b16 v[102:103], v208 offset:14336
  v_mfma_f32_16x16x32_bf16 v[136:139], v[64:67], a[196:199], v[136:139]
  v_mfma_f32_16x16x32_bf16 v[140:143], v[72:75], a[196:199], v[140:143]
  ds_read_b64_tr_b16 v[104:105], v209 offset:8192
  ds_read_b64_tr_b16 v[106:107], v209 offset:10240
  v_mfma_f32_16x16x32_bf16 v[140:143], v[76:79], a[204:207], v[140:143]
  buffer_load_dwordx4 a[244:247], v1, s[28:31], s100 offen offset:1024 sc1
  v_mfma_f32_16x16x32_bf16 v[132:135], v[76:79], a[200:203], v[132:135]
  ds_read_b64_tr_b16 v[108:109], v209 offset:12288
  ds_read_b64_tr_b16 v[110:111], v209 offset:14336
  v_mfma_f32_16x16x32_bf16 v[132:135], v[72:75], a[192:195], v[132:135]
  s_waitcnt lgkmcnt(8)
  v_mfma_f32_16x16x32_bf16 v[144:147], v[80:83], a[192:195], v[144:147]
  ds_read_b64_tr_b16 v[112:113], v210 offset:8192
  ds_read_b64_tr_b16 v[114:115], v210 offset:10240
  v_mfma_f32_16x16x32_bf16 v[144:147], v[84:87], a[200:203], v[144:147]
  v_mfma_f32_16x16x32_bf16 v[152:155], v[84:87], a[204:207], v[152:155]
  ds_read_b64_tr_b16 v[116:117], v210 offset:12288
  ds_read_b64_tr_b16 v[118:119], v210 offset:14336
  v_mfma_f32_16x16x32_bf16 v[152:155], v[80:83], a[196:199], v[152:155]
  buffer_load_dwordx4 v12, s[12:15], s97 offen offset:2048 lds
  v_mfma_f32_16x16x32_bf16 v[156:159], v[88:91], a[196:199], v[156:159]
  ds_read_b64_tr_b16 v[120:121], v211 offset:8192
  ds_read_b64_tr_b16 v[122:123], v211 offset:10240
  v_mfma_f32_16x16x32_bf16 v[156:159], v[92:95], a[204:207], v[156:159]
  buffer_load_dwordx4 a[248:251], v1, s[28:31], s100 offen offset:2048 sc1
  v_mfma_f32_16x16x32_bf16 v[148:151], v[92:95], a[200:203], v[148:151]
  ds_read_b64_tr_b16 v[124:125], v211 offset:12288
  ds_read_b64_tr_b16 v[126:127], v211 offset:14336
  v_mfma_f32_16x16x32_bf16 v[148:151], v[88:91], a[192:195], v[148:151]
  s_waitcnt lgkmcnt(8)
  v_mfma_f32_16x16x32_bf16 v[160:163], v[96:99], a[192:195], v[160:163]
  ds_read_b64_tr_b16 v[64:65], v208 offset:16384
  ds_read_b64_tr_b16 v[66:67], v208 offset:18432
  v_mfma_f32_16x16x32_bf16 v[160:163], v[100:103], a[200:203], v[160:163]
  v_mfma_f32_16x16x32_bf16 v[168:171], v[100:103], a[204:207], v[168:171]
  ds_read_b64_tr_b16 v[68:69], v208 offset:20480
  ds_read_b64_tr_b16 v[70:71], v208 offset:22528
  v_mfma_f32_16x16x32_bf16 v[168:171], v[96:99], a[196:199], v[168:171]
  v_mfma_f32_16x16x32_bf16 v[172:175], v[104:107], a[196:199], v[172:175]
  ds_read_b64_tr_b16 v[72:73], v209 offset:16384
  ds_read_b64_tr_b16 v[74:75], v209 offset:18432
  v_mfma_f32_16x16x32_bf16 v[172:175], v[108:111], a[204:207], v[172:175]
  buffer_load_dwordx4 v13, s[12:15], s97 offen offset:3072 lds
  v_mfma_f32_16x16x32_bf16 v[164:167], v[108:111], a[200:203], v[164:167]
  ds_read_b64_tr_b16 v[76:77], v209 offset:20480
  ds_read_b64_tr_b16 v[78:79], v209 offset:22528
  v_mfma_f32_16x16x32_bf16 v[164:167], v[104:107], a[192:195], v[164:167]
  s_waitcnt lgkmcnt(8)
  buffer_load_dwordx4 a[252:255], v1, s[28:31], s100 offen offset:3072 sc1
  v_mfma_f32_16x16x32_bf16 v[176:179], v[112:115], a[192:195], v[176:179]
  ds_read_b64_tr_b16 v[80:81], v210 offset:16384
  ds_read_b64_tr_b16 v[82:83], v210 offset:18432
  v_mfma_f32_16x16x32_bf16 v[176:179], v[116:119], a[200:203], v[176:179]
  v_mfma_f32_16x16x32_bf16 v[184:187], v[116:119], a[204:207], v[184:187]
  ds_read_b64_tr_b16 v[84:85], v210 offset:20480
  ds_read_b64_tr_b16 v[86:87], v210 offset:22528
  v_mfma_f32_16x16x32_bf16 v[184:187], v[112:115], a[196:199], v[184:187]
  v_mfma_f32_16x16x32_bf16 v[188:191], v[120:123], a[196:199], v[188:191]
  s_add_u32 s100, s58, 28672
  ds_read_b64_tr_b16 v[88:89], v211 offset:16384
  ds_read_b64_tr_b16 v[90:91], v211 offset:18432
  v_mfma_f32_16x16x32_bf16 v[188:191], v[124:127], a[204:207], v[188:191]
  s_add_u32 m0, s62, 0
  buffer_load_dwordx4 a[128:131], v1, s[28:31], s100 offen offset:0 sc1
  v_mfma_f32_16x16x32_bf16 v[180:183], v[124:127], a[200:203], v[180:183]
  s_add_u32 s97, s60, 589824
  ds_read_b64_tr_b16 v[92:93], v211 offset:20480
  ds_read_b64_tr_b16 v[94:95], v211 offset:22528
  v_mfma_f32_16x16x32_bf16 v[180:183], v[120:123], a[192:195], v[180:183]
  s_waitcnt vmcnt(16) lgkmcnt(8)
  buffer_load_dwordx4 v10, s[12:15], s97 offen offset:0 lds
  v_mfma_f32_16x16x32_bf16 v[128:131], v[64:67], a[208:211], v[128:131]
  ds_read_b64_tr_b16 v[96:97], v208 offset:24576
  ds_read_b64_tr_b16 v[98:99], v208 offset:26624
  v_mfma_f32_16x16x32_bf16 v[128:131], v[68:71], a[216:219], v[128:131]
  v_mfma_f32_16x16x32_bf16 v[136:139], v[68:71], a[220:223], v[136:139]
  ds_read_b64_tr_b16 v[100:101], v208 offset:28672
  ds_read_b64_tr_b16 v[102:103], v208 offset:30720
  v_mfma_f32_16x16x32_bf16 v[136:139], v[64:67], a[212:215], v[136:139]
  v_mfma_f32_16x16x32_bf16 v[140:143], v[72:75], a[212:215], v[140:143]
  ds_read_b64_tr_b16 v[104:105], v209 offset:24576
  ds_read_b64_tr_b16 v[106:107], v209 offset:26624
  v_mfma_f32_16x16x32_bf16 v[140:143], v[76:79], a[220:223], v[140:143]
  buffer_load_dwordx4 a[132:135], v1, s[28:31], s100 offen offset:1024 sc1
  v_mfma_f32_16x16x32_bf16 v[132:135], v[76:79], a[216:219], v[132:135]
  ds_read_b64_tr_b16 v[108:109], v209 offset:28672
  ds_read_b64_tr_b16 v[110:111], v209 offset:30720
  v_mfma_f32_16x16x32_bf16 v[132:135], v[72:75], a[208:211], v[132:135]
  s_waitcnt lgkmcnt(8)
  v_mfma_f32_16x16x32_bf16 v[144:147], v[80:83], a[208:211], v[144:147]
  ds_read_b64_tr_b16 v[112:113], v210 offset:24576
  ds_read_b64_tr_b16 v[114:115], v210 offset:26624
  v_mfma_f32_16x16x32_bf16 v[144:147], v[84:87], a[216:219], v[144:147]
  buffer_load_dwordx4 v11, s[12:15], s97 offen offset:1024 lds
  v_mfma_f32_16x16x32_bf16 v[152:155], v[84:87], a[220:223], v[152:155]
  ds_read_b64_tr_b16 v[116:117], v210 offset:28672
  ds_read_b64_tr_b16 v[118:119], v210 offset:30720
  v_mfma_f32_16x16x32_bf16 v[152:155], v[80:83], a[212:215], v[152:155]
  v_mfma_f32_16x16x32_bf16 v[156:159], v[88:91], a[212:215], v[156:159]
  ds_read_b64_tr_b16 v[120:121], v211 offset:24576
  ds_read_b64_tr_b16 v[122:123], v211 offset:26624
  v_mfma_f32_16x16x32_bf16 v[156:159], v[92:95], a[220:223], v[156:159]
  s_barrier
  v_mfma_f32_16x16x32_bf16 v[148:151], v[92:95], a[216:219], v[148:151]
  ds_read_b64_tr_b16 v[124:125], v211 offset:28672
  ds_read_b64_tr_b16 v[126:127], v211 offset:30720
  v_mfma_f32_16x16x32_bf16 v[148:151], v[88:91], a[208:211], v[148:151]
  s_waitcnt lgkmcnt(8)
  buffer_load_dwordx4 a[136:139], v1, s[28:31], s100 offen offset:2048 sc1
  v_mfma_f32_16x16x32_bf16 v[160:163], v[96:99], a[208:211], v[160:163]
  ds_read_b64_tr_b16 v[64:65], v200 offset:0
  ds_read_b64_tr_b16 v[66:67], v200 offset:2048
  v_mfma_f32_16x16x32_bf16 v[160:163], v[100:103], a[216:219], v[160:163]
  v_mfma_f32_16x16x32_bf16 v[168:171], v[100:103], a[220:223], v[168:171]
  ds_read_b64_tr_b16 v[68:69], v200 offset:4096
  ds_read_b64_tr_b16 v[70:71], v200 offset:6144
  v_mfma_f32_16x16x32_bf16 v[168:171], v[96:99], a[212:215], v[168:171]
  buffer_load_dwordx4 v12, s[12:15], s97 offen offset:2048 lds
  v_mfma_f32_16x16x32_bf16 v[172:175], v[104:107], a[212:215], v[172:175]
  ds_read_b64_tr_b16 v[72:73], v201 offset:0
  ds_read_b64_tr_b16 v[74:75], v201 offset:2048
  v_mfma_f32_16x16x32_bf16 v[172:175], v[108:111], a[220:223], v[172:175]
  buffer_load_dwordx4 a[140:143], v1, s[28:31], s100 offen offset:3072 sc1
  v_mfma_f32_16x16x32_bf16 v[164:167], v[108:111], a[216:219], v[164:167]
  ds_read_b64_tr_b16 v[76:77], v201 offset:4096
  ds_read_b64_tr_b16 v[78:79], v201 offset:6144
  v_mfma_f32_16x16x32_bf16 v[164:167], v[104:107], a[208:211], v[164:167]
  s_waitcnt lgkmcnt(8)
  v_mfma_f32_16x16x32_bf16 v[176:179], v[112:115], a[208:211], v[176:179]
  ds_read_b64_tr_b16 v[80:81], v202 offset:0
  ds_read_b64_tr_b16 v[82:83], v202 offset:2048
  v_mfma_f32_16x16x32_bf16 v[176:179], v[116:119], a[216:219], v[176:179]
  v_mfma_f32_16x16x32_bf16 v[184:187], v[116:119], a[220:223], v[184:187]
  ds_read_b64_tr_b16 v[84:85], v202 offset:4096
  ds_read_b64_tr_b16 v[86:87], v202 offset:6144
  v_mfma_f32_16x16x32_bf16 v[184:187], v[112:115], a[212:215], v[184:187]
  v_mfma_f32_16x16x32_bf16 v[188:191], v[120:123], a[212:215], v[188:191]
  ds_read_b64_tr_b16 v[88:89], v203 offset:0
  ds_read_b64_tr_b16 v[90:91], v203 offset:2048
  v_mfma_f32_16x16x32_bf16 v[188:191], v[124:127], a[220:223], v[188:191]
  buffer_load_dwordx4 v13, s[12:15], s97 offen offset:3072 lds
  v_mfma_f32_16x16x32_bf16 v[180:183], v[124:127], a[216:219], v[180:183]
  s_add_u32 s100, s58, 32768
  ds_read_b64_tr_b16 v[92:93], v203 offset:4096
  ds_read_b64_tr_b16 v[94:95], v203 offset:6144
  v_mfma_f32_16x16x32_bf16 v[180:183], v[120:123], a[208:211], v[180:183]
  s_waitcnt vmcnt(16) lgkmcnt(8)
  buffer_load_dwordx4 a[144:147], v1, s[28:31], s100 offen offset:0 sc1
  v_mfma_f32_16x16x32_bf16 v[128:131], v[64:67], a[224:227], v[128:131]
  ds_read_b64_tr_b16 v[96:97], v200 offset:8192
  ds_read_b64_tr_b16 v[98:99], v200 offset:10240
  v_mfma_f32_16x16x32_bf16 v[128:131], v[68:71], a[232:235], v[128:131]
  v_mfma_f32_16x16x32_bf16 v[136:139], v[68:71], a[236:239], v[136:139]
  ds_read_b64_tr_b16 v[100:101], v200 offset:12288
  ds_read_b64_tr_b16 v[102:103], v200 offset:14336
  v_mfma_f32_16x16x32_bf16 v[136:139], v[64:67], a[228:231], v[136:139]
  v_mfma_f32_16x16x32_bf16 v[140:143], v[72:75], a[228:231], v[140:143]
  ds_read_b64_tr_b16 v[104:105], v201 offset:8192
  ds_read_b64_tr_b16 v[106:107], v201 offset:10240
  v_mfma_f32_16x16x32_bf16 v[140:143], v[76:79], a[236:239], v[140:143]
  s_add_u32 m0, s62, 16384
  buffer_load_dwordx4 a[148:151], v1, s[28:31], s100 offen offset:1024 sc1
  v_mfma_f32_16x16x32_bf16 v[132:135], v[76:79], a[232:235], v[132:135]
  s_add_u32 s97, s60, 655360
  ds_read_b64_tr_b16 v[108:109], v201 offset:12288
  ds_read_b64_tr_b16 v[110:111], v201 offset:14336
  v_mfma_f32_16x16x32_bf16 v[132:135], v[72:75], a[224:227], v[132:135]
  s_waitcnt lgkmcnt(8)
  buffer_load_dwordx4 v10, s[12:15], s97 offen offset:0 lds
  v_mfma_f32_16x16x32_bf16 v[144:147], v[80:83], a[224:227], v[144:147]
  ds_read_b64_tr_b16 v[112:113], v202 offset:8192
  ds_read_b64_tr_b16 v[114:115], v202 offset:10240
  v_mfma_f32_16x16x32_bf16 v[144:147], v[84:87], a[232:235], v[144:147]
  v_mfma_f32_16x16x32_bf16 v[152:155], v[84:87], a[236:239], v[152:155]
  ds_read_b64_tr_b16 v[116:117], v202 offset:12288
  ds_read_b64_tr_b16 v[118:119], v202 offset:14336
  v_mfma_f32_16x16x32_bf16 v[152:155], v[80:83], a[228:231], v[152:155]
  v_mfma_f32_16x16x32_bf16 v[156:159], v[88:91], a[228:231], v[156:159]
  ds_read_b64_tr_b16 v[120:121], v203 offset:8192
  ds_read_b64_tr_b16 v[122:123], v203 offset:10240
  v_mfma_f32_16x16x32_bf16 v[156:159], v[92:95], a[236:239], v[156:159]
  buffer_load_dwordx4 a[152:155], v1, s[28:31], s100 offen offset:2048 sc1
  v_mfma_f32_16x16x32_bf16 v[148:151], v[92:95], a[232:235], v[148:151]
  ds_read_b64_tr_b16 v[124:125], v203 offset:12288
  ds_read_b64_tr_b16 v[126:127], v203 offset:14336
  v_mfma_f32_16x16x32_bf16 v[148:151], v[88:91], a[224:227], v[148:151]
  s_waitcnt lgkmcnt(8)
  v_mfma_f32_16x16x32_bf16 v[160:163], v[96:99], a[224:227], v[160:163]
  ds_read_b64_tr_b16 v[64:65], v200 offset:16384
  ds_read_b64_tr_b16 v[66:67], v200 offset:18432
  v_mfma_f32_16x16x32_bf16 v[160:163], v[100:103], a[232:235], v[160:163]
  buffer_load_dwordx4 v11, s[12:15], s97 offen offset:1024 lds
  v_mfma_f32_16x16x32_bf16 v[168:171], v[100:103], a[236:239], v[168:171]
  ds_read_b64_tr_b16 v[68:69], v200 offset:20480
  ds_read_b64_tr_b16 v[70:71], v200 offset:22528
  v_mfma_f32_16x16x32_bf16 v[168:171], v[96:99], a[228:231], v[168:171]
L_pad13:
  s_cbranch_execz L_pad17
  v_mfma_f32_16x16x32_bf16 v[172:175], v[104:107], a[228:231], v[172:175]
  ds_read_b64_tr_b16 v[72:73], v201 offset:16384
  ds_read_b64_tr_b16 v[74:75], v201 offset:18432
  v_mfma_f32_16x16x32_bf16 v[172:175], v[108:111], a[236:239], v[172:175]
  buffer_load_dwordx4 a[156:159], v1, s[28:31], s100 offen offset:3072 sc1
  v_mfma_f32_16x16x32_bf16 v[164:167], v[108:111], a[232:235], v[164:167]
  ds_read_b64_tr_b16 v[76:77], v201 offset:20480
  ds_read_b64_tr_b16 v[78:79], v201 offset:22528
  v_mfma_f32_16x16x32_bf16 v[164:167], v[104:107], a[224:227], v[164:167]
  s_waitcnt lgkmcnt(8)
  v_mfma_f32_16x16x32_bf16 v[176:179], v[112:115], a[224:227], v[176:179]
  ds_read_b64_tr_b16 v[80:81], v202 offset:16384
  ds_read_b64_tr_b16 v[82:83], v202 offset:18432
  v_mfma_f32_16x16x32_bf16 v[176:179], v[116:119], a[232:235], v[176:179]
  v_mfma_f32_16x16x32_bf16 v[184:187], v[116:119], a[236:239], v[184:187]
  ds_read_b64_tr_b16 v[84:85], v202 offset:20480
  ds_read_b64_tr_b16 v[86:87], v202 offset:22528
  v_mfma_f32_16x16x32_bf16 v[184:187], v[112:115], a[228:231], v[184:187]
  buffer_load_dwordx4 v12, s[12:15], s97 offen offset:2048 lds
  v_mfma_f32_16x16x32_bf16 v[188:191], v[120:123], a[228:231], v[188:191]
  ds_read_b64_tr_b16 v[88:89], v203 offset:16384
  ds_read_b64_tr_b16 v[90:91], v203 offset:18432
  v_mfma_f32_16x16x32_bf16 v[188:191], v[124:127], a[236:239], v[188:191]
  s_add_u32 s100, s58, 36864
  buffer_load_dwordx4 a[160:163], v1, s[28:31], s100 offen offset:0 sc1
  v_mfma_f32_16x16x32_bf16 v[180:183], v[124:127], a[232:235], v[180:183]
  ds_read_b64_tr_b16 v[92:93], v203 offset:20480
  ds_read_b64_tr_b16 v[94:95], v203 offset:22528
  v_mfma_f32_16x16x32_bf16 v[180:183], v[120:123], a[224:227], v[180:183]
  s_waitcnt vmcnt(16) lgkmcnt(8)
  v_mfma_f32_16x16x32_bf16 v[128:131], v[64:67], a[240:243], v[128:131]
  ds_read_b64_tr_b16 v[96:97], v200 offset:24576
  ds_read_b64_tr_b16 v[98:99], v200 offset:26624
  v_mfma_f32_16x16x32_bf16 v[128:131], v[68:71], a[248:251], v[128:131]
  v_mfma_f32_16x16x32_bf16 v[136:139], v[68:71], a[252:255], v[136:139]
  ds_read_b64_tr_b16 v[100:101], v200 offset:28672
  ds_read_b64_tr_b16 v[102:103], v200 offset:30720
  v_mfma_f32_16x16x32_bf16 v[136:139], v[64:67], a[244:247], v[136:139]
  v_mfma_f32_16x16x32_bf16 v[140:143], v[72:75], a[244:247], v[140:143]
  ds_read_b64_tr_b16 v[104:105], v201 offset:24576
  ds_read_b64_tr_b16 v[106:107], v201 offset:26624
  v_mfma_f32_16x16x32_bf16 v[140:143], v[76:79], a[252:255], v[140:143]
  buffer_load_dwordx4 v13, s[12:15], s97 offen offset:3072 lds
  v_mfma_f32_16x16x32_bf16 v[132:135], v[76:79], a[248:251], v[132:135]
  ds_read_b64_tr_b16 v[108:109], v201 offset:28672
  ds_read_b64_tr_b16 v[110:111], v201 offset:30720
  v_mfma_f32_16x16x32_bf16 v[132:135], v[72:75], a[240:243], v[132:135]
  s_waitcnt lgkmcnt(8)
  buffer_load_dwordx4 a[164:167], v1, s[28:31], s100 offen offset:1024 sc1
  v_mfma_f32_16x16x32_bf16 v[144:147], v[80:83], a[240:243], v[144:147]
  ds_read_b64_tr_b16 v[112:113], v202 offset:24576
  ds_read_b64_tr_b16 v[114:115], v202 offset:26624
  v_mfma_f32_16x16x32_bf16 v[144:147], v[84:87], a[248:251], v[144:147]
  v_mfma_f32_16x16x32_bf16 v[152:155], v[84:87], a[252:255], v[152:155]
  ds_read_b64_tr_b16 v[116:117], v202 offset:28672
  ds_read_b64_tr_b16 v[118:119], v202 offset:30720
  v_mfma_f32_16x16x32_bf16 v[152:155], v[80:83], a[244:247], v[152:155]
  s_add_u32 m0, s62, 32768
  v_mfma_f32_16x16x32_bf16 v[156:159], v[88:91], a[244:247], v[156:159]
  ds_read_b64_tr_b16 v[120:121], v203 offset:24576
  ds_read_b64_tr_b16 v[122:123], v203 offset:26624
  v_mfma_f32_16x16x32_bf16 v[156:159], v[92:95], a[252:255], v[156:159]
  s_barrier
  v_mfma_f32_16x16x32_bf16 v[148:151], v[92:95], a[248:251], v[148:151]
  s_add_u32 s97, s60, 720896
  ds_read_b64_tr_b16 v[124:125], v203 offset:28672
  ds_read_b64_tr_b16 v[126:127], v203 offset:30720
  v_mfma_f32_16x16x32_bf16 v[148:151], v[88:91], a[240:243], v[148:151]
  s_waitcnt lgkmcnt(8)
  buffer_load_dwordx4 v10, s[12:15], s97 offen offset:0 lds
  v_mfma_f32_16x16x32_bf16 v[160:163], v[96:99], a[240:243], v[160:163]
  ds_read_b64_tr_b16 v[64:65], v200 offset:32768
  ds_read_b64_tr_b16 v[66:67], v200 offset:34816
  v_mfma_f32_16x16x32_bf16 v[160:163], v[100:103], a[248:251], v[160:163]
  buffer_load_dwordx4 a[168:171], v1, s[28:31], s100 offen offset:2048 sc1
  v_mfma_f32_16x16x32_bf16 v[168:171], v[100:103], a[252:255], v[168:171]
  ds_read_b64_tr_b16 v[68:69], v200 offset:36864
  ds_read_b64_tr_b16 v[70:71], v200 offset:38912
  v_mfma_f32_16x16x32_bf16 v[168:171], v[96:99], a[244:247], v[168:171]
  v_mfma_f32_16x16x32_bf16 v[172:175], v[104:107], a[244:247], v[172:175]
  ds_read_b64_tr_b16 v[72:73], v201 offset:32768
  ds_read_b64_tr_b16 v[74:75], v201 offset:34816
  v_mfma_f32_16x16x32_bf16 v[172:175], v[108:111], a[252:255], v[172:175]
  buffer_load_dwordx4 a[172:175], v1, s[28:31], s100 offen offset:3072 sc1
  v_mfma_f32_16x16x32_bf16 v[164:167], v[108:111], a[248:251], v[164:167]
  ds_read_b64_tr_b16 v[76:77], v201 offset:36864
  ds_read_b64_tr_b16 v[78:79], v201 offset:38912
  v_mfma_f32_16x16x32_bf16 v[164:167], v[104:107], a[240:243], v[164:167]
  s_waitcnt lgkmcnt(8)
  v_mfma_f32_16x16x32_bf16 v[176:179], v[112:115], a[240:243], v[176:179]
  ds_read_b64_tr_b16 v[80:81], v202 offset:32768
  ds_read_b64_tr_b16 v[82:83], v202 offset:34816
  v_mfma_f32_16x16x32_bf16 v[176:179], v[116:119], a[248:251], v[176:179]
  buffer_load_dwordx4 v11, s[12:15], s97 offen offset:1024 lds
  v_mfma_f32_16x16x32_bf16 v[184:187], v[116:119], a[252:255], v[184:187]
  ds_read_b64_tr_b16 v[84:85], v202 offset:36864
  ds_read_b64_tr_b16 v[86:87], v202 offset:38912
  v_mfma_f32_16x16x32_bf16 v[184:187], v[112:115], a[244:247], v[184:187]
  v_mfma_f32_16x16x32_bf16 v[188:191], v[120:123], a[244:247], v[188:191]
  ds_read_b64_tr_b16 v[88:89], v203 offset:32768
  ds_read_b64_tr_b16 v[90:91], v203 offset:34816
  v_mfma_f32_16x16x32_bf16 v[188:191], v[124:127], a[252:255], v[188:191]
  s_add_u32 s100, s58, 40960
  buffer_load_dwordx4 a[176:179], v1, s[28:31], s100 offen offset:0 sc1
  v_mfma_f32_16x16x32_bf16 v[180:183], v[124:127], a[248:251], v[180:183]
  ds_read_b64_tr_b16 v[92:93], v203 offset:36864
  ds_read_b64_tr_b16 v[94:95], v203 offset:38912
  v_mfma_f32_16x16x32_bf16 v[180:183], v[120:123], a[240:243], v[180:183]
  s_waitcnt vmcnt(16) lgkmcnt(8)
  v_mfma_f32_16x16x32_bf16 v[128:131], v[64:67], a[128:131], v[128:131]
  ds_read_b64_tr_b16 v[96:97], v200 offset:40960
  ds_read_b64_tr_b16 v[98:99], v200 offset:43008
  v_mfma_f32_16x16x32_bf16 v[128:131], v[68:71], a[136:139], v[128:131]
  v_mfma_f32_16x16x32_bf16 v[136:139], v[68:71], a[140:143], v[136:139]
  ds_read_b64_tr_b16 v[100:101], v200 offset:45056
  ds_read_b64_tr_b16 v[102:103], v200 offset:47104
  v_mfma_f32_16x16x32_bf16 v[136:139], v[64:67], a[132:135], v[136:139]
  buffer_load_dwordx4 v12, s[12:15], s97 offen offset:2048 lds
  v_mfma_f32_16x16x32_bf16 v[140:143], v[72:75], a[132:135], v[140:143]
  ds_read_b64_tr_b16 v[104:105], v201 offset:40960
  ds_read_b64_tr_b16 v[106:107], v201 offset:43008
  v_mfma_f32_16x16x32_bf16 v[140:143], v[76:79], a[140:143], v[140:143]
  buffer_load_dwordx4 a[180:183], v1, s[28:31], s100 offen offset:1024 sc1
  v_mfma_f32_16x16x32_bf16 v[132:135], v[76:79], a[136:139], v[132:135]
  ds_read_b64_tr_b16 v[108:109], v201 offset:45056
  ds_read_b64_tr_b16 v[110:111], v201 offset:47104
  v_mfma_f32_16x16x32_bf16 v[132:135], v[72:75], a[128:131], v[132:135]
  s_waitcnt lgkmcnt(8)
  v_mfma_f32_16x16x32_bf16 v[144:147], v[80:83], a[128:131], v[144:147]
  ds_read_b64_tr_b16 v[112:113], v202 offset:40960
  ds_read_b64_tr_b16 v[114:115], v202 offset:43008
  v_mfma_f32_16x16x32_bf16 v[144:147], v[84:87], a[136:139], v[144:147]
  v_mfma_f32_16x16x32_bf16 v[152:155], v[84:87], a[140:143], v[152:155]
  ds_read_b64_tr_b16 v[116:117], v202 offset:45056
  ds_read_b64_tr_b16 v[118:119], v202 offset:47104
  v_mfma_f32_16x16x32_bf16 v[152:155], v[80:83], a[132:135], v[152:155]
  v_mfma_f32_16x16x32_bf16 v[156:159], v[88:91], a[132:135], v[156:159]
  ds_read_b64_tr_b16 v[120:121], v203 offset:40960
  ds_read_b64_tr_b16 v[122:123], v203 offset:43008
  v_mfma_f32_16x16x32_bf16 v[156:159], v[92:95], a[140:143], v[156:159]
  buffer_load_dwordx4 v13, s[12:15], s97 offen offset:3072 lds
  v_mfma_f32_16x16x32_bf16 v[148:151], v[92:95], a[136:139], v[148:151]
  ds_read_b64_tr_b16 v[124:125], v203 offset:45056
  ds_read_b64_tr_b16 v[126:127], v203 offset:47104
  v_mfma_f32_16x16x32_bf16 v[148:151], v[88:91], a[128:131], v[148:151]
  s_waitcnt lgkmcnt(8)
  buffer_load_dwordx4 a[184:187], v1, s[28:31], s100 offen offset:2048 sc1
  v_mfma_f32_16x16x32_bf16 v[160:163], v[96:99], a[128:131], v[160:163]
  ds_read_b64_tr_b16 v[64:65], v200 offset:49152
  ds_read_b64_tr_b16 v[66:67], v200 offset:51200
  v_mfma_f32_16x16x32_bf16 v[160:163], v[100:103], a[136:139], v[160:163]
  v_mfma_f32_16x16x32_bf16 v[168:171], v[100:103], a[140:143], v[168:171]
  ds_read_b64_tr_b16 v[68:69], v200 offset:53248
  ds_read_b64_tr_b16 v[70:71], v200 offset:55296
  v_mfma_f32_16x16x32_bf16 v[168:171], v[96:99], a[132:135], v[168:171]
  v_mfma_f32_16x16x32_bf16 v[172:175], v[104:107], a[132:135], v[172:175]
  ds_read_b64_tr_b16 v[72:73], v201 offset:49152
  ds_read_b64_tr_b16 v[74:75], v201 offset:51200
  v_mfma_f32_16x16x32_bf16 v[172:175], v[108:111], a[140:143], v[172:175]
  s_add_u32 m0, s62, 49152
  buffer_load_dwordx4 a[188:191], v1, s[28:31], s100 offen offset:3072 sc1
  v_mfma_f32_16x16x32_bf16 v[164:167], v[108:111], a[136:139], v[164:167]
  s_add_u32 s97, s60, 786432
  ds_read_b64_tr_b16 v[76:77], v201 offset:53248
  ds_read_b64_tr_b16 v[78:79], v201 offset:55296
  v_mfma_f32_16x16x32_bf16 v[164:167], v[104:107], a[128:131], v[164:167]
  s_waitcnt lgkmcnt(8)
  buffer_load_dwordx4 v10, s[12:15], s97 offen offset:0 lds
  v_mfma_f32_16x16x32_bf16 v[176:179], v[112:115], a[128:131], v[176:179]
  ds_read_b64_tr_b16 v[80:81], v202 offset:49152
  ds_read_b64_tr_b16 v[82:83], v202 offset:51200
  v_mfma_f32_16x16x32_bf16 v[176:179], v[116:119], a[136:139], v[176:179]
  v_mfma_f32_16x16x32_bf16 v[184:187], v[116:119], a[140:143], v[184:187]
  ds_read_b64_tr_b16 v[84:85], v202 offset:53248
  ds_read_b64_tr_b16 v[86:87], v202 offset:55296
  v_mfma_f32_16x16x32_bf16 v[184:187], v[112:115], a[132:135], v[184:187]
  v_mfma_f32_16x16x32_bf16 v[188:191], v[120:123], a[132:135], v[188:191]
  ds_read_b64_tr_b16 v[88:89], v203 offset:49152
  ds_read_b64_tr_b16 v[90:91], v203 offset:51200
  v_mfma_f32_16x16x32_bf16 v[188:191], v[124:127], a[140:143], v[188:191]
  s_add_u32 s100, s58, 45056
  buffer_load_dwordx4 a[192:195], v1, s[28:31], s100 offen offset:0 sc1
  v_mfma_f32_16x16x32_bf16 v[180:183], v[124:127], a[136:139], v[180:183]
  ds_read_b64_tr_b16 v[92:93], v203 offset:53248
  ds_read_b64_tr_b16 v[94:95], v203 offset:55296
  v_mfma_f32_16x16x32_bf16 v[180:183], v[120:123], a[128:131], v[180:183]
  s_waitcnt vmcnt(16) lgkmcnt(8)
  v_mfma_f32_16x16x32_bf16 v[128:131], v[64:67], a[144:147], v[128:131]
  ds_read_b64_tr_b16 v[96:97], v200 offset:57344
  ds_read_b64_tr_b16 v[98:99], v200 offset:59392
  v_mfma_f32_16x16x32_bf16 v[128:131], v[68:71], a[152:155], v[128:131]
  buffer_load_dwordx4 v11, s[12:15], s97 offen offset:1024 lds
  v_mfma_f32_16x16x32_bf16 v[136:139], v[68:71], a[156:159], v[136:139]
  ds_read_b64_tr_b16 v[100:101], v200 offset:61440
  ds_read_b64_tr_b16 v[102:103], v200 offset:63488
  v_mfma_f32_16x16x32_bf16 v[136:139], v[64:67], a[148:151], v[136:139]
  v_mfma_f32_16x16x32_bf16 v[140:143], v[72:75], a[148:151], v[140:143]
  ds_read_b64_tr_b16 v[104:105], v201 offset:57344
  ds_read_b64_tr_b16 v[106:107], v201 offset:59392
  v_mfma_f32_16x16x32_bf16 v[140:143], v[76:79], a[156:159], v[140:143]
  buffer_load_dwordx4 a[196:199], v1, s[28:31], s100 offen offset:1024 sc1
  v_mfma_f32_16x16x32_bf16 v[132:135], v[76:79], a[152:155], v[132:135]
  ds_read_b64_tr_b16 v[108:109], v201 offset:61440
  ds_read_b64_tr_b16 v[110:111], v201 offset:63488
  v_mfma_f32_16x16x32_bf16 v[132:135], v[72:75], a[144:147], v[132:135]
  s_waitcnt lgkmcnt(8)
  v_mfma_f32_16x16x32_bf16 v[144:147], v[80:83], a[144:147], v[144:147]
  ds_read_b64_tr_b16 v[112:113], v202 offset:57344
  ds_read_b64_tr_b16 v[114:115], v202 offset:59392
  v_mfma_f32_16x16x32_bf16 v[144:147], v[84:87], a[152:155], v[144:147]
  v_mfma_f32_16x16x32_bf16 v[152:155], v[84:87], a[156:159], v[152:155]
  ds_read_b64_tr_b16 v[116:117], v202 offset:61440
  ds_read_b64_tr_b16 v[118:119], v202 offset:63488
  v_mfma_f32_16x16x32_bf16 v[152:155], v[80:83], a[148:151], v[152:155]
  buffer_load_dwordx4 v12, s[12:15], s97 offen offset:2048 lds
  v_mfma_f32_16x16x32_bf16 v[156:159], v[88:91], a[148:151], v[156:159]
  s_waitcnt vmcnt(16)
  ds_read_b64_tr_b16 v[120:121], v203 offset:57344
  ds_read_b64_tr_b16 v[122:123], v203 offset:59392
  v_mfma_f32_16x16x32_bf16 v[156:159], v[92:95], a[156:159], v[156:159]
  s_barrier
  v_mfma_f32_16x16x32_bf16 v[148:151], v[92:95], a[152:155], v[148:151]
  ds_read_b64_tr_b16 v[124:125], v203 offset:61440
  ds_read_b64_tr_b16 v[126:127], v203 offset:63488
  v_mfma_f32_16x16x32_bf16 v[148:151], v[88:91], a[144:147], v[148:151]
  s_waitcnt lgkmcnt(8)
  buffer_load_dwordx4 a[200:203], v1, s[28:31], s100 offen offset:2048 sc1
  v_mfma_f32_16x16x32_bf16 v[160:163], v[96:99], a[144:147], v[160:163]
  ds_read_b64_tr_b16 v[64:65], v204 offset:0
  ds_read_b64_tr_b16 v[66:67], v204 offset:2048
  v_mfma_f32_16x16x32_bf16 v[160:163], v[100:103], a[152:155], v[160:163]
  v_mfma_f32_16x16x32_bf16 v[168:171], v[100:103], a[156:159], v[168:171]
  ds_read_b64_tr_b16 v[68:69], v204 offset:4096
  ds_read_b64_tr_b16 v[70:71], v204 offset:6144
  v_mfma_f32_16x16x32_bf16 v[168:171], v[96:99], a[148:151], v[168:171]
  v_mfma_f32_16x16x32_bf16 v[172:175], v[104:107], a[148:151], v[172:175]
  s_and_b32 s68, s2, 1
  ds_read_b64_tr_b16 v[72:73], v205 offset:0
  ds_read_b64_tr_b16 v[74:75], v205 offset:2048
  v_mfma_f32_16x16x32_bf16 v[172:175], v[108:111], a[156:159], v[172:175]
  s_lshl_b32 s68, s68, 5
  buffer_load_dwordx4 v13, s[12:15], s97 offen offset:3072 lds
  v_mfma_f32_16x16x32_bf16 v[164:167], v[108:111], a[152:155], v[164:167]
  s_add_u32 s68, s68, s48
  ds_read_b64_tr_b16 v[76:77], v205 offset:4096
  ds_read_b64_tr_b16 v[78:79], v205 offset:6144
  v_mfma_f32_16x16x32_bf16 v[164:167], v[104:107], a[144:147], v[164:167]
  s_waitcnt lgkmcnt(8)
  buffer_load_dwordx4 a[204:207], v1, s[28:31], s100 offen offset:3072 sc1
  v_mfma_f32_16x16x32_bf16 v[176:179], v[112:115], a[144:147], v[176:179]
  s_lshl_b32 s68, s68, 15
  ds_read_b64_tr_b16 v[80:81], v206 offset:0
  ds_read_b64_tr_b16 v[82:83], v206 offset:2048
  v_mfma_f32_16x16x32_bf16 v[176:179], v[116:119], a[152:155], v[176:179]
  s_lshr_b32 s7, s2, 6
  v_mfma_f32_16x16x32_bf16 v[184:187], v[116:119], a[156:159], v[184:187]
  s_lshl_b32 s6, s7, 8
  ds_read_b64_tr_b16 v[84:85], v206 offset:4096
  ds_read_b64_tr_b16 v[86:87], v206 offset:6144
  v_mfma_f32_16x16x32_bf16 v[184:187], v[112:115], a[148:151], v[184:187]
  s_add_u32 s68, s68, s6
  v_mfma_f32_16x16x32_bf16 v[188:191], v[120:123], a[148:151], v[188:191]
  s_add_u32 s100, s58, 49152
  ds_read_b64_tr_b16 v[88:89], v207 offset:0
  ds_read_b64_tr_b16 v[90:91], v207 offset:2048
  v_mfma_f32_16x16x32_bf16 v[188:191], v[124:127], a[156:159], v[188:191]
  s_add_u32 m0, s63, 0
  buffer_load_dwordx4 a[208:211], v1, s[28:31], s100 offen offset:0 sc1
  v_mfma_f32_16x16x32_bf16 v[180:183], v[124:127], a[152:155], v[180:183]
  s_add_u32 s97, s60, 851968
  ds_read_b64_tr_b16 v[92:93], v207 offset:4096
  ds_read_b64_tr_b16 v[94:95], v207 offset:6144
  v_mfma_f32_16x16x32_bf16 v[180:183], v[120:123], a[144:147], v[180:183]
  s_waitcnt vmcnt(16) lgkmcnt(8)
  buffer_load_dwordx4 v10, s[12:15], s97 offen offset:0 lds
  v_mfma_f32_16x16x32_bf16 v[128:131], v[64:67], a[160:163], v[128:131]
  s_lshl_b32 s6, s67, 6
  ds_read_b64_tr_b16 v[96:97], v204 offset:8192
  ds_read_b64_tr_b16 v[98:99], v204 offset:10240
  v_mfma_f32_16x16x32_bf16 v[128:131], v[68:71], a[168:171], v[128:131]
  s_add_u32 s68, s68, s6
  v_mfma_f32_16x16x32_bf16 v[136:139], v[68:71], a[172:175], v[136:139]
  s_add_u32 s69, s68, 0x4000
  ds_read_b64_tr_b16 v[100:101], v204 offset:12288
  ds_read_b64_tr_b16 v[102:103], v204 offset:14336
  v_mfma_f32_16x16x32_bf16 v[136:139], v[64:67], a[164:167], v[136:139]
  s_mov_b32 s71, s67
  v_mfma_f32_16x16x32_bf16 v[140:143], v[72:75], a[164:167], v[140:143]
  s_and_b32 s76, s2, 1
  ds_read_b64_tr_b16 v[104:105], v205 offset:8192
  ds_read_b64_tr_b16 v[106:107], v205 offset:10240
  v_mfma_f32_16x16x32_bf16 v[140:143], v[76:79], a[172:175], v[140:143]
  s_lshl_b32 s76, s76, 3
  buffer_load_dwordx4 a[212:215], v1, s[28:31], s100 offen offset:1024 sc1
  v_mfma_f32_16x16x32_bf16 v[132:135], v[76:79], a[168:171], v[132:135]
  s_add_u32 s76, s76, s5
  ds_read_b64_tr_b16 v[108:109], v205 offset:12288
  ds_read_b64_tr_b16 v[110:111], v205 offset:14336
  v_mfma_f32_16x16x32_bf16 v[132:135], v[72:75], a[160:163], v[132:135]
  s_waitcnt lgkmcnt(8)
  v_mfma_f32_16x16x32_bf16 v[144:147], v[80:83], a[160:163], v[144:147]
  s_lshl_b32 s76, s76, 2
  ds_read_b64_tr_b16 v[112:113], v206 offset:8192
  ds_read_b64_tr_b16 v[114:115], v206 offset:10240
  v_mfma_f32_16x16x32_bf16 v[144:147], v[84:87], a[168:171], v[144:147]
  s_lshr_b32 s7, s2, 6
  buffer_load_dwordx4 v11, s[12:15], s97 offen offset:1024 lds
  v_mfma_f32_16x16x32_bf16 v[152:155], v[84:87], a[172:175], v[152:155]
  s_add_u32 s76, s76, s7
  ds_read_b64_tr_b16 v[116:117], v206 offset:12288
  ds_read_b64_tr_b16 v[118:119], v206 offset:14336
  v_mfma_f32_16x16x32_bf16 v[152:155], v[80:83], a[164:167], v[152:155]
  s_lshl_b32 s76, s76, 17
  v_mfma_f32_16x16x32_bf16 v[156:159], v[88:91], a[164:167], v[156:159]
  s_lshl_b32 s6, s3, 11
  ds_read_b64_tr_b16 v[120:121], v207 offset:8192
  ds_read_b64_tr_b16 v[122:123], v207 offset:10240
  v_mfma_f32_16x16x32_bf16 v[156:159], v[92:95], a[172:175], v[156:159]
  s_add_u32 s76, s76, s6
  buffer_load_dwordx4 a[216:219], v1, s[28:31], s100 offen offset:2048 sc1
  v_mfma_f32_16x16x32_bf16 v[148:151], v[92:95], a[168:171], v[148:151]
  s_add_u32 s76, s76, 67108864
  ds_read_b64_tr_b16 v[124:125], v207 offset:12288
  ds_read_b64_tr_b16 v[126:127], v207 offset:14336
  v_mfma_f32_16x16x32_bf16 v[148:151], v[88:91], a[160:163], v[148:151]
  s_waitcnt lgkmcnt(8)
  v_mfma_f32_16x16x32_bf16 v[160:163], v[96:99], a[160:163], v[160:163]
  s_xor_b32 s6, s71, 3
  ds_read_b64_tr_b16 v[64:65], v204 offset:16384
  ds_read_b64_tr_b16 v[66:67], v204 offset:18432
  v_mfma_f32_16x16x32_bf16 v[160:163], v[100:103], a[168:171], v[160:163]
  s_lshl_b32 s7, s6, 2
  v_mfma_f32_16x16x32_bf16 v[168:171], v[100:103], a[172:175], v[168:171]
  s_add_u32 s7, s7, s71
  ds_read_b64_tr_b16 v[68:69], v204 offset:20480
  ds_read_b64_tr_b16 v[70:71], v204 offset:22528
  v_mfma_f32_16x16x32_bf16 v[168:171], v[96:99], a[164:167], v[168:171]
  s_lshl_b32 s7, s7, 13
  buffer_load_dwordx4 v12, s[12:15], s97 offen offset:2048 lds
  v_mfma_f32_16x16x32_bf16 v[172:175], v[104:107], a[164:167], v[172:175]
  s_add_u32 s72, s76, s7
  ds_read_b64_tr_b16 v[72:73], v205 offset:16384
  ds_read_b64_tr_b16 v[74:75], v205 offset:18432
  v_mfma_f32_16x16x32_bf16 v[172:175], v[108:111], a[172:175], v[172:175]
  s_lshl_b32 s7, s71, 2
  buffer_load_dwordx4 a[220:223], v1, s[28:31], s100 offen offset:3072 sc1
  v_mfma_f32_16x16x32_bf16 v[164:167], v[108:111], a[168:171], v[164:167]
  s_add_u32 s7, s7, s6
  ds_read_b64_tr_b16 v[76:77], v205 offset:20480
  ds_read_b64_tr_b16 v[78:79], v205 offset:22528
  v_mfma_f32_16x16x32_bf16 v[164:167], v[104:107], a[160:163], v[164:167]
  s_waitcnt lgkmcnt(8)
  v_mfma_f32_16x16x32_bf16 v[176:179], v[112:115], a[160:163], v[176:179]
  s_lshl_b32 s7, s7, 13
  ds_read_b64_tr_b16 v[80:81], v206 offset:16384
  ds_read_b64_tr_b16 v[82:83], v206 offset:18432
  v_mfma_f32_16x16x32_bf16 v[176:179], v[116:119], a[168:171], v[176:179]
  s_add_u32 s24, s76, s7
  v_mfma_f32_16x16x32_bf16 v[184:187], v[116:119], a[172:175], v[184:187]
  s_xor_b32 s6, s71, 2
  ds_read_b64_tr_b16 v[84:85], v206 offset:20480
  ds_read_b64_tr_b16 v[86:87], v206 offset:22528
  v_mfma_f32_16x16x32_bf16 v[184:187], v[112:115], a[164:167], v[184:187]
  s_lshl_b32 s7, s6, 2
  v_mfma_f32_16x16x32_bf16 v[188:191], v[120:123], a[164:167], v[188:191]
  s_add_u32 s7, s7, s71
  ds_read_b64_tr_b16 v[88:89], v207 offset:16384
  ds_read_b64_tr_b16 v[90:91], v207 offset:18432
  v_mfma_f32_16x16x32_bf16 v[188:191], v[124:127], a[172:175], v[188:191]
  s_lshl_b32 s7, s7, 13
  buffer_load_dwordx4 v13, s[12:15], s97 offen offset:3072 lds
  v_mfma_f32_16x16x32_bf16 v[180:183], v[124:127], a[168:171], v[180:183]
  s_add_u32 s100, s58, 53248
  ds_read_b64_tr_b16 v[92:93], v207 offset:20480
  ds_read_b64_tr_b16 v[94:95], v207 offset:22528
  v_mfma_f32_16x16x32_bf16 v[180:183], v[120:123], a[160:163], v[180:183]
  s_waitcnt vmcnt(16) lgkmcnt(8)
  buffer_load_dwordx4 a[224:227], v1, s[28:31], s100 offen offset:0 sc1
  v_mfma_f32_16x16x32_bf16 v[128:131], v[64:67], a[176:179], v[128:131]
  s_add_u32 s73, s76, s7
  ds_read_b64_tr_b16 v[96:97], v204 offset:24576
  ds_read_b64_tr_b16 v[98:99], v204 offset:26624
  v_mfma_f32_16x16x32_bf16 v[128:131], v[68:71], a[184:187], v[128:131]
  s_lshl_b32 s7, s71, 2
  v_mfma_f32_16x16x32_bf16 v[136:139], v[68:71], a[188:191], v[136:139]
  s_add_u32 s7, s7, s6
  ds_read_b64_tr_b16 v[100:101], v204 offset:28672
  ds_read_b64_tr_b16 v[102:103], v204 offset:30720
  v_mfma_f32_16x16x32_bf16 v[136:139], v[64:67], a[180:183], v[136:139]
  s_lshl_b32 s7, s7, 13
  v_mfma_f32_16x16x32_bf16 v[140:143], v[72:75], a[180:183], v[140:143]
  s_add_u32 s25, s76, s7
  ds_read_b64_tr_b16 v[104:105], v205 offset:24576
  ds_read_b64_tr_b16 v[106:107], v205 offset:26624
  v_mfma_f32_16x16x32_bf16 v[140:143], v[76:79], a[188:191], v[140:143]
  s_add_u32 m0, s63, 16384
  buffer_load_dwordx4 a[228:231], v1, s[28:31], s100 offen offset:1024 sc1
  v_mfma_f32_16x16x32_bf16 v[132:135], v[76:79], a[184:187], v[132:135]
  s_add_u32 s97, s60, 917504
  ds_read_b64_tr_b16 v[108:109], v205 offset:28672
  ds_read_b64_tr_b16 v[110:111], v205 offset:30720
  v_mfma_f32_16x16x32_bf16 v[132:135], v[72:75], a[176:179], v[132:135]
  s_waitcnt lgkmcnt(8)
  buffer_load_dwordx4 v10, s[12:15], s97 offen offset:0 lds
  v_mfma_f32_16x16x32_bf16 v[144:147], v[80:83], a[176:179], v[144:147]
  s_xor_b32 s6, s71, 1
  ds_read_b64_tr_b16 v[112:113], v206 offset:24576
  ds_read_b64_tr_b16 v[114:115], v206 offset:26624
  v_mfma_f32_16x16x32_bf16 v[144:147], v[84:87], a[184:187], v[144:147]
  s_lshl_b32 s7, s6, 2
  v_mfma_f32_16x16x32_bf16 v[152:155], v[84:87], a[188:191], v[152:155]
  s_add_u32 s7, s7, s71
  ds_read_b64_tr_b16 v[116:117], v206 offset:28672
  ds_read_b64_tr_b16 v[118:119], v206 offset:30720
  v_mfma_f32_16x16x32_bf16 v[152:155], v[80:83], a[180:183], v[152:155]
  s_lshl_b32 s7, s7, 13
  v_mfma_f32_16x16x32_bf16 v[156:159], v[88:91], a[180:183], v[156:159]
  s_waitcnt vmcnt(12)
  ds_read_b64_tr_b16 v[120:121], v207 offset:24576
  ds_read_b64_tr_b16 v[122:123], v207 offset:26624
  v_mfma_f32_16x16x32_bf16 v[156:159], v[92:95], a[188:191], v[156:159]
  s_barrier
  v_mfma_f32_16x16x32_bf16 v[148:151], v[92:95], a[184:187], v[148:151]
  s_add_u32 s74, s76, s7
  ds_read_b64_tr_b16 v[124:125], v207 offset:28672
  ds_read_b64_tr_b16 v[126:127], v207 offset:30720
  v_mfma_f32_16x16x32_bf16 v[148:151], v[88:91], a[176:179], v[148:151]
  s_waitcnt lgkmcnt(8)
  buffer_load_dwordx4 a[232:235], v1, s[28:31], s100 offen offset:2048 sc1
  v_mfma_f32_16x16x32_bf16 v[160:163], v[96:99], a[176:179], v[160:163]
  s_lshl_b32 s7, s71, 2
  ds_read_b64_tr_b16 v[64:65], v204 offset:32768
  ds_read_b64_tr_b16 v[66:67], v204 offset:34816
  v_mfma_f32_16x16x32_bf16 v[160:163], v[100:103], a[184:187], v[160:163]
  s_add_u32 s7, s7, s6
  buffer_load_dwordx4 v11, s[12:15], s97 offen offset:1024 lds
  v_mfma_f32_16x16x32_bf16 v[168:171], v[100:103], a[188:191], v[168:171]
  s_lshl_b32 s7, s7, 13
  ds_read_b64_tr_b16 v[68:69], v204 offset:36864
  ds_read_b64_tr_b16 v[70:71], v204 offset:38912
  v_mfma_f32_16x16x32_bf16 v[168:171], v[96:99], a[180:183], v[168:171]
  s_add_u32 s26, s76, s7
  v_mfma_f32_16x16x32_bf16 v[172:175], v[104:107], a[180:183], v[172:175]
  s_and_b32 s27, s2, 1
  ds_read_b64_tr_b16 v[72:73], v205 offset:32768
  ds_read_b64_tr_b16 v[74:75], v205 offset:34816
  v_mfma_f32_16x16x32_bf16 v[172:175], v[108:111], a[188:191], v[172:175]
  s_lshl_b32 s27, s27, 3
  buffer_load_dwordx4 a[236:239], v1, s[28:31], s100 offen offset:3072 sc1
  v_mfma_f32_16x16x32_bf16 v[164:167], v[108:111], a[184:187], v[164:167]
  s_add_u32 s27, s27, s5
  ds_read_b64_tr_b16 v[76:77], v205 offset:36864
  ds_read_b64_tr_b16 v[78:79], v205 offset:38912
  v_mfma_f32_16x16x32_bf16 v[164:167], v[104:107], a[176:179], v[164:167]
  s_waitcnt lgkmcnt(8)
  v_mfma_f32_16x16x32_bf16 v[176:179], v[112:115], a[176:179], v[176:179]
  s_lshl_b32 s27, s27, 2
  ds_read_b64_tr_b16 v[80:81], v206 offset:32768
  ds_read_b64_tr_b16 v[82:83], v206 offset:34816
  v_mfma_f32_16x16x32_bf16 v[176:179], v[116:119], a[184:187], v[176:179]
  s_lshr_b32 s7, s2, 6
  v_mfma_f32_16x16x32_bf16 v[184:187], v[116:119], a[188:191], v[184:187]
  s_add_u32 s27, s27, s7
  ds_read_b64_tr_b16 v[84:85], v206 offset:36864
  ds_read_b64_tr_b16 v[86:87], v206 offset:38912
  v_mfma_f32_16x16x32_bf16 v[184:187], v[112:115], a[180:183], v[184:187]
  s_lshl_b32 s27, s27, 2
  buffer_load_dwordx4 v12, s[12:15], s97 offen offset:2048 lds
  v_mfma_f32_16x16x32_bf16 v[188:191], v[120:123], a[180:183], v[188:191]
  s_add_u32 s27, s27, s3
  ds_read_b64_tr_b16 v[88:89], v207 offset:32768
  ds_read_b64_tr_b16 v[90:91], v207 offset:34816
  v_mfma_f32_16x16x32_bf16 v[188:191], v[124:127], a[188:191], v[188:191]
  s_add_u32 s100, s58, 57344
  buffer_load_dwordx4 a[240:243], v1, s[28:31], s100 offen offset:0 sc1
  v_mfma_f32_16x16x32_bf16 v[180:183], v[124:127], a[184:187], v[180:183]
  s_lshl_b32 s27, s27, 7
  ds_read_b64_tr_b16 v[92:93], v207 offset:36864
  ds_read_b64_tr_b16 v[94:95], v207 offset:38912
  v_mfma_f32_16x16x32_bf16 v[180:183], v[120:123], a[176:179], v[180:183]
  s_waitcnt vmcnt(16) lgkmcnt(8)
  v_mfma_f32_16x16x32_bf16 v[128:131], v[64:67], a[192:195], v[128:131]
  s_and_b32 s7, s2, 6
  ds_read_b64_tr_b16 v[96:97], v204 offset:40960
  ds_read_b64_tr_b16 v[98:99], v204 offset:43008
  v_mfma_f32_16x16x32_bf16 v[128:131], v[68:71], a[200:203], v[128:131]
  s_lshl_b32 s7, s7, 1
  v_mfma_f32_16x16x32_bf16 v[136:139], v[68:71], a[204:207], v[136:139]
  s_add_u32 s27, s27, s7
  ds_read_b64_tr_b16 v[100:101], v204 offset:45056
  ds_read_b64_tr_b16 v[102:103], v204 offset:47104
  v_mfma_f32_16x16x32_bf16 v[136:139], v[64:67], a[196:199], v[136:139]
  s_add_u32 s27, s27, 60850176
  v_mfma_f32_16x16x32_bf16 v[140:143], v[72:75], a[196:199], v[140:143]
  s_and_b32 s77, s27, 0xffffff80
  ds_read_b64_tr_b16 v[104:105], v205 offset:40960
  ds_read_b64_tr_b16 v[106:107], v205 offset:43008
  v_mfma_f32_16x16x32_bf16 v[140:143], v[76:79], a[204:207], v[140:143]
  buffer_load_dwordx4 v13, s[12:15], s97 offen offset:3072 lds
  v_mfma_f32_16x16x32_bf16 v[132:135], v[76:79], a[200:203], v[132:135]
  ds_read_b64_tr_b16 v[108:109], v205 offset:45056
  ds_read_b64_tr_b16 v[110:111], v205 offset:47104
  v_mfma_f32_16x16x32_bf16 v[132:135], v[72:75], a[192:195], v[132:135]
  s_waitcnt lgkmcnt(8)
  buffer_load_dwordx4 a[244:247], v1, s[28:31], s100 offen offset:1024 sc1
  v_mfma_f32_16x16x32_bf16 v[144:147], v[80:83], a[192:195], v[144:147]
  ds_read_b64_tr_b16 v[112:113], v206 offset:40960
  ds_read_b64_tr_b16 v[114:115], v206 offset:43008
  v_mfma_f32_16x16x32_bf16 v[144:147], v[84:87], a[200:203], v[144:147]
  v_mfma_f32_16x16x32_bf16 v[152:155], v[84:87], a[204:207], v[152:155]
  ds_read_b64_tr_b16 v[116:117], v206 offset:45056
  ds_read_b64_tr_b16 v[118:119], v206 offset:47104
  v_mfma_f32_16x16x32_bf16 v[152:155], v[80:83], a[196:199], v[152:155]
  v_mfma_f32_16x16x32_bf16 v[156:159], v[88:91], a[196:199], v[156:159]
  ds_read_b64_tr_b16 v[120:121], v207 offset:40960
  ds_read_b64_tr_b16 v[122:123], v207 offset:43008
  v_mfma_f32_16x16x32_bf16 v[156:159], v[92:95], a[204:207], v[156:159]
  s_add_u32 m0, s61, 0
  buffer_load_dwordx4 a[248:251], v1, s[28:31], s100 offen offset:2048 sc1
  v_mfma_f32_16x16x32_bf16 v[148:151], v[92:95], a[200:203], v[148:151]
  s_add_u32 s97, s60, 983040
  ds_read_b64_tr_b16 v[124:125], v207 offset:45056
  ds_read_b64_tr_b16 v[126:127], v207 offset:47104
  v_mfma_f32_16x16x32_bf16 v[148:151], v[88:91], a[192:195], v[148:151]
  s_waitcnt lgkmcnt(8)
  buffer_load_dwordx4 v10, s[12:15], s97 offen offset:0 lds
  v_mfma_f32_16x16x32_bf16 v[160:163], v[96:99], a[192:195], v[160:163]
  ds_read_b64_tr_b16 v[64:65], v204 offset:49152
  ds_read_b64_tr_b16 v[66:67], v204 offset:51200
  v_mfma_f32_16x16x32_bf16 v[160:163], v[100:103], a[200:203], v[160:163]
  v_mfma_f32_16x16x32_bf16 v[168:171], v[100:103], a[204:207], v[168:171]
  ds_read_b64_tr_b16 v[68:69], v204 offset:53248
  ds_read_b64_tr_b16 v[70:71], v204 offset:55296
  v_mfma_f32_16x16x32_bf16 v[168:171], v[96:99], a[196:199], v[168:171]
  v_mfma_f32_16x16x32_bf16 v[172:175], v[104:107], a[196:199], v[172:175]
  ds_read_b64_tr_b16 v[72:73], v205 offset:49152
  ds_read_b64_tr_b16 v[74:75], v205 offset:51200
  v_mfma_f32_16x16x32_bf16 v[172:175], v[108:111], a[204:207], v[172:175]
  buffer_load_dwordx4 a[252:255], v1, s[28:31], s100 offen offset:3072 sc1
  v_mfma_f32_16x16x32_bf16 v[164:167], v[108:111], a[200:203], v[164:167]
  ds_read_b64_tr_b16 v[76:77], v205 offset:53248
  ds_read_b64_tr_b16 v[78:79], v205 offset:55296
  v_mfma_f32_16x16x32_bf16 v[164:167], v[104:107], a[192:195], v[164:167]
  s_waitcnt lgkmcnt(8)
  v_mfma_f32_16x16x32_bf16 v[176:179], v[112:115], a[192:195], v[176:179]
  ds_read_b64_tr_b16 v[80:81], v206 offset:49152
  ds_read_b64_tr_b16 v[82:83], v206 offset:51200
  v_mfma_f32_16x16x32_bf16 v[176:179], v[116:119], a[200:203], v[176:179]
  buffer_load_dwordx4 v11, s[12:15], s97 offen offset:1024 lds
  v_mfma_f32_16x16x32_bf16 v[184:187], v[116:119], a[204:207], v[184:187]
  ds_read_b64_tr_b16 v[84:85], v206 offset:53248
  ds_read_b64_tr_b16 v[86:87], v206 offset:55296
  v_mfma_f32_16x16x32_bf16 v[184:187], v[112:115], a[196:199], v[184:187]
  v_and_b32 v20, 15, v0
  v_mfma_f32_16x16x32_bf16 v[188:191], v[120:123], a[196:199], v[188:191]
  ds_read_b64_tr_b16 v[88:89], v207 offset:49152
  ds_read_b64_tr_b16 v[90:91], v207 offset:51200
  v_mfma_f32_16x16x32_bf16 v[188:191], v[124:127], a[204:207], v[188:191]
  s_add_u32 s100, s58, 61440
  buffer_load_dwordx4 a[128:131], v1, s[28:31], s100 offen offset:0 sc1
  v_mfma_f32_16x16x32_bf16 v[180:183], v[124:127], a[200:203], v[180:183]
L_pad14:
  s_cbranch_execz L_pad18
  ds_read_b64_tr_b16 v[92:93], v207 offset:53248
  ds_read_b64_tr_b16 v[94:95], v207 offset:55296
  v_mfma_f32_16x16x32_bf16 v[180:183], v[120:123], a[192:195], v[180:183]
  s_waitcnt vmcnt(16) lgkmcnt(8)
  v_lshrrev_b32 v21, 4, v0
  v_mfma_f32_16x16x32_bf16 v[128:131], v[64:67], a[208:211], v[128:131]
  ds_read_b64_tr_b16 v[96:97], v204 offset:57344
  ds_read_b64_tr_b16 v[98:99], v204 offset:59392
  v_mfma_f32_16x16x32_bf16 v[128:131], v[68:71], a[216:219], v[128:131]
  v_lshlrev_b32 v20, 10, v20
  v_mfma_f32_16x16x32_bf16 v[136:139], v[68:71], a[220:223], v[136:139]
  ds_read_b64_tr_b16 v[100:101], v204 offset:61440
  ds_read_b64_tr_b16 v[102:103], v204 offset:63488
  v_mfma_f32_16x16x32_bf16 v[136:139], v[64:67], a[212:215], v[136:139]
  buffer_load_dwordx4 v12, s[12:15], s97 offen offset:2048 lds
  v_mfma_f32_16x16x32_bf16 v[140:143], v[72:75], a[212:215], v[140:143]
  ds_read_b64_tr_b16 v[104:105], v205 offset:57344
  ds_read_b64_tr_b16 v[106:107], v205 offset:59392
  v_mfma_f32_16x16x32_bf16 v[140:143], v[76:79], a[220:223], v[140:143]
  buffer_load_dwordx4 a[132:135], v1, s[28:31], s100 offen offset:1024 sc1
  v_mfma_f32_16x16x32_bf16 v[132:135], v[76:79], a[216:219], v[132:135]
  ds_read_b64_tr_b16 v[108:109], v205 offset:61440
  ds_read_b64_tr_b16 v[110:111], v205 offset:63488
  v_mfma_f32_16x16x32_bf16 v[132:135], v[72:75], a[208:211], v[132:135]
  s_waitcnt lgkmcnt(8)
  v_lshl_add_u32 v22, v21, 3, v20
  v_mfma_f32_16x16x32_bf16 v[144:147], v[80:83], a[208:211], v[144:147]
  ds_read_b64_tr_b16 v[112:113], v206 offset:57344
  ds_read_b64_tr_b16 v[114:115], v206 offset:59392
  v_mfma_f32_16x16x32_bf16 v[144:147], v[84:87], a[216:219], v[144:147]
  v_lshrrev_b32 v21, 5, v0
  v_mfma_f32_16x16x32_bf16 v[152:155], v[84:87], a[220:223], v[152:155]
  ds_read_b64_tr_b16 v[116:117], v206 offset:61440
  ds_read_b64_tr_b16 v[118:119], v206 offset:63488
  v_mfma_f32_16x16x32_bf16 v[152:155], v[80:83], a[212:215], v[152:155]
  v_lshl_add_u32 v23, v21, 4, v20
  v_mfma_f32_16x16x32_bf16 v[156:159], v[88:91], a[212:215], v[156:159]
  s_waitcnt vmcnt(8)
  ds_read_b64_tr_b16 v[120:121], v207 offset:57344
  ds_read_b64_tr_b16 v[122:123], v207 offset:59392
  v_mfma_f32_16x16x32_bf16 v[156:159], v[92:95], a[220:223], v[156:159]
  s_barrier
  v_bfe_u32 v21, v0, 4, 1
  v_mfma_f32_16x16x32_bf16 v[148:151], v[92:95], a[216:219], v[148:151]
  ds_read_b64_tr_b16 v[124:125], v207 offset:61440
  ds_read_b64_tr_b16 v[126:127], v207 offset:63488
  v_mfma_f32_16x16x32_bf16 v[148:151], v[88:91], a[208:211], v[148:151]
  s_waitcnt lgkmcnt(8)
  buffer_load_dwordx4 v13, s[12:15], s97 offen offset:3072 lds
  v_mfma_f32_16x16x32_bf16 v[160:163], v[96:99], a[208:211], v[160:163]
  ds_read_b64_tr_b16 v[64:65], v208 offset:0
  ds_read_b64_tr_b16 v[66:67], v208 offset:2048
  v_mfma_f32_16x16x32_bf16 v[160:163], v[100:103], a[216:219], v[160:163]
  buffer_load_dwordx4 a[136:139], v1, s[28:31], s100 offen offset:2048 sc1
  v_mfma_f32_16x16x32_bf16 v[168:171], v[100:103], a[220:223], v[168:171]
  ds_read_b64_tr_b16 v[68:69], v208 offset:4096
  ds_read_b64_tr_b16 v[70:71], v208 offset:6144
  v_mfma_f32_16x16x32_bf16 v[168:171], v[96:99], a[212:215], v[168:171]
  v_lshl_add_u32 v23, v21, 5, v23
  v_mfma_f32_16x16x32_bf16 v[172:175], v[104:107], a[212:215], v[172:175]
  ds_read_b64_tr_b16 v[72:73], v209 offset:0
  ds_read_b64_tr_b16 v[74:75], v209 offset:2048
  v_mfma_f32_16x16x32_bf16 v[172:175], v[108:111], a[220:223], v[172:175]
  buffer_load_dwordx4 a[140:143], v1, s[28:31], s100 offen offset:3072 sc1
  v_mfma_f32_16x16x32_bf16 v[164:167], v[108:111], a[216:219], v[164:167]
  ds_read_b64_tr_b16 v[76:77], v209 offset:4096
  ds_read_b64_tr_b16 v[78:79], v209 offset:6144
  v_mfma_f32_16x16x32_bf16 v[164:167], v[104:107], a[208:211], v[164:167]
  s_waitcnt lgkmcnt(8)
  v_min_u32 v27, 2, v0
  v_mfma_f32_16x16x32_bf16 v[176:179], v[112:115], a[208:211], v[176:179]
  ds_read_b64_tr_b16 v[80:81], v210 offset:0
  ds_read_b64_tr_b16 v[82:83], v210 offset:2048
  v_mfma_f32_16x16x32_bf16 v[176:179], v[116:119], a[216:219], v[176:179]
  v_xor_b32 v27, 3, v27
  v_mfma_f32_16x16x32_bf16 v[184:187], v[116:119], a[220:223], v[184:187]
  ds_read_b64_tr_b16 v[84:85], v210 offset:4096
  ds_read_b64_tr_b16 v[86:87], v210 offset:6144
  v_mfma_f32_16x16x32_bf16 v[184:187], v[112:115], a[212:215], v[184:187]
  v_xor_b32 v27, s67, v27
  v_mfma_f32_16x16x32_bf16 v[188:191], v[120:123], a[212:215], v[188:191]
  ds_read_b64_tr_b16 v[88:89], v211 offset:0
  ds_read_b64_tr_b16 v[90:91], v211 offset:2048
  v_mfma_f32_16x16x32_bf16 v[188:191], v[124:127], a[220:223], v[188:191]
  v_lshlrev_b32 v27, 2, v27
  v_mfma_f32_16x16x32_bf16 v[180:183], v[124:127], a[216:219], v[180:183]
  ds_read_b64_tr_b16 v[92:93], v211 offset:4096
  ds_read_b64_tr_b16 v[94:95], v211 offset:6144
  v_mfma_f32_16x16x32_bf16 v[180:183], v[120:123], a[208:211], v[180:183]
  s_waitcnt lgkmcnt(8)
  v_mfma_f32_16x16x32_bf16 v[128:131], v[64:67], a[224:227], v[128:131]
  ds_read_b64_tr_b16 v[96:97], v208 offset:8192
  ds_read_b64_tr_b16 v[98:99], v208 offset:10240
  v_mfma_f32_16x16x32_bf16 v[128:131], v[68:71], a[232:235], v[128:131]
  v_mfma_f32_16x16x32_bf16 v[136:139], v[68:71], a[236:239], v[136:139]
  ds_read_b64_tr_b16 v[100:101], v208 offset:12288
  ds_read_b64_tr_b16 v[102:103], v208 offset:14336
  v_mfma_f32_16x16x32_bf16 v[136:139], v[64:67], a[228:231], v[136:139]
  v_mfma_f32_16x16x32_bf16 v[140:143], v[72:75], a[228:231], v[140:143]
  ds_read_b64_tr_b16 v[104:105], v209 offset:8192
  ds_read_b64_tr_b16 v[106:107], v209 offset:10240
  v_mfma_f32_16x16x32_bf16 v[140:143], v[76:79], a[236:239], v[140:143]
  v_mfma_f32_16x16x32_bf16 v[132:135], v[76:79], a[232:235], v[132:135]
  ds_read_b64_tr_b16 v[108:109], v209 offset:12288
  ds_read_b64_tr_b16 v[110:111], v209 offset:14336
  v_mfma_f32_16x16x32_bf16 v[132:135], v[72:75], a[224:227], v[132:135]
  s_waitcnt lgkmcnt(8)
  v_mfma_f32_16x16x32_bf16 v[144:147], v[80:83], a[224:227], v[144:147]
  ds_read_b64_tr_b16 v[112:113], v210 offset:8192
  ds_read_b64_tr_b16 v[114:115], v210 offset:10240
  v_mfma_f32_16x16x32_bf16 v[144:147], v[84:87], a[232:235], v[144:147]
  v_mfma_f32_16x16x32_bf16 v[152:155], v[84:87], a[236:239], v[152:155]
  ds_read_b64_tr_b16 v[116:117], v210 offset:12288
  ds_read_b64_tr_b16 v[118:119], v210 offset:14336
  v_mfma_f32_16x16x32_bf16 v[152:155], v[80:83], a[228:231], v[152:155]
  v_mfma_f32_16x16x32_bf16 v[156:159], v[88:91], a[228:231], v[156:159]
  ds_read_b64_tr_b16 v[120:121], v211 offset:8192
  ds_read_b64_tr_b16 v[122:123], v211 offset:10240
  v_mfma_f32_16x16x32_bf16 v[156:159], v[92:95], a[236:239], v[156:159]
  v_mfma_f32_16x16x32_bf16 v[148:151], v[92:95], a[232:235], v[148:151]
  ds_read_b64_tr_b16 v[124:125], v211 offset:12288
  ds_read_b64_tr_b16 v[126:127], v211 offset:14336
  v_mfma_f32_16x16x32_bf16 v[148:151], v[88:91], a[224:227], v[148:151]
  s_waitcnt lgkmcnt(8)
  v_mfma_f32_16x16x32_bf16 v[160:163], v[96:99], a[224:227], v[160:163]
  ds_read_b64_tr_b16 v[64:65], v208 offset:16384
  ds_read_b64_tr_b16 v[66:67], v208 offset:18432
  v_mfma_f32_16x16x32_bf16 v[160:163], v[100:103], a[232:235], v[160:163]
  buffer_load_dwordx2 v[192:193], v22, s[32:35], s68 offen offset:0
  v_mfma_f32_16x16x32_bf16 v[168:171], v[100:103], a[236:239], v[168:171]
  ds_read_b64_tr_b16 v[68:69], v208 offset:20480
  ds_read_b64_tr_b16 v[70:71], v208 offset:22528
  v_mfma_f32_16x16x32_bf16 v[168:171], v[96:99], a[228:231], v[168:171]
  v_mfma_f32_16x16x32_bf16 v[172:175], v[104:107], a[228:231], v[172:175]
  ds_read_b64_tr_b16 v[72:73], v209 offset:16384
  ds_read_b64_tr_b16 v[74:75], v209 offset:18432
  v_mfma_f32_16x16x32_bf16 v[172:175], v[108:111], a[236:239], v[172:175]
  v_mfma_f32_16x16x32_bf16 v[164:167], v[108:111], a[232:235], v[164:167]
  ds_read_b64_tr_b16 v[76:77], v209 offset:20480
  ds_read_b64_tr_b16 v[78:79], v209 offset:22528
  v_mfma_f32_16x16x32_bf16 v[164:167], v[104:107], a[224:227], v[164:167]
  s_waitcnt lgkmcnt(8)
  v_mfma_f32_16x16x32_bf16 v[176:179], v[112:115], a[224:227], v[176:179]
  ds_read_b64_tr_b16 v[80:81], v210 offset:16384
  ds_read_b64_tr_b16 v[82:83], v210 offset:18432
  v_mfma_f32_16x16x32_bf16 v[176:179], v[116:119], a[232:235], v[176:179]
  buffer_load_dwordx2 v[194:195], v22, s[32:35], s68 offen offset:32
  v_mfma_f32_16x16x32_bf16 v[184:187], v[116:119], a[236:239], v[184:187]
  ds_read_b64_tr_b16 v[84:85], v210 offset:20480
  ds_read_b64_tr_b16 v[86:87], v210 offset:22528
  v_mfma_f32_16x16x32_bf16 v[184:187], v[112:115], a[228:231], v[184:187]
  v_mfma_f32_16x16x32_bf16 v[188:191], v[120:123], a[228:231], v[188:191]
  ds_read_b64_tr_b16 v[88:89], v211 offset:16384
  ds_read_b64_tr_b16 v[90:91], v211 offset:18432
  v_mfma_f32_16x16x32_bf16 v[188:191], v[124:127], a[236:239], v[188:191]
  v_mfma_f32_16x16x32_bf16 v[180:183], v[124:127], a[232:235], v[180:183]
  ds_read_b64_tr_b16 v[92:93], v211 offset:20480
  ds_read_b64_tr_b16 v[94:95], v211 offset:22528
  v_mfma_f32_16x16x32_bf16 v[180:183], v[120:123], a[224:227], v[180:183]
  s_waitcnt vmcnt(9) lgkmcnt(8)
  v_mfma_f32_16x16x32_bf16 v[128:131], v[64:67], a[240:243], v[128:131]
  ds_read_b64_tr_b16 v[96:97], v208 offset:24576
  ds_read_b64_tr_b16 v[98:99], v208 offset:26624
  v_mfma_f32_16x16x32_bf16 v[128:131], v[68:71], a[248:251], v[128:131]
  buffer_load_dwordx2 v[196:197], v22, s[32:35], s69 offen offset:0
  v_mfma_f32_16x16x32_bf16 v[136:139], v[68:71], a[252:255], v[136:139]
  ds_read_b64_tr_b16 v[100:101], v208 offset:28672
  ds_read_b64_tr_b16 v[102:103], v208 offset:30720
  v_mfma_f32_16x16x32_bf16 v[136:139], v[64:67], a[244:247], v[136:139]
  v_mfma_f32_16x16x32_bf16 v[140:143], v[72:75], a[244:247], v[140:143]
  ds_read_b64_tr_b16 v[104:105], v209 offset:24576
  ds_read_b64_tr_b16 v[106:107], v209 offset:26624
  v_mfma_f32_16x16x32_bf16 v[140:143], v[76:79], a[252:255], v[140:143]
  v_mfma_f32_16x16x32_bf16 v[132:135], v[76:79], a[248:251], v[132:135]
  ds_read_b64_tr_b16 v[108:109], v209 offset:28672
  ds_read_b64_tr_b16 v[110:111], v209 offset:30720
  v_mfma_f32_16x16x32_bf16 v[132:135], v[72:75], a[240:243], v[132:135]
  s_waitcnt lgkmcnt(8)
  v_mfma_f32_16x16x32_bf16 v[144:147], v[80:83], a[240:243], v[144:147]
  ds_read_b64_tr_b16 v[112:113], v210 offset:24576
  ds_read_b64_tr_b16 v[114:115], v210 offset:26624
  v_mfma_f32_16x16x32_bf16 v[144:147], v[84:87], a[248:251], v[144:147]
  buffer_load_dwordx2 v[198:199], v22, s[32:35], s69 offen offset:32
  v_mfma_f32_16x16x32_bf16 v[152:155], v[84:87], a[252:255], v[152:155]
  ds_read_b64_tr_b16 v[116:117], v210 offset:28672
  ds_read_b64_tr_b16 v[118:119], v210 offset:30720
  v_mfma_f32_16x16x32_bf16 v[152:155], v[80:83], a[244:247], v[152:155]
  v_mfma_f32_16x16x32_bf16 v[156:159], v[88:91], a[244:247], v[156:159]
  s_waitcnt vmcnt(6)
  ds_read_b64_tr_b16 v[120:121], v211 offset:24576
  ds_read_b64_tr_b16 v[122:123], v211 offset:26624
  v_mfma_f32_16x16x32_bf16 v[156:159], v[92:95], a[252:255], v[156:159]
  s_barrier
  v_mfma_f32_16x16x32_bf16 v[148:151], v[92:95], a[248:251], v[148:151]
  ds_read_b64_tr_b16 v[124:125], v211 offset:28672
  ds_read_b64_tr_b16 v[126:127], v211 offset:30720
  v_mfma_f32_16x16x32_bf16 v[148:151], v[88:91], a[240:243], v[148:151]
  s_waitcnt lgkmcnt(8)
  v_mfma_f32_16x16x32_bf16 v[160:163], v[96:99], a[240:243], v[160:163]
  ds_read_b64_tr_b16 v[64:65], v200 offset:0
  ds_read_b64_tr_b16 v[66:67], v200 offset:2048
  v_mfma_f32_16x16x32_bf16 v[160:163], v[100:103], a[248:251], v[160:163]
  v_mfma_f32_16x16x32_bf16 v[168:171], v[100:103], a[252:255], v[168:171]
  ds_read_b64_tr_b16 v[68:69], v200 offset:4096
  ds_read_b64_tr_b16 v[70:71], v200 offset:6144
  v_mfma_f32_16x16x32_bf16 v[168:171], v[96:99], a[244:247], v[168:171]
  v_mfma_f32_16x16x32_bf16 v[172:175], v[104:107], a[244:247], v[172:175]
  ds_read_b64_tr_b16 v[72:73], v201 offset:0
  ds_read_b64_tr_b16 v[74:75], v201 offset:2048
  v_mfma_f32_16x16x32_bf16 v[172:175], v[108:111], a[252:255], v[172:175]
  v_mfma_f32_16x16x32_bf16 v[164:167], v[108:111], a[248:251], v[164:167]
  ds_read_b64_tr_b16 v[76:77], v201 offset:4096
  ds_read_b64_tr_b16 v[78:79], v201 offset:6144
  v_mfma_f32_16x16x32_bf16 v[164:167], v[104:107], a[240:243], v[164:167]
  s_waitcnt lgkmcnt(8)
  v_mfma_f32_16x16x32_bf16 v[176:179], v[112:115], a[240:243], v[176:179]
  ds_read_b64_tr_b16 v[80:81], v202 offset:0
  ds_read_b64_tr_b16 v[82:83], v202 offset:2048
  v_mfma_f32_16x16x32_bf16 v[176:179], v[116:119], a[248:251], v[176:179]
  v_mfma_f32_16x16x32_bf16 v[184:187], v[116:119], a[252:255], v[184:187]
  ds_read_b64_tr_b16 v[84:85], v202 offset:4096
  ds_read_b64_tr_b16 v[86:87], v202 offset:6144
  v_mfma_f32_16x16x32_bf16 v[184:187], v[112:115], a[244:247], v[184:187]
  v_mfma_f32_16x16x32_bf16 v[188:191], v[120:123], a[244:247], v[188:191]
  ds_read_b64_tr_b16 v[88:89], v203 offset:0
  ds_read_b64_tr_b16 v[90:91], v203 offset:2048
  v_mfma_f32_16x16x32_bf16 v[188:191], v[124:127], a[252:255], v[188:191]
  v_mfma_f32_16x16x32_bf16 v[180:183], v[124:127], a[248:251], v[180:183]
  ds_read_b64_tr_b16 v[92:93], v203 offset:4096
  ds_read_b64_tr_b16 v[94:95], v203 offset:6144
  v_mfma_f32_16x16x32_bf16 v[180:183], v[120:123], a[240:243], v[180:183]
  s_waitcnt vmcnt(4) lgkmcnt(8)
  v_mfma_f32_16x16x32_bf16 v[128:131], v[64:67], a[128:131], v[128:131]
  ds_read_b64_tr_b16 v[96:97], v200 offset:8192
  ds_read_b64_tr_b16 v[98:99], v200 offset:10240
  v_mfma_f32_16x16x32_bf16 v[128:131], v[68:71], a[136:139], v[128:131]
  v_mfma_f32_16x16x32_bf16 v[136:139], v[68:71], a[140:143], v[136:139]
  ds_read_b64_tr_b16 v[100:101], v200 offset:12288
  ds_read_b64_tr_b16 v[102:103], v200 offset:14336
  v_mfma_f32_16x16x32_bf16 v[136:139], v[64:67], a[132:135], v[136:139]
  v_mfma_f32_16x16x32_bf16 v[140:143], v[72:75], a[132:135], v[140:143]
  ds_read_b64_tr_b16 v[104:105], v201 offset:8192
  ds_read_b64_tr_b16 v[106:107], v201 offset:10240
  v_mfma_f32_16x16x32_bf16 v[140:143], v[76:79], a[140:143], v[140:143]
  v_mfma_f32_16x16x32_bf16 v[132:135], v[76:79], a[136:139], v[132:135]
  ds_read_b64_tr_b16 v[108:109], v201 offset:12288
  ds_read_b64_tr_b16 v[110:111], v201 offset:14336
  v_mfma_f32_16x16x32_bf16 v[132:135], v[72:75], a[128:131], v[132:135]
  s_waitcnt lgkmcnt(8)
  v_mfma_f32_16x16x32_bf16 v[144:147], v[80:83], a[128:131], v[144:147]
  ds_read_b64_tr_b16 v[112:113], v202 offset:8192
  ds_read_b64_tr_b16 v[114:115], v202 offset:10240
  v_mfma_f32_16x16x32_bf16 v[144:147], v[84:87], a[136:139], v[144:147]
  v_mfma_f32_16x16x32_bf16 v[152:155], v[84:87], a[140:143], v[152:155]
  ds_read_b64_tr_b16 v[116:117], v202 offset:12288
  ds_read_b64_tr_b16 v[118:119], v202 offset:14336
  v_mfma_f32_16x16x32_bf16 v[152:155], v[80:83], a[132:135], v[152:155]
  v_cvt_pk_bf16_f32 v128, v128, v129
  v_cvt_pk_bf16_f32 v129, v130, v131
  v_mfma_f32_16x16x32_bf16 v[156:159], v[88:91], a[132:135], v[156:159]
  ds_read_b64_tr_b16 v[120:121], v203 offset:8192
  ds_read_b64_tr_b16 v[122:123], v203 offset:10240
  v_mfma_f32_16x16x32_bf16 v[156:159], v[92:95], a[140:143], v[156:159]
  v_cvt_pk_bf16_f32 v130, v132, v133
  v_cvt_pk_bf16_f32 v131, v134, v135
  v_mfma_f32_16x16x32_bf16 v[148:151], v[92:95], a[136:139], v[148:151]
  ds_read_b64_tr_b16 v[124:125], v203 offset:12288
  ds_read_b64_tr_b16 v[126:127], v203 offset:14336
  v_mfma_f32_16x16x32_bf16 v[148:151], v[88:91], a[128:131], v[148:151]
  s_waitcnt lgkmcnt(8)
  buffer_store_dwordx4 v[128:131], v1, s[28:31], s72 offen offset:0 sc1
  v_mfma_f32_16x16x32_bf16 v[160:163], v[96:99], a[128:131], v[160:163]
  v_cvt_pk_bf16_f32 v132, v136, v137
  v_cvt_pk_bf16_f32 v133, v138, v139
  v_mfma_f32_16x16x32_bf16 v[160:163], v[100:103], a[136:139], v[160:163]
  v_cvt_pk_bf16_f32 v134, v140, v141
  v_cvt_pk_bf16_f32 v135, v142, v143
  v_mfma_f32_16x16x32_bf16 v[168:171], v[100:103], a[140:143], v[168:171]
  buffer_store_dwordx4 v[132:135], v1, s[28:31], s72 offen offset:1024 sc1
  v_mfma_f32_16x16x32_bf16 v[168:171], v[96:99], a[132:135], v[168:171]
  v_cvt_pk_bf16_f32 v144, v144, v145
  v_cvt_pk_bf16_f32 v145, v146, v147
  v_mfma_f32_16x16x32_bf16 v[172:175], v[104:107], a[132:135], v[172:175]
  v_cvt_pk_bf16_f32 v146, v148, v149
  v_cvt_pk_bf16_f32 v147, v150, v151
  v_mfma_f32_16x16x32_bf16 v[172:175], v[108:111], a[140:143], v[172:175]
  buffer_store_dwordx4 v[144:147], v1, s[28:31], s73 offen offset:0 sc1
  v_mfma_f32_16x16x32_bf16 v[164:167], v[108:111], a[136:139], v[164:167]
  v_cvt_pk_bf16_f32 v148, v152, v153
  v_mfma_f32_16x16x32_bf16 v[164:167], v[104:107], a[128:131], v[164:167]
  s_waitcnt lgkmcnt(0)
  v_cvt_pk_bf16_f32 v149, v154, v155
  v_cvt_pk_bf16_f32 v150, v156, v157
  v_mfma_f32_16x16x32_bf16 v[176:179], v[112:115], a[128:131], v[176:179]
  v_cvt_pk_bf16_f32 v151, v158, v159
  v_mfma_f32_16x16x32_bf16 v[176:179], v[116:119], a[136:139], v[176:179]
  buffer_store_dwordx4 v[148:151], v1, s[28:31], s73 offen offset:1024 sc1
  v_mfma_f32_16x16x32_bf16 v[184:187], v[116:119], a[140:143], v[184:187]
  v_cvt_pk_bf16_f32 v160, v160, v161
  v_cvt_pk_bf16_f32 v161, v162, v163
  v_mfma_f32_16x16x32_bf16 v[184:187], v[112:115], a[132:135], v[184:187]
  v_cvt_pk_bf16_f32 v162, v164, v165
  v_cvt_pk_bf16_f32 v163, v166, v167
  v_mfma_f32_16x16x32_bf16 v[188:191], v[120:123], a[132:135], v[188:191]
  buffer_store_dwordx4 v[160:163], v1, s[28:31], s74 offen offset:0 sc1
  v_mfma_f32_16x16x32_bf16 v[188:191], v[124:127], a[140:143], v[188:191]
  v_cvt_pk_bf16_f32 v164, v168, v169
  v_cvt_pk_bf16_f32 v165, v170, v171
  v_mfma_f32_16x16x32_bf16 v[180:183], v[124:127], a[136:139], v[180:183]
  v_cvt_pk_bf16_f32 v166, v172, v173
  v_cvt_pk_bf16_f32 v167, v174, v175
  v_mfma_f32_16x16x32_bf16 v[180:183], v[120:123], a[128:131], v[180:183]
  buffer_store_dwordx4 v[164:167], v1, s[28:31], s74 offen offset:1024 sc1
  s_nop 3
  s_waitcnt vmcnt(6)
  v_lshlrev_b32 v20, 16, v192
  v_and_b32 v21, 0xffff0000, v192
  v_pk_add_f32 v[176:177], v[176:177], v[20:21]
  v_lshlrev_b32 v20, 16, v193
  v_and_b32 v21, 0xffff0000, v193
  v_pk_add_f32 v[178:179], v[178:179], v[20:21]
  v_lshlrev_b32 v20, 16, v194
  v_and_b32 v21, 0xffff0000, v194
  v_pk_add_f32 v[180:181], v[180:181], v[20:21]
  v_lshlrev_b32 v20, 16, v195
  v_and_b32 v21, 0xffff0000, v195
  v_pk_add_f32 v[182:183], v[182:183], v[20:21]
  v_lshlrev_b32 v20, 16, v196
  v_and_b32 v21, 0xffff0000, v196
  v_pk_add_f32 v[184:185], v[184:185], v[20:21]
  v_lshlrev_b32 v20, 16, v197
  v_and_b32 v21, 0xffff0000, v197
  v_pk_add_f32 v[186:187], v[186:187], v[20:21]
  v_lshlrev_b32 v20, 16, v198
  v_and_b32 v21, 0xffff0000, v198
  v_pk_add_f32 v[188:189], v[188:189], v[20:21]
  v_lshlrev_b32 v20, 16, v199
  v_and_b32 v21, 0xffff0000, v199
  v_pk_add_f32 v[190:191], v[190:191], v[20:21]
  s_waitcnt vmcnt(0)
  s_mov_b32 s96, 0x40000
  s_mov_b64 exec, 1
  v_mov_b32 v29, 1
  buffer_atomic_add v29, off, s[28:31], s77 sc0
  s_waitcnt vmcnt(0)
  v_cmp_gt_u32 vcc, 3, v29
  s_cbranch_vccz L_pollEX_done
L_pollEX:
  v_mov_b32 v29, 0
  buffer_atomic_add v29, off, s[28:31], s77 sc0
  s_waitcnt vmcnt(0)
  v_cmp_gt_u32 vcc, 4, v29
  s_sub_u32 s96, s96, 1
  s_cbranch_scc1 L_pollEX_done
  s_cbranch_vccnz L_pollEX
L_pollEX_done:
  s_mov_b64 exec, -1
  buffer_load_dwordx4 v[200:203], v1, s[28:31], s24 offen offset:0 sc1
  buffer_load_dwordx4 v[204:207], v1, s[28:31], s24 offen offset:1024 sc1
  buffer_load_dwordx4 v[208:211], v1, s[28:31], s25 offen offset:0 sc1
  buffer_load_dwordx4 v[212:215], v1, s[28:31], s25 offen offset:1024 sc1
  buffer_load_dwordx4 v[216:219], v1, s[28:31], s26 offen offset:0 sc1
  buffer_load_dwordx4 v[220:223], v1, s[28:31], s26 offen offset:1024 sc1
  s_waitcnt vmcnt(4)
  v_lshlrev_b32 v20, 16, v200
  v_and_b32 v21, 0xffff0000, v200
  v_pk_add_f32 v[176:177], v[176:177], v[20:21]
  v_lshlrev_b32 v20, 16, v201
  v_and_b32 v21, 0xffff0000, v201
  v_pk_add_f32 v[178:179], v[178:179], v[20:21]
  v_lshlrev_b32 v20, 16, v202
  v_and_b32 v21, 0xffff0000, v202
  v_pk_add_f32 v[180:181], v[180:181], v[20:21]
  v_lshlrev_b32 v20, 16, v203
  v_and_b32 v21, 0xffff0000, v203
  v_pk_add_f32 v[182:183], v[182:183], v[20:21]
  v_lshlrev_b32 v20, 16, v204
  v_and_b32 v21, 0xffff0000, v204
  v_pk_add_f32 v[184:185], v[184:185], v[20:21]
  v_lshlrev_b32 v20, 16, v205
  v_and_b32 v21, 0xffff0000, v205
  v_pk_add_f32 v[186:187], v[186:187], v[20:21]
  v_lshlrev_b32 v20, 16, v206
  v_and_b32 v21, 0xffff0000, v206
  v_pk_add_f32 v[188:189], v[188:189], v[20:21]
  v_lshlrev_b32 v20, 16, v207
  v_and_b32 v21, 0xffff0000, v207
  v_pk_add_f32 v[190:191], v[190:191], v[20:21]
  s_waitcnt vmcnt(2)
  v_lshlrev_b32 v20, 16, v208
  v_and_b32 v21, 0xffff0000, v208
  v_pk_add_f32 v[176:177], v[176:177], v[20:21]
  v_lshlrev_b32 v20, 16, v209
  v_and_b32 v21, 0xffff0000, v209
  v_pk_add_f32 v[178:179], v[178:179], v[20:21]
  v_lshlrev_b32 v20, 16, v210
  v_and_b32 v21, 0xffff0000, v210
  v_pk_add_f32 v[180:181], v[180:181], v[20:21]
  v_lshlrev_b32 v20, 16, v211
  v_and_b32 v21, 0xffff0000, v211
  v_pk_add_f32 v[182:183], v[182:183], v[20:21]
  v_lshlrev_b32 v20, 16, v212
  v_and_b32 v21, 0xffff0000, v212
  v_pk_add_f32 v[184:185], v[184:185], v[20:21]
  v_lshlrev_b32 v20, 16, v213
  v_and_b32 v21, 0xffff0000, v213
  v_pk_add_f32 v[186:187], v[186:187], v[20:21]
  v_lshlrev_b32 v20, 16, v214
  v_and_b32 v21, 0xffff0000, v214
  v_pk_add_f32 v[188:189], v[188:189], v[20:21]
  v_lshlrev_b32 v20, 16, v215
  v_and_b32 v21, 0xffff0000, v215
  v_pk_add_f32 v[190:191], v[190:191], v[20:21]
  s_waitcnt vmcnt(0)
  v_lshlrev_b32 v20, 16, v216
  v_and_b32 v21, 0xffff0000, v216
  v_pk_add_f32 v[176:177], v[176:177], v[20:21]
  v_lshlrev_b32 v20, 16, v217
  v_and_b32 v21, 0xffff0000, v217
  v_pk_add_f32 v[178:179], v[178:179], v[20:21]
  v_lshlrev_b32 v20, 16, v218
  v_and_b32 v21, 0xffff0000, v218
  v_pk_add_f32 v[180:181], v[180:181], v[20:21]
  v_lshlrev_b32 v20, 16, v219
  v_and_b32 v21, 0xffff0000, v219
  v_pk_add_f32 v[182:183], v[182:183], v[20:21]
  v_lshlrev_b32 v20, 16, v220
  v_and_b32 v21, 0xffff0000, v220
  v_pk_add_f32 v[184:185], v[184:185], v[20:21]
  v_lshlrev_b32 v20, 16, v221
  v_and_b32 v21, 0xffff0000, v221
  v_pk_add_f32 v[186:187], v[186:187], v[20:21]
  v_lshlrev_b32 v20, 16, v222
  v_and_b32 v21, 0xffff0000, v222
  v_pk_add_f32 v[188:189], v[188:189], v[20:21]
  v_lshlrev_b32 v20, 16, v223
  v_and_b32 v21, 0xffff0000, v223
  v_pk_add_f32 v[190:191], v[190:191], v[20:21]
  v_cvt_pk_bf16_f32 v176, v176, v177
  v_cvt_pk_bf16_f32 v177, v178, v179
  v_cvt_pk_bf16_f32 v178, v180, v181
  v_cvt_pk_bf16_f32 v179, v182, v183
  v_cvt_pk_bf16_f32 v180, v184, v185
  v_cvt_pk_bf16_f32 v181, v186, v187
  v_cvt_pk_bf16_f32 v182, v188, v189
  v_cvt_pk_bf16_f32 v183, v190, v191
  s_nop 1
  v_permlane16_swap_b32 v176, v178
  v_permlane16_swap_b32 v177, v179
  v_permlane16_swap_b32 v180, v182
  v_permlane16_swap_b32 v181, v183
  buffer_store_dwordx4 v[176:179], v23, s[16:19], s68 offen
  buffer_store_dwordx4 v[180:183], v23, s[16:19], s69 offen
L_end:
  s_endpgm
L_pad15:
  s_cbranch_execz L_padret
L_pollLN:
  s_mov_b32 s96, 0x40000
L_pollLN_l:
  s_sleep 2
  buffer_load_dword v29, v26, s[40:43], 0 offen sc1
  s_waitcnt vmcnt(0)
  v_cmp_gt_u32 vcc, 4, v29
  s_sub_u32 s96, s96, 1
  s_cbranch_scc1 L_pollLN_back
  s_cbranch_vccnz L_pollLN_l
  s_branch L_pollLN_back
L_xrel:
  s_mov_b32 s71, 1
  buffer_wbl2 sc1
  s_waitcnt vmcnt(0)
  s_branch L_xrel_back
L_pollKV:
  s_mov_b32 s96, 0x40000
L_pollKV_l:
  buffer_load_dword v29, v27, s[28:31], s80 offen sc1
  s_waitcnt vmcnt(0)
  v_cmp_gt_u32 vcc, 0x100, v29
  s_sub_u32 s96, s96, 1
  s_cbranch_scc1 L_pollKV_back
  s_cbranch_vccnz L_pollKV_l
  s_branch L_pollKV_back
L_xacq:
  buffer_inv sc1
  s_waitcnt vmcnt(0)
  s_branch L_xacq_back
L_mask0:
  v_cndmask_b32 v96, v96, v7, s[64:65]
  v_cndmask_b32 v97, v97, v7, s[66:67]
  v_cndmask_b32 v98, v98, v7, s[68:69]
  v_cndmask_b32 v99, v99, v7, s[70:71]
  v_cndmask_b32 v108, v108, v7, s[64:65]
  v_cndmask_b32 v109, v109, v7, s[66:67]
  v_cndmask_b32 v110, v110, v7, s[68:69]
  v_cndmask_b32 v111, v111, v7, s[70:71]
  v_mov_b32 v100, v7
  v_mov_b32 v101, v7
  v_mov_b32 v102, v7
  v_mov_b32 v103, v7
  s_nop 1
  s_branch L_mask0_back
L_site0:
  s_call_b64 s[46:47], L_rare_0_192_0
  s_branch L_back0
L_site1:
  s_call_b64 s[46:47], L_rare_1_208_0
  s_branch L_back1
L_site3:
  s_call_b64 s[46:47], L_rare_1_208_1
  s_branch L_back3
L_site4:
  s_call_b64 s[46:47], L_rare_1_192_1
  s_branch L_back4
L_site5:
  s_call_b64 s[46:47], L_rare_1_208_1
  s_branch L_back5
L_site7:
  s_call_b64 s[46:47], L_rare_1_208_1
  s_branch L_back7
L_site8:
  s_call_b64 s[46:47], L_rare_1_192_0
  s_branch L_back8
L_site9:
  s_call_b64 s[46:47], L_rare_0_192_0
  s_branch L_back9
L_mB0:
  v_cndmask_b32 v112, v112, v7, s[64:65]
  v_cndmask_b32 v113, v113, v7, s[66:67]
  v_cndmask_b32 v114, v114, v7, s[68:69]
  v_cndmask_b32 v115, v115, v7, s[70:71]
  v_cndmask_b32 v124, v124, v7, s[64:65]
  v_cndmask_b32 v125, v125, v7, s[66:67]
  v_cndmask_b32 v126, v126, v7, s[68:69]
  v_cndmask_b32 v127, v127, v7, s[70:71]
  v_mov_b32 v116, v7
  v_mov_b32 v117, v7
  v_mov_b32 v118, v7
  v_mov_b32 v119, v7
  s_nop 1
  s_branch L_mB0_back
L_pollACT:
  s_mov_b32 s96, 0x40000
L_pollACT_l:
  buffer_load_dword v29, v27, s[28:31], s101 offen sc1
  s_waitcnt vmcnt(0)
  v_cmp_ne_u32 vcc, 1, v29
  s_sub_u32 s96, s96, 1
  s_cbranch_scc1 L_pollACT_back
  s_cbranch_vccnz L_pollACT_l
  s_branch L_pollACT_back
L_site10:
  s_call_b64 s[46:47], L_rare_1_192_1
  s_branch L_back10
L_site11:
  s_call_b64 s[46:47], L_rare_1_208_1
  s_branch L_back11
L_site12:
  s_call_b64 s[46:47], L_rare_1_192_1
  s_branch L_back12
L_site13:
  s_call_b64 s[46:47], L_rare_1_192_1
  s_branch L_back13
L_site14:
  s_call_b64 s[46:47], L_rare_1_208_1
  s_branch L_back14
L_site15:
  s_call_b64 s[46:47], L_rare_1_192_1
  s_branch L_back15
L_site16:
  s_call_b64 s[46:47], L_rare_1_208_1
  s_branch L_back16
L_site17:
  s_call_b64 s[46:47], L_rare_1_192_1
  s_branch L_back17
L_site18:
  s_call_b64 s[46:47], L_rare_1_208_1
  s_branch L_back18
L_pollCTX:
  s_mov_b32 s96, 0x40000
  s_mov_b64 exec, 0xff
L_pollCTX_l:
  v_mov_b32 v29, 0
  buffer_atomic_or v29, v27, s[28:31], s66 offen sc0
  s_waitcnt vmcnt(0)
  v_cmp_ne_u32 vcc, 1, v29
  s_sub_u32 s96, s96, 1
  s_cbranch_scc1 L_pollCTX_x
  s_cbranch_vccnz L_pollCTX_l
L_pollCTX_x:
  s_mov_b64 exec, -1
  s_branch L_pollCTX_back
.p2align 12
.p2align 6
L_pad16:
  s_cbranch_execz L_padret
.p2align 5
L_Z1:
  v_mfma_f32_16x16x32_bf16 v[84:87], v[228:231], v[144:147], v[84:87]
  s_waitcnt lgkmcnt(5)
  v_exp_f32 v128, v208
  v_mfma_f32_16x16x32_bf16 a[64:67], a[160:163], v[144:147], a[64:67]
  s_add_u32 s54, s54, 0x4000
  ds_read_b128 a[148:151], v2 offset:5120
  v_exp_f32 v129, v209
  v_mfma_f32_16x16x32_bf16 a[72:75], a[160:163], v[148:151], a[72:75]
  s_bitset0_b32 s54, 17
  v_exp_f32 v130, v210
  v_mfma_f32_16x16x32_bf16 a[76:79], a[164:167], v[148:151], a[76:79]
  s_add_u32 s53, s53, 0x8000
  ds_read_b128 a[152:155], v2 offset:6144
  v_cvt_pk_bf16_f32 v152, v128, v129
  v_mfma_f32_16x16x32_bf16 a[68:71], a[164:167], v[144:147], a[68:71]
  v_exp_f32 v131, v211
  v_mfma_f32_16x16x32_bf16 a[80:83], a[168:171], v[144:147], a[80:83]
  ds_read_b128 a[156:159], v2 offset:7168
  v_exp_f32 v132, v212
  v_mfma_f32_16x16x32_bf16 a[88:91], a[168:171], v[148:151], a[88:91]
  buffer_load_dwordx4 v1, s[36:39], s52 offen offset:2048 sc1 lds
  v_mfma_f32_16x16x32_bf16 a[92:95], a[172:175], v[148:151], a[92:95]
  ds_read_b128 a[160:163], v3 offset:8192
  v_cvt_pk_bf16_f32 v153, v130, v131
  v_mfma_f32_16x16x32_bf16 a[84:87], a[172:175], v[144:147], a[84:87]
  v_exp_f32 v133, v213
  v_mfma_f32_16x16x32_bf16 a[96:99], a[176:179], v[144:147], a[96:99]
  ds_read_b128 a[164:167], v3 offset:9216
  v_exp_f32 v134, v214
  v_mfma_f32_16x16x32_bf16 a[104:107], a[176:179], v[148:151], a[104:107]
  v_exp_f32 v135, v215
  v_mfma_f32_16x16x32_bf16 a[108:111], a[180:183], v[148:151], a[108:111]
  s_waitcnt vmcnt(7)
  ds_read_b128 a[168:171], v3 offset:10240
  v_cvt_pk_bf16_f32 v154, v132, v133
  v_mfma_f32_16x16x32_bf16 a[100:103], a[180:183], v[144:147], a[100:103]
  v_exp_f32 v136, v216
  v_mfma_f32_16x16x32_bf16 a[112:115], a[184:187], v[144:147], a[112:115]
  ds_read_b128 a[172:175], v3 offset:11264
  v_cvt_pk_bf16_f32 v155, v134, v135
  v_mfma_f32_16x16x32_bf16 a[120:123], a[184:187], v[148:151], a[120:123]
  buffer_load_dwordx4 v1, s[36:39], s52 offen offset:3072 sc1 lds
  v_mfma_f32_16x16x32_bf16 a[124:127], a[188:191], v[148:151], a[124:127]
  v_exp_f32 v137, v217
  v_mfma_f32_16x16x32_bf16 a[116:119], a[188:191], v[144:147], a[116:119]
  s_waitcnt lgkmcnt(4)
  v_exp_f32 v138, v218
  v_mfma_f32_16x16x32_bf16 v[192:195], a[128:131], v[168:171], v[112:115]
  ds_read_b128 a[176:179], v3 offset:12288
  v_or3_b32 v5, v152, v153, v154
  v_mfma_f32_16x16x32_bf16 v[192:195], a[132:135], v[184:187], v[192:195]
  s_cmp_lt_u32 s53, s38
  v_exp_f32 v139, v219
  v_mfma_f32_16x16x32_bf16 v[192:195], a[136:139], v[80:83], v[192:195]
  s_barrier
  ds_read_b128 a[180:183], v3 offset:13312
  v_cvt_pk_bf16_f32 v156, v136, v137
  v_mfma_f32_16x16x32_bf16 v[192:195], a[140:143], v[240:243], v[192:195]
  s_cselect_b32 m0, s54, 0x30000
  v_exp_f32 v140, v220
  v_mfma_f32_16x16x32_bf16 v[200:203], a[140:143], v[248:251], v[120:123]
  ds_read_b128 a[184:187], v3 offset:14336
  v_or3_b32 v5, v5, v155, v156
  v_mfma_f32_16x16x32_bf16 v[200:203], a[136:139], v[88:91], v[200:203]
  v_exp_f32 v141, v221
  v_mfma_f32_16x16x32_bf16 v[200:203], a[132:135], v[188:191], v[200:203]
  ds_read_b128 a[188:191], v3 offset:15360
  v_and_or_b32 v3, s53, v4, v1
  v_mfma_f32_16x16x32_bf16 v[200:203], a[128:131], v[172:175], v[200:203]
  buffer_load_dwordx4 v1, s[36:39], s53 offen offset:0 sc1 lds
  v_mfma_f32_16x16x32_bf16 v[204:207], a[144:147], v[172:175], v[124:127]
  ds_read_b128 a[128:131], v3 offset:0
  v_cvt_pk_bf16_f32 v157, v138, v139
  v_exp_f32 v142, v222
  v_mfma_f32_16x16x32_bf16 v[204:207], a[148:151], v[188:191], v[204:207]
  v_exp_f32_e64 v143, v223
  v_mfma_f32_16x16x32_bf16 v[204:207], a[152:155], v[88:91], v[204:207]
  ds_read_b128 a[132:135], v3 offset:1024
  v_cvt_pk_bf16_f32 v158, v140, v141
  v_mfma_f32_16x16x32_bf16 v[204:207], a[156:159], v[248:251], v[204:207]
  v_or3_b32 v5, v5, v157, v158
  v_cvt_pk_bf16_f32 v159, v142, v143
  v_mfma_f32_16x16x32_bf16 v[196:199], a[156:159], v[240:243], v[116:119]
  v_bitop3_b32 v5, v5, v159, v6 bitop3:0xa8
  v_cmp_ne_u32 vcc, 0, v5
  v_mfma_f32_16x16x32_bf16 v[196:199], a[152:155], v[80:83], v[196:199]
  ds_read_b128 a[136:139], v3 offset:2048
  ds_read_b128 a[140:143], v3 offset:3072
  v_mfma_f32_16x16x32_bf16 v[196:199], a[148:151], v[184:187], v[196:199]
  buffer_load_dwordx4 v1, s[36:39], s53 offen offset:1024 sc1 lds
  v_mfma_f32_16x16x32_bf16 v[196:199], a[144:147], v[168:171], v[196:199]
  s_cbranch_vccnz L_site14
L_back14:
  ds_read_b128 a[144:147], v3 offset:4096
  v_mfma_f32_16x16x32_bf16 v[92:95], v[228:231], v[156:159], v[92:95]
  v_exp_f32 v128, v192
  v_mfma_f32_16x16x32_bf16 v[84:87], v[228:231], v[152:155], v[84:87]
  s_waitcnt lgkmcnt(5)
  v_exp_f32 v129, v193
  v_mfma_f32_16x16x32_bf16 a[64:67], a[160:163], v[152:155], a[64:67]
  s_add_u32 s54, s54, 0x4000
  ds_read_b128 a[148:151], v3 offset:5120
  v_exp_f32 v130, v194
  v_mfma_f32_16x16x32_bf16 a[72:75], a[160:163], v[156:159], a[72:75]
  s_bitset0_b32 s54, 17
  v_exp_f32 v131, v195
  v_mfma_f32_16x16x32_bf16 a[76:79], a[164:167], v[156:159], a[76:79]
  s_add_u32 s52, s52, 0x8000
  ds_read_b128 a[152:155], v3 offset:6144
  v_cvt_pk_bf16_f32 v144, v128, v129
  v_mfma_f32_16x16x32_bf16 a[68:71], a[164:167], v[152:155], a[68:71]
  v_exp_f32 v132, v196
  v_mfma_f32_16x16x32_bf16 a[80:83], a[168:171], v[152:155], a[80:83]
  ds_read_b128 a[156:159], v3 offset:7168
  v_cvt_pk_bf16_f32 v145, v130, v131
  v_mfma_f32_16x16x32_bf16 a[88:91], a[168:171], v[156:159], a[88:91]
  buffer_load_dwordx4 v1, s[36:39], s53 offen offset:2048 sc1 lds
  v_mfma_f32_16x16x32_bf16 a[92:95], a[172:175], v[156:159], a[92:95]
  ds_read_b128 a[160:163], v2 offset:8192
  v_exp_f32 v133, v197
  v_mfma_f32_16x16x32_bf16 a[84:87], a[172:175], v[152:155], a[84:87]
  v_exp_f32 v134, v198
  v_mfma_f32_16x16x32_bf16 a[96:99], a[176:179], v[152:155], a[96:99]
  ds_read_b128 a[164:167], v2 offset:9216
  v_cvt_pk_bf16_f32 v146, v132, v133
  v_mfma_f32_16x16x32_bf16 a[104:107], a[176:179], v[156:159], a[104:107]
  v_exp_f32 v135, v199
  v_mfma_f32_16x16x32_bf16 a[108:111], a[180:183], v[156:159], a[108:111]
  s_waitcnt vmcnt(7)
  ds_read_b128 a[168:171], v2 offset:10240
  v_exp_f32 v136, v200
  v_mfma_f32_16x16x32_bf16 a[100:103], a[180:183], v[152:155], a[100:103]
  v_exp_f32 v137, v201
  v_mfma_f32_16x16x32_bf16 a[112:115], a[184:187], v[152:155], a[112:115]
  ds_read_b128 a[172:175], v2 offset:11264
  v_cvt_pk_bf16_f32 v147, v134, v135
  v_mfma_f32_16x16x32_bf16 a[120:123], a[184:187], v[156:159], a[120:123]
  buffer_load_dwordx4 v1, s[36:39], s53 offen offset:3072 sc1 lds
  v_mfma_f32_16x16x32_bf16 a[124:127], a[188:191], v[156:159], a[124:127]
  v_exp_f32 v138, v202
  v_mfma_f32_16x16x32_bf16 a[116:119], a[188:191], v[152:155], a[116:119]
  s_waitcnt lgkmcnt(4)
  v_exp_f32 v139, v203
  v_mfma_f32_16x16x32_bf16 v[208:211], a[128:131], v[168:171], v[112:115]
  ds_read_b128 a[176:179], v2 offset:12288
  v_or3_b32 v5, v144, v145, v146
  v_mfma_f32_16x16x32_bf16 v[208:211], a[132:135], v[184:187], v[208:211]
  s_cmp_lt_u32 s52, s38
  v_exp_f32 v140, v204
  v_mfma_f32_16x16x32_bf16 v[208:211], a[136:139], v[80:83], v[208:211]
  s_barrier
  ds_read_b128 a[180:183], v2 offset:13312
  v_cvt_pk_bf16_f32 v148, v136, v137
  v_mfma_f32_16x16x32_bf16 v[208:211], a[140:143], v[240:243], v[208:211]
  s_cselect_b32 m0, s54, 0x30000
  v_exp_f32_e64 v141, v205
  v_mfma_f32_16x16x32_bf16 v[216:219], a[140:143], v[248:251], v[120:123]
  ds_read_b128 a[184:187], v2 offset:14336
  v_or3_b32 v5, v5, v147, v148
  v_mfma_f32_16x16x32_bf16 v[216:219], a[136:139], v[88:91], v[216:219]
  v_exp_f32_e64 v142, v206
  v_mfma_f32_16x16x32_bf16 v[216:219], a[132:135], v[188:191], v[216:219]
  ds_read_b128 a[188:191], v2 offset:15360
  v_and_or_b32 v2, s52, v4, v1
  v_mfma_f32_16x16x32_bf16 v[216:219], a[128:131], v[172:175], v[216:219]
  buffer_load_dwordx4 v1, s[36:39], s52 offen offset:0 sc1 lds
  v_mfma_f32_16x16x32_bf16 v[220:223], a[144:147], v[172:175], v[124:127]
  ds_read_b128 a[128:131], v2 offset:0
  v_cvt_pk_bf16_f32 v149, v138, v139
  v_mfma_f32_16x16x32_bf16 v[220:223], a[148:151], v[188:191], v[220:223]
  s_sub_u32 s56, s56, 1
  v_exp_f32_e64 v143, v207
  v_mfma_f32_16x16x32_bf16 v[220:223], a[152:155], v[88:91], v[220:223]
  ds_read_b128 a[132:135], v2 offset:1024
  v_cvt_pk_bf16_f32 v150, v140, v141
  v_mfma_f32_16x16x32_bf16 v[220:223], a[156:159], v[248:251], v[220:223]
  v_or3_b32 v5, v5, v149, v150
  v_cvt_pk_bf16_f32 v151, v142, v143
  v_mfma_f32_16x16x32_bf16 v[212:215], a[156:159], v[240:243], v[116:119]
  v_bitop3_b32 v5, v5, v151, v6 bitop3:0xa8
  v_cmp_ne_u32 vcc, 0, v5
  v_mfma_f32_16x16x32_bf16 v[212:215], a[152:155], v[80:83], v[212:215]
  ds_read_b128 a[136:139], v2 offset:2048
  ds_read_b128 a[140:143], v2 offset:3072
  v_mfma_f32_16x16x32_bf16 v[212:215], a[148:151], v[184:187], v[212:215]
  buffer_load_dwordx4 v1, s[36:39], s52 offen offset:1024 sc1 lds
  v_mfma_f32_16x16x32_bf16 v[212:215], a[144:147], v[168:171], v[212:215]
  s_cbranch_vccnz L_site13
L_back13:
  ds_read_b128 a[144:147], v2 offset:4096
  v_mfma_f32_16x16x32_bf16 v[92:95], v[228:231], v[148:151], v[92:95]
  s_cbranch_scc0 L_Z1
  s_branch L_Zx
.p2align 6
L_pad17:
  s_cbranch_execz L_padret
.p2align 5
L_Z2:
  v_mfma_f32_16x16x32_bf16 v[84:87], v[228:231], v[144:147], v[84:87]
  s_waitcnt lgkmcnt(5)
  v_exp_f32 v128, v208
  v_mfma_f32_16x16x32_bf16 a[64:67], a[160:163], v[144:147], a[64:67]
  s_add_u32 s54, s54, 0x4000
  ds_read_b128 a[148:151], v2 offset:5120
  v_exp_f32 v129, v209
  v_mfma_f32_16x16x32_bf16 a[72:75], a[160:163], v[148:151], a[72:75]
  s_bitset0_b32 s54, 17
  v_exp_f32 v130, v210
  v_mfma_f32_16x16x32_bf16 a[76:79], a[164:167], v[148:151], a[76:79]
  s_add_u32 s53, s53, 0x8000
  ds_read_b128 a[152:155], v2 offset:6144
  v_cvt_pk_bf16_f32 v152, v128, v129
  v_mfma_f32_16x16x32_bf16 a[68:71], a[164:167], v[144:147], a[68:71]
  v_exp_f32 v131, v211
  v_mfma_f32_16x16x32_bf16 a[80:83], a[168:171], v[144:147], a[80:83]
  ds_read_b128 a[156:159], v2 offset:7168
  v_exp_f32 v132, v212
  v_mfma_f32_16x16x32_bf16 a[88:91], a[168:171], v[148:151], a[88:91]
  buffer_load_dwordx4 v1, s[36:39], s52 offen offset:2048 sc1 lds
  v_mfma_f32_16x16x32_bf16 a[92:95], a[172:175], v[148:151], a[92:95]
  ds_read_b128 a[160:163], v3 offset:8192
  v_cvt_pk_bf16_f32 v153, v130, v131
  v_mfma_f32_16x16x32_bf16 a[84:87], a[172:175], v[144:147], a[84:87]
  v_exp_f32 v133, v213
  v_mfma_f32_16x16x32_bf16 a[96:99], a[176:179], v[144:147], a[96:99]
  ds_read_b128 a[164:167], v3 offset:9216
  v_exp_f32 v134, v214
  v_mfma_f32_16x16x32_bf16 a[104:107], a[176:179], v[148:151], a[104:107]
  v_exp_f32 v135, v215
  v_mfma_f32_16x16x32_bf16 a[108:111], a[180:183], v[148:151], a[108:111]
  s_waitcnt vmcnt(7)
  ds_read_b128 a[168:171], v3 offset:10240
  v_cvt_pk_bf16_f32 v154, v132, v133
  v_mfma_f32_16x16x32_bf16 a[100:103], a[180:183], v[144:147], a[100:103]
  v_exp_f32 v136, v216
  v_mfma_f32_16x16x32_bf16 a[112:115], a[184:187], v[144:147], a[112:115]
  ds_read_b128 a[172:175], v3 offset:11264
  v_cvt_pk_bf16_f32 v155, v134, v135
  v_mfma_f32_16x16x32_bf16 a[120:123], a[184:187], v[148:151], a[120:123]
  buffer_load_dwordx4 v1, s[36:39], s52 offen offset:3072 sc1 lds
  v_mfma_f32_16x16x32_bf16 a[124:127], a[188:191], v[148:151], a[124:127]
  v_exp_f32 v137, v217
  v_mfma_f32_16x16x32_bf16 a[116:119], a[188:191], v[144:147], a[116:119]
  s_waitcnt lgkmcnt(4)
  v_exp_f32 v138, v218
  v_mfma_f32_16x16x32_bf16 v[192:195], a[128:131], v[168:171], v[112:115]
  ds_read_b128 a[176:179], v3 offset:12288
  v_or3_b32 v5, v152, v153, v154
  v_mfma_f32_16x16x32_bf16 v[192:195], a[132:135], v[184:187], v[192:195]
  s_cmp_lt_u32 s53, s38
  v_exp_f32 v139, v219
  v_mfma_f32_16x16x32_bf16 v[192:195], a[136:139], v[80:83], v[192:195]
  ds_read_b128 a[180:183], v3 offset:13312
  v_cvt_pk_bf16_f32 v156, v136, v137
  v_mfma_f32_16x16x32_bf16 v[192:195], a[140:143], v[240:243], v[192:195]
  s_cselect_b32 m0, s54, 0x30000
  v_exp_f32 v140, v220
  v_mfma_f32_16x16x32_bf16 v[200:203], a[140:143], v[248:251], v[120:123]
  s_barrier
  ds_read_b128 a[184:187], v3 offset:14336
  v_or3_b32 v5, v5, v155, v156
  v_mfma_f32_16x16x32_bf16 v[200:203], a[136:139], v[88:91], v[200:203]
  v_exp_f32 v141, v221
  v_mfma_f32_16x16x32_bf16 v[200:203], a[132:135], v[188:191], v[200:203]
  ds_read_b128 a[188:191], v3 offset:15360
  v_and_or_b32 v3, s53, v4, v1
  v_mfma_f32_16x16x32_bf16 v[200:203], a[128:131], v[172:175], v[200:203]
  buffer_load_dwordx4 v1, s[36:39], s53 offen offset:0 sc1 lds
  v_mfma_f32_16x16x32_bf16 v[204:207], a[144:147], v[172:175], v[124:127]
  ds_read_b128 a[128:131], v3 offset:0
  v_cvt_pk_bf16_f32 v157, v138, v139
  v_exp_f32 v142, v222
  v_mfma_f32_16x16x32_bf16 v[204:207], a[148:151], v[188:191], v[204:207]
  v_exp_f32_e64 v143, v223
  v_mfma_f32_16x16x32_bf16 v[204:207], a[152:155], v[88:91], v[204:207]
  ds_read_b128 a[132:135], v3 offset:1024
  v_cvt_pk_bf16_f32 v158, v140, v141
  v_mfma_f32_16x16x32_bf16 v[204:207], a[156:159], v[248:251], v[204:207]
  v_or3_b32 v5, v5, v157, v158
  v_cvt_pk_bf16_f32 v159, v142, v143
  v_mfma_f32_16x16x32_bf16 v[196:199], a[156:159], v[240:243], v[116:119]
  v_bitop3_b32 v5, v5, v159, v6 bitop3:0xa8
  v_cmp_ne_u32 vcc, 0, v5
  v_mfma_f32_16x16x32_bf16 v[196:199], a[152:155], v[80:83], v[196:199]
  ds_read_b128 a[136:139], v3 offset:2048
  ds_read_b128 a[140:143], v3 offset:3072
  v_mfma_f32_16x16x32_bf16 v[196:199], a[148:151], v[184:187], v[196:199]
  buffer_load_dwordx4 v1, s[36:39], s53 offen offset:1024 sc1 lds
  v_mfma_f32_16x16x32_bf16 v[196:199], a[144:147], v[168:171], v[196:199]
  s_cbranch_vccnz L_site16
L_back16:
  ds_read_b128 a[144:147], v3 offset:4096
  v_mfma_f32_16x16x32_bf16 v[92:95], v[228:231], v[156:159], v[92:95]
  v_exp_f32 v128, v192
  v_mfma_f32_16x16x32_bf16 v[84:87], v[228:231], v[152:155], v[84:87]
  s_waitcnt lgkmcnt(5)
  v_exp_f32 v129, v193
  v_mfma_f32_16x16x32_bf16 a[64:67], a[160:163], v[152:155], a[64:67]
  s_add_u32 s54, s54, 0x4000
  ds_read_b128 a[148:151], v3 offset:5120
  v_exp_f32 v130, v194
  v_mfma_f32_16x16x32_bf16 a[72:75], a[160:163], v[156:159], a[72:75]
  s_bitset0_b32 s54, 17
  v_exp_f32 v131, v195
  v_mfma_f32_16x16x32_bf16 a[76:79], a[164:167], v[156:159], a[76:79]
  s_add_u32 s52, s52, 0x8000
  ds_read_b128 a[152:155], v3 offset:6144
  v_cvt_pk_bf16_f32 v144, v128, v129
  v_mfma_f32_16x16x32_bf16 a[68:71], a[164:167], v[152:155], a[68:71]
  v_exp_f32 v132, v196
  v_mfma_f32_16x16x32_bf16 a[80:83], a[168:171], v[152:155], a[80:83]
  ds_read_b128 a[156:159], v3 offset:7168
  v_cvt_pk_bf16_f32 v145, v130, v131
  v_mfma_f32_16x16x32_bf16 a[88:91], a[168:171], v[156:159], a[88:91]
  buffer_load_dwordx4 v1, s[36:39], s53 offen offset:2048 sc1 lds
  v_mfma_f32_16x16x32_bf16 a[92:95], a[172:175], v[156:159], a[92:95]
  ds_read_b128 a[160:163], v2 offset:8192
  v_exp_f32 v133, v197
  v_mfma_f32_16x16x32_bf16 a[84:87], a[172:175], v[152:155], a[84:87]
  v_exp_f32 v134, v198
  v_mfma_f32_16x16x32_bf16 a[96:99], a[176:179], v[152:155], a[96:99]
  ds_read_b128 a[164:167], v2 offset:9216
  v_cvt_pk_bf16_f32 v146, v132, v133
  v_mfma_f32_16x16x32_bf16 a[104:107], a[176:179], v[156:159], a[104:107]
  v_exp_f32 v135, v199
  v_mfma_f32_16x16x32_bf16 a[108:111], a[180:183], v[156:159], a[108:111]
  s_waitcnt vmcnt(7)
  ds_read_b128 a[168:171], v2 offset:10240
  v_exp_f32 v136, v200
  v_mfma_f32_16x16x32_bf16 a[100:103], a[180:183], v[152:155], a[100:103]
  v_exp_f32 v137, v201
  v_mfma_f32_16x16x32_bf16 a[112:115], a[184:187], v[152:155], a[112:115]
  ds_read_b128 a[172:175], v2 offset:11264
  v_cvt_pk_bf16_f32 v147, v134, v135
  v_mfma_f32_16x16x32_bf16 a[120:123], a[184:187], v[156:159], a[120:123]
  buffer_load_dwordx4 v1, s[36:39], s53 offen offset:3072 sc1 lds
  v_mfma_f32_16x16x32_bf16 a[124:127], a[188:191], v[156:159], a[124:127]
  v_exp_f32 v138, v202
  v_mfma_f32_16x16x32_bf16 a[116:119], a[188:191], v[152:155], a[116:119]
  s_waitcnt lgkmcnt(4)
  v_exp_f32 v139, v203
  v_mfma_f32_16x16x32_bf16 v[208:211], a[128:131], v[168:171], v[112:115]
  ds_read_b128 a[176:179], v2 offset:12288
  v_or3_b32 v5, v144, v145, v146
  v_mfma_f32_16x16x32_bf16 v[208:211], a[132:135], v[184:187], v[208:211]
  s_cmp_lt_u32 s52, s38
  v_exp_f32 v140, v204
  v_mfma_f32_16x16x32_bf16 v[208:211], a[136:139], v[80:83], v[208:211]
  ds_read_b128 a[180:183], v2 offset:13312
  v_cvt_pk_bf16_f32 v148, v136, v137
  v_mfma_f32_16x16x32_bf16 v[208:211], a[140:143], v[240:243], v[208:211]
  s_cselect_b32 m0, s54, 0x30000
  v_exp_f32_e64 v141, v205
  v_mfma_f32_16x16x32_bf16 v[216:219], a[140:143], v[248:251], v[120:123]
  s_barrier
  ds_read_b128 a[184:187], v2 offset:14336
  v_or3_b32 v5, v5, v147, v148
  v_mfma_f32_16x16x32_bf16 v[216:219], a[136:139], v[88:91], v[216:219]
  v_exp_f32_e64 v142, v206
  v_mfma_f32_16x16x32_bf16 v[216:219], a[132:135], v[188:191], v[216:219]
  ds_read_b128 a[188:191], v2 offset:15360
  v_and_or_b32 v2, s52, v4, v1
  v_mfma_f32_16x16x32_bf16 v[216:219], a[128:131], v[172:175], v[216:219]
  buffer_load_dwordx4 v1, s[36:39], s52 offen offset:0 sc1 lds
  v_mfma_f32_16x16x32_bf16 v[220:223], a[144:147], v[172:175], v[124:127]
  ds_read_b128 a[128:131], v2 offset:0
  v_cvt_pk_bf16_f32 v149, v138, v139
  v_mfma_f32_16x16x32_bf16 v[220:223], a[148:151], v[188:191], v[220:223]
  s_sub_u32 s56, s56, 1
  v_exp_f32_e64 v143, v207
  v_mfma_f32_16x16x32_bf16 v[220:223], a[152:155], v[88:91], v[220:223]
  ds_read_b128 a[132:135], v2 offset:1024
  v_cvt_pk_bf16_f32 v150, v140, v141
  v_mfma_f32_16x16x32_bf16 v[220:223], a[156:159], v[248:251], v[220:223]
  v_or3_b32 v5, v5, v149, v150
  v_cvt_pk_bf16_f32 v151, v142, v143
  v_mfma_f32_16x16x32_bf16 v[212:215], a[156:159], v[240:243], v[116:119]
  v_bitop3_b32 v5, v5, v151, v6 bitop3:0xa8
  v_cmp_ne_u32 vcc, 0, v5
  v_mfma_f32_16x16x32_bf16 v[212:215], a[152:155], v[80:83], v[212:215]
  ds_read_b128 a[136:139], v2 offset:2048
  ds_read_b128 a[140:143], v2 offset:3072
  v_mfma_f32_16x16x32_bf16 v[212:215], a[148:151], v[184:187], v[212:215]
  buffer_load_dwordx4 v1, s[36:39], s52 offen offset:1024 sc1 lds
  v_mfma_f32_16x16x32_bf16 v[212:215], a[144:147], v[168:171], v[212:215]
  s_cbranch_vccnz L_site15
L_back15:
  ds_read_b128 a[144:147], v2 offset:4096
  v_mfma_f32_16x16x32_bf16 v[92:95], v[228:231], v[148:151], v[92:95]
  s_cbranch_scc0 L_Z2
  s_branch L_Zx
.p2align 12
.p2align 6
L_pad18:
  s_cbranch_execz L_padret
.p2align 5
L_Z3:
  v_mfma_f32_16x16x32_bf16 v[84:87], v[228:231], v[144:147], v[84:87]
  s_waitcnt lgkmcnt(5)
  v_exp_f32 v128, v208
  v_mfma_f32_16x16x32_bf16 a[64:67], a[160:163], v[144:147], a[64:67]
  s_add_u32 s54, s54, 0x4000
  ds_read_b128 a[148:151], v2 offset:5120
  v_exp_f32 v129, v209
  v_mfma_f32_16x16x32_bf16 a[72:75], a[160:163], v[148:151], a[72:75]
  s_bitset0_b32 s54, 17
  v_exp_f32 v130, v210
  v_mfma_f32_16x16x32_bf16 a[76:79], a[164:167], v[148:151], a[76:79]
  s_add_u32 s53, s53, 0x8000
  ds_read_b128 a[152:155], v2 offset:6144
  v_cvt_pk_bf16_f32 v152, v128, v129
  v_mfma_f32_16x16x32_bf16 a[68:71], a[164:167], v[144:147], a[68:71]
  v_exp_f32 v131, v211
  v_mfma_f32_16x16x32_bf16 a[80:83], a[168:171], v[144:147], a[80:83]
  ds_read_b128 a[156:159], v2 offset:7168
  v_exp_f32 v132, v212
  v_mfma_f32_16x16x32_bf16 a[88:91], a[168:171], v[148:151], a[88:91]
  buffer_load_dwordx4 v1, s[36:39], s52 offen offset:2048 sc1 lds
  v_mfma_f32_16x16x32_bf16 a[92:95], a[172:175], v[148:151], a[92:95]
  ds_read_b128 a[160:163], v3 offset:8192
  v_cvt_pk_bf16_f32 v153, v130, v131
  v_mfma_f32_16x16x32_bf16 a[84:87], a[172:175], v[144:147], a[84:87]
  v_exp_f32 v133, v213
  v_mfma_f32_16x16x32_bf16 a[96:99], a[176:179], v[144:147], a[96:99]
  ds_read_b128 a[164:167], v3 offset:9216
  v_exp_f32 v134, v214
  v_mfma_f32_16x16x32_bf16 a[104:107], a[176:179], v[148:151], a[104:107]
  v_exp_f32 v135, v215
  v_mfma_f32_16x16x32_bf16 a[108:111], a[180:183], v[148:151], a[108:111]
  s_waitcnt vmcnt(7)
  ds_read_b128 a[168:171], v3 offset:10240
  v_cvt_pk_bf16_f32 v154, v132, v133
  v_mfma_f32_16x16x32_bf16 a[100:103], a[180:183], v[144:147], a[100:103]
  v_exp_f32 v136, v216
  v_mfma_f32_16x16x32_bf16 a[112:115], a[184:187], v[144:147], a[112:115]
  ds_read_b128 a[172:175], v3 offset:11264
  v_cvt_pk_bf16_f32 v155, v134, v135
  v_mfma_f32_16x16x32_bf16 a[120:123], a[184:187], v[148:151], a[120:123]
  buffer_load_dwordx4 v1, s[36:39], s52 offen offset:3072 sc1 lds
  v_mfma_f32_16x16x32_bf16 a[124:127], a[188:191], v[148:151], a[124:127]
  v_exp_f32 v137, v217
  v_mfma_f32_16x16x32_bf16 a[116:119], a[188:191], v[144:147], a[116:119]
  s_waitcnt lgkmcnt(4)
  v_exp_f32 v138, v218
  v_mfma_f32_16x16x32_bf16 v[192:195], a[128:131], v[168:171], v[112:115]
  ds_read_b128 a[176:179], v3 offset:12288
  v_or3_b32 v5, v152, v153, v154
  v_mfma_f32_16x16x32_bf16 v[192:195], a[132:135], v[184:187], v[192:195]
  s_cmp_lt_u32 s53, s38
  v_exp_f32 v139, v219
  v_mfma_f32_16x16x32_bf16 v[192:195], a[136:139], v[80:83], v[192:195]
  ds_read_b128 a[180:183], v3 offset:13312
  v_cvt_pk_bf16_f32 v156, v136, v137
  v_mfma_f32_16x16x32_bf16 v[192:195], a[140:143], v[240:243], v[192:195]
  s_cselect_b32 m0, s54, 0x30000
  v_exp_f32 v140, v220
  v_mfma_f32_16x16x32_bf16 v[200:203], a[140:143], v[248:251], v[120:123]
  ds_read_b128 a[184:187], v3 offset:14336
  v_or3_b32 v5, v5, v155, v156
  v_mfma_f32_16x16x32_bf16 v[200:203], a[136:139], v[88:91], v[200:203]
  v_exp_f32 v141, v221
  v_mfma_f32_16x16x32_bf16 v[200:203], a[132:135], v[188:191], v[200:203]
  s_barrier
  ds_read_b128 a[188:191], v3 offset:15360
  v_and_or_b32 v3, s53, v4, v1
  v_mfma_f32_16x16x32_bf16 v[200:203], a[128:131], v[172:175], v[200:203]
  buffer_load_dwordx4 v1, s[36:39], s53 offen offset:0 sc1 lds
  v_mfma_f32_16x16x32_bf16 v[204:207], a[144:147], v[172:175], v[124:127]
  ds_read_b128 a[128:131], v3 offset:0
  v_cvt_pk_bf16_f32 v157, v138, v139
  v_exp_f32 v142, v222
  v_mfma_f32_16x16x32_bf16 v[204:207], a[148:151], v[188:191], v[204:207]
  v_exp_f32_e64 v143, v223
  v_mfma_f32_16x16x32_bf16 v[204:207], a[152:155], v[88:91], v[204:207]
  ds_read_b128 a[132:135], v3 offset:1024
  v_cvt_pk_bf16_f32 v158, v140, v141
  v_mfma_f32_16x16x32_bf16 v[204:207], a[156:159], v[248:251], v[204:207]
  v_or3_b32 v5, v5, v157, v158
  v_cvt_pk_bf16_f32 v159, v142, v143
  v_mfma_f32_16x16x32_bf16 v[196:199], a[156:159], v[240:243], v[116:119]
  v_bitop3_b32 v5, v5, v159, v6 bitop3:0xa8
  v_cmp_ne_u32 vcc, 0, v5
  v_mfma_f32_16x16x32_bf16 v[196:199], a[152:155], v[80:83], v[196:199]
  ds_read_b128 a[136:139], v3 offset:2048
  ds_read_b128 a[140:143], v3 offset:3072
  v_mfma_f32_16x16x32_bf16 v[196:199], a[148:151], v[184:187], v[196:199]
  buffer_load_dwordx4 v1, s[36:39], s53 offen offset:1024 sc1 lds
  v_mfma_f32_16x16x32_bf16 v[196:199], a[144:147], v[168:171], v[196:199]
  s_cbranch_vccnz L_site18
L_back18:
  ds_read_b128 a[144:147], v3 offset:4096
  v_mfma_f32_16x16x32_bf16 v[92:95], v[228:231], v[156:159], v[92:95]
  v_exp_f32 v128, v192
  v_mfma_f32_16x16x32_bf16 v[84:87], v[228:231], v[152:155], v[84:87]
  s_waitcnt lgkmcnt(5)
  v_exp_f32 v129, v193
  v_mfma_f32_16x16x32_bf16 a[64:67], a[160:163], v[152:155], a[64:67]
  s_add_u32 s54, s54, 0x4000
  ds_read_b128 a[148:151], v3 offset:5120
  v_exp_f32 v130, v194
  v_mfma_f32_16x16x32_bf16 a[72:75], a[160:163], v[156:159], a[72:75]
  s_bitset0_b32 s54, 17
  v_exp_f32 v131, v195
  v_mfma_f32_16x16x32_bf16 a[76:79], a[164:167], v[156:159], a[76:79]
  s_add_u32 s52, s52, 0x8000
  ds_read_b128 a[152:155], v3 offset:6144
  v_cvt_pk_bf16_f32 v144, v128, v129
  v_mfma_f32_16x16x32_bf16 a[68:71], a[164:167], v[152:155], a[68:71]
  v_exp_f32 v132, v196
  v_mfma_f32_16x16x32_bf16 a[80:83], a[168:171], v[152:155], a[80:83]
  ds_read_b128 a[156:159], v3 offset:7168
  v_cvt_pk_bf16_f32 v145, v130, v131
  v_mfma_f32_16x16x32_bf16 a[88:91], a[168:171], v[156:159], a[88:91]
  buffer_load_dwordx4 v1, s[36:39], s53 offen offset:2048 sc1 lds
  v_mfma_f32_16x16x32_bf16 a[92:95], a[172:175], v[156:159], a[92:95]
  ds_read_b128 a[160:163], v2 offset:8192
  v_exp_f32 v133, v197
  v_mfma_f32_16x16x32_bf16 a[84:87], a[172:175], v[152:155], a[84:87]
  v_exp_f32 v134, v198
  v_mfma_f32_16x16x32_bf16 a[96:99], a[176:179], v[152:155], a[96:99]
  ds_read_b128 a[164:167], v2 offset:9216
  v_cvt_pk_bf16_f32 v146, v132, v133
  v_mfma_f32_16x16x32_bf16 a[104:107], a[176:179], v[156:159], a[104:107]
  v_exp_f32 v135, v199
  v_mfma_f32_16x16x32_bf16 a[108:111], a[180:183], v[156:159], a[108:111]
  s_waitcnt vmcnt(7)
  ds_read_b128 a[168:171], v2 offset:10240
  v_exp_f32 v136, v200
  v_mfma_f32_16x16x32_bf16 a[100:103], a[180:183], v[152:155], a[100:103]
  v_exp_f32 v137, v201
  v_mfma_f32_16x16x32_bf16 a[112:115], a[184:187], v[152:155], a[112:115]
  ds_read_b128 a[172:175], v2 offset:11264
  v_cvt_pk_bf16_f32 v147, v134, v135
  v_mfma_f32_16x16x32_bf16 a[120:123], a[184:187], v[156:159], a[120:123]
  buffer_load_dwordx4 v1, s[36:39], s53 offen offset:3072 sc1 lds
  v_mfma_f32_16x16x32_bf16 a[124:127], a[188:191], v[156:159], a[124:127]
  v_exp_f32 v138, v202
  v_mfma_f32_16x16x32_bf16 a[116:119], a[188:191], v[152:155], a[116:119]
  s_waitcnt lgkmcnt(4)
  v_exp_f32 v139, v203
  v_mfma_f32_16x16x32_bf16 v[208:211], a[128:131], v[168:171], v[112:115]
  ds_read_b128 a[176:179], v2 offset:12288
  v_or3_b32 v5, v144, v145, v146
  v_mfma_f32_16x16x32_bf16 v[208:211], a[132:135], v[184:187], v[208:211]
  s_cmp_lt_u32 s52, s38
  v_exp_f32 v140, v204
  v_mfma_f32_16x16x32_bf16 v[208:211], a[136:139], v[80:83], v[208:211]
  ds_read_b128 a[180:183], v2 offset:13312
  v_cvt_pk_bf16_f32 v148, v136, v137
  v_mfma_f32_16x16x32_bf16 v[208:211], a[140:143], v[240:243], v[208:211]
  s_cselect_b32 m0, s54, 0x30000
  v_exp_f32_e64 v141, v205
  v_mfma_f32_16x16x32_bf16 v[216:219], a[140:143], v[248:251], v[120:123]
  ds_read_b128 a[184:187], v2 offset:14336
  v_or3_b32 v5, v5, v147, v148
  v_mfma_f32_16x16x32_bf16 v[216:219], a[136:139], v[88:91], v[216:219]
  v_exp_f32_e64 v142, v206
  v_mfma_f32_16x16x32_bf16 v[216:219], a[132:135], v[188:191], v[216:219]
  s_barrier
  ds_read_b128 a[188:191], v2 offset:15360
  v_and_or_b32 v2, s52, v4, v1
  v_mfma_f32_16x16x32_bf16 v[216:219], a[128:131], v[172:175], v[216:219]
  buffer_load_dwordx4 v1, s[36:39], s52 offen offset:0 sc1 lds
  v_mfma_f32_16x16x32_bf16 v[220:223], a[144:147], v[172:175], v[124:127]
  ds_read_b128 a[128:131], v2 offset:0
  v_cvt_pk_bf16_f32 v149, v138, v139
  v_mfma_f32_16x16x32_bf16 v[220:223], a[148:151], v[188:191], v[220:223]
  s_sub_u32 s56, s56, 1
  v_exp_f32_e64 v143, v207
  v_mfma_f32_16x16x32_bf16 v[220:223], a[152:155], v[88:91], v[220:223]
  ds_read_b128 a[132:135], v2 offset:1024
  v_cvt_pk_bf16_f32 v150, v140, v141
  v_mfma_f32_16x16x32_bf16 v[220:223], a[156:159], v[248:251], v[220:223]
  v_or3_b32 v5, v5, v149, v150
  v_cvt_pk_bf16_f32 v151, v142, v143
  v_mfma_f32_16x16x32_bf16 v[212:215], a[156:159], v[240:243], v[116:119]
  v_bitop3_b32 v5, v5, v151, v6 bitop3:0xa8
  v_cmp_ne_u32 vcc, 0, v5
  v_mfma_f32_16x16x32_bf16 v[212:215], a[152:155], v[80:83], v[212:215]
  ds_read_b128 a[136:139], v2 offset:2048
  ds_read_b128 a[140:143], v2 offset:3072
  v_mfma_f32_16x16x32_bf16 v[212:215], a[148:151], v[184:187], v[212:215]
  buffer_load_dwordx4 v1, s[36:39], s52 offen offset:1024 sc1 lds
  v_mfma_f32_16x16x32_bf16 v[212:215], a[144:147], v[168:171], v[212:215]
  s_cbranch_vccnz L_site17
L_back17:
  ds_read_b128 a[144:147], v2 offset:4096
  v_mfma_f32_16x16x32_bf16 v[92:95], v[228:231], v[148:151], v[92:95]
  s_cbranch_scc0 L_Z3
  s_branch L_Zx
L_lateA:
  s_waitcnt vmcnt(16)
  v_rcp_f32 v68, v68
  v_rcp_f32 v76, v76
  s_lshl_b32 s6, s4, 13
  s_add_u32 s6, s6, s50
  s_add_u32 s7, s6, 4096
  s_add_u32 s100, s57, 0
  buffer_load_dwordx4 a[192:195], v1, s[28:31], s100 offen offset:0 sc1
  buffer_load_dwordx4 a[196:199], v1, s[28:31], s100 offen offset:1024 sc1
  buffer_load_dwordx4 a[200:203], v1, s[28:31], s100 offen offset:2048 sc1
  buffer_load_dwordx4 a[204:207], v1, s[28:31], s100 offen offset:3072 sc1
  v_accvgpr_read_b32 v96, a0
  v_accvgpr_read_b32 v97, a1
  v_accvgpr_read_b32 v98, a2
  v_accvgpr_read_b32 v99, a3
  v_accvgpr_read_b32 v100, a4
  v_accvgpr_read_b32 v101, a5
  v_accvgpr_read_b32 v102, a6
  v_accvgpr_read_b32 v103, a7
  v_pk_mul_f32 v[96:97], v[96:97], v[68:69] op_sel_hi:[1,0]
  v_pk_mul_f32 v[98:99], v[98:99], v[68:69] op_sel_hi:[1,0]
  v_pk_mul_f32 v[100:101], v[100:101], v[68:69] op_sel_hi:[1,0]
  v_pk_mul_f32 v[102:103], v[102:103], v[68:69] op_sel_hi:[1,0]
  v_cvt_pk_bf16_f32 v96, v96, v97
  v_cvt_pk_bf16_f32 v97, v98, v99
  v_cvt_pk_bf16_f32 v98, v100, v101
  v_cvt_pk_bf16_f32 v99, v102, v103
  buffer_store_dwordx4 v[96:99], v1, s[28:31], s6 offen offset:0 sc1
  s_add_u32 s100, s57, 4096
  buffer_load_dwordx4 a[208:211], v1, s[28:31], s100 offen offset:0 sc1
  buffer_load_dwordx4 a[212:215], v1, s[28:31], s100 offen offset:1024 sc1
  buffer_load_dwordx4 a[216:219], v1, s[28:31], s100 offen offset:2048 sc1
  buffer_load_dwordx4 a[220:223], v1, s[28:31], s100 offen offset:3072 sc1
  v_accvgpr_read_b32 v104, a8
  v_accvgpr_read_b32 v105, a9
  v_accvgpr_read_b32 v106, a10
  v_accvgpr_read_b32 v107, a11
  v_accvgpr_read_b32 v108, a12
  v_accvgpr_read_b32 v109, a13
  v_accvgpr_read_b32 v110, a14
  v_accvgpr_read_b32 v111, a15
  v_pk_mul_f32 v[104:105], v[104:105], v[76:77] op_sel_hi:[1,0]
  v_pk_mul_f32 v[106:107], v[106:107], v[76:77] op_sel_hi:[1,0]
  v_pk_mul_f32 v[108:109], v[108:109], v[76:77] op_sel_hi:[1,0]
  v_pk_mul_f32 v[110:111], v[110:111], v[76:77] op_sel_hi:[1,0]
  v_cvt_pk_bf16_f32 v104, v104, v105
  v_cvt_pk_bf16_f32 v105, v106, v107
  v_cvt_pk_bf16_f32 v106, v108, v109
  v_cvt_pk_bf16_f32 v107, v110, v111
  buffer_store_dwordx4 v[104:107], v1, s[28:31], s6 offen offset:1024 sc1
  s_add_u32 s100, s57, 8192
  buffer_load_dwordx4 a[224:227], v1, s[28:31], s100 offen offset:0 sc1
  buffer_load_dwordx4 a[228:231], v1, s[28:31], s100 offen offset:1024 sc1
  buffer_load_dwordx4 a[232:235], v1, s[28:31], s100 offen offset:2048 sc1
  buffer_load_dwordx4 a[236:239], v1, s[28:31], s100 offen offset:3072 sc1
  v_accvgpr_read_b32 v96, a16
  v_accvgpr_read_b32 v97, a17
  v_accvgpr_read_b32 v98, a18
  v_accvgpr_read_b32 v99, a19
  v_accvgpr_read_b32 v100, a20
  v_accvgpr_read_b32 v101, a21
  v_accvgpr_read_b32 v102, a22
  v_accvgpr_read_b32 v103, a23
  v_pk_mul_f32 v[96:97], v[96:97], v[68:69] op_sel_hi:[1,0]
  v_pk_mul_f32 v[98:99], v[98:99], v[68:69] op_sel_hi:[1,0]
  v_pk_mul_f32 v[100:101], v[100:101], v[68:69] op_sel_hi:[1,0]
  v_pk_mul_f32 v[102:103], v[102:103], v[68:69] op_sel_hi:[1,0]
  v_cvt_pk_bf16_f32 v96, v96, v97
  v_cvt_pk_bf16_f32 v97, v98, v99
  v_cvt_pk_bf16_f32 v98, v100, v101
  v_cvt_pk_bf16_f32 v99, v102, v103
  buffer_store_dwordx4 v[96:99], v1, s[28:31], s6 offen offset:2048 sc1
  s_add_u32 s100, s57, 12288
  buffer_load_dwordx4 a[240:243], v1, s[28:31], s100 offen offset:0 sc1
  buffer_load_dwordx4 a[244:247], v1, s[28:31], s100 offen offset:1024 sc1
  buffer_load_dwordx4 a[248:251], v1, s[28:31], s100 offen offset:2048 sc1
  buffer_load_dwordx4 a[252:255], v1, s[28:31], s100 offen offset:3072 sc1
  v_accvgpr_read_b32 v104, a24
  v_accvgpr_read_b32 v105, a25
  v_accvgpr_read_b32 v106, a26
  v_accvgpr_read_b32 v107, a27
  v_accvgpr_read_b32 v108, a28
  v_accvgpr_read_b32 v109, a29
  v_accvgpr_read_b32 v110, a30
  v_accvgpr_read_b32 v111, a31
  v_pk_mul_f32 v[104:105], v[104:105], v[76:77] op_sel_hi:[1,0]
  v_pk_mul_f32 v[106:107], v[106:107], v[76:77] op_sel_hi:[1,0]
  v_pk_mul_f32 v[108:109], v[108:109], v[76:77] op_sel_hi:[1,0]
  v_pk_mul_f32 v[110:111], v[110:111], v[76:77] op_sel_hi:[1,0]
  v_cvt_pk_bf16_f32 v104, v104, v105
  v_cvt_pk_bf16_f32 v105, v106, v107
  v_cvt_pk_bf16_f32 v106, v108, v109
  v_cvt_pk_bf16_f32 v107, v110, v111
  buffer_store_dwordx4 v[104:107], v1, s[28:31], s6 offen offset:3072 sc1
  s_add_u32 s100, s57, 16384
  buffer_load_dwordx4 v[32:35], v1, s[28:31], s100 offen offset:0 sc1
  buffer_load_dwordx4 v[36:39], v1, s[28:31], s100 offen offset:1024 sc1
  buffer_load_dwordx4 v[40:43], v1, s[28:31], s100 offen offset:2048 sc1
  buffer_load_dwordx4 v[44:47], v1, s[28:31], s100 offen offset:3072 sc1
  v_accvgpr_read_b32 v96, a32
  v_accvgpr_read_b32 v97, a33
  v_accvgpr_read_b32 v98, a34
  v_accvgpr_read_b32 v99, a35
  v_accvgpr_read_b32 v100, a36
  v_accvgpr_read_b32 v101, a37
  v_accvgpr_read_b32 v102, a38
  v_accvgpr_read_b32 v103, a39
  v_pk_mul_f32 v[96:97], v[96:97], v[68:69] op_sel_hi:[1,0]
  v_pk_mul_f32 v[98:99], v[98:99], v[68:69] op_sel_hi:[1,0]
  v_pk_mul_f32 v[100:101], v[100:101], v[68:69] op_sel_hi:[1,0]
  v_pk_mul_f32 v[102:103], v[102:103], v[68:69] op_sel_hi:[1,0]
  v_cvt_pk_bf16_f32 v96, v96, v97
  v_cvt_pk_bf16_f32 v97, v98, v99
  v_cvt_pk_bf16_f32 v98, v100, v101
  v_cvt_pk_bf16_f32 v99, v102, v103
  buffer_store_dwordx4 v[96:99], v1, s[28:31], s7 offen offset:0 sc1
  s_add_u32 s100, s57, 20480
  buffer_load_dwordx4 v[48:51], v1, s[28:31], s100 offen offset:0 sc1
  buffer_load_dwordx4 v[52:55], v1, s[28:31], s100 offen offset:1024 sc1
  buffer_load_dwordx4 v[56:59], v1, s[28:31], s100 offen offset:2048 sc1
  buffer_load_dwordx4 v[60:63], v1, s[28:31], s100 offen offset:3072 sc1
  v_accvgpr_read_b32 v104, a40
  v_accvgpr_read_b32 v105, a41
  v_accvgpr_read_b32 v106, a42
  v_accvgpr_read_b32 v107, a43
  v_accvgpr_read_b32 v108, a44
  v_accvgpr_read_b32 v109, a45
  v_accvgpr_read_b32 v110, a46
  v_accvgpr_read_b32 v111, a47
  v_pk_mul_f32 v[104:105], v[104:105], v[76:77] op_sel_hi:[1,0]
  v_pk_mul_f32 v[106:107], v[106:107], v[76:77] op_sel_hi:[1,0]
  v_pk_mul_f32 v[108:109], v[108:109], v[76:77] op_sel_hi:[1,0]
  v_pk_mul_f32 v[110:111], v[110:111], v[76:77] op_sel_hi:[1,0]
  v_cvt_pk_bf16_f32 v104, v104, v105
  v_cvt_pk_bf16_f32 v105, v106, v107
  v_cvt_pk_bf16_f32 v106, v108, v109
  v_cvt_pk_bf16_f32 v107, v110, v111
  buffer_store_dwordx4 v[104:107], v1, s[28:31], s7 offen offset:1024 sc1
  s_add_u32 s100, s57, 24576
  buffer_load_dwordx4 v[224:227], v1, s[28:31], s100 offen offset:0 sc1
  buffer_load_dwordx4 v[232:235], v1, s[28:31], s100 offen offset:1024 sc1
  buffer_load_dwordx4 v[236:239], v1, s[28:31], s100 offen offset:2048 sc1
  buffer_load_dwordx4 v[244:247], v1, s[28:31], s100 offen offset:3072 sc1
  v_accvgpr_read_b32 v96, a48
  v_accvgpr_read_b32 v97, a49
  v_accvgpr_read_b32 v98, a50
  v_accvgpr_read_b32 v99, a51
  v_accvgpr_read_b32 v100, a52
  v_accvgpr_read_b32 v101, a53
  v_accvgpr_read_b32 v102, a54
  v_accvgpr_read_b32 v103, a55
  v_pk_mul_f32 v[96:97], v[96:97], v[68:69] op_sel_hi:[1,0]
  v_pk_mul_f32 v[98:99], v[98:99], v[68:69] op_sel_hi:[1,0]
  v_pk_mul_f32 v[100:101], v[100:101], v[68:69] op_sel_hi:[1,0]
  v_pk_mul_f32 v[102:103], v[102:103], v[68:69] op_sel_hi:[1,0]
  v_cvt_pk_bf16_f32 v96, v96, v97
  v_cvt_pk_bf16_f32 v97, v98, v99
  v_cvt_pk_bf16_f32 v98, v100, v101
  v_cvt_pk_bf16_f32 v99, v102, v103
  buffer_store_dwordx4 v[96:99], v1, s[28:31], s7 offen offset:2048 sc1
  v_accvgpr_read_b32 v104, a56
  v_accvgpr_read_b32 v105, a57
  v_accvgpr_read_b32 v106, a58
  v_accvgpr_read_b32 v107, a59
  v_accvgpr_read_b32 v108, a60
  v_accvgpr_read_b32 v109, a61
  v_accvgpr_read_b32 v110, a62
  v_accvgpr_read_b32 v111, a63
  v_pk_mul_f32 v[104:105], v[104:105], v[76:77] op_sel_hi:[1,0]
  v_pk_mul_f32 v[106:107], v[106:107], v[76:77] op_sel_hi:[1,0]
  v_pk_mul_f32 v[108:109], v[108:109], v[76:77] op_sel_hi:[1,0]
  v_pk_mul_f32 v[110:111], v[110:111], v[76:77] op_sel_hi:[1,0]
  v_cvt_pk_bf16_f32 v104, v104, v105
  v_cvt_pk_bf16_f32 v105, v106, v107
  v_cvt_pk_bf16_f32 v106, v108, v109
  v_cvt_pk_bf16_f32 v107, v110, v111
  buffer_store_dwordx4 v[104:107], v1, s[28:31], s7 offen offset:3072 sc1
  s_branch L_epiB
L_hot_end:
L_rare_0_192_0:
  s_nop 15
  v_max3_f32 v20, v194, v192, v193
  v_max3_f32 v21, v202, v200, v201
  v_max3_f32 v20, v20, v195, v196
  v_max3_f32 v21, v21, v203, v204
  v_max3_f32 v20, v20, v197, v198
  v_max3_f32 v21, v21, v205, v206
  v_max_f32 v20, v20, v199
  v_max_f32 v21, v21, v207
  v_mov_b32 v22, v20
  v_mov_b32 v23, v21
  s_nop 0
  v_permlane16_swap_b32 v20, v22
  v_permlane16_swap_b32 v21, v23
  v_max_f32 v20, v20, v22
  v_max_f32 v21, v21, v23
  v_mov_b32 v22, v20
  v_mov_b32 v23, v21
  s_nop 0
  v_permlane32_swap_b32 v20, v22
  v_permlane32_swap_b32 v21, v23
  v_max_f32 v20, v20, v22
  v_max_f32 v21, v21, v23
  v_add_f32 v20, 0x42200000, v20
  v_max_f32 v20, 0, v20
  v_exp_f32 v22, -v20
  v_add_f32 v21, 0x42200000, v21
  v_max_f32 v21, 0, v21
  v_exp_f32 v23, -v21
  v_sub_f32 v96, v96, v20
  v_sub_f32 v192, v192, v20
  v_sub_f32 v97, v97, v20
  v_sub_f32 v193, v193, v20
  v_sub_f32 v98, v98, v20
  v_sub_f32 v194, v194, v20
  v_sub_f32 v99, v99, v20
  v_sub_f32 v195, v195, v20
  v_sub_f32 v100, v100, v20
  v_sub_f32 v196, v196, v20
  v_sub_f32 v101, v101, v20
  v_sub_f32 v197, v197, v20
  v_sub_f32 v102, v102, v20
  v_sub_f32 v198, v198, v20
  v_sub_f32 v103, v103, v20
  v_sub_f32 v199, v199, v20
  v_sub_f32 v104, v104, v21
  v_sub_f32 v200, v200, v21
  v_sub_f32 v105, v105, v21
  v_sub_f32 v201, v201, v21
  v_sub_f32 v106, v106, v21
  v_sub_f32 v202, v202, v21
  v_sub_f32 v107, v107, v21
  v_sub_f32 v203, v203, v21
  v_sub_f32 v108, v108, v21
  v_sub_f32 v204, v204, v21
  v_sub_f32 v109, v109, v21
  v_sub_f32 v205, v205, v21
  v_sub_f32 v110, v110, v21
  v_sub_f32 v206, v206, v21
  v_sub_f32 v111, v111, v21
  v_sub_f32 v207, v207, v21
  v_mul_f32 v68, v68, v22
  v_mul_f32 v69, v69, v22
  v_mul_f32 v70, v70, v22
  v_mul_f32 v71, v71, v22
  v_mul_f32 v76, v76, v23
  v_mul_f32 v77, v77, v23
  v_mul_f32 v78, v78, v23
  v_mul_f32 v79, v79, v23
  v_accvgpr_read_b32 v24, a0
  v_mul_f32 v24, v24, v22
  v_accvgpr_write_b32 a0, v24
  v_accvgpr_read_b32 v24, a1
  v_mul_f32 v24, v24, v22
  v_accvgpr_write_b32 a1, v24
  v_accvgpr_read_b32 v24, a2
  v_mul_f32 v24, v24, v22
  v_accvgpr_write_b32 a2, v24
  v_accvgpr_read_b32 v24, a3
  v_mul_f32 v24, v24, v22
  v_accvgpr_write_b32 a3, v24
  v_accvgpr_read_b32 v24, a4
  v_mul_f32 v24, v24, v22
  v_accvgpr_write_b32 a4, v24
  v_accvgpr_read_b32 v24, a5
  v_mul_f32 v24, v24, v22
  v_accvgpr_write_b32 a5, v24
  v_accvgpr_read_b32 v24, a6
  v_mul_f32 v24, v24, v22
  v_accvgpr_write_b32 a6, v24
  v_accvgpr_read_b32 v24, a7
  v_mul_f32 v24, v24, v22
  v_accvgpr_write_b32 a7, v24
  v_accvgpr_read_b32 v24, a8
  v_mul_f32 v24, v24, v23
  v_accvgpr_write_b32 a8, v24
  v_accvgpr_read_b32 v24, a9
  v_mul_f32 v24, v24, v23
  v_accvgpr_write_b32 a9, v24
  v_accvgpr_read_b32 v24, a10
  v_mul_f32 v24, v24, v23
  v_accvgpr_write_b32 a10, v24
  v_accvgpr_read_b32 v24, a11
  v_mul_f32 v24, v24, v23
  v_accvgpr_write_b32 a11, v24
  v_accvgpr_read_b32 v24, a12
  v_mul_f32 v24, v24, v23
  v_accvgpr_write_b32 a12, v24
  v_accvgpr_read_b32 v24, a13
  v_mul_f32 v24, v24, v23
  v_accvgpr_write_b32 a13, v24
  v_accvgpr_read_b32 v24, a14
  v_mul_f32 v24, v24, v23
  v_accvgpr_write_b32 a14, v24
  v_accvgpr_read_b32 v24, a15
  v_mul_f32 v24, v24, v23
  v_accvgpr_write_b32 a15, v24
  v_accvgpr_read_b32 v24, a16
  v_mul_f32 v24, v24, v22
  v_accvgpr_write_b32 a16, v24
  v_accvgpr_read_b32 v24, a17
  v_mul_f32 v24, v24, v22
  v_accvgpr_write_b32 a17, v24
  v_accvgpr_read_b32 v24, a18
  v_mul_f32 v24, v24, v22
  v_accvgpr_write_b32 a18, v24
  v_accvgpr_read_b32 v24, a19
  v_mul_f32 v24, v24, v22
  v_accvgpr_write_b32 a19, v24
  v_accvgpr_read_b32 v24, a20
  v_mul_f32 v24, v24, v22
  v_accvgpr_write_b32 a20, v24
  v_accvgpr_read_b32 v24, a21
  v_mul_f32 v24, v24, v22
  v_accvgpr_write_b32 a21, v24
  v_accvgpr_read_b32 v24, a22
  v_mul_f32 v24, v24, v22
  v_accvgpr_write_b32 a22, v24
  v_accvgpr_read_b32 v24, a23
  v_mul_f32 v24, v24, v22
  v_accvgpr_write_b32 a23, v24
  v_accvgpr_read_b32 v24, a24
  v_mul_f32 v24, v24, v23
  v_accvgpr_write_b32 a24, v24
  v_accvgpr_read_b32 v24, a25
  v_mul_f32 v24, v24, v23
  v_accvgpr_write_b32 a25, v24
  v_accvgpr_read_b32 v24, a26
  v_mul_f32 v24, v24, v23
  v_accvgpr_write_b32 a26, v24
  v_accvgpr_read_b32 v24, a27
  v_mul_f32 v24, v24, v23
  v_accvgpr_write_b32 a27, v24
  v_accvgpr_read_b32 v24, a28
  v_mul_f32 v24, v24, v23
  v_accvgpr_write_b32 a28, v24
  v_accvgpr_read_b32 v24, a29
  v_mul_f32 v24, v24, v23
  v_accvgpr_write_b32 a29, v24
  v_accvgpr_read_b32 v24, a30
  v_mul_f32 v24, v24, v23
  v_accvgpr_write_b32 a30, v24
  v_accvgpr_read_b32 v24, a31
  v_mul_f32 v24, v24, v23
  v_accvgpr_write_b32 a31, v24
  v_accvgpr_read_b32 v24, a32
  v_mul_f32 v24, v24, v22
  v_accvgpr_write_b32 a32, v24
  v_accvgpr_read_b32 v24, a33
  v_mul_f32 v24, v24, v22
  v_accvgpr_write_b32 a33, v24
  v_accvgpr_read_b32 v24, a34
  v_mul_f32 v24, v24, v22
  v_accvgpr_write_b32 a34, v24
  v_accvgpr_read_b32 v24, a35
  v_mul_f32 v24, v24, v22
  v_accvgpr_write_b32 a35, v24
  v_accvgpr_read_b32 v24, a36
  v_mul_f32 v24, v24, v22
  v_accvgpr_write_b32 a36, v24
  v_accvgpr_read_b32 v24, a37
  v_mul_f32 v24, v24, v22
  v_accvgpr_write_b32 a37, v24
  v_accvgpr_read_b32 v24, a38
  v_mul_f32 v24, v24, v22
  v_accvgpr_write_b32 a38, v24
  v_accvgpr_read_b32 v24, a39
  v_mul_f32 v24, v24, v22
  v_accvgpr_write_b32 a39, v24
  v_accvgpr_read_b32 v24, a40
  v_mul_f32 v24, v24, v23
  v_accvgpr_write_b32 a40, v24
  v_accvgpr_read_b32 v24, a41
  v_mul_f32 v24, v24, v23
  v_accvgpr_write_b32 a41, v24
  v_accvgpr_read_b32 v24, a42
  v_mul_f32 v24, v24, v23
  v_accvgpr_write_b32 a42, v24
  v_accvgpr_read_b32 v24, a43
  v_mul_f32 v24, v24, v23
  v_accvgpr_write_b32 a43, v24
  v_accvgpr_read_b32 v24, a44
  v_mul_f32 v24, v24, v23
  v_accvgpr_write_b32 a44, v24
  v_accvgpr_read_b32 v24, a45
  v_mul_f32 v24, v24, v23
  v_accvgpr_write_b32 a45, v24
  v_accvgpr_read_b32 v24, a46
  v_mul_f32 v24, v24, v23
  v_accvgpr_write_b32 a46, v24
  v_accvgpr_read_b32 v24, a47
  v_mul_f32 v24, v24, v23
  v_accvgpr_write_b32 a47, v24
  v_accvgpr_read_b32 v24, a48
  v_mul_f32 v24, v24, v22
  v_accvgpr_write_b32 a48, v24
  v_accvgpr_read_b32 v24, a49
  v_mul_f32 v24, v24, v22
  v_accvgpr_write_b32 a49, v24
  v_accvgpr_read_b32 v24, a50
  v_mul_f32 v24, v24, v22
  v_accvgpr_write_b32 a50, v24
  v_accvgpr_read_b32 v24, a51
  v_mul_f32 v24, v24, v22
  v_accvgpr_write_b32 a51, v24
  v_accvgpr_read_b32 v24, a52
  v_mul_f32 v24, v24, v22
  v_accvgpr_write_b32 a52, v24
  v_accvgpr_read_b32 v24, a53
  v_mul_f32 v24, v24, v22
  v_accvgpr_write_b32 a53, v24
  v_accvgpr_read_b32 v24, a54
  v_mul_f32 v24, v24, v22
  v_accvgpr_write_b32 a54, v24
  v_accvgpr_read_b32 v24, a55
  v_mul_f32 v24, v24, v22
  v_accvgpr_write_b32 a55, v24
  v_accvgpr_read_b32 v24, a56
  v_mul_f32 v24, v24, v23
  v_accvgpr_write_b32 a56, v24
  v_accvgpr_read_b32 v24, a57
  v_mul_f32 v24, v24, v23
  v_accvgpr_write_b32 a57, v24
  v_accvgpr_read_b32 v24, a58
  v_mul_f32 v24, v24, v23
  v_accvgpr_write_b32 a58, v24
  v_accvgpr_read_b32 v24, a59
  v_mul_f32 v24, v24, v23
  v_accvgpr_write_b32 a59, v24
  v_accvgpr_read_b32 v24, a60
  v_mul_f32 v24, v24, v23
  v_accvgpr_write_b32 a60, v24
  v_accvgpr_read_b32 v24, a61
  v_mul_f32 v24, v24, v23
  v_accvgpr_write_b32 a61, v24
  v_accvgpr_read_b32 v24, a62
  v_mul_f32 v24, v24, v23
  v_accvgpr_write_b32 a62, v24
  v_accvgpr_read_b32 v24, a63
  v_mul_f32 v24, v24, v23
  v_accvgpr_write_b32 a63, v24
  v_exp_f32 v128, v192
  v_exp_f32 v129, v193
  v_exp_f32 v130, v194
  v_exp_f32 v131, v195
  v_exp_f32 v132, v196
  v_exp_f32 v133, v197
  v_exp_f32 v134, v198
  v_exp_f32 v135, v199
  v_exp_f32 v136, v200
  v_exp_f32 v137, v201
  v_exp_f32 v138, v202
  v_exp_f32 v139, v203
  v_exp_f32 v140, v204
  v_exp_f32 v141, v205
  v_exp_f32 v142, v206
  v_exp_f32 v143, v207
  v_cvt_pk_bf16_f32 v144, v128, v129
  v_cvt_pk_bf16_f32 v145, v130, v131
  v_cvt_pk_bf16_f32 v146, v132, v133
  v_cvt_pk_bf16_f32 v147, v134, v135
  v_cvt_pk_bf16_f32 v148, v136, v137
  v_cvt_pk_bf16_f32 v149, v138, v139
  v_cvt_pk_bf16_f32 v150, v140, v141
  v_cvt_pk_bf16_f32 v151, v142, v143
  s_nop 1
  s_setpc_b64 s[46:47]
L_rare_1_208_0:
  s_nop 15
  v_max3_f32 v20, v210, v208, v209
  v_max3_f32 v21, v218, v216, v217
  v_max3_f32 v20, v20, v211, v212
  v_max3_f32 v21, v21, v219, v220
  v_max3_f32 v20, v20, v213, v214
  v_max3_f32 v21, v21, v221, v222
  v_max_f32 v20, v20, v215
  v_max_f32 v21, v21, v223
  v_mov_b32 v22, v20
  v_mov_b32 v23, v21
  s_nop 0
  v_permlane16_swap_b32 v20, v22
  v_permlane16_swap_b32 v21, v23
  v_max_f32 v20, v20, v22
  v_max_f32 v21, v21, v23
  v_mov_b32 v22, v20
  v_mov_b32 v23, v21
  s_nop 0
  v_permlane32_swap_b32 v20, v22
  v_permlane32_swap_b32 v21, v23
  v_max_f32 v20, v20, v22
  v_max_f32 v21, v21, v23
  v_add_f32 v20, 0x42200000, v20
  v_max_f32 v20, 0, v20
  v_exp_f32 v22, -v20
  v_add_f32 v21, 0x42200000, v21
  v_max_f32 v21, 0, v21
  v_exp_f32 v23, -v21
  v_sub_f32 v112, v112, v20
  v_sub_f32 v208, v208, v20
  v_sub_f32 v113, v113, v20
  v_sub_f32 v209, v209, v20
  v_sub_f32 v114, v114, v20
  v_sub_f32 v210, v210, v20
  v_sub_f32 v115, v115, v20
  v_sub_f32 v211, v211, v20
  v_sub_f32 v116, v116, v20
  v_sub_f32 v212, v212, v20
  v_sub_f32 v117, v117, v20
  v_sub_f32 v213, v213, v20
  v_sub_f32 v118, v118, v20
  v_sub_f32 v214, v214, v20
  v_sub_f32 v119, v119, v20
  v_sub_f32 v215, v215, v20
  v_sub_f32 v120, v120, v21
  v_sub_f32 v216, v216, v21
  v_sub_f32 v121, v121, v21
  v_sub_f32 v217, v217, v21
  v_sub_f32 v122, v122, v21
  v_sub_f32 v218, v218, v21
  v_sub_f32 v123, v123, v21
  v_sub_f32 v219, v219, v21
  v_sub_f32 v124, v124, v21
  v_sub_f32 v220, v220, v21
  v_sub_f32 v125, v125, v21
  v_sub_f32 v221, v221, v21
  v_sub_f32 v126, v126, v21
  v_sub_f32 v222, v222, v21
  v_sub_f32 v127, v127, v21
  v_sub_f32 v223, v223, v21
  v_mul_f32 v84, v84, v22
  v_mul_f32 v85, v85, v22
  v_mul_f32 v86, v86, v22
  v_mul_f32 v87, v87, v22
  v_mul_f32 v92, v92, v23
  v_mul_f32 v93, v93, v23
  v_mul_f32 v94, v94, v23
  v_mul_f32 v95, v95, v23
  v_accvgpr_read_b32 v24, a64
  v_mul_f32 v24, v24, v22
  v_accvgpr_write_b32 a64, v24
  v_accvgpr_read_b32 v24, a65
  v_mul_f32 v24, v24, v22
  v_accvgpr_write_b32 a65, v24
  v_accvgpr_read_b32 v24, a66
  v_mul_f32 v24, v24, v22
  v_accvgpr_write_b32 a66, v24
  v_accvgpr_read_b32 v24, a67
  v_mul_f32 v24, v24, v22
  v_accvgpr_write_b32 a67, v24
  v_accvgpr_read_b32 v24, a68
  v_mul_f32 v24, v24, v22
  v_accvgpr_write_b32 a68, v24
  v_accvgpr_read_b32 v24, a69
  v_mul_f32 v24, v24, v22
  v_accvgpr_write_b32 a69, v24
  v_accvgpr_read_b32 v24, a70
  v_mul_f32 v24, v24, v22
  v_accvgpr_write_b32 a70, v24
  v_accvgpr_read_b32 v24, a71
  v_mul_f32 v24, v24, v22
  v_accvgpr_write_b32 a71, v24
  v_accvgpr_read_b32 v24, a72
  v_mul_f32 v24, v24, v23
  v_accvgpr_write_b32 a72, v24
  v_accvgpr_read_b32 v24, a73
  v_mul_f32 v24, v24, v23
  v_accvgpr_write_b32 a73, v24
  v_accvgpr_read_b32 v24, a74
  v_mul_f32 v24, v24, v23
  v_accvgpr_write_b32 a74, v24
  v_accvgpr_read_b32 v24, a75
  v_mul_f32 v24, v24, v23
  v_accvgpr_write_b32 a75, v24
  v_accvgpr_read_b32 v24, a76
  v_mul_f32 v24, v24, v23
  v_accvgpr_write_b32 a76, v24
  v_accvgpr_read_b32 v24, a77
  v_mul_f32 v24, v24, v23
  v_accvgpr_write_b32 a77, v24
  v_accvgpr_read_b32 v24, a78
  v_mul_f32 v24, v24, v23
  v_accvgpr_write_b32 a78, v24
  v_accvgpr_read_b32 v24, a79
  v_mul_f32 v24, v24, v23
  v_accvgpr_write_b32 a79, v24
  v_accvgpr_read_b32 v24, a80
  v_mul_f32 v24, v24, v22
  v_accvgpr_write_b32 a80, v24
  v_accvgpr_read_b32 v24, a81
  v_mul_f32 v24, v24, v22
  v_accvgpr_write_b32 a81, v24
  v_accvgpr_read_b32 v24, a82
  v_mul_f32 v24, v24, v22
  v_accvgpr_write_b32 a82, v24
  v_accvgpr_read_b32 v24, a83
  v_mul_f32 v24, v24, v22
  v_accvgpr_write_b32 a83, v24
  v_accvgpr_read_b32 v24, a84
  v_mul_f32 v24, v24, v22
  v_accvgpr_write_b32 a84, v24
  v_accvgpr_read_b32 v24, a85
  v_mul_f32 v24, v24, v22
  v_accvgpr_write_b32 a85, v24
  v_accvgpr_read_b32 v24, a86
  v_mul_f32 v24, v24, v22
  v_accvgpr_write_b32 a86, v24
  v_accvgpr_read_b32 v24, a87
  v_mul_f32 v24, v24, v22
  v_accvgpr_write_b32 a87, v24
  v_accvgpr_read_b32 v24, a88
  v_mul_f32 v24, v24, v23
  v_accvgpr_write_b32 a88, v24
  v_accvgpr_read_b32 v24, a89
  v_mul_f32 v24, v24, v23
  v_accvgpr_write_b32 a89, v24
  v_accvgpr_read_b32 v24, a90
  v_mul_f32 v24, v24, v23
  v_accvgpr_write_b32 a90, v24
  v_accvgpr_read_b32 v24, a91
  v_mul_f32 v24, v24, v23
  v_accvgpr_write_b32 a91, v24
  v_accvgpr_read_b32 v24, a92
  v_mul_f32 v24, v24, v23
  v_accvgpr_write_b32 a92, v24
  v_accvgpr_read_b32 v24, a93
  v_mul_f32 v24, v24, v23
  v_accvgpr_write_b32 a93, v24
  v_accvgpr_read_b32 v24, a94
  v_mul_f32 v24, v24, v23
  v_accvgpr_write_b32 a94, v24
  v_accvgpr_read_b32 v24, a95
  v_mul_f32 v24, v24, v23
  v_accvgpr_write_b32 a95, v24
  v_accvgpr_read_b32 v24, a96
  v_mul_f32 v24, v24, v22
  v_accvgpr_write_b32 a96, v24
  v_accvgpr_read_b32 v24, a97
  v_mul_f32 v24, v24, v22
  v_accvgpr_write_b32 a97, v24
  v_accvgpr_read_b32 v24, a98
  v_mul_f32 v24, v24, v22
  v_accvgpr_write_b32 a98, v24
  v_accvgpr_read_b32 v24, a99
  v_mul_f32 v24, v24, v22
  v_accvgpr_write_b32 a99, v24
  v_accvgpr_read_b32 v24, a100
  v_mul_f32 v24, v24, v22
  v_accvgpr_write_b32 a100, v24
  v_accvgpr_read_b32 v24, a101
  v_mul_f32 v24, v24, v22
  v_accvgpr_write_b32 a101, v24
  v_accvgpr_read_b32 v24, a102
  v_mul_f32 v24, v24, v22
  v_accvgpr_write_b32 a102, v24
  v_accvgpr_read_b32 v24, a103
  v_mul_f32 v24, v24, v22
  v_accvgpr_write_b32 a103, v24
  v_accvgpr_read_b32 v24, a104
  v_mul_f32 v24, v24, v23
  v_accvgpr_write_b32 a104, v24
  v_accvgpr_read_b32 v24, a105
  v_mul_f32 v24, v24, v23
  v_accvgpr_write_b32 a105, v24
  v_accvgpr_read_b32 v24, a106
  v_mul_f32 v24, v24, v23
  v_accvgpr_write_b32 a106, v24
  v_accvgpr_read_b32 v24, a107
  v_mul_f32 v24, v24, v23
  v_accvgpr_write_b32 a107, v24
  v_accvgpr_read_b32 v24, a108
  v_mul_f32 v24, v24, v23
  v_accvgpr_write_b32 a108, v24
  v_accvgpr_read_b32 v24, a109
  v_mul_f32 v24, v24, v23
  v_accvgpr_write_b32 a109, v24
  v_accvgpr_read_b32 v24, a110
  v_mul_f32 v24, v24, v23
  v_accvgpr_write_b32 a110, v24
  v_accvgpr_read_b32 v24, a111
  v_mul_f32 v24, v24, v23
  v_accvgpr_write_b32 a111, v24
  v_accvgpr_read_b32 v24, a112
  v_mul_f32 v24, v24, v22
  v_accvgpr_write_b32 a112, v24
  v_accvgpr_read_b32 v24, a113
  v_mul_f32 v24, v24, v22
  v_accvgpr_write_b32 a113, v24
  v_accvgpr_read_b32 v24, a114
  v_mul_f32 v24, v24, v22
  v_accvgpr_write_b32 a114, v24
  v_accvgpr_read_b32 v24, a115
  v_mul_f32 v24, v24, v22
  v_accvgpr_write_b32 a115, v24
  v_accvgpr_read_b32 v24, a116
  v_mul_f32 v24, v24, v22
  v_accvgpr_write_b32 a116, v24
  v_accvgpr_read_b32 v24, a117
  v_mul_f32 v24, v24, v22
  v_accvgpr_write_b32 a117, v24
  v_accvgpr_read_b32 v24, a118
  v_mul_f32 v24, v24, v22
  v_accvgpr_write_b32 a118, v24
  v_accvgpr_read_b32 v24, a119
  v_mul_f32 v24, v24, v22
  v_accvgpr_write_b32 a119, v24
  v_accvgpr_read_b32 v24, a120
  v_mul_f32 v24, v24, v23
  v_accvgpr_write_b32 a120, v24
  v_accvgpr_read_b32 v24, a121
  v_mul_f32 v24, v24, v23
  v_accvgpr_write_b32 a121, v24
  v_accvgpr_read_b32 v24, a122
  v_mul_f32 v24, v24, v23
  v_accvgpr_write_b32 a122, v24
  v_accvgpr_read_b32 v24, a123
  v_mul_f32 v24, v24, v23
  v_accvgpr_write_b32 a123, v24
  v_accvgpr_read_b32 v24, a124
  v_mul_f32 v24, v24, v23
  v_accvgpr_write_b32 a124, v24
  v_accvgpr_read_b32 v24, a125
  v_mul_f32 v24, v24, v23
  v_accvgpr_write_b32 a125, v24
  v_accvgpr_read_b32 v24, a126
  v_mul_f32 v24, v24, v23
  v_accvgpr_write_b32 a126, v24
  v_accvgpr_read_b32 v24, a127
  v_mul_f32 v24, v24, v23
  v_accvgpr_write_b32 a127, v24
  v_exp_f32 v128, v208
  v_exp_f32 v129, v209
  v_exp_f32 v130, v210
  v_exp_f32 v131, v211
  v_exp_f32 v132, v212
  v_exp_f32 v133, v213
  v_exp_f32 v134, v214
  v_exp_f32 v135, v215
  v_exp_f32 v136, v216
  v_exp_f32 v137, v217
  v_exp_f32 v138, v218
  v_exp_f32 v139, v219
  v_exp_f32 v140, v220
  v_exp_f32 v141, v221
  v_exp_f32 v142, v222
  v_exp_f32 v143, v223
  v_cvt_pk_bf16_f32 v152, v128, v129
  v_cvt_pk_bf16_f32 v153, v130, v131
  v_cvt_pk_bf16_f32 v154, v132, v133
  v_cvt_pk_bf16_f32 v155, v134, v135
  v_cvt_pk_bf16_f32 v156, v136, v137
  v_cvt_pk_bf16_f32 v157, v138, v139
  v_cvt_pk_bf16_f32 v158, v140, v141
  v_cvt_pk_bf16_f32 v159, v142, v143
  s_nop 1
  s_setpc_b64 s[46:47]
L_rare_1_208_1:
  s_nop 15
  v_max3_f32 v20, v210, v208, v209
  v_max3_f32 v21, v218, v216, v217
  v_max3_f32 v20, v20, v211, v212
  v_max3_f32 v21, v21, v219, v220
  v_max3_f32 v20, v20, v213, v214
  v_max3_f32 v21, v21, v221, v222
  v_max_f32 v20, v20, v215
  v_max_f32 v21, v21, v223
  v_mov_b32 v22, v20
  v_mov_b32 v23, v21
  s_nop 0
  v_permlane16_swap_b32 v20, v22
  v_permlane16_swap_b32 v21, v23
  v_max_f32 v20, v20, v22
  v_max_f32 v21, v21, v23
  v_mov_b32 v22, v20
  v_mov_b32 v23, v21
  s_nop 0
  v_permlane32_swap_b32 v20, v22
  v_permlane32_swap_b32 v21, v23
  v_max_f32 v20, v20, v22
  v_max_f32 v21, v21, v23
  v_add_f32 v20, 0x42200000, v20
  v_max_f32 v20, 0, v20
  v_exp_f32 v22, -v20
  v_add_f32 v21, 0x42200000, v21
  v_max_f32 v21, 0, v21
  v_exp_f32 v23, -v21
  v_sub_f32 v112, v112, v20
  v_sub_f32 v208, v208, v20
  v_sub_f32 v192, v192, v20
  v_sub_f32 v113, v113, v20
  v_sub_f32 v209, v209, v20
  v_sub_f32 v193, v193, v20
  v_sub_f32 v114, v114, v20
  v_sub_f32 v210, v210, v20
  v_sub_f32 v194, v194, v20
  v_sub_f32 v115, v115, v20
  v_sub_f32 v211, v211, v20
  v_sub_f32 v195, v195, v20
  v_sub_f32 v116, v116, v20
  v_sub_f32 v212, v212, v20
  v_sub_f32 v196, v196, v20
  v_sub_f32 v117, v117, v20
  v_sub_f32 v213, v213, v20
  v_sub_f32 v197, v197, v20
  v_sub_f32 v118, v118, v20
  v_sub_f32 v214, v214, v20
  v_sub_f32 v198, v198, v20
  v_sub_f32 v119, v119, v20
  v_sub_f32 v215, v215, v20
  v_sub_f32 v199, v199, v20
  v_sub_f32 v120, v120, v21
  v_sub_f32 v216, v216, v21
  v_sub_f32 v200, v200, v21
  v_sub_f32 v121, v121, v21
  v_sub_f32 v217, v217, v21
  v_sub_f32 v201, v201, v21
  v_sub_f32 v122, v122, v21
  v_sub_f32 v218, v218, v21
  v_sub_f32 v202, v202, v21
  v_sub_f32 v123, v123, v21
  v_sub_f32 v219, v219, v21
  v_sub_f32 v203, v203, v21
  v_sub_f32 v124, v124, v21
  v_sub_f32 v220, v220, v21
  v_sub_f32 v204, v204, v21
  v_sub_f32 v125, v125, v21
  v_sub_f32 v221, v221, v21
  v_sub_f32 v205, v205, v21
  v_sub_f32 v126, v126, v21
  v_sub_f32 v222, v222, v21
  v_sub_f32 v206, v206, v21
  v_sub_f32 v127, v127, v21
  v_sub_f32 v223, v223, v21
  v_sub_f32 v207, v207, v21
  v_mul_f32 v84, v84, v22
  v_mul_f32 v85, v85, v22
  v_mul_f32 v86, v86, v22
  v_mul_f32 v87, v87, v22
  v_mul_f32 v92, v92, v23
  v_mul_f32 v93, v93, v23
  v_mul_f32 v94, v94, v23
  v_mul_f32 v95, v95, v23
  v_accvgpr_read_b32 v24, a64
  v_mul_f32 v24, v24, v22
  v_accvgpr_write_b32 a64, v24
  v_accvgpr_read_b32 v24, a65
  v_mul_f32 v24, v24, v22
  v_accvgpr_write_b32 a65, v24
  v_accvgpr_read_b32 v24, a66
  v_mul_f32 v24, v24, v22
  v_accvgpr_write_b32 a66, v24
  v_accvgpr_read_b32 v24, a67
  v_mul_f32 v24, v24, v22
  v_accvgpr_write_b32 a67, v24
  v_accvgpr_read_b32 v24, a68
  v_mul_f32 v24, v24, v22
  v_accvgpr_write_b32 a68, v24
  v_accvgpr_read_b32 v24, a69
  v_mul_f32 v24, v24, v22
  v_accvgpr_write_b32 a69, v24
  v_accvgpr_read_b32 v24, a70
  v_mul_f32 v24, v24, v22
  v_accvgpr_write_b32 a70, v24
  v_accvgpr_read_b32 v24, a71
  v_mul_f32 v24, v24, v22
  v_accvgpr_write_b32 a71, v24
  v_accvgpr_read_b32 v24, a72
  v_mul_f32 v24, v24, v23
  v_accvgpr_write_b32 a72, v24
  v_accvgpr_read_b32 v24, a73
  v_mul_f32 v24, v24, v23
  v_accvgpr_write_b32 a73, v24
  v_accvgpr_read_b32 v24, a74
  v_mul_f32 v24, v24, v23
  v_accvgpr_write_b32 a74, v24
  v_accvgpr_read_b32 v24, a75
  v_mul_f32 v24, v24, v23
  v_accvgpr_write_b32 a75, v24
  v_accvgpr_read_b32 v24, a76
  v_mul_f32 v24, v24, v23
  v_accvgpr_write_b32 a76, v24
  v_accvgpr_read_b32 v24, a77
  v_mul_f32 v24, v24, v23
  v_accvgpr_write_b32 a77, v24
  v_accvgpr_read_b32 v24, a78
  v_mul_f32 v24, v24, v23
  v_accvgpr_write_b32 a78, v24
  v_accvgpr_read_b32 v24, a79
  v_mul_f32 v24, v24, v23
  v_accvgpr_write_b32 a79, v24
  v_accvgpr_read_b32 v24, a80
  v_mul_f32 v24, v24, v22
  v_accvgpr_write_b32 a80, v24
  v_accvgpr_read_b32 v24, a81
  v_mul_f32 v24, v24, v22
  v_accvgpr_write_b32 a81, v24
  v_accvgpr_read_b32 v24, a82
  v_mul_f32 v24, v24, v22
  v_accvgpr_write_b32 a82, v24
  v_accvgpr_read_b32 v24, a83
  v_mul_f32 v24, v24, v22
  v_accvgpr_write_b32 a83, v24
  v_accvgpr_read_b32 v24, a84
  v_mul_f32 v24, v24, v22
  v_accvgpr_write_b32 a84, v24
  v_accvgpr_read_b32 v24, a85
  v_mul_f32 v24, v24, v22
  v_accvgpr_write_b32 a85, v24
  v_accvgpr_read_b32 v24, a86
  v_mul_f32 v24, v24, v22
  v_accvgpr_write_b32 a86, v24
  v_accvgpr_read_b32 v24, a87
  v_mul_f32 v24, v24, v22
  v_accvgpr_write_b32 a87, v24
  v_accvgpr_read_b32 v24, a88
  v_mul_f32 v24, v24, v23
  v_accvgpr_write_b32 a88, v24
  v_accvgpr_read_b32 v24, a89
  v_mul_f32 v24, v24, v23
  v_accvgpr_write_b32 a89, v24
  v_accvgpr_read_b32 v24, a90
  v_mul_f32 v24, v24, v23
  v_accvgpr_write_b32 a90, v24
  v_accvgpr_read_b32 v24, a91
  v_mul_f32 v24, v24, v23
  v_accvgpr_write_b32 a91, v24
  v_accvgpr_read_b32 v24, a92
  v_mul_f32 v24, v24, v23
  v_accvgpr_write_b32 a92, v24
  v_accvgpr_read_b32 v24, a93
  v_mul_f32 v24, v24, v23
  v_accvgpr_write_b32 a93, v24
  v_accvgpr_read_b32 v24, a94
  v_mul_f32 v24, v24, v23
  v_accvgpr_write_b32 a94, v24
  v_accvgpr_read_b32 v24, a95
  v_mul_f32 v24, v24, v23
  v_accvgpr_write_b32 a95, v24
  v_accvgpr_read_b32 v24, a96
  v_mul_f32 v24, v24, v22
  v_accvgpr_write_b32 a96, v24
  v_accvgpr_read_b32 v24, a97
  v_mul_f32 v24, v24, v22
  v_accvgpr_write_b32 a97, v24
  v_accvgpr_read_b32 v24, a98
  v_mul_f32 v24, v24, v22
  v_accvgpr_write_b32 a98, v24
  v_accvgpr_read_b32 v24, a99
  v_mul_f32 v24, v24, v22
  v_accvgpr_write_b32 a99, v24
  v_accvgpr_read_b32 v24, a100
  v_mul_f32 v24, v24, v22
  v_accvgpr_write_b32 a100, v24
  v_accvgpr_read_b32 v24, a101
  v_mul_f32 v24, v24, v22
  v_accvgpr_write_b32 a101, v24
  v_accvgpr_read_b32 v24, a102
  v_mul_f32 v24, v24, v22
  v_accvgpr_write_b32 a102, v24
  v_accvgpr_read_b32 v24, a103
  v_mul_f32 v24, v24, v22
  v_accvgpr_write_b32 a103, v24
  v_accvgpr_read_b32 v24, a104
  v_mul_f32 v24, v24, v23
  v_accvgpr_write_b32 a104, v24
  v_accvgpr_read_b32 v24, a105
  v_mul_f32 v24, v24, v23
  v_accvgpr_write_b32 a105, v24
  v_accvgpr_read_b32 v24, a106
  v_mul_f32 v24, v24, v23
  v_accvgpr_write_b32 a106, v24
  v_accvgpr_read_b32 v24, a107
  v_mul_f32 v24, v24, v23
  v_accvgpr_write_b32 a107, v24
  v_accvgpr_read_b32 v24, a108
  v_mul_f32 v24, v24, v23
  v_accvgpr_write_b32 a108, v24
  v_accvgpr_read_b32 v24, a109
  v_mul_f32 v24, v24, v23
  v_accvgpr_write_b32 a109, v24
  v_accvgpr_read_b32 v24, a110
  v_mul_f32 v24, v24, v23
  v_accvgpr_write_b32 a110, v24
  v_accvgpr_read_b32 v24, a111
  v_mul_f32 v24, v24, v23
  v_accvgpr_write_b32 a111, v24
  v_accvgpr_read_b32 v24, a112
  v_mul_f32 v24, v24, v22
  v_accvgpr_write_b32 a112, v24
  v_accvgpr_read_b32 v24, a113
  v_mul_f32 v24, v24, v22
  v_accvgpr_write_b32 a113, v24
  v_accvgpr_read_b32 v24, a114
  v_mul_f32 v24, v24, v22
  v_accvgpr_write_b32 a114, v24
  v_accvgpr_read_b32 v24, a115
  v_mul_f32 v24, v24, v22
  v_accvgpr_write_b32 a115, v24
  v_accvgpr_read_b32 v24, a116
  v_mul_f32 v24, v24, v22
  v_accvgpr_write_b32 a116, v24
  v_accvgpr_read_b32 v24, a117
  v_mul_f32 v24, v24, v22
  v_accvgpr_write_b32 a117, v24
  v_accvgpr_read_b32 v24, a118
  v_mul_f32 v24, v24, v22
  v_accvgpr_write_b32 a118, v24
  v_accvgpr_read_b32 v24, a119
  v_mul_f32 v24, v24, v22
  v_accvgpr_write_b32 a119, v24
  v_accvgpr_read_b32 v24, a120
  v_mul_f32 v24, v24, v23
  v_accvgpr_write_b32 a120, v24
  v_accvgpr_read_b32 v24, a121
  v_mul_f32 v24, v24, v23
  v_accvgpr_write_b32 a121, v24
  v_accvgpr_read_b32 v24, a122
  v_mul_f32 v24, v24, v23
  v_accvgpr_write_b32 a122, v24
  v_accvgpr_read_b32 v24, a123
  v_mul_f32 v24, v24, v23
  v_accvgpr_write_b32 a123, v24
  v_accvgpr_read_b32 v24, a124
  v_mul_f32 v24, v24, v23
  v_accvgpr_write_b32 a124, v24
  v_accvgpr_read_b32 v24, a125
  v_mul_f32 v24, v24, v23
  v_accvgpr_write_b32 a125, v24
  v_accvgpr_read_b32 v24, a126
  v_mul_f32 v24, v24, v23
  v_accvgpr_write_b32 a126, v24
  v_accvgpr_read_b32 v24, a127
  v_mul_f32 v24, v24, v23
  v_accvgpr_write_b32 a127, v24
  v_exp_f32 v128, v208
  v_exp_f32 v129, v209
  v_exp_f32 v130, v210
  v_exp_f32 v131, v211
  v_exp_f32 v132, v212
  v_exp_f32 v133, v213
  v_exp_f32 v134, v214
  v_exp_f32 v135, v215
  v_exp_f32 v136, v216
  v_exp_f32 v137, v217
  v_exp_f32 v138, v218
  v_exp_f32 v139, v219
  v_exp_f32 v140, v220
  v_exp_f32 v141, v221
  v_exp_f32 v142, v222
  v_exp_f32 v143, v223
  v_cvt_pk_bf16_f32 v152, v128, v129
  v_cvt_pk_bf16_f32 v153, v130, v131
  v_cvt_pk_bf16_f32 v154, v132, v133
  v_cvt_pk_bf16_f32 v155, v134, v135
  v_cvt_pk_bf16_f32 v156, v136, v137
  v_cvt_pk_bf16_f32 v157, v138, v139
  v_cvt_pk_bf16_f32 v158, v140, v141
  v_cvt_pk_bf16_f32 v159, v142, v143
  s_nop 1
  s_setpc_b64 s[46:47]
L_rare_1_192_1:
  s_nop 15
  v_max3_f32 v20, v194, v192, v193
  v_max3_f32 v21, v202, v200, v201
  v_max3_f32 v20, v20, v195, v196
  v_max3_f32 v21, v21, v203, v204
  v_max3_f32 v20, v20, v197, v198
  v_max3_f32 v21, v21, v205, v206
  v_max_f32 v20, v20, v199
  v_max_f32 v21, v21, v207
  v_mov_b32 v22, v20
  v_mov_b32 v23, v21
  s_nop 0
  v_permlane16_swap_b32 v20, v22
  v_permlane16_swap_b32 v21, v23
  v_max_f32 v20, v20, v22
  v_max_f32 v21, v21, v23
  v_mov_b32 v22, v20
  v_mov_b32 v23, v21
  s_nop 0
  v_permlane32_swap_b32 v20, v22
  v_permlane32_swap_b32 v21, v23
  v_max_f32 v20, v20, v22
  v_max_f32 v21, v21, v23
  v_add_f32 v20, 0x42200000, v20
  v_max_f32 v20, 0, v20
  v_exp_f32 v22, -v20
  v_add_f32 v21, 0x42200000, v21
  v_max_f32 v21, 0, v21
  v_exp_f32 v23, -v21
  v_sub_f32 v112, v112, v20
  v_sub_f32 v192, v192, v20
  v_sub_f32 v208, v208, v20
  v_sub_f32 v113, v113, v20
  v_sub_f32 v193, v193, v20
  v_sub_f32 v209, v209, v20
  v_sub_f32 v114, v114, v20
  v_sub_f32 v194, v194, v20
  v_sub_f32 v210, v210, v20
  v_sub_f32 v115, v115, v20
  v_sub_f32 v195, v195, v20
  v_sub_f32 v211, v211, v20
  v_sub_f32 v116, v116, v20
  v_sub_f32 v196, v196, v20
  v_sub_f32 v212, v212, v20
  v_sub_f32 v117, v117, v20
  v_sub_f32 v197, v197, v20
  v_sub_f32 v213, v213, v20
  v_sub_f32 v118, v118, v20
  v_sub_f32 v198, v198, v20
  v_sub_f32 v214, v214, v20
  v_sub_f32 v119, v119, v20
  v_sub_f32 v199, v199, v20
  v_sub_f32 v215, v215, v20
  v_sub_f32 v120, v120, v21
  v_sub_f32 v200, v200, v21
  v_sub_f32 v216, v216, v21
  v_sub_f32 v121, v121, v21
  v_sub_f32 v201, v201, v21
  v_sub_f32 v217, v217, v21
  v_sub_f32 v122, v122, v21
  v_sub_f32 v202, v202, v21
  v_sub_f32 v218, v218, v21
  v_sub_f32 v123, v123, v21
  v_sub_f32 v203, v203, v21
  v_sub_f32 v219, v219, v21
  v_sub_f32 v124, v124, v21
  v_sub_f32 v204, v204, v21
  v_sub_f32 v220, v220, v21
  v_sub_f32 v125, v125, v21
  v_sub_f32 v205, v205, v21
  v_sub_f32 v221, v221, v21
  v_sub_f32 v126, v126, v21
  v_sub_f32 v206, v206, v21
  v_sub_f32 v222, v222, v21
  v_sub_f32 v127, v127, v21
  v_sub_f32 v207, v207, v21
  v_sub_f32 v223, v223, v21
  v_mul_f32 v84, v84, v22
  v_mul_f32 v85, v85, v22
  v_mul_f32 v86, v86, v22
  v_mul_f32 v87, v87, v22
  v_mul_f32 v92, v92, v23
  v_mul_f32 v93, v93, v23
  v_mul_f32 v94, v94, v23
  v_mul_f32 v95, v95, v23
  v_accvgpr_read_b32 v24, a64
  v_mul_f32 v24, v24, v22
  v_accvgpr_write_b32 a64, v24
  v_accvgpr_read_b32 v24, a65
  v_mul_f32 v24, v24, v22
  v_accvgpr_write_b32 a65, v24
  v_accvgpr_read_b32 v24, a66
  v_mul_f32 v24, v24, v22
  v_accvgpr_write_b32 a66, v24
  v_accvgpr_read_b32 v24, a67
  v_mul_f32 v24, v24, v22
  v_accvgpr_write_b32 a67, v24
  v_accvgpr_read_b32 v24, a68
  v_mul_f32 v24, v24, v22
  v_accvgpr_write_b32 a68, v24
  v_accvgpr_read_b32 v24, a69
  v_mul_f32 v24, v24, v22
  v_accvgpr_write_b32 a69, v24
  v_accvgpr_read_b32 v24, a70
  v_mul_f32 v24, v24, v22
  v_accvgpr_write_b32 a70, v24
  v_accvgpr_read_b32 v24, a71
  v_mul_f32 v24, v24, v22
  v_accvgpr_write_b32 a71, v24
  v_accvgpr_read_b32 v24, a72
  v_mul_f32 v24, v24, v23
  v_accvgpr_write_b32 a72, v24
  v_accvgpr_read_b32 v24, a73
  v_mul_f32 v24, v24, v23
  v_accvgpr_write_b32 a73, v24
  v_accvgpr_read_b32 v24, a74
  v_mul_f32 v24, v24, v23
  v_accvgpr_write_b32 a74, v24
  v_accvgpr_read_b32 v24, a75
  v_mul_f32 v24, v24, v23
  v_accvgpr_write_b32 a75, v24
  v_accvgpr_read_b32 v24, a76
  v_mul_f32 v24, v24, v23
  v_accvgpr_write_b32 a76, v24
  v_accvgpr_read_b32 v24, a77
  v_mul_f32 v24, v24, v23
  v_accvgpr_write_b32 a77, v24
  v_accvgpr_read_b32 v24, a78
  v_mul_f32 v24, v24, v23
  v_accvgpr_write_b32 a78, v24
  v_accvgpr_read_b32 v24, a79
  v_mul_f32 v24, v24, v23
  v_accvgpr_write_b32 a79, v24
  v_accvgpr_read_b32 v24, a80
  v_mul_f32 v24, v24, v22
  v_accvgpr_write_b32 a80, v24
  v_accvgpr_read_b32 v24, a81
  v_mul_f32 v24, v24, v22
  v_accvgpr_write_b32 a81, v24
  v_accvgpr_read_b32 v24, a82
  v_mul_f32 v24, v24, v22
  v_accvgpr_write_b32 a82, v24
  v_accvgpr_read_b32 v24, a83
  v_mul_f32 v24, v24, v22
  v_accvgpr_write_b32 a83, v24
  v_accvgpr_read_b32 v24, a84
  v_mul_f32 v24, v24, v22
  v_accvgpr_write_b32 a84, v24
  v_accvgpr_read_b32 v24, a85
  v_mul_f32 v24, v24, v22
  v_accvgpr_write_b32 a85, v24
  v_accvgpr_read_b32 v24, a86
  v_mul_f32 v24, v24, v22
  v_accvgpr_write_b32 a86, v24
  v_accvgpr_read_b32 v24, a87
  v_mul_f32 v24, v24, v22
  v_accvgpr_write_b32 a87, v24
  v_accvgpr_read_b32 v24, a88
  v_mul_f32 v24, v24, v23
  v_accvgpr_write_b32 a88, v24
  v_accvgpr_read_b32 v24, a89
  v_mul_f32 v24, v24, v23
  v_accvgpr_write_b32 a89, v24
  v_accvgpr_read_b32 v24, a90
  v_mul_f32 v24, v24, v23
  v_accvgpr_write_b32 a90, v24
  v_accvgpr_read_b32 v24, a91
  v_mul_f32 v24, v24, v23
  v_accvgpr_write_b32 a91, v24
  v_accvgpr_read_b32 v24, a92
  v_mul_f32 v24, v24, v23
  v_accvgpr_write_b32 a92, v24
  v_accvgpr_read_b32 v24, a93
  v_mul_f32 v24, v24, v23
  v_accvgpr_write_b32 a93, v24
  v_accvgpr_read_b32 v24, a94
  v_mul_f32 v24, v24, v23
  v_accvgpr_write_b32 a94, v24
  v_accvgpr_read_b32 v24, a95
  v_mul_f32 v24, v24, v23
  v_accvgpr_write_b32 a95, v24
  v_accvgpr_read_b32 v24, a96
  v_mul_f32 v24, v24, v22
  v_accvgpr_write_b32 a96, v24
  v_accvgpr_read_b32 v24, a97
  v_mul_f32 v24, v24, v22
  v_accvgpr_write_b32 a97, v24
  v_accvgpr_read_b32 v24, a98
  v_mul_f32 v24, v24, v22
  v_accvgpr_write_b32 a98, v24
  v_accvgpr_read_b32 v24, a99
  v_mul_f32 v24, v24, v22
  v_accvgpr_write_b32 a99, v24
  v_accvgpr_read_b32 v24, a100
  v_mul_f32 v24, v24, v22
  v_accvgpr_write_b32 a100, v24
  v_accvgpr_read_b32 v24, a101
  v_mul_f32 v24, v24, v22
  v_accvgpr_write_b32 a101, v24
  v_accvgpr_read_b32 v24, a102
  v_mul_f32 v24, v24, v22
  v_accvgpr_write_b32 a102, v24
  v_accvgpr_read_b32 v24, a103
  v_mul_f32 v24, v24, v22
  v_accvgpr_write_b32 a103, v24
  v_accvgpr_read_b32 v24, a104
  v_mul_f32 v24, v24, v23
  v_accvgpr_write_b32 a104, v24
  v_accvgpr_read_b32 v24, a105
  v_mul_f32 v24, v24, v23
  v_accvgpr_write_b32 a105, v24
  v_accvgpr_read_b32 v24, a106
  v_mul_f32 v24, v24, v23
  v_accvgpr_write_b32 a106, v24
  v_accvgpr_read_b32 v24, a107
  v_mul_f32 v24, v24, v23
  v_accvgpr_write_b32 a107, v24
  v_accvgpr_read_b32 v24, a108
  v_mul_f32 v24, v24, v23
  v_accvgpr_write_b32 a108, v24
  v_accvgpr_read_b32 v24, a109
  v_mul_f32 v24, v24, v23
  v_accvgpr_write_b32 a109, v24
  v_accvgpr_read_b32 v24, a110
  v_mul_f32 v24, v24, v23
  v_accvgpr_write_b32 a110, v24
  v_accvgpr_read_b32 v24, a111
  v_mul_f32 v24, v24, v23
  v_accvgpr_write_b32 a111, v24
  v_accvgpr_read_b32 v24, a112
  v_mul_f32 v24, v24, v22
  v_accvgpr_write_b32 a112, v24
  v_accvgpr_read_b32 v24, a113
  v_mul_f32 v24, v24, v22
  v_accvgpr_write_b32 a113, v24
  v_accvgpr_read_b32 v24, a114
  v_mul_f32 v24, v24, v22
  v_accvgpr_write_b32 a114, v24
  v_accvgpr_read_b32 v24, a115
  v_mul_f32 v24, v24, v22
  v_accvgpr_write_b32 a115, v24
  v_accvgpr_read_b32 v24, a116
  v_mul_f32 v24, v24, v22
  v_accvgpr_write_b32 a116, v24
  v_accvgpr_read_b32 v24, a117
  v_mul_f32 v24, v24, v22
  v_accvgpr_write_b32 a117, v24
  v_accvgpr_read_b32 v24, a118
  v_mul_f32 v24, v24, v22
  v_accvgpr_write_b32 a118, v24
  v_accvgpr_read_b32 v24, a119
  v_mul_f32 v24, v24, v22
  v_accvgpr_write_b32 a119, v24
  v_accvgpr_read_b32 v24, a120
  v_mul_f32 v24, v24, v23
  v_accvgpr_write_b32 a120, v24
  v_accvgpr_read_b32 v24, a121
  v_mul_f32 v24, v24, v23
  v_accvgpr_write_b32 a121, v24
  v_accvgpr_read_b32 v24, a122
  v_mul_f32 v24, v24, v23
  v_accvgpr_write_b32 a122, v24
  v_accvgpr_read_b32 v24, a123
  v_mul_f32 v24, v24, v23
  v_accvgpr_write_b32 a123, v24
  v_accvgpr_read_b32 v24, a124
  v_mul_f32 v24, v24, v23
  v_accvgpr_write_b32 a124, v24
  v_accvgpr_read_b32 v24, a125
  v_mul_f32 v24, v24, v23
  v_accvgpr_write_b32 a125, v24
  v_accvgpr_read_b32 v24, a126
  v_mul_f32 v24, v24, v23
  v_accvgpr_write_b32 a126, v24
  v_accvgpr_read_b32 v24, a127
  v_mul_f32 v24, v24, v23
  v_accvgpr_write_b32 a127, v24
  v_exp_f32 v128, v192
  v_exp_f32 v129, v193
  v_exp_f32 v130, v194
  v_exp_f32 v131, v195
  v_exp_f32 v132, v196
  v_exp_f32 v133, v197
  v_exp_f32 v134, v198
  v_exp_f32 v135, v199
  v_exp_f32 v136, v200
  v_exp_f32 v137, v201
  v_exp_f32 v138, v202
  v_exp_f32 v139, v203
  v_exp_f32 v140, v204
  v_exp_f32 v141, v205
  v_exp_f32 v142, v206
  v_exp_f32 v143, v207
  v_cvt_pk_bf16_f32 v144, v128, v129
  v_cvt_pk_bf16_f32 v145, v130, v131
  v_cvt_pk_bf16_f32 v146, v132, v133
  v_cvt_pk_bf16_f32 v147, v134, v135
  v_cvt_pk_bf16_f32 v148, v136, v137
  v_cvt_pk_bf16_f32 v149, v138, v139
  v_cvt_pk_bf16_f32 v150, v140, v141
  v_cvt_pk_bf16_f32 v151, v142, v143
  s_nop 1
  s_setpc_b64 s[46:47]
L_rare_1_192_0:
  s_nop 15
  v_max3_f32 v20, v194, v192, v193
  v_max3_f32 v21, v202, v200, v201
  v_max3_f32 v20, v20, v195, v196
  v_max3_f32 v21, v21, v203, v204
  v_max3_f32 v20, v20, v197, v198
  v_max3_f32 v21, v21, v205, v206
  v_max_f32 v20, v20, v199
  v_max_f32 v21, v21, v207
  v_mov_b32 v22, v20
  v_mov_b32 v23, v21
  s_nop 0
  v_permlane16_swap_b32 v20, v22
  v_permlane16_swap_b32 v21, v23
  v_max_f32 v20, v20, v22
  v_max_f32 v21, v21, v23
  v_mov_b32 v22, v20
  v_mov_b32 v23, v21
  s_nop 0
  v_permlane32_swap_b32 v20, v22
  v_permlane32_swap_b32 v21, v23
  v_max_f32 v20, v20, v22
  v_max_f32 v21, v21, v23
  v_add_f32 v20, 0x42200000, v20
  v_max_f32 v20, 0, v20
  v_exp_f32 v22, -v20
  v_add_f32 v21, 0x42200000, v21
  v_max_f32 v21, 0, v21
  v_exp_f32 v23, -v21
  v_sub_f32 v112, v112, v20
  v_sub_f32 v192, v192, v20
  v_sub_f32 v113, v113, v20
  v_sub_f32 v193, v193, v20
  v_sub_f32 v114, v114, v20
  v_sub_f32 v194, v194, v20
  v_sub_f32 v115, v115, v20
  v_sub_f32 v195, v195, v20
  v_sub_f32 v116, v116, v20
  v_sub_f32 v196, v196, v20
  v_sub_f32 v117, v117, v20
  v_sub_f32 v197, v197, v20
  v_sub_f32 v118, v118, v20
  v_sub_f32 v198, v198, v20
  v_sub_f32 v119, v119, v20
  v_sub_f32 v199, v199, v20
  v_sub_f32 v120, v120, v21
  v_sub_f32 v200, v200, v21
  v_sub_f32 v121, v121, v21
  v_sub_f32 v201, v201, v21
  v_sub_f32 v122, v122, v21
  v_sub_f32 v202, v202, v21
  v_sub_f32 v123, v123, v21
  v_sub_f32 v203, v203, v21
  v_sub_f32 v124, v124, v21
  v_sub_f32 v204, v204, v21
  v_sub_f32 v125, v125, v21
  v_sub_f32 v205, v205, v21
  v_sub_f32 v126, v126, v21
  v_sub_f32 v206, v206, v21
  v_sub_f32 v127, v127, v21
  v_sub_f32 v207, v207, v21
  v_mul_f32 v84, v84, v22
  v_mul_f32 v85, v85, v22
  v_mul_f32 v86, v86, v22
  v_mul_f32 v87, v87, v22
  v_mul_f32 v92, v92, v23
  v_mul_f32 v93, v93, v23
  v_mul_f32 v94, v94, v23
  v_mul_f32 v95, v95, v23
  v_accvgpr_read_b32 v24, a64
  v_mul_f32 v24, v24, v22
  v_accvgpr_write_b32 a64, v24
  v_accvgpr_read_b32 v24, a65
  v_mul_f32 v24, v24, v22
  v_accvgpr_write_b32 a65, v24
  v_accvgpr_read_b32 v24, a66
  v_mul_f32 v24, v24, v22
  v_accvgpr_write_b32 a66, v24
  v_accvgpr_read_b32 v24, a67
  v_mul_f32 v24, v24, v22
  v_accvgpr_write_b32 a67, v24
  v_accvgpr_read_b32 v24, a68
  v_mul_f32 v24, v24, v22
  v_accvgpr_write_b32 a68, v24
  v_accvgpr_read_b32 v24, a69
  v_mul_f32 v24, v24, v22
  v_accvgpr_write_b32 a69, v24
  v_accvgpr_read_b32 v24, a70
  v_mul_f32 v24, v24, v22
  v_accvgpr_write_b32 a70, v24
  v_accvgpr_read_b32 v24, a71
  v_mul_f32 v24, v24, v22
  v_accvgpr_write_b32 a71, v24
  v_accvgpr_read_b32 v24, a72
  v_mul_f32 v24, v24, v23
  v_accvgpr_write_b32 a72, v24
  v_accvgpr_read_b32 v24, a73
  v_mul_f32 v24, v24, v23
  v_accvgpr_write_b32 a73, v24
  v_accvgpr_read_b32 v24, a74
  v_mul_f32 v24, v24, v23
  v_accvgpr_write_b32 a74, v24
  v_accvgpr_read_b32 v24, a75
  v_mul_f32 v24, v24, v23
  v_accvgpr_write_b32 a75, v24
  v_accvgpr_read_b32 v24, a76
  v_mul_f32 v24, v24, v23
  v_accvgpr_write_b32 a76, v24
  v_accvgpr_read_b32 v24, a77
  v_mul_f32 v24, v24, v23
  v_accvgpr_write_b32 a77, v24
  v_accvgpr_read_b32 v24, a78
  v_mul_f32 v24, v24, v23
  v_accvgpr_write_b32 a78, v24
  v_accvgpr_read_b32 v24, a79
  v_mul_f32 v24, v24, v23
  v_accvgpr_write_b32 a79, v24
  v_accvgpr_read_b32 v24, a80
  v_mul_f32 v24, v24, v22
  v_accvgpr_write_b32 a80, v24
  v_accvgpr_read_b32 v24, a81
  v_mul_f32 v24, v24, v22
  v_accvgpr_write_b32 a81, v24
  v_accvgpr_read_b32 v24, a82
  v_mul_f32 v24, v24, v22
  v_accvgpr_write_b32 a82, v24
  v_accvgpr_read_b32 v24, a83
  v_mul_f32 v24, v24, v22
  v_accvgpr_write_b32 a83, v24
  v_accvgpr_read_b32 v24, a84
  v_mul_f32 v24, v24, v22
  v_accvgpr_write_b32 a84, v24
  v_accvgpr_read_b32 v24, a85
  v_mul_f32 v24, v24, v22
  v_accvgpr_write_b32 a85, v24
  v_accvgpr_read_b32 v24, a86
  v_mul_f32 v24, v24, v22
  v_accvgpr_write_b32 a86, v24
  v_accvgpr_read_b32 v24, a87
  v_mul_f32 v24, v24, v22
  v_accvgpr_write_b32 a87, v24
  v_accvgpr_read_b32 v24, a88
  v_mul_f32 v24, v24, v23
  v_accvgpr_write_b32 a88, v24
  v_accvgpr_read_b32 v24, a89
  v_mul_f32 v24, v24, v23
  v_accvgpr_write_b32 a89, v24
  v_accvgpr_read_b32 v24, a90
  v_mul_f32 v24, v24, v23
  v_accvgpr_write_b32 a90, v24
  v_accvgpr_read_b32 v24, a91
  v_mul_f32 v24, v24, v23
  v_accvgpr_write_b32 a91, v24
  v_accvgpr_read_b32 v24, a92
  v_mul_f32 v24, v24, v23
  v_accvgpr_write_b32 a92, v24
  v_accvgpr_read_b32 v24, a93
  v_mul_f32 v24, v24, v23
  v_accvgpr_write_b32 a93, v24
  v_accvgpr_read_b32 v24, a94
  v_mul_f32 v24, v24, v23
  v_accvgpr_write_b32 a94, v24
  v_accvgpr_read_b32 v24, a95
  v_mul_f32 v24, v24, v23
  v_accvgpr_write_b32 a95, v24
  v_accvgpr_read_b32 v24, a96
  v_mul_f32 v24, v24, v22
  v_accvgpr_write_b32 a96, v24
  v_accvgpr_read_b32 v24, a97
  v_mul_f32 v24, v24, v22
  v_accvgpr_write_b32 a97, v24
  v_accvgpr_read_b32 v24, a98
  v_mul_f32 v24, v24, v22
  v_accvgpr_write_b32 a98, v24
  v_accvgpr_read_b32 v24, a99
  v_mul_f32 v24, v24, v22
  v_accvgpr_write_b32 a99, v24
  v_accvgpr_read_b32 v24, a100
  v_mul_f32 v24, v24, v22
  v_accvgpr_write_b32 a100, v24
  v_accvgpr_read_b32 v24, a101
  v_mul_f32 v24, v24, v22
  v_accvgpr_write_b32 a101, v24
  v_accvgpr_read_b32 v24, a102
  v_mul_f32 v24, v24, v22
  v_accvgpr_write_b32 a102, v24
  v_accvgpr_read_b32 v24, a103
  v_mul_f32 v24, v24, v22
  v_accvgpr_write_b32 a103, v24
  v_accvgpr_read_b32 v24, a104
  v_mul_f32 v24, v24, v23
  v_accvgpr_write_b32 a104, v24
  v_accvgpr_read_b32 v24, a105
  v_mul_f32 v24, v24, v23
  v_accvgpr_write_b32 a105, v24
  v_accvgpr_read_b32 v24, a106
  v_mul_f32 v24, v24, v23
  v_accvgpr_write_b32 a106, v24
  v_accvgpr_read_b32 v24, a107
  v_mul_f32 v24, v24, v23
  v_accvgpr_write_b32 a107, v24
  v_accvgpr_read_b32 v24, a108
  v_mul_f32 v24, v24, v23
  v_accvgpr_write_b32 a108, v24
  v_accvgpr_read_b32 v24, a109
  v_mul_f32 v24, v24, v23
  v_accvgpr_write_b32 a109, v24
  v_accvgpr_read_b32 v24, a110
  v_mul_f32 v24, v24, v23
  v_accvgpr_write_b32 a110, v24
  v_accvgpr_read_b32 v24, a111
  v_mul_f32 v24, v24, v23
  v_accvgpr_write_b32 a111, v24
  v_accvgpr_read_b32 v24, a112
  v_mul_f32 v24, v24, v22
  v_accvgpr_write_b32 a112, v24
  v_accvgpr_read_b32 v24, a113
  v_mul_f32 v24, v24, v22
  v_accvgpr_write_b32 a113, v24
  v_accvgpr_read_b32 v24, a114
  v_mul_f32 v24, v24, v22
  v_accvgpr_write_b32 a114, v24
  v_accvgpr_read_b32 v24, a115
  v_mul_f32 v24, v24, v22
  v_accvgpr_write_b32 a115, v24
  v_accvgpr_read_b32 v24, a116
  v_mul_f32 v24, v24, v22
  v_accvgpr_write_b32 a116, v24
  v_accvgpr_read_b32 v24, a117
  v_mul_f32 v24, v24, v22
  v_accvgpr_write_b32 a117, v24
  v_accvgpr_read_b32 v24, a118
  v_mul_f32 v24, v24, v22
  v_accvgpr_write_b32 a118, v24
  v_accvgpr_read_b32 v24, a119
  v_mul_f32 v24, v24, v22
  v_accvgpr_write_b32 a119, v24
  v_accvgpr_read_b32 v24, a120
  v_mul_f32 v24, v24, v23
  v_accvgpr_write_b32 a120, v24
  v_accvgpr_read_b32 v24, a121
  v_mul_f32 v24, v24, v23
  v_accvgpr_write_b32 a121, v24
  v_accvgpr_read_b32 v24, a122
  v_mul_f32 v24, v24, v23
  v_accvgpr_write_b32 a122, v24
  v_accvgpr_read_b32 v24, a123
  v_mul_f32 v24, v24, v23
  v_accvgpr_write_b32 a123, v24
  v_accvgpr_read_b32 v24, a124
  v_mul_f32 v24, v24, v23
  v_accvgpr_write_b32 a124, v24
  v_accvgpr_read_b32 v24, a125
  v_mul_f32 v24, v24, v23
  v_accvgpr_write_b32 a125, v24
  v_accvgpr_read_b32 v24, a126
  v_mul_f32 v24, v24, v23
  v_accvgpr_write_b32 a126, v24
  v_accvgpr_read_b32 v24, a127
  v_mul_f32 v24, v24, v23
  v_accvgpr_write_b32 a127, v24
  v_exp_f32 v128, v192
  v_exp_f32 v129, v193
  v_exp_f32 v130, v194
  v_exp_f32 v131, v195
  v_exp_f32 v132, v196
  v_exp_f32 v133, v197
  v_exp_f32 v134, v198
  v_exp_f32 v135, v199
  v_exp_f32 v136, v200
  v_exp_f32 v137, v201
  v_exp_f32 v138, v202
  v_exp_f32 v139, v203
  v_exp_f32 v140, v204
  v_exp_f32 v141, v205
  v_exp_f32 v142, v206
  v_exp_f32 v143, v207
  v_cvt_pk_bf16_f32 v144, v128, v129
  v_cvt_pk_bf16_f32 v145, v130, v131
  v_cvt_pk_bf16_f32 v146, v132, v133
  v_cvt_pk_bf16_f32 v147, v134, v135
  v_cvt_pk_bf16_f32 v148, v136, v137
  v_cvt_pk_bf16_f32 v149, v138, v139
  v_cvt_pk_bf16_f32 v150, v140, v141
  v_cvt_pk_bf16_f32 v151, v142, v143
  s_nop 1
  s_setpc_b64 s[46:47]

.section .rodata,"a"
.p2align 6
.amdhsa_kernel parallel_sum__compressed_kv_cla__dense_activation_mish__prompt_kernel
  .amdhsa_next_free_vgpr 512
  .amdhsa_next_free_sgpr 102
  .amdhsa_accum_offset 256
  .amdhsa_group_segment_fixed_size 0
  .amdhsa_kernarg_size 104
  .amdhsa_user_sgpr_count 2
  .amdhsa_user_sgpr_kernarg_segment_ptr 1
  .amdhsa_system_sgpr_workgroup_id_x 1
.end_amdhsa_kernel
```
